```python
import torch

def _softmax(x, axis=-1):
    return torch.softmax(x, dim=axis)
def _gelu(x):
    return torch.nn.functional.gelu(x, approximate="tanh")
def _silu(x):
    return torch.nn.functional.silu(x)
def _sigmoid(x):
    return torch.sigmoid(x)
def _layernorm(x, axis=-1, eps=1e-5):
    m = x.mean(dim=axis, keepdim=True)
    v = x.var(dim=axis, keepdim=True, unbiased=False)
    return (x - m) / torch.sqrt(v + eps)
def _scatter_add(tgt, idx, src, axis=0):
    return tgt.clone().index_add_(axis, idx, src)
def _segment_sum(src, seg, n):
    out = torch.zeros((n,) + src.shape[1:], dtype=src.dtype)
    return out.index_add_(0, seg, src)
def _pad(x, pw):
    flat = tuple(v for pair in reversed(pw) for v in pair)
    return torch.nn.functional.pad(x, flat)

kernel_name = 'gated_mix__ssm_conv_h3__compressed_kv_cla__prompt'

def setup_inputs():

    _w = (lambda a: (lambda t: t.to(torch.bfloat16) if t.is_floating_point() else t)(torch.as_tensor(a)))
    def _A_setup():
        B, S, D = 1, 2048, 576
        ks = 4
        return {
            "q": _w((lambda *s: torch.randn(*s, dtype=torch.bfloat16) * 0.05)(B, S, D)),
            "k": _w((lambda *s: torch.randn(*s, dtype=torch.bfloat16) * 0.4)(B, S, D)),
            "v": _w((lambda *s: torch.randn(*s, dtype=torch.bfloat16) * 0.4)(B, S, D)),
            "shift_k": _w((lambda *s: torch.randn(*s, dtype=torch.bfloat16) * 0.4)(D, ks) * 0.5),
            "ssm_k": _w((lambda *s: torch.randn(*s, dtype=torch.bfloat16) * 0.8)(D, S) * (1.0 / S ** 0.5)),
            "ssm_D": _w((lambda *s: torch.randn(*s, dtype=torch.bfloat16) * 0.4)(D)),
        }
    _A_in = _A_setup()

    def _B_setup():
        B, H, Sq, Sk, D, M = 1, 32, 2048, 2048, 128, 576
        Dc = 4 * D
        return {
            "x": _w((lambda *s: torch.randn(*s, dtype=torch.bfloat16) * 0.05)(B, Sq, M)),
            "c_kv": _w((lambda *s: torch.randn(*s, dtype=torch.bfloat16) * 0.4)(B, Sk, Dc)),
            "w_q": _w((lambda *s: torch.randn(*s, dtype=torch.bfloat16) * 6.4)(M, H, D) * (M ** -0.5)),
            "w_uk": _w((lambda *s: torch.randn(*s, dtype=torch.bfloat16) * 6.4)(Dc, H, D) * (Dc ** -0.5)),
            "w_uv": _w((lambda *s: torch.randn(*s, dtype=torch.bfloat16) * 0.4)(Dc, H, D) * (Dc ** -0.5)),
            "w_o": _w((lambda *s: torch.randn(*s, dtype=torch.bfloat16) * 0.4)(H, D, M) * ((H * D) ** -0.5)),
        }
    _B_in = _B_setup()

    return {
        "A_q": _A_in["q"],
        "A_k": _A_in["k"],
        "A_v": _A_in["v"],
        "A_shift_k": _A_in["shift_k"],
        "A_ssm_k": _A_in["ssm_k"],
        "A_ssm_D": _A_in["ssm_D"],
        "B_x": _B_in["x"],
        "B_c_kv": _B_in["c_kv"],
        "B_w_q": _B_in["w_q"],
        "B_w_uk": _B_in["w_uk"],
        "B_w_uv": _B_in["w_uv"],
        "B_w_o": _B_in["w_o"],
        "gate_w": _w((lambda *s: torch.randn(*s, dtype=torch.bfloat16) * 0.05)(576) * 16.0),
    }

def reference(A_q, A_k, A_v, A_shift_k, A_ssm_k, A_ssm_D, B_x, B_c_kv, B_w_q, B_w_uk, B_w_uv, B_w_o, gate_w):
    def _A_ref(q, k, v, shift_k, ssm_k, ssm_D):
        B, S, D = q.shape
        ks = shift_k.shape[-1]
        k_pad = _pad(k, ((0, 0), (ks - 1, 0), (0, 0)))
        k_shift = torch.zeros_like(k)
        for t in range(ks):
            k_shift = k_shift + k_pad[:, t:t + S, :] * shift_k[:, ks - 1 - t][None, None, :]
        kv = k_shift * v
        L = 2 * S
        kv_pad = _pad(kv, ((0, 0), (0, S), (0, 0)))
        kf_pad = _pad(ssm_k, ((0, 0), (0, S)))
        kv_f = (lambda x, axes=(-2,-1): torch.fft.rfft2(x.float(), dim=axes))(kv_pad[:, None, :, :], axes=(1, 2))
        kf_f = (lambda x, axes=(-2,-1): torch.fft.rfft2(x.float(), dim=axes))(kf_pad[:, None, :], axes=(1, 2))
        kf_f = (lambda x, *d: x.permute(*d))(kf_f, 1, 2, 0)
        y_f = kv_f * kf_f[None, :, :, :]
        y = (lambda x, s, axes=(-2,-1): torch.fft.irfft2(x, s=s, dim=axes).to(torch.bfloat16))(y_f, (1, L), axes=(1, 2))[:, 0, :S, :]
        y = y + kv * ssm_D[None, None, :]
        return q * y

    def _B_ref(x, c_kv, w_q, w_uk, w_uv, w_o):
        B, Sq, M = x.shape[0], x.shape[1], x.shape[2]
        Sk = c_kv.shape[1]
        H, D = w_q.shape[1], w_q.shape[2]
        q = torch.einsum("bqm,mhd->bhqd", x, w_q)
        k = torch.einsum("bkc,chd->bhkd", c_kv, w_uk)
        v = torch.einsum("bkc,chd->bhkd", c_kv, w_uv)
        scores = torch.einsum("bhqd,bhkd->bhqk", q, k) * (D ** -0.5)
        off = Sk - Sq
        qi = torch.arange(Sq)[:, None]
        kj = torch.arange(Sk)[None, :]
        cmask = kj <= (qi + off)
        scores = torch.where(cmask[None, None], scores, -1e9)
        p = _softmax(scores, axis=-1)
        ctx = torch.einsum("bhqk,bhkd->bhqd", p, v)
        return torch.einsum("bhqd,hdm->bqm", ctx, w_o)

    x = A_q
    g = _sigmoid((x * gate_w).sum(-1, keepdims=True))
    a = _A_ref(x, A_k, A_v, A_shift_k, A_ssm_k, A_ssm_D)
    b = _B_ref(x, B_c_kv, B_w_q, B_w_uk, B_w_uv, B_w_o)
    return g * a + (1 - g) * b
```

```asm
; @launch grid=(256,1,1) block=(256,1,1) lds=163840
.amdgcn_target "amdgcn-amd-amdhsa--gfx950"
.text
.globl gated_mix__ssm_conv_h3__compressed_kv_cla__prompt_kernel
.p2align 8
.type gated_mix__ssm_conv_h3__compressed_kv_cla__prompt_kernel,@function
gated_mix__ssm_conv_h3__compressed_kv_cla__prompt_kernel:
s_cmp_ge_u32 s2, 256
s_cbranch_scc1 L_end_K
s_load_dwordx16 s[68:83], s[0:1], 0
s_load_dwordx16 s[84:99], s[0:1], 64
v_lshrrev_b32 v1, 6, v0
v_and_b32 v0, 63, v0
v_readfirstlane_b32 s3, v1
s_and_b32 s50, s2, 7
s_lshl_b32 s50, s50, 2
s_lshr_b32 s51, s2, 6
s_add_u32 s4, s50, s51
s_lshr_b32 s5, s2, 3
s_and_b32 s5, s5, 7
v_lshrrev_b32 v243, 3, v0
v_lshrrev_b32 v240, 4, v0
v_and_b32 v241, 7, v0
v_and_b32 v242, 15, v0
v_add_u32 v244, 0, v240
v_xor_b32 v244, v244, v241
v_lshlrev_b32 v246, 4, v244
v_lshl_add_u32 v6, v243, 10, v246
v_add_u32 v244, 4, v240
v_xor_b32 v244, v244, v241
v_lshlrev_b32 v247, 4, v244
v_lshl_add_u32 v7, v243, 10, v247
v_add_u32 v7, 7168, v7
v_add_u32 v8, 14336, v6
v_add_u32 v9, 14336, v7
v_lshlrev_b32 v244, 1, v240
v_xor_b32 v244, v244, v242
v_lshlrev_b32 v244, 4, v244
v_lshl_add_u32 v10, v240, 13, v244
v_add_u32 v11, 31744, v10
v_xor_b32 v12, 128, v10
v_add_u32 v12, 63488, v12
v_add_u32 v13, 31744, v12
s_sub_u32 s50, 15, s5
s_and_b32 s52, s3, 1
s_cselect_b32 s51, s5, s50
s_lshl_b32 s51, s51, 7
s_cmp_lt_u32 s3, 2
s_cselect_b32 s53, 64, 0
s_add_u32 s51, s51, s53
s_lshl_b32 s36, s51, 10
s_add_u32 s37, s36, 32768
s_lshl_b32 s48, s4, 8
s_lshl_b32 s53, s52, 18
s_add_u32 s38, s53, s48
s_add_u32 s39, s38, 131072
s_lshl_b32 s41, s3, 13
s_add_u32 s40, s41, 65536
s_waitcnt lgkmcnt(0)
s_mov_b32 s8, s82
s_mov_b32 s9, s83
s_mov_b32 s10, 2097152
s_mov_b32 s11, 0x20000
s_cmp_lt_u32 s3, 2
s_cselect_b32 s12, s86, s88
s_cselect_b32 s13, s87, s89
s_mov_b32 s14, 4194304
s_mov_b32 s15, 0x20000
s_add_u32 m0, s40, 0
s_nop 0
buffer_load_dwordx4 v6, s[8:11], s36 offen offset:0 lds
buffer_load_dwordx4 v7, s[8:11], s36 offen offset:1024 lds
buffer_load_dwordx4 v8, s[8:11], s36 offen offset:2048 lds
buffer_load_dwordx4 v9, s[8:11], s36 offen offset:3072 lds
s_add_u32 s36, s36, 128
s_add_u32 m0, s41, 0
s_nop 0
buffer_load_dwordx4 v10, s[12:15], s38 offen offset:0 lds
buffer_load_dwordx4 v11, s[12:15], s38 offen offset:1024 lds
v_lshlrev_b32 v1, 4, v0
v_add_u32 v28, 4096, v1
buffer_load_dwordx4 v12, s[12:15], s38 offen offset:2048 lds
v_mov_b32 v248, 0
v_mov_b32 v249, 0
v_mov_b32 v250, 0
v_mov_b32 v251, 0
buffer_load_dwordx4 v13, s[12:15], s38 offen offset:3072 lds
s_add_u32 s38, s38, 524288
v_mul_u32_u24 v244, 1152, v243
v_add_u32 v24, v244, v246
v_add_u32 v25, v244, v247
v_add_u32 v25, 8192, v25
v_add_u32 v26, 16384, v24
v_add_u32 v27, 16384, v25
v_mov_b32 v30, v24
s_add_u32 m0, s40, 4096
s_nop 0
buffer_load_dwordx4 v6, s[8:11], s37 offen offset:0 lds
s_lshl_b32 s53, s3, 5
s_lshl_b32 s51, s5, 7
s_add_u32 s51, s51, s53
s_mul_i32 s46, s51, 1152
s_lshl_b32 s51, s50, 7
s_add_u32 s51, s51, s53
s_mul_i32 s47, s51, 1152
v_mfma_f32_32x32x16_bf16 a[0:15], v[248:251], v[248:251], 0
buffer_load_dwordx4 v7, s[8:11], s37 offen offset:1024 lds
s_mov_b32 s16, s68
s_mov_b32 s17, s69
s_mov_b32 s18, 2359296
s_mov_b32 s19, 0x20000
v_mfma_f32_32x32x16_bf16 a[16:31], v[248:251], v[248:251], 0
buffer_load_dwordx4 v8, s[8:11], s37 offen offset:2048 lds
s_mov_b32 s20, s84
s_mov_b32 s21, s85
s_mov_b32 s22, 4718592
s_mov_b32 s23, 0x20000
v_mfma_f32_32x32x16_bf16 a[32:47], v[248:251], v[248:251], 0
buffer_load_dwordx4 v9, s[8:11], s37 offen offset:3072 lds
s_add_u32 s37, s37, 128
s_mov_b32 s28, s98
s_mov_b32 s29, s99
s_mov_b32 s30, 70254592
s_mov_b32 s31, 0x20000
v_mfma_f32_32x32x16_bf16 a[48:63], v[248:251], v[248:251], 0
s_add_u32 m0, s41, 4096
s_nop 0
buffer_load_dwordx4 v10, s[12:15], s39 offen offset:0 lds
s_mov_b32 s32, s96
s_mov_b32 s33, s97
s_mov_b32 s34, 256
s_mov_b32 s35, 0x20000
v_mfma_f32_32x32x16_bf16 a[64:79], v[248:251], v[248:251], 0
buffer_load_dwordx4 v11, s[12:15], s39 offen offset:1024 lds
s_lshl_b32 s51, s4, 20
s_add_u32 s24, s98, s51
s_addc_u32 s25, s99, 0
s_mov_b32 s26, 1048576
s_mov_b32 s27, 0x20000
v_mfma_f32_32x32x16_bf16 a[80:95], v[248:251], v[248:251], 0
buffer_load_dwordx4 v12, s[12:15], s39 offen offset:2048 lds
s_xor_b32 s51, s52, 1
s_lshl_b32 s51, s51, 15
s_lshr_b32 s53, s3, 1
s_lshl_b32 s53, s53, 14
s_add_u32 s53, s53, s51
s_lshl_b32 s51, s5, 16
s_add_u32 s49, s51, s53
s_lshl_b32 s51, s50, 16
s_add_u32 s60, s51, s53
v_mfma_f32_32x32x16_bf16 a[96:111], v[248:251], v[248:251], 0
buffer_load_dwordx4 v13, s[12:15], s39 offen offset:3072 lds
s_add_u32 s39, s39, 524288
s_lshr_b32 s53, s3, 1
s_lshl_b32 s53, s53, 19
s_lshl_b32 s51, s4, 14
s_add_u32 s53, s53, s51
s_lshl_b32 s51, s52, 11
s_add_u32 s53, s53, s51
s_add_u32 s53, s53, 33554432
s_lshl_b32 s51, s5, 20
s_add_u32 s56, s53, s51
s_lshl_b32 s51, s50, 20
s_add_u32 s57, s53, s51
v_mfma_f32_32x32x16_bf16 a[112:127], v[248:251], v[248:251], 0
s_add_u32 m0, s40, 32768
s_nop 0
buffer_load_dwordx4 v6, s[8:11], s36 offen offset:0 lds
s_lshl_b32 s58, s3, 17
s_add_u32 s58, s58, s48
s_lshl_b32 s59, s3, 12
s_lshl_b32 s51, s5, 1
s_add_u32 s54, s51, 4
s_sub_u32 s55, 30, s51
v_mfma_f32_32x32x16_bf16 a[128:143], v[248:251], v[248:251], 0
buffer_load_dwordx4 v7, s[8:11], s36 offen offset:1024 lds
s_lshl_b32 s51, s52, 14
s_mov_b32 s53, 16384
s_cmp_lt_u32 s3, 2
s_cselect_b32 s53, s53, 65536
s_cselect_b32 s62, 0, 65536
s_add_u32 s61, s51, s53
s_cmp_eq_u32 s3, 3
s_cselect_b32 s63, 1, 2
v_mfma_f32_32x32x16_bf16 a[144:159], v[248:251], v[248:251], 0
buffer_load_dwordx4 v8, s[8:11], s36 offen offset:2048 lds
v_lshrrev_b32 v244, 1, v242
v_xor_b32 v244, v244, v240
v_lshlrev_b32 v244, 4, v244
v_lshl_add_u32 v244, v242, 7, v244
s_lshl_b32 s51, s52, 14
s_add_u32 s51, s51, 65536
v_add_u32 v2, s51, v244
v_xor_b32 v3, 64, v2
s_lshl_b32 s53, s3, 13
s_add_u32 s6, s53, 131072
v_add_u32 v4, s6, v244
v_xor_b32 v5, 64, v4
s_add_u32 s7, s46, 256
v_mfma_f32_32x32x16_bf16 v[32:47], v[248:251], v[248:251], 0
buffer_load_dwordx4 v9, s[8:11], s36 offen offset:3072 lds
s_add_u32 s36, s36, 128
v_lshrrev_b32 v244, 2, v242
v_lshl_add_u32 v245, v240, 3, v244
v_lshlrev_b32 v245, 8, v245
v_and_b32 v14, 1, v240
v_lshl_add_u32 v244, v14, 2, v244
v_lshl_add_u32 v245, v244, 5, v245
v_and_b32 v244, 3, v0
v_lshl_add_u32 v245, v244, 3, v245
s_lshr_b32 s53, s3, 1
s_lshl_b32 s53, s53, 14
v_add_u32 v16, s53, v245
v_mfma_f32_32x32x16_bf16 v[48:63], v[248:251], v[248:251], 0
s_add_u32 m0, s40, 36864
s_nop 0
buffer_load_dwordx4 v6, s[8:11], s37 offen offset:0 lds
v_xor_b32 v17, 32, v16
v_xor_b32 v18, 64, v16
v_xor_b32 v19, 96, v16
v_xor_b32 v20, 128, v16
v_xor_b32 v21, 160, v16
v_xor_b32 v22, 192, v16
v_xor_b32 v23, 224, v16
v_mfma_f32_32x32x16_bf16 v[64:79], v[248:251], v[248:251], 0
buffer_load_dwordx4 v7, s[8:11], s37 offen offset:1024 lds
s_lshl_b32 s67, s3, 8
s_add_u32 s67, s67, s2
s_lshl_b32 s51, s4, 1
s_lshr_b32 s53, s5, 1
s_and_b32 s53, s53, 1
s_add_u32 s51, s51, s53
s_add_u32 s51, s51, 512
s_and_b32 s53, s5, 5
s_cmp_eq_u32 s53, 5
s_cselect_b32 s51, s51, 576
s_cmp_eq_u32 s3, 2
s_cselect_b32 s67, s51, s67
s_min_u32 s67, s67, 576
v_mfma_f32_32x32x16_bf16 v[80:95], v[248:251], v[248:251], 0
buffer_load_dwordx4 v8, s[8:11], s37 offen offset:2048 lds
s_and_b32 s53, s4, 3
s_cmp_lt_u32 s53, 2
s_cselect_b32 s51, s5, s50
s_lshl_b32 s51, s51, 17
s_and_b32 s53, s53, 1
s_lshl_b32 s53, s53, 16
s_add_u32 s51, s51, s53
s_lshl_b32 s53, s52, 15
s_add_u32 s51, s51, s53
s_add_u32 s51, s51, 256
s_lshl_b32 s84, s5, 16
s_add_u32 s84, s84, s48
s_add_u32 s84, s84, 1048576
v_lshrrev_b32 v244, 1, v0
v_lshlrev_b32 v244, 10, v244
v_and_b32 v245, 1, v0
v_lshl_add_u32 v244, v245, 6, v244
v_lshrrev_b32 v245, 2, v0
v_lshlrev_b32 v245, 13, v245
v_and_b32 v14, 3, v0
v_lshl_add_u32 v254, v14, 6, v245
v_and_b32 v245, 0xffff, v254
s_add_u32 s53, s3, 1
s_and_b32 s53, s53, 2
s_mov_b32 s85, 128
s_cmp_eq_u32 s53, 0
s_cselect_b32 s84, s51, s84
s_cselect_b32 s85, s85, 524288
s_cselect_b32 s92, s8, s12
s_cselect_b32 s93, s9, s13
s_cselect_b32 s94, s10, s14
s_mov_b32 s95, 0x20000
s_cselect_b64 vcc, -1, 0
v_cndmask_b32 v253, v245, v244, vcc
v_mfma_f32_32x32x16_bf16 v[96:111], v[248:251], v[248:251], 0
buffer_load_dwordx4 v9, s[8:11], s37 offen offset:3072 lds
s_add_u32 s37, s37, 128
s_mov_b32 s80, s90
s_mov_b32 s81, s91
s_mov_b32 s82, 4718592
s_mov_b32 s83, 0x20000
v_min_u32 v244, 35, v0
v_lshrrev_b32 v245, 1, v244
v_lshlrev_b32 v245, 13, v245
v_and_b32 v14, 1, v244
v_lshl_add_u32 v254, v14, 7, v245
s_mul_i32 s51, s5, 147456
s_add_u32 s51, s51, s48
s_sub_u32 s90, 4718592, s51
s_add_u32 s88, s20, s51
s_addc_u32 s89, s21, 0
s_mov_b32 s91, 0x20000
s_mov_b32 s87, 1179648
s_mov_b32 s86, 4291428352
s_cmp_eq_u32 s3, 0
s_cbranch_scc1 L_pb_K
v_lshlrev_b32 v254, 7, v244
s_mov_b32 s87, 4608
s_mul_i32 s51, s2, 9216
s_mov_b32 s90, 9216
s_add_u32 s96, s70, s51
s_addc_u32 s97, s71, 0
s_add_u32 s88, s68, s51
s_addc_u32 s89, s69, 0
s_mov_b32 s86, 4294962688
s_cmp_eq_u32 s3, 1
s_cbranch_scc1 L_pb_K
s_add_u32 s88, s72, s51
s_addc_u32 s89, s73, 0
s_mov_b32 s86, 4294948864
s_cmp_eq_u32 s3, 3
s_cbranch_scc1 L_pb_K
s_lshl_b32 s51, s51, 1
s_mov_b32 s90, 18432
s_add_u32 s88, s80, s51
s_addc_u32 s89, s81, 0
s_mov_b32 s86, 4294948864
L_pb_K:
v_mfma_f32_32x32x16_bf16 v[112:127], v[248:251], v[248:251], 0
s_add_u32 m0, s41, 32768
s_nop 0
buffer_load_dwordx4 v10, s[12:15], s38 offen offset:0 lds
s_mov_b32 s98, s76
s_mov_b32 s64, s77
buffer_load_dwordx4 v11, s[12:15], s38 offen offset:1024 lds
s_mov_b32 s76, s74
s_mov_b32 s77, s75
s_mov_b32 s78, 4608
s_mov_b32 s79, 0x20000
s_mov_b32 s74, 2359296
s_mov_b32 s75, 0x20000
s_mov_b32 s68, s70
s_mov_b32 s69, s71
s_mov_b32 s70, 2359296
s_mov_b32 s71, 0x20000
buffer_load_dwordx4 v12, s[12:15], s38 offen offset:2048 lds
s_mov_b32 s45, 524288
s_mov_b32 s43, 32768
s_mov_b32 s44, 32768
s_mov_b32 s42, 0
buffer_load_dwordx4 v13, s[12:15], s38 offen offset:3072 lds
s_add_u32 s38, s38, 524288
s_getreg_b32 s66, hwreg(HW_REG_XCC_ID, 0, 3)
s_add_u32 s66, s66, 1
s_lshl_b32 s51, s5, 5
s_add_u32 s51, s51, s4
s_lshl_b32 s51, s51, 2
v_lshl_add_u32 v244, v0, 10, s51
s_lshl_b32 s51, s51, 7
v_subrev_u32 v245, 1, v0
v_and_b32 v14, 3, v245
v_lshl_add_u32 v14, v14, 7, s51
v_lshrrev_b32 v245, 2, v245
v_lshl_add_u32 v14, v245, 17, v14
s_and_b32 s51, s4, 16
s_add_u32 s51, s51, s4
s_lshl_b32 s51, s51, 5
s_add_u32 s51, s51, s5
s_lshl_b32 s51, s51, 2
s_add_u32 s99, s51, 69214208
s_add_u32 s51, s51, 2048
v_lshl_add_u32 v245, v0, 11, s51
v_cmp_gt_u32 vcc, 3, v0
s_lshl_b32 s53, s3, 6
s_nop 0
v_cndmask_b32 v244, v245, v244, vcc
v_cmp_gt_u32 vcc, 5, v0
v_add_u32 v15, s53, v0
s_nop 0
v_cndmask_b32 v244, v14, v244, vcc
v_cmp_gt_u32 vcc, 13, v15
v_mov_b32 v245, 2146435072
s_mov_b32 s51, 69206016
v_cndmask_b32 v244, v245, v244, vcc
buffer_store_dword v248, v244, s[28:31], s51 offen sc1
s_lshl_b32 s51, s5, 5
s_add_u32 s51, s51, s4
s_lshl_b32 s51, s51, 4
s_add_u32 s51, s51, 69222400
v_cmp_gt_u32 vcc, 2, v15
v_lshlrev_b32 v244, 13, v0
s_nop 0
v_cndmask_b32 v244, v245, v244, vcc
buffer_store_dwordx4 v[248:251], v244, s[28:31], s51 offen sc1
v_mul_u32_u24 v15, 0x400000, v15
s_and_b32 s51, s5, 3
s_lshr_b32 s53, s51, 1
s_add_u32 s51, s51, s53
s_add_u32 s51, s51, 1
s_lshl_b32 s51, 1, s51
s_cmp_eq_u32 s3, 0
s_cselect_b32 s51, s51, 0
s_or_b32 s65, s51, 0xc8
s_xor_b32 s41, s41, 32768
buffer_load_dword v255, v253, s[92:95], s84 offen
s_add_u32 s84, s84, s85
buffer_load_dword v255, v253, s[92:95], s84 offen
s_add_u32 s84, s84, s85
s_lshr_b32 s50, s2, 3
s_lshl_b32 s50, s50, 2
s_add_u32 s50, s50, s3
s_lshl_b32 s50, s50, 9
s_getpc_b64 s[52:53]
L_pc_K:
v_lshl_add_u32 v244, v241, 6, s50
v_min_u32 v244, CODE_END-L_pc_K-4, v244
v_mov_b32 v245, s53
v_add_co_u32 v244, vcc, s52, v244
s_nop 1
v_addc_co_u32 v245, vcc, 0, v245, vcc
global_load_dword v255, v[244:245], off
s_waitcnt vmcnt(17)
s_barrier
ds_read_b64_tr_b16 a[224:225], v16 offset:0
ds_read_b64_tr_b16 a[226:227], v16 offset:1024
ds_read_b64_tr_b16 a[228:229], v16 offset:8192
ds_read_b64_tr_b16 a[230:231], v16 offset:9216
ds_read_b64_tr_b16 a[232:233], v17 offset:0
ds_read_b64_tr_b16 a[234:235], v17 offset:1024
ds_read_b64_tr_b16 a[236:237], v17 offset:8192
ds_read_b64_tr_b16 a[238:239], v17 offset:9216
ds_read_b128 a[160:163], v2 offset:0
ds_read_b128 a[164:167], v3 offset:0
ds_read_b128 a[168:171], v2 offset:2048
ds_read_b128 a[172:175], v3 offset:2048
ds_read_b128 a[176:179], v2 offset:4096
ds_read_b128 a[180:183], v3 offset:4096
ds_read_b128 a[184:187], v2 offset:6144
ds_read_b128 a[188:191], v3 offset:6144
ds_read_b128 a[192:195], v2 offset:8192
ds_read_b128 a[196:199], v3 offset:8192
ds_read_b128 a[200:203], v2 offset:10240
ds_read_b128 a[204:207], v3 offset:10240
ds_read_b128 a[208:211], v2 offset:12288
ds_read_b128 a[212:215], v3 offset:12288
ds_read_b128 a[216:219], v2 offset:14336
ds_read_b128 a[220:223], v3 offset:14336
s_waitcnt lgkmcnt(8)
s_cmp_ge_u32 s3, 2
s_cbranch_scc1 L_p1_KV
L_p1_KK:
v_mfma_f32_16x16x32_bf16 a[0:3], a[224:227], a[160:163], a[0:3]
s_add_u32 m0, s41, 4096
v_mfma_f32_16x16x32_bf16 a[0:3], a[228:231], a[164:167], a[0:3]
buffer_load_dwordx4 v10, s[12:15], s39 offen offset:0 lds
v_mfma_f32_16x16x32_bf16 a[4:7], a[236:239], a[164:167], a[4:7]
ds_read_b64_tr_b16 a[240:241], v18 offset:0
v_mfma_f32_16x16x32_bf16 a[4:7], a[232:235], a[160:163], a[4:7]
v_mfma_f32_16x16x32_bf16 a[32:35], a[224:227], a[168:171], a[32:35]
ds_read_b64_tr_b16 a[242:243], v18 offset:1024
v_mfma_f32_16x16x32_bf16 a[32:35], a[228:231], a[172:175], a[32:35]
v_mfma_f32_16x16x32_bf16 a[36:39], a[236:239], a[172:175], a[36:39]
buffer_load_dwordx4 v11, s[12:15], s39 offen offset:1024 lds
v_mfma_f32_16x16x32_bf16 a[36:39], a[232:235], a[168:171], a[36:39]
ds_read_b64_tr_b16 a[244:245], v18 offset:8192
v_mfma_f32_16x16x32_bf16 a[64:67], a[224:227], a[176:179], a[64:67]
v_mfma_f32_16x16x32_bf16 a[64:67], a[228:231], a[180:183], a[64:67]
ds_read_b64_tr_b16 a[246:247], v18 offset:9216
v_mfma_f32_16x16x32_bf16 a[68:71], a[236:239], a[180:183], a[68:71]
s_waitcnt lgkmcnt(4)
v_mfma_f32_16x16x32_bf16 a[68:71], a[232:235], a[176:179], a[68:71]
buffer_load_dwordx4 v12, s[12:15], s39 offen offset:2048 lds
v_mfma_f32_16x16x32_bf16 a[96:99], a[224:227], a[184:187], a[96:99]
ds_read_b64_tr_b16 a[248:249], v19 offset:0
v_mfma_f32_16x16x32_bf16 a[96:99], a[228:231], a[188:191], a[96:99]
v_mfma_f32_16x16x32_bf16 a[100:103], a[236:239], a[188:191], a[100:103]
ds_read_b64_tr_b16 a[250:251], v19 offset:1024
v_mfma_f32_16x16x32_bf16 a[100:103], a[232:235], a[184:187], a[100:103]
v_mfma_f32_16x16x32_bf16 v[32:35], a[224:227], a[192:195], v[32:35]
buffer_load_dwordx4 v13, s[12:15], s39 offen offset:3072 lds
v_mfma_f32_16x16x32_bf16 v[32:35], a[228:231], a[196:199], v[32:35]
s_add_u32 s39, s39, s45
s_xor_b32 s41, s41, 32768
v_mfma_f32_16x16x32_bf16 v[36:39], a[236:239], a[196:199], v[36:39]
ds_read_b64_tr_b16 a[252:253], v19 offset:8192
s_mov_b32 m0, s6
v_mfma_f32_16x16x32_bf16 v[36:39], a[232:235], a[192:195], v[36:39]
ds_read_b64_tr_b16 a[254:255], v19 offset:9216
v_mfma_f32_16x16x32_bf16 v[64:67], a[224:227], a[200:203], v[64:67]
v_mfma_f32_16x16x32_bf16 v[64:67], a[228:231], a[204:207], v[64:67]
v_mfma_f32_16x16x32_bf16 v[68:71], a[236:239], a[204:207], v[68:71]
buffer_load_dwordx4 v30, s[16:19], s7 offen offset:0 lds
v_mfma_f32_16x16x32_bf16 v[68:71], a[232:235], a[200:203], v[68:71]
v_xor_b32 v30, 64, v30
v_add_u32 v30, 9216, v30
v_mfma_f32_16x16x32_bf16 v[96:99], a[224:227], a[208:211], v[96:99]
s_add_u32 s6, s6, 1024
v_mfma_f32_16x16x32_bf16 v[96:99], a[228:231], a[212:215], v[96:99]
v_mfma_f32_16x16x32_bf16 v[100:103], a[236:239], a[212:215], v[100:103]
v_mfma_f32_16x16x32_bf16 v[100:103], a[232:235], a[208:211], v[100:103]
v_mfma_f32_16x16x32_bf16 a[128:131], a[224:227], a[216:219], a[128:131]
buffer_load_dword v255, v253, s[92:95], s84 offen
v_mfma_f32_16x16x32_bf16 a[128:131], a[228:231], a[220:223], a[128:131]
s_add_u32 s84, s84, s85
s_waitcnt lgkmcnt(0)
v_mfma_f32_16x16x32_bf16 a[132:135], a[236:239], a[220:223], a[132:135]
v_mfma_f32_16x16x32_bf16 a[132:135], a[232:235], a[216:219], a[132:135]
v_mfma_f32_16x16x32_bf16 a[8:11], a[240:243], a[160:163], a[8:11]
ds_read_b64_tr_b16 a[224:225], v20 offset:0
v_mfma_f32_16x16x32_bf16 a[8:11], a[244:247], a[164:167], a[8:11]
v_mfma_f32_16x16x32_bf16 a[40:43], a[244:247], a[172:175], a[40:43]
ds_read_b64_tr_b16 a[226:227], v20 offset:1024
v_mfma_f32_16x16x32_bf16 a[40:43], a[240:243], a[168:171], a[40:43]
ds_read_b64_tr_b16 a[228:229], v20 offset:8192
v_mfma_f32_16x16x32_bf16 a[72:75], a[240:243], a[176:179], a[72:75]
v_mfma_f32_16x16x32_bf16 a[72:75], a[244:247], a[180:183], a[72:75]
ds_read_b64_tr_b16 a[230:231], v20 offset:9216
v_mfma_f32_16x16x32_bf16 a[104:107], a[244:247], a[188:191], a[104:107]
v_mfma_f32_16x16x32_bf16 a[104:107], a[240:243], a[184:187], a[104:107]
ds_read_b64_tr_b16 a[232:233], v21 offset:0
v_mfma_f32_16x16x32_bf16 v[40:43], a[240:243], a[192:195], v[40:43]
v_mfma_f32_16x16x32_bf16 v[40:43], a[244:247], a[196:199], v[40:43]
ds_read_b64_tr_b16 a[234:235], v21 offset:1024
v_mfma_f32_16x16x32_bf16 v[72:75], a[244:247], a[204:207], v[72:75]
ds_read_b64_tr_b16 a[236:237], v21 offset:8192
v_mfma_f32_16x16x32_bf16 v[72:75], a[240:243], a[200:203], v[72:75]
v_mfma_f32_16x16x32_bf16 v[104:107], a[240:243], a[208:211], v[104:107]
ds_read_b64_tr_b16 a[238:239], v21 offset:9216
s_bitcmp1_b32 s65, s42
v_mfma_f32_16x16x32_bf16 v[104:107], a[244:247], a[212:215], v[104:107]
s_cbranch_scc1 L_p1sw_KK
L_p1bk_KK:
v_mfma_f32_16x16x32_bf16 a[136:139], a[244:247], a[220:223], a[136:139]
v_mfma_f32_16x16x32_bf16 a[136:139], a[240:243], a[216:219], a[136:139]
buffer_load_dword v255, v254, s[88:91], s86 offen
v_mfma_f32_16x16x32_bf16 a[12:15], a[248:251], a[160:163], a[12:15]
v_mfma_f32_16x16x32_bf16 a[12:15], a[252:255], a[164:167], a[12:15]
v_mfma_f32_16x16x32_bf16 a[44:47], a[252:255], a[172:175], a[44:47]
ds_read_b64_tr_b16 a[240:241], v22 offset:0
s_add_u32 s86, s86, s87
v_mfma_f32_16x16x32_bf16 a[44:47], a[248:251], a[168:171], a[44:47]
v_mfma_f32_16x16x32_bf16 a[76:79], a[248:251], a[176:179], a[76:79]
ds_read_b64_tr_b16 a[242:243], v22 offset:1024
v_mfma_f32_16x16x32_bf16 a[76:79], a[252:255], a[180:183], a[76:79]
v_mfma_f32_16x16x32_bf16 a[108:111], a[252:255], a[188:191], a[108:111]
ds_read_b64_tr_b16 a[244:245], v22 offset:8192
v_mfma_f32_16x16x32_bf16 a[108:111], a[248:251], a[184:187], a[108:111]
v_mfma_f32_16x16x32_bf16 v[44:47], a[248:251], a[192:195], v[44:47]
ds_read_b64_tr_b16 a[246:247], v22 offset:9216
v_mfma_f32_16x16x32_bf16 v[44:47], a[252:255], a[196:199], v[44:47]
v_mfma_f32_16x16x32_bf16 v[76:79], a[252:255], a[204:207], v[76:79]
v_mfma_f32_16x16x32_bf16 v[76:79], a[248:251], a[200:203], v[76:79]
v_mfma_f32_16x16x32_bf16 v[108:111], a[248:251], a[208:211], v[108:111]
s_waitcnt lgkmcnt(4)
v_mfma_f32_16x16x32_bf16 v[108:111], a[252:255], a[212:215], v[108:111]
v_mfma_f32_16x16x32_bf16 a[140:143], a[252:255], a[220:223], a[140:143]
v_mfma_f32_16x16x32_bf16 a[140:143], a[248:251], a[216:219], a[140:143]
v_mfma_f32_16x16x32_bf16 a[16:19], a[224:227], a[160:163], a[16:19]
ds_read_b64_tr_b16 a[248:249], v23 offset:0
v_mfma_f32_16x16x32_bf16 a[16:19], a[228:231], a[164:167], a[16:19]
ds_read_b64_tr_b16 a[250:251], v23 offset:1024
v_mfma_f32_16x16x32_bf16 a[48:51], a[228:231], a[172:175], a[48:51]
v_mfma_f32_16x16x32_bf16 a[48:51], a[224:227], a[168:171], a[48:51]
ds_read_b64_tr_b16 a[252:253], v23 offset:8192
v_mfma_f32_16x16x32_bf16 a[80:83], a[224:227], a[176:179], a[80:83]
ds_read_b64_tr_b16 a[254:255], v23 offset:9216
v_mfma_f32_16x16x32_bf16 a[80:83], a[228:231], a[180:183], a[80:83]
v_mfma_f32_16x16x32_bf16 a[112:115], a[228:231], a[188:191], a[112:115]
v_mfma_f32_16x16x32_bf16 a[112:115], a[224:227], a[184:187], a[112:115]
v_mfma_f32_16x16x32_bf16 v[48:51], a[224:227], a[192:195], v[48:51]
v_mfma_f32_16x16x32_bf16 v[48:51], a[228:231], a[196:199], v[48:51]
v_add_u32 v16, s44, v16
v_add_u32 v17, s44, v17
v_mfma_f32_16x16x32_bf16 v[80:83], a[228:231], a[204:207], v[80:83]
v_add_u32 v18, s44, v18
v_add_u32 v19, s44, v19
v_mfma_f32_16x16x32_bf16 v[80:83], a[224:227], a[200:203], v[80:83]
v_add_u32 v20, s44, v20
v_add_u32 v21, s44, v21
v_mfma_f32_16x16x32_bf16 v[112:115], a[224:227], a[208:211], v[112:115]
v_add_u32 v22, s44, v22
v_add_u32 v23, s44, v23
v_mfma_f32_16x16x32_bf16 v[112:115], a[228:231], a[212:215], v[112:115]
v_add_u32 v2, s43, v2
v_add_u32 v3, s43, v3
v_mfma_f32_16x16x32_bf16 a[144:147], a[228:231], a[220:223], a[144:147]
s_waitcnt vmcnt(3) lgkmcnt(0)
s_sub_u32 s44, 0, s44
v_mfma_f32_16x16x32_bf16 a[144:147], a[224:227], a[216:219], a[144:147]
s_barrier
s_sub_u32 s43, 0, s43
v_mfma_f32_16x16x32_bf16 a[20:23], a[232:235], a[160:163], a[20:23]
s_mov_b32 m0, s40
s_add_u32 s42, s42, 1
v_mfma_f32_16x16x32_bf16 a[20:23], a[236:239], a[164:167], a[20:23]
buffer_load_dwordx4 v6, s[8:11], s36 offen offset:0 lds
v_mfma_f32_16x16x32_bf16 a[52:55], a[236:239], a[172:175], a[52:55]
ds_read_b64_tr_b16 a[224:225], v16 offset:0
v_mfma_f32_16x16x32_bf16 a[52:55], a[232:235], a[168:171], a[52:55]
v_mfma_f32_16x16x32_bf16 a[84:87], a[232:235], a[176:179], a[84:87]
ds_read_b64_tr_b16 a[226:227], v16 offset:1024
v_mfma_f32_16x16x32_bf16 a[84:87], a[236:239], a[180:183], a[84:87]
buffer_load_dwordx4 v7, s[8:11], s36 offen offset:1024 lds
v_mfma_f32_16x16x32_bf16 a[116:119], a[236:239], a[188:191], a[116:119]
v_mfma_f32_16x16x32_bf16 a[116:119], a[232:235], a[184:187], a[116:119]
ds_read_b64_tr_b16 a[228:229], v16 offset:8192
v_mfma_f32_16x16x32_bf16 v[52:55], a[232:235], a[192:195], v[52:55]
v_mfma_f32_16x16x32_bf16 v[52:55], a[236:239], a[196:199], v[52:55]
buffer_load_dwordx4 v8, s[8:11], s36 offen offset:2048 lds
v_mfma_f32_16x16x32_bf16 v[84:87], a[236:239], a[204:207], v[84:87]
ds_read_b64_tr_b16 a[230:231], v16 offset:9216
v_mfma_f32_16x16x32_bf16 v[84:87], a[232:235], a[200:203], v[84:87]
v_mfma_f32_16x16x32_bf16 v[116:119], a[232:235], a[208:211], v[116:119]
v_mfma_f32_16x16x32_bf16 v[116:119], a[236:239], a[212:215], v[116:119]
buffer_load_dwordx4 v9, s[8:11], s36 offen offset:3072 lds
v_mfma_f32_16x16x32_bf16 a[148:151], a[236:239], a[220:223], a[148:151]
s_add_u32 m0, s40, 4096
s_add_u32 s36, s36, 128
v_mfma_f32_16x16x32_bf16 a[148:151], a[232:235], a[216:219], a[148:151]
v_mfma_f32_16x16x32_bf16 a[24:27], a[240:243], a[160:163], a[24:27]
ds_read_b64_tr_b16 a[232:233], v17 offset:0
v_mfma_f32_16x16x32_bf16 a[24:27], a[244:247], a[164:167], a[24:27]
buffer_load_dwordx4 v6, s[8:11], s37 offen offset:0 lds
v_mfma_f32_16x16x32_bf16 a[28:31], a[252:255], a[164:167], a[28:31]
ds_read_b128 a[164:167], v3 offset:0
v_mfma_f32_16x16x32_bf16 a[28:31], a[248:251], a[160:163], a[28:31]
ds_read_b128 a[160:163], v2 offset:0
v_mfma_f32_16x16x32_bf16 a[56:59], a[240:243], a[168:171], a[56:59]
ds_read_b64_tr_b16 a[234:235], v17 offset:1024
v_mfma_f32_16x16x32_bf16 a[56:59], a[244:247], a[172:175], a[56:59]
buffer_load_dwordx4 v7, s[8:11], s37 offen offset:1024 lds
v_mfma_f32_16x16x32_bf16 a[60:63], a[252:255], a[172:175], a[60:63]
ds_read_b128 a[172:175], v3 offset:2048
v_mfma_f32_16x16x32_bf16 a[60:63], a[248:251], a[168:171], a[60:63]
ds_read_b128 a[168:171], v2 offset:2048
v_mfma_f32_16x16x32_bf16 a[88:91], a[240:243], a[176:179], a[88:91]
ds_read_b64_tr_b16 a[236:237], v17 offset:8192
v_mfma_f32_16x16x32_bf16 a[88:91], a[244:247], a[180:183], a[88:91]
buffer_load_dwordx4 v8, s[8:11], s37 offen offset:2048 lds
v_mfma_f32_16x16x32_bf16 a[92:95], a[252:255], a[180:183], a[92:95]
ds_read_b128 a[180:183], v3 offset:4096
v_mfma_f32_16x16x32_bf16 a[92:95], a[248:251], a[176:179], a[92:95]
ds_read_b128 a[176:179], v2 offset:4096
v_mfma_f32_16x16x32_bf16 a[120:123], a[240:243], a[184:187], a[120:123]
ds_read_b64_tr_b16 a[238:239], v17 offset:9216
v_mfma_f32_16x16x32_bf16 a[120:123], a[244:247], a[188:191], a[120:123]
buffer_load_dwordx4 v9, s[8:11], s37 offen offset:3072 lds
v_mfma_f32_16x16x32_bf16 a[124:127], a[252:255], a[188:191], a[124:127]
ds_read_b128 a[188:191], v3 offset:6144
s_mov_b32 m0, s41
v_mfma_f32_16x16x32_bf16 a[124:127], a[248:251], a[184:187], a[124:127]
ds_read_b128 a[184:187], v2 offset:6144
s_add_u32 s37, s37, 128
v_mfma_f32_16x16x32_bf16 v[56:59], a[240:243], a[192:195], v[56:59]
s_xor_b32 s40, s40, 32768
v_mfma_f32_16x16x32_bf16 v[56:59], a[244:247], a[196:199], v[56:59]
buffer_load_dwordx4 v10, s[12:15], s38 offen offset:0 lds
v_mfma_f32_16x16x32_bf16 v[60:63], a[252:255], a[196:199], v[60:63]
ds_read_b128 a[196:199], v3 offset:8192
v_mfma_f32_16x16x32_bf16 v[60:63], a[248:251], a[192:195], v[60:63]
ds_read_b128 a[192:195], v2 offset:8192
v_mfma_f32_16x16x32_bf16 v[88:91], a[240:243], a[200:203], v[88:91]
v_mfma_f32_16x16x32_bf16 v[88:91], a[244:247], a[204:207], v[88:91]
buffer_load_dwordx4 v11, s[12:15], s38 offen offset:1024 lds
v_mfma_f32_16x16x32_bf16 v[92:95], a[252:255], a[204:207], v[92:95]
ds_read_b128 a[204:207], v3 offset:10240
v_mfma_f32_16x16x32_bf16 v[92:95], a[248:251], a[200:203], v[92:95]
ds_read_b128 a[200:203], v2 offset:10240
v_mfma_f32_16x16x32_bf16 v[120:123], a[240:243], a[208:211], v[120:123]
s_waitcnt lgkmcnt(4)
v_mfma_f32_16x16x32_bf16 v[120:123], a[244:247], a[212:215], v[120:123]
buffer_load_dwordx4 v12, s[12:15], s38 offen offset:2048 lds
v_mfma_f32_16x16x32_bf16 v[124:127], a[252:255], a[212:215], v[124:127]
ds_read_b128 a[212:215], v3 offset:12288
v_mfma_f32_16x16x32_bf16 v[124:127], a[248:251], a[208:211], v[124:127]
ds_read_b128 a[208:211], v2 offset:12288
v_mfma_f32_16x16x32_bf16 a[152:155], a[240:243], a[216:219], a[152:155]
v_mfma_f32_16x16x32_bf16 a[152:155], a[244:247], a[220:223], a[152:155]
buffer_load_dwordx4 v13, s[12:15], s38 offen offset:3072 lds
v_mfma_f32_16x16x32_bf16 a[156:159], a[252:255], a[220:223], a[156:159]
ds_read_b128 a[220:223], v3 offset:14336
s_add_u32 s38, s38, s45
v_mfma_f32_16x16x32_bf16 a[156:159], a[248:251], a[216:219], a[156:159]
ds_read_b128 a[216:219], v2 offset:14336
s_cmp_lt_u32 s42, 8
s_cbranch_scc1 L_p1_KK
s_branch L_p2_K
L_p1_KV:
v_mfma_f32_16x16x32_bf16 a[0:3], a[160:163], a[224:227], a[0:3]
s_add_u32 m0, s41, 4096
v_mfma_f32_16x16x32_bf16 a[0:3], a[164:167], a[228:231], a[0:3]
v_mfma_f32_16x16x32_bf16 a[8:11], a[164:167], a[236:239], a[8:11]
ds_read_b64_tr_b16 a[240:241], v18 offset:0
v_mfma_f32_16x16x32_bf16 a[8:11], a[160:163], a[232:235], a[8:11]
buffer_load_dwordx4 v10, s[12:15], s39 offen offset:0 lds
v_mfma_f32_16x16x32_bf16 a[4:7], a[168:171], a[224:227], a[4:7]
ds_read_b64_tr_b16 a[242:243], v18 offset:1024
v_mfma_f32_16x16x32_bf16 a[4:7], a[172:175], a[228:231], a[4:7]
v_mfma_f32_16x16x32_bf16 a[12:15], a[172:175], a[236:239], a[12:15]
v_mfma_f32_16x16x32_bf16 a[12:15], a[168:171], a[232:235], a[12:15]
ds_read_b64_tr_b16 a[244:245], v18 offset:8192
v_mfma_f32_16x16x32_bf16 a[64:67], a[176:179], a[224:227], a[64:67]
buffer_load_dwordx4 v11, s[12:15], s39 offen offset:1024 lds
v_mfma_f32_16x16x32_bf16 a[64:67], a[180:183], a[228:231], a[64:67]
ds_read_b64_tr_b16 a[246:247], v18 offset:9216
v_mfma_f32_16x16x32_bf16 a[72:75], a[180:183], a[236:239], a[72:75]
s_waitcnt lgkmcnt(4)
v_mfma_f32_16x16x32_bf16 a[72:75], a[176:179], a[232:235], a[72:75]
v_mfma_f32_16x16x32_bf16 a[68:71], a[184:187], a[224:227], a[68:71]
ds_read_b64_tr_b16 a[248:249], v19 offset:0
v_mfma_f32_16x16x32_bf16 a[68:71], a[188:191], a[228:231], a[68:71]
buffer_load_dwordx4 v12, s[12:15], s39 offen offset:2048 lds
v_mfma_f32_16x16x32_bf16 a[76:79], a[188:191], a[236:239], a[76:79]
ds_read_b64_tr_b16 a[250:251], v19 offset:1024
v_mfma_f32_16x16x32_bf16 a[76:79], a[184:187], a[232:235], a[76:79]
v_mfma_f32_16x16x32_bf16 v[32:35], a[192:195], a[224:227], v[32:35]
v_mfma_f32_16x16x32_bf16 v[32:35], a[196:199], a[228:231], v[32:35]
ds_read_b64_tr_b16 a[252:253], v19 offset:8192
v_mfma_f32_16x16x32_bf16 v[40:43], a[196:199], a[236:239], v[40:43]
buffer_load_dwordx4 v13, s[12:15], s39 offen offset:3072 lds
v_mfma_f32_16x16x32_bf16 v[40:43], a[192:195], a[232:235], v[40:43]
s_add_u32 s39, s39, s45
s_xor_b32 s41, s41, 32768
v_mfma_f32_16x16x32_bf16 v[36:39], a[200:203], a[224:227], v[36:39]
ds_read_b64_tr_b16 a[254:255], v19 offset:9216
s_mov_b32 m0, s6
v_mfma_f32_16x16x32_bf16 v[36:39], a[204:207], a[228:231], v[36:39]
v_mfma_f32_16x16x32_bf16 v[44:47], a[204:207], a[236:239], v[44:47]
v_mfma_f32_16x16x32_bf16 v[44:47], a[200:203], a[232:235], v[44:47]
v_mfma_f32_16x16x32_bf16 v[96:99], a[208:211], a[224:227], v[96:99]
buffer_load_dwordx4 v30, s[16:19], s7 offen offset:0 lds
v_mfma_f32_16x16x32_bf16 v[96:99], a[212:215], a[228:231], v[96:99]
v_xor_b32 v30, 64, v30
v_add_u32 v30, 9216, v30
v_mfma_f32_16x16x32_bf16 v[104:107], a[212:215], a[236:239], v[104:107]
s_add_u32 s6, s6, 1024
v_mfma_f32_16x16x32_bf16 v[104:107], a[208:211], a[232:235], v[104:107]
v_mfma_f32_16x16x32_bf16 v[100:103], a[216:219], a[224:227], v[100:103]
v_mfma_f32_16x16x32_bf16 v[100:103], a[220:223], a[228:231], v[100:103]
s_waitcnt lgkmcnt(0)
v_mfma_f32_16x16x32_bf16 v[108:111], a[220:223], a[236:239], v[108:111]
buffer_load_dword v255, v253, s[92:95], s84 offen
v_mfma_f32_16x16x32_bf16 v[108:111], a[216:219], a[232:235], v[108:111]
s_add_u32 s84, s84, s85
v_mfma_f32_16x16x32_bf16 a[16:19], a[160:163], a[240:243], a[16:19]
ds_read_b64_tr_b16 a[224:225], v20 offset:0
v_mfma_f32_16x16x32_bf16 a[16:19], a[164:167], a[244:247], a[16:19]
v_mfma_f32_16x16x32_bf16 a[20:23], a[172:175], a[244:247], a[20:23]
ds_read_b64_tr_b16 a[226:227], v20 offset:1024
v_mfma_f32_16x16x32_bf16 a[20:23], a[168:171], a[240:243], a[20:23]
ds_read_b64_tr_b16 a[228:229], v20 offset:8192
v_mfma_f32_16x16x32_bf16 a[80:83], a[176:179], a[240:243], a[80:83]
v_mfma_f32_16x16x32_bf16 a[80:83], a[180:183], a[244:247], a[80:83]
ds_read_b64_tr_b16 a[230:231], v20 offset:9216
v_mfma_f32_16x16x32_bf16 a[84:87], a[188:191], a[244:247], a[84:87]
v_mfma_f32_16x16x32_bf16 a[84:87], a[184:187], a[240:243], a[84:87]
ds_read_b64_tr_b16 a[232:233], v21 offset:0
v_mfma_f32_16x16x32_bf16 v[48:51], a[192:195], a[240:243], v[48:51]
v_mfma_f32_16x16x32_bf16 v[48:51], a[196:199], a[244:247], v[48:51]
ds_read_b64_tr_b16 a[234:235], v21 offset:1024
v_mfma_f32_16x16x32_bf16 v[52:55], a[204:207], a[244:247], v[52:55]
ds_read_b64_tr_b16 a[236:237], v21 offset:8192
v_mfma_f32_16x16x32_bf16 v[52:55], a[200:203], a[240:243], v[52:55]
v_mfma_f32_16x16x32_bf16 v[112:115], a[208:211], a[240:243], v[112:115]
ds_read_b64_tr_b16 a[238:239], v21 offset:9216
s_bitcmp1_b32 s65, s42
v_mfma_f32_16x16x32_bf16 v[112:115], a[212:215], a[244:247], v[112:115]
s_cbranch_scc1 L_p1sw_KV
L_p1bk_KV:
v_mfma_f32_16x16x32_bf16 v[116:119], a[220:223], a[244:247], v[116:119]
v_mfma_f32_16x16x32_bf16 v[116:119], a[216:219], a[240:243], v[116:119]
v_mfma_f32_16x16x32_bf16 a[24:27], a[160:163], a[248:251], a[24:27]
v_mfma_f32_16x16x32_bf16 a[24:27], a[164:167], a[252:255], a[24:27]
buffer_load_dword v255, v254, s[88:91], s86 offen
v_mfma_f32_16x16x32_bf16 a[28:31], a[172:175], a[252:255], a[28:31]
ds_read_b64_tr_b16 a[240:241], v22 offset:0
s_add_u32 s86, s86, s87
v_mfma_f32_16x16x32_bf16 a[28:31], a[168:171], a[248:251], a[28:31]
v_mfma_f32_16x16x32_bf16 a[88:91], a[176:179], a[248:251], a[88:91]
ds_read_b64_tr_b16 a[242:243], v22 offset:1024
v_mfma_f32_16x16x32_bf16 a[88:91], a[180:183], a[252:255], a[88:91]
v_mfma_f32_16x16x32_bf16 a[92:95], a[188:191], a[252:255], a[92:95]
ds_read_b64_tr_b16 a[244:245], v22 offset:8192
v_mfma_f32_16x16x32_bf16 a[92:95], a[184:187], a[248:251], a[92:95]
v_mfma_f32_16x16x32_bf16 v[56:59], a[192:195], a[248:251], v[56:59]
ds_read_b64_tr_b16 a[246:247], v22 offset:9216
v_mfma_f32_16x16x32_bf16 v[56:59], a[196:199], a[252:255], v[56:59]
v_mfma_f32_16x16x32_bf16 v[60:63], a[204:207], a[252:255], v[60:63]
v_mfma_f32_16x16x32_bf16 v[60:63], a[200:203], a[248:251], v[60:63]
v_mfma_f32_16x16x32_bf16 v[120:123], a[208:211], a[248:251], v[120:123]
s_waitcnt lgkmcnt(4)
v_mfma_f32_16x16x32_bf16 v[120:123], a[212:215], a[252:255], v[120:123]
v_mfma_f32_16x16x32_bf16 v[124:127], a[220:223], a[252:255], v[124:127]
v_mfma_f32_16x16x32_bf16 v[124:127], a[216:219], a[248:251], v[124:127]
v_mfma_f32_16x16x32_bf16 a[32:35], a[160:163], a[224:227], a[32:35]
ds_read_b64_tr_b16 a[248:249], v23 offset:0
v_mfma_f32_16x16x32_bf16 a[32:35], a[164:167], a[228:231], a[32:35]
ds_read_b64_tr_b16 a[250:251], v23 offset:1024
v_mfma_f32_16x16x32_bf16 a[36:39], a[172:175], a[228:231], a[36:39]
v_mfma_f32_16x16x32_bf16 a[36:39], a[168:171], a[224:227], a[36:39]
ds_read_b64_tr_b16 a[252:253], v23 offset:8192
v_mfma_f32_16x16x32_bf16 a[96:99], a[176:179], a[224:227], a[96:99]
ds_read_b64_tr_b16 a[254:255], v23 offset:9216
v_mfma_f32_16x16x32_bf16 a[96:99], a[180:183], a[228:231], a[96:99]
v_mfma_f32_16x16x32_bf16 a[100:103], a[188:191], a[228:231], a[100:103]
v_mfma_f32_16x16x32_bf16 a[100:103], a[184:187], a[224:227], a[100:103]
v_mfma_f32_16x16x32_bf16 v[64:67], a[192:195], a[224:227], v[64:67]
v_mfma_f32_16x16x32_bf16 v[64:67], a[196:199], a[228:231], v[64:67]
v_add_u32 v16, s44, v16
v_add_u32 v17, s44, v17
v_mfma_f32_16x16x32_bf16 v[68:71], a[204:207], a[228:231], v[68:71]
v_add_u32 v18, s44, v18
v_add_u32 v19, s44, v19
v_mfma_f32_16x16x32_bf16 v[68:71], a[200:203], a[224:227], v[68:71]
v_add_u32 v20, s44, v20
v_add_u32 v21, s44, v21
v_mfma_f32_16x16x32_bf16 a[128:131], a[208:211], a[224:227], a[128:131]
v_add_u32 v22, s44, v22
v_add_u32 v23, s44, v23
v_mfma_f32_16x16x32_bf16 a[128:131], a[212:215], a[228:231], a[128:131]
v_add_u32 v2, s43, v2
v_add_u32 v3, s43, v3
v_mfma_f32_16x16x32_bf16 a[132:135], a[220:223], a[228:231], a[132:135]
s_waitcnt vmcnt(3) lgkmcnt(0)
s_sub_u32 s44, 0, s44
v_mfma_f32_16x16x32_bf16 a[132:135], a[216:219], a[224:227], a[132:135]
s_barrier
s_sub_u32 s43, 0, s43
v_mfma_f32_16x16x32_bf16 a[40:43], a[160:163], a[232:235], a[40:43]
s_mov_b32 m0, s40
s_add_u32 s42, s42, 1
v_mfma_f32_16x16x32_bf16 a[40:43], a[164:167], a[236:239], a[40:43]
v_mfma_f32_16x16x32_bf16 a[44:47], a[172:175], a[236:239], a[44:47]
ds_read_b64_tr_b16 a[224:225], v16 offset:0
v_mfma_f32_16x16x32_bf16 a[44:47], a[168:171], a[232:235], a[44:47]
buffer_load_dwordx4 v6, s[8:11], s36 offen offset:0 lds
v_mfma_f32_16x16x32_bf16 a[104:107], a[176:179], a[232:235], a[104:107]
ds_read_b64_tr_b16 a[226:227], v16 offset:1024
v_mfma_f32_16x16x32_bf16 a[104:107], a[180:183], a[236:239], a[104:107]
v_mfma_f32_16x16x32_bf16 a[108:111], a[188:191], a[236:239], a[108:111]
v_mfma_f32_16x16x32_bf16 a[108:111], a[184:187], a[232:235], a[108:111]
buffer_load_dwordx4 v7, s[8:11], s36 offen offset:1024 lds
v_mfma_f32_16x16x32_bf16 v[72:75], a[192:195], a[232:235], v[72:75]
ds_read_b64_tr_b16 a[228:229], v16 offset:8192
v_mfma_f32_16x16x32_bf16 v[72:75], a[196:199], a[236:239], v[72:75]
ds_read_b64_tr_b16 a[230:231], v16 offset:9216
v_mfma_f32_16x16x32_bf16 v[76:79], a[204:207], a[236:239], v[76:79]
v_mfma_f32_16x16x32_bf16 v[76:79], a[200:203], a[232:235], v[76:79]
buffer_load_dwordx4 v8, s[8:11], s36 offen offset:2048 lds
v_mfma_f32_16x16x32_bf16 a[136:139], a[208:211], a[232:235], a[136:139]
v_mfma_f32_16x16x32_bf16 a[136:139], a[212:215], a[236:239], a[136:139]
v_mfma_f32_16x16x32_bf16 a[140:143], a[220:223], a[236:239], a[140:143]
v_mfma_f32_16x16x32_bf16 a[140:143], a[216:219], a[232:235], a[140:143]
buffer_load_dwordx4 v9, s[8:11], s36 offen offset:3072 lds
v_mfma_f32_16x16x32_bf16 a[48:51], a[160:163], a[240:243], a[48:51]
ds_read_b64_tr_b16 a[232:233], v17 offset:0
s_add_u32 m0, s40, 4096
s_add_u32 s36, s36, 128
v_mfma_f32_16x16x32_bf16 a[48:51], a[164:167], a[244:247], a[48:51]
buffer_load_dwordx4 v6, s[8:11], s37 offen offset:0 lds
v_mfma_f32_16x16x32_bf16 a[56:59], a[164:167], a[252:255], a[56:59]
ds_read_b128 a[164:167], v3 offset:0
v_mfma_f32_16x16x32_bf16 a[56:59], a[160:163], a[248:251], a[56:59]
ds_read_b128 a[160:163], v2 offset:0
v_mfma_f32_16x16x32_bf16 a[52:55], a[168:171], a[240:243], a[52:55]
ds_read_b64_tr_b16 a[234:235], v17 offset:1024
v_mfma_f32_16x16x32_bf16 a[52:55], a[172:175], a[244:247], a[52:55]
buffer_load_dwordx4 v7, s[8:11], s37 offen offset:1024 lds
v_mfma_f32_16x16x32_bf16 a[60:63], a[172:175], a[252:255], a[60:63]
ds_read_b128 a[172:175], v3 offset:2048
v_mfma_f32_16x16x32_bf16 a[60:63], a[168:171], a[248:251], a[60:63]
ds_read_b128 a[168:171], v2 offset:2048
v_mfma_f32_16x16x32_bf16 a[112:115], a[176:179], a[240:243], a[112:115]
ds_read_b64_tr_b16 a[236:237], v17 offset:8192
v_mfma_f32_16x16x32_bf16 a[112:115], a[180:183], a[244:247], a[112:115]
buffer_load_dwordx4 v8, s[8:11], s37 offen offset:2048 lds
v_mfma_f32_16x16x32_bf16 a[120:123], a[180:183], a[252:255], a[120:123]
ds_read_b128 a[180:183], v3 offset:4096
v_mfma_f32_16x16x32_bf16 a[120:123], a[176:179], a[248:251], a[120:123]
ds_read_b128 a[176:179], v2 offset:4096
v_mfma_f32_16x16x32_bf16 a[116:119], a[184:187], a[240:243], a[116:119]
ds_read_b64_tr_b16 a[238:239], v17 offset:9216
v_mfma_f32_16x16x32_bf16 a[116:119], a[188:191], a[244:247], a[116:119]
buffer_load_dwordx4 v9, s[8:11], s37 offen offset:3072 lds
v_mfma_f32_16x16x32_bf16 a[124:127], a[188:191], a[252:255], a[124:127]
ds_read_b128 a[188:191], v3 offset:6144
s_mov_b32 m0, s41
v_mfma_f32_16x16x32_bf16 a[124:127], a[184:187], a[248:251], a[124:127]
ds_read_b128 a[184:187], v2 offset:6144
s_add_u32 s37, s37, 128
v_mfma_f32_16x16x32_bf16 v[80:83], a[192:195], a[240:243], v[80:83]
s_xor_b32 s40, s40, 32768
v_mfma_f32_16x16x32_bf16 v[80:83], a[196:199], a[244:247], v[80:83]
buffer_load_dwordx4 v10, s[12:15], s38 offen offset:0 lds
v_mfma_f32_16x16x32_bf16 v[88:91], a[196:199], a[252:255], v[88:91]
ds_read_b128 a[196:199], v3 offset:8192
v_mfma_f32_16x16x32_bf16 v[88:91], a[192:195], a[248:251], v[88:91]
ds_read_b128 a[192:195], v2 offset:8192
v_mfma_f32_16x16x32_bf16 v[84:87], a[200:203], a[240:243], v[84:87]
v_mfma_f32_16x16x32_bf16 v[84:87], a[204:207], a[244:247], v[84:87]
buffer_load_dwordx4 v11, s[12:15], s38 offen offset:1024 lds
v_mfma_f32_16x16x32_bf16 v[92:95], a[204:207], a[252:255], v[92:95]
ds_read_b128 a[204:207], v3 offset:10240
v_mfma_f32_16x16x32_bf16 v[92:95], a[200:203], a[248:251], v[92:95]
ds_read_b128 a[200:203], v2 offset:10240
v_mfma_f32_16x16x32_bf16 a[144:147], a[208:211], a[240:243], a[144:147]
s_waitcnt lgkmcnt(4)
v_mfma_f32_16x16x32_bf16 a[144:147], a[212:215], a[244:247], a[144:147]
buffer_load_dwordx4 v12, s[12:15], s38 offen offset:2048 lds
v_mfma_f32_16x16x32_bf16 a[152:155], a[212:215], a[252:255], a[152:155]
ds_read_b128 a[212:215], v3 offset:12288
v_mfma_f32_16x16x32_bf16 a[152:155], a[208:211], a[248:251], a[152:155]
ds_read_b128 a[208:211], v2 offset:12288
v_mfma_f32_16x16x32_bf16 a[148:151], a[216:219], a[240:243], a[148:151]
v_mfma_f32_16x16x32_bf16 a[148:151], a[220:223], a[244:247], a[148:151]
buffer_load_dwordx4 v13, s[12:15], s38 offen offset:3072 lds
v_mfma_f32_16x16x32_bf16 a[156:159], a[220:223], a[252:255], a[156:159]
ds_read_b128 a[220:223], v3 offset:14336
s_add_u32 s38, s38, s45
v_mfma_f32_16x16x32_bf16 a[156:159], a[216:219], a[248:251], a[156:159]
ds_read_b128 a[216:219], v2 offset:14336
s_cmp_lt_u32 s42, 8
s_cbranch_scc1 L_p1_KV
L_p2_K:
s_lshl_b32 s53, s3, 13
v_mfma_f32_16x16x32_bf16 v[128:131], a[224:227], a[160:163], 0
ds_read_b64_tr_b16 a[240:241], v18 offset:0
s_add_u32 m0, s41, 4096
v_mfma_f32_16x16x32_bf16 v[128:131], a[228:231], a[164:167], v[128:131]
buffer_load_dwordx4 v10, s[20:23], s39 offen offset:0 lds
v_mfma_f32_16x16x32_bf16 v[160:163], a[228:231], a[172:175], 0
ds_read_b64_tr_b16 a[242:243], v18 offset:1024
v_mfma_f32_16x16x32_bf16 v[160:163], a[224:227], a[168:171], v[160:163]
ds_read_b64_tr_b16 a[244:245], v18 offset:8192
v_mfma_f32_16x16x32_bf16 v[192:195], a[224:227], a[176:179], 0
ds_read_b64_tr_b16 a[246:247], v18 offset:9216
v_cvt_pk_bf16_f32 v48, v48, v49
v_mfma_f32_16x16x32_bf16 v[192:195], a[228:231], a[180:183], v[192:195]
buffer_load_dwordx4 v11, s[20:23], s39 offen offset:1024 lds
v_mfma_f32_16x16x32_bf16 v[224:227], a[228:231], a[188:191], 0
v_cvt_pk_bf16_f32 v49, v50, v51
v_cvt_pk_bf16_f32 v50, v52, v53
v_mfma_f32_16x16x32_bf16 v[224:227], a[224:227], a[184:187], v[224:227]
v_cvt_pk_bf16_f32 v51, v54, v55
s_waitcnt lgkmcnt(15)
v_mfma_f32_16x16x32_bf16 v[132:135], a[232:235], a[160:163], 0
ds_read_b64_tr_b16 a[248:249], v19 offset:0
v_cvt_pk_bf16_f32 v32, v32, v33
v_mfma_f32_16x16x32_bf16 v[132:135], a[236:239], a[164:167], v[132:135]
buffer_load_dwordx4 v12, s[20:23], s39 offen offset:2048 lds
v_mfma_f32_16x16x32_bf16 v[164:167], a[236:239], a[172:175], 0
ds_read_b64_tr_b16 a[250:251], v19 offset:1024
v_cvt_pk_bf16_f32 v33, v34, v35
v_mfma_f32_16x16x32_bf16 v[164:167], a[232:235], a[168:171], v[164:167]
ds_read_b64_tr_b16 a[252:253], v19 offset:8192
v_cvt_pk_bf16_f32 v34, v36, v37
v_mfma_f32_16x16x32_bf16 v[196:199], a[232:235], a[176:179], 0
ds_read_b64_tr_b16 a[254:255], v19 offset:9216
v_cvt_pk_bf16_f32 v35, v38, v39
v_mfma_f32_16x16x32_bf16 v[196:199], a[236:239], a[180:183], v[196:199]
buffer_load_dwordx4 v13, s[20:23], s39 offen offset:3072 lds
v_mfma_f32_16x16x32_bf16 v[228:231], a[236:239], a[188:191], 0
s_waitcnt vmcnt(8) lgkmcnt(4)
s_add_u32 s50, s46, 384
v_mfma_f32_16x16x32_bf16 v[228:231], a[232:235], a[184:187], v[228:231]
s_barrier
s_add_u32 m0, s53, 65536
v_mfma_f32_16x16x32_bf16 v[136:139], a[240:243], a[160:163], 0
ds_read_b64_tr_b16 a[224:225], v20 offset:0
v_accvgpr_read_b32 v52, a64
v_mfma_f32_16x16x32_bf16 v[136:139], a[244:247], a[164:167], v[136:139]
buffer_load_dwordx4 v24, s[16:19], s50 offen offset:0 lds
v_mfma_f32_16x16x32_bf16 v[168:171], a[244:247], a[172:175], 0
ds_read_b64_tr_b16 a[226:227], v20 offset:1024
v_accvgpr_read_b32 v53, a65
v_mfma_f32_16x16x32_bf16 v[168:171], a[240:243], a[168:171], v[168:171]
ds_read_b128 a[192:195], v2 offset:32768
v_cvt_pk_bf16_f32 v36, v52, v53
v_mfma_f32_16x16x32_bf16 v[200:203], a[240:243], a[176:179], 0
ds_read_b64_tr_b16 a[228:229], v20 offset:8192
v_accvgpr_write_b32 a64, v36
v_mfma_f32_16x16x32_bf16 v[200:203], a[244:247], a[180:183], v[200:203]
buffer_load_dwordx4 v25, s[16:19], s50 offen offset:1024 lds
v_mfma_f32_16x16x32_bf16 v[232:235], a[244:247], a[188:191], 0
ds_read_b64_tr_b16 a[230:231], v20 offset:9216
v_accvgpr_read_b32 v54, a66
v_mfma_f32_16x16x32_bf16 v[232:235], a[240:243], a[184:187], v[232:235]
ds_read_b128 a[196:199], v3 offset:32768
s_waitcnt lgkmcnt(6)
v_mfma_f32_16x16x32_bf16 v[140:143], a[248:251], a[160:163], 0
ds_read_b64_tr_b16 a[232:233], v21 offset:0
v_accvgpr_read_b32 v55, a67
v_mfma_f32_16x16x32_bf16 v[140:143], a[252:255], a[164:167], v[140:143]
buffer_load_dwordx4 v26, s[16:19], s50 offen offset:2048 lds
v_mfma_f32_16x16x32_bf16 v[172:175], a[252:255], a[172:175], 0
ds_read_b64_tr_b16 a[234:235], v21 offset:1024
v_cvt_pk_bf16_f32 v37, v54, v55
v_mfma_f32_16x16x32_bf16 v[172:175], a[248:251], a[168:171], v[172:175]
ds_read_b64_tr_b16 a[236:237], v21 offset:8192
v_accvgpr_write_b32 a65, v37
v_mfma_f32_16x16x32_bf16 v[204:207], a[248:251], a[176:179], 0
ds_read_b128 a[200:203], v2 offset:34816
v_accvgpr_read_b32 v52, a68
v_mfma_f32_16x16x32_bf16 v[204:207], a[252:255], a[180:183], v[204:207]
buffer_load_dwordx4 v27, s[16:19], s50 offen offset:3072 lds
v_mfma_f32_16x16x32_bf16 v[236:239], a[252:255], a[188:191], 0
ds_read_b64_tr_b16 a[238:239], v21 offset:9216
v_accvgpr_read_b32 v53, a69
v_mfma_f32_16x16x32_bf16 v[236:239], a[248:251], a[184:187], v[236:239]
ds_read_b128 a[204:207], v3 offset:34816
s_waitcnt lgkmcnt(7)
v_mfma_f32_16x16x32_bf16 v[144:147], a[224:227], a[160:163], 0
ds_read_b64_tr_b16 a[240:241], v22 offset:0
s_add_u32 s52, s49, 0
v_mfma_f32_16x16x32_bf16 v[144:147], a[228:231], a[164:167], v[144:147]
buffer_store_dwordx4 v[32:35], v1, s[24:27], s52 offen offset:0 sc1
v_mfma_f32_16x16x32_bf16 v[176:179], a[228:231], a[172:175], 0
ds_read_b64_tr_b16 a[242:243], v22 offset:1024
v_cvt_pk_bf16_f32 v38, v52, v53
v_mfma_f32_16x16x32_bf16 v[176:179], a[224:227], a[168:171], v[176:179]
ds_read_b64_tr_b16 a[244:245], v22 offset:8192
v_accvgpr_write_b32 a66, v38
v_mfma_f32_16x16x32_bf16 v[208:211], a[224:227], a[176:179], 0
s_add_u32 s50, s47, 384
s_add_u32 m0, s53, 69632
v_mfma_f32_16x16x32_bf16 v[208:211], a[228:231], a[180:183], v[208:211]
buffer_load_dwordx4 v24, s[16:19], s50 offen offset:0 lds
v_mfma_f32_16x16x32_bf16 v[240:243], a[228:231], a[188:191], 0
ds_read_b128 a[208:211], v2 offset:36864
v_accvgpr_read_b32 v54, a70
v_mfma_f32_16x16x32_bf16 v[240:243], a[224:227], a[184:187], v[240:243]
ds_read_b64_tr_b16 a[246:247], v22 offset:9216
s_waitcnt lgkmcnt(6)
v_mfma_f32_16x16x32_bf16 v[148:151], a[232:235], a[160:163], 0
ds_read_b64_tr_b16 a[248:249], v23 offset:0
v_accvgpr_read_b32 v55, a71
v_mfma_f32_16x16x32_bf16 v[148:151], a[236:239], a[164:167], v[148:151]
buffer_load_dwordx4 v25, s[16:19], s50 offen offset:1024 lds
v_mfma_f32_16x16x32_bf16 v[180:183], a[236:239], a[172:175], 0
ds_read_b128 a[212:215], v3 offset:36864
v_cvt_pk_bf16_f32 v39, v54, v55
v_mfma_f32_16x16x32_bf16 v[180:183], a[232:235], a[168:171], v[180:183]
ds_read_b64_tr_b16 a[250:251], v23 offset:1024
v_accvgpr_write_b32 a67, v39
v_mfma_f32_16x16x32_bf16 v[212:215], a[232:235], a[176:179], 0
ds_read_b64_tr_b16 a[252:253], v23 offset:8192
v_cvt_pk_bf16_f32 v40, v40, v41
v_mfma_f32_16x16x32_bf16 v[212:215], a[236:239], a[180:183], v[212:215]
buffer_load_dwordx4 v26, s[16:19], s50 offen offset:2048 lds
v_mfma_f32_16x16x32_bf16 v[244:247], a[236:239], a[188:191], 0
ds_read_b64_tr_b16 a[254:255], v23 offset:9216
v_cvt_pk_bf16_f32 v41, v42, v43
v_mfma_f32_16x16x32_bf16 v[244:247], a[232:235], a[184:187], v[244:247]
ds_read_b128 a[216:219], v2 offset:38912
s_waitcnt lgkmcnt(6)
v_mfma_f32_16x16x32_bf16 v[152:155], a[240:243], a[160:163], 0
ds_read_b64_tr_b16 a[224:225], v16 offset:16384
v_cvt_pk_bf16_f32 v42, v44, v45
v_mfma_f32_16x16x32_bf16 v[152:155], a[244:247], a[164:167], v[152:155]
buffer_load_dwordx4 v27, s[16:19], s50 offen offset:3072 lds
v_mfma_f32_16x16x32_bf16 v[184:187], a[244:247], a[172:175], 0
ds_read_b64_tr_b16 a[226:227], v16 offset:17408
v_cvt_pk_bf16_f32 v43, v46, v47
v_mfma_f32_16x16x32_bf16 v[184:187], a[240:243], a[168:171], v[184:187]
ds_read_b128 a[220:223], v3 offset:38912
v_accvgpr_read_b32 v52, a72
v_mfma_f32_16x16x32_bf16 v[216:219], a[240:243], a[176:179], 0
ds_read_b64_tr_b16 a[228:229], v16 offset:24576
v_accvgpr_read_b32 v53, a73
v_mfma_f32_16x16x32_bf16 v[216:219], a[244:247], a[180:183], v[216:219]
buffer_store_dwordx4 v[40:43], v1, s[24:27], s52 offen offset:1024 sc1
v_mfma_f32_16x16x32_bf16 v[248:251], a[244:247], a[188:191], 0
ds_read_b64_tr_b16 a[230:231], v16 offset:25600
v_cvt_pk_bf16_f32 v36, v52, v53
v_mfma_f32_16x16x32_bf16 v[248:251], a[240:243], a[184:187], v[248:251]
v_accvgpr_write_b32 a72, v36
s_waitcnt lgkmcnt(6)
v_mfma_f32_16x16x32_bf16 v[156:159], a[248:251], a[160:163], 0
ds_read_b64_tr_b16 a[232:233], v17 offset:16384
v_accvgpr_read_b32 v54, a74
v_mfma_f32_16x16x32_bf16 v[156:159], a[252:255], a[164:167], v[156:159]
ds_read_b64_tr_b16 a[234:235], v17 offset:17408
v_accvgpr_read_b32 v55, a75
v_mfma_f32_16x16x32_bf16 v[188:191], a[252:255], a[172:175], 0
ds_read_b64_tr_b16 a[236:237], v17 offset:24576
v_cvt_pk_bf16_f32 v37, v54, v55
v_mfma_f32_16x16x32_bf16 v[188:191], a[248:251], a[168:171], v[188:191]
ds_read_b64_tr_b16 a[238:239], v17 offset:25600
v_accvgpr_write_b32 a73, v37
v_mfma_f32_16x16x32_bf16 v[220:223], a[248:251], a[176:179], 0
v_accvgpr_read_b32 v52, a76
v_accvgpr_read_b32 v53, a77
v_mfma_f32_16x16x32_bf16 v[220:223], a[252:255], a[180:183], v[220:223]
v_cvt_pk_bf16_f32 v38, v52, v53
v_accvgpr_write_b32 a74, v38
v_mfma_f32_16x16x32_bf16 v[252:255], a[252:255], a[188:191], 0
v_accvgpr_read_b32 v54, a78
v_accvgpr_read_b32 v55, a79
v_mfma_f32_16x16x32_bf16 v[252:255], a[248:251], a[184:187], v[252:255]
v_cvt_pk_bf16_f32 v39, v54, v55
s_waitcnt lgkmcnt(4)
v_mfma_f32_16x16x32_bf16 v[128:131], a[224:227], a[192:195], v[128:131]
ds_read_b64_tr_b16 a[240:241], v18 offset:16384
v_accvgpr_write_b32 a75, v39
v_mfma_f32_16x16x32_bf16 v[128:131], a[228:231], a[196:199], v[128:131]
ds_read_b64_tr_b16 a[242:243], v18 offset:17408
v_accvgpr_read_b32 v52, a80
v_mfma_f32_16x16x32_bf16 v[160:163], a[228:231], a[204:207], v[160:163]
ds_read_b64_tr_b16 a[244:245], v18 offset:24576
v_accvgpr_read_b32 v53, a81
v_mfma_f32_16x16x32_bf16 v[160:163], a[224:227], a[200:203], v[160:163]
ds_read_b64_tr_b16 a[246:247], v18 offset:25600
v_cvt_pk_bf16_f32 v36, v52, v53
v_mfma_f32_16x16x32_bf16 v[192:195], a[224:227], a[208:211], v[192:195]
v_accvgpr_write_b32 a80, v36
v_accvgpr_read_b32 v54, a82
v_mfma_f32_16x16x32_bf16 v[192:195], a[228:231], a[212:215], v[192:195]
buffer_store_dwordx4 v[48:51], v1, s[24:27], s52 offen offset:2048 sc1
v_mfma_f32_16x16x32_bf16 v[224:227], a[228:231], a[220:223], v[224:227]
v_accvgpr_read_b32 v55, a83
s_waitcnt lgkmcnt(4)
v_mfma_f32_16x16x32_bf16 v[224:227], a[224:227], a[216:219], v[224:227]
v_cvt_pk_bf16_f32 v37, v54, v55
v_accvgpr_write_b32 a81, v37
v_mfma_f32_16x16x32_bf16 v[132:135], a[232:235], a[192:195], v[132:135]
s_add_u32 s50, s46, 512
s_add_u32 m0, s53, 98304
v_mfma_f32_16x16x32_bf16 v[132:135], a[236:239], a[196:199], v[132:135]
buffer_load_dwordx4 v24, s[16:19], s50 offen offset:0 lds
v_mfma_f32_16x16x32_bf16 v[164:167], a[236:239], a[204:207], v[164:167]
ds_read_b64_tr_b16 a[248:249], v19 offset:16384
v_accvgpr_read_b32 v52, a84
v_mfma_f32_16x16x32_bf16 v[164:167], a[232:235], a[200:203], v[164:167]
ds_read_b64_tr_b16 a[250:251], v19 offset:17408
v_accvgpr_read_b32 v53, a85
v_mfma_f32_16x16x32_bf16 v[196:199], a[232:235], a[208:211], v[196:199]
ds_read_b64_tr_b16 a[252:253], v19 offset:24576
v_cvt_pk_bf16_f32 v38, v52, v53
v_mfma_f32_16x16x32_bf16 v[196:199], a[236:239], a[212:215], v[196:199]
buffer_load_dwordx4 v25, s[16:19], s50 offen offset:1024 lds
v_mfma_f32_16x16x32_bf16 v[228:231], a[236:239], a[220:223], v[228:231]
ds_read_b64_tr_b16 a[254:255], v19 offset:25600
s_waitcnt vmcnt(13) lgkmcnt(4)
v_mfma_f32_16x16x32_bf16 v[228:231], a[232:235], a[216:219], v[228:231]
v_accvgpr_write_b32 a82, v38
s_barrier
v_mfma_f32_16x16x32_bf16 v[136:139], a[240:243], a[192:195], v[136:139]
ds_read_b64_tr_b16 a[224:225], v20 offset:16384
v_accvgpr_read_b32 v54, a86
v_mfma_f32_16x16x32_bf16 v[136:139], a[244:247], a[196:199], v[136:139]
buffer_load_dwordx4 v26, s[16:19], s50 offen offset:2048 lds
v_mfma_f32_16x16x32_bf16 v[168:171], a[244:247], a[204:207], v[168:171]
ds_read_b64_tr_b16 a[226:227], v20 offset:17408
v_accvgpr_read_b32 v55, a87
v_mfma_f32_16x16x32_bf16 v[168:171], a[240:243], a[200:203], v[168:171]
ds_read_b128 a[160:163], v4 offset:0
v_cvt_pk_bf16_f32 v39, v54, v55
v_mfma_f32_16x16x32_bf16 v[200:203], a[240:243], a[208:211], v[200:203]
ds_read_b64_tr_b16 a[228:229], v20 offset:24576
v_accvgpr_write_b32 a83, v39
v_mfma_f32_16x16x32_bf16 v[200:203], a[244:247], a[212:215], v[200:203]
buffer_load_dwordx4 v27, s[16:19], s50 offen offset:3072 lds
v_mfma_f32_16x16x32_bf16 v[232:235], a[244:247], a[220:223], v[232:235]
ds_read_b64_tr_b16 a[230:231], v20 offset:25600
v_cvt_pk_bf16_f32 v56, v56, v57
v_mfma_f32_16x16x32_bf16 v[232:235], a[240:243], a[216:219], v[232:235]
ds_read_b128 a[164:167], v5 offset:0
s_waitcnt lgkmcnt(6)
v_mfma_f32_16x16x32_bf16 v[140:143], a[248:251], a[192:195], v[140:143]
ds_read_b64_tr_b16 a[232:233], v21 offset:16384
v_cvt_pk_bf16_f32 v57, v58, v59
v_mfma_f32_16x16x32_bf16 v[140:143], a[252:255], a[196:199], v[140:143]
ds_read_b64_tr_b16 a[234:235], v21 offset:17408
v_cvt_pk_bf16_f32 v58, v60, v61
v_mfma_f32_16x16x32_bf16 v[172:175], a[252:255], a[204:207], v[172:175]
ds_read_b64_tr_b16 a[236:237], v21 offset:24576
v_cvt_pk_bf16_f32 v59, v62, v63
v_mfma_f32_16x16x32_bf16 v[172:175], a[248:251], a[200:203], v[172:175]
ds_read_b128 a[168:171], v4 offset:2048
s_add_u32 s51, s58, 2097152
v_mfma_f32_16x16x32_bf16 v[204:207], a[248:251], a[208:211], v[204:207]
ds_read_b64_tr_b16 a[238:239], v21 offset:25600
s_add_u32 m0, s59, 0
v_mfma_f32_16x16x32_bf16 v[204:207], a[252:255], a[212:215], v[204:207]
buffer_load_dwordx4 v10, s[20:23], s51 offen offset:0 lds
v_mfma_f32_16x16x32_bf16 v[236:239], a[252:255], a[220:223], v[236:239]
ds_read_b128 a[172:175], v5 offset:2048
s_waitcnt lgkmcnt(7)
v_mfma_f32_16x16x32_bf16 v[236:239], a[248:251], a[216:219], v[236:239]
ds_read_b128 a[176:179], v4 offset:4096
v_accvgpr_read_b32 v52, a88
v_mfma_f32_16x16x32_bf16 v[144:147], a[224:227], a[192:195], v[144:147]
ds_read_b64_tr_b16 a[240:241], v22 offset:16384
v_accvgpr_read_b32 v53, a89
v_mfma_f32_16x16x32_bf16 v[144:147], a[228:231], a[196:199], v[144:147]
buffer_load_dwordx4 v11, s[20:23], s51 offen offset:1024 lds
v_mfma_f32_16x16x32_bf16 v[176:179], a[228:231], a[204:207], v[176:179]
ds_read_b64_tr_b16 a[242:243], v22 offset:17408
v_cvt_pk_bf16_f32 v36, v52, v53
v_mfma_f32_16x16x32_bf16 v[176:179], a[224:227], a[200:203], v[176:179]
ds_read_b64_tr_b16 a[244:245], v22 offset:24576
v_accvgpr_write_b32 a88, v36
v_mfma_f32_16x16x32_bf16 v[208:211], a[224:227], a[208:211], v[208:211]
ds_read_b64_tr_b16 a[246:247], v22 offset:25600
v_accvgpr_read_b32 v54, a90
v_mfma_f32_16x16x32_bf16 v[208:211], a[228:231], a[212:215], v[208:211]
buffer_load_dwordx4 v12, s[20:23], s51 offen offset:2048 lds
v_mfma_f32_16x16x32_bf16 v[240:243], a[228:231], a[220:223], v[240:243]
ds_read_b128 a[180:183], v5 offset:4096
v_accvgpr_read_b32 v55, a91
v_mfma_f32_16x16x32_bf16 v[240:243], a[224:227], a[216:219], v[240:243]
ds_read_b128 a[184:187], v4 offset:6144
s_waitcnt lgkmcnt(8)
v_mfma_f32_16x16x32_bf16 v[148:151], a[232:235], a[192:195], v[148:151]
ds_read_b64_tr_b16 a[248:249], v23 offset:16384
v_cvt_pk_bf16_f32 v37, v54, v55
v_mfma_f32_16x16x32_bf16 v[148:151], a[236:239], a[196:199], v[148:151]
buffer_load_dwordx4 v13, s[20:23], s51 offen offset:3072 lds
v_mfma_f32_16x16x32_bf16 v[180:183], a[236:239], a[204:207], v[180:183]
ds_read_b64_tr_b16 a[250:251], v23 offset:17408
v_accvgpr_write_b32 a89, v37
v_mfma_f32_16x16x32_bf16 v[180:183], a[232:235], a[200:203], v[180:183]
ds_read_b64_tr_b16 a[252:253], v23 offset:24576
v_accvgpr_read_b32 v52, a92
v_mfma_f32_16x16x32_bf16 v[212:215], a[232:235], a[208:211], v[212:215]
ds_read_b64_tr_b16 a[254:255], v23 offset:25600
v_accvgpr_read_b32 v53, a93
v_mfma_f32_16x16x32_bf16 v[212:215], a[236:239], a[212:215], v[212:215]
buffer_store_dwordx4 v[56:59], v1, s[24:27], s52 offen offset:3072 sc1
v_mfma_f32_16x16x32_bf16 v[244:247], a[236:239], a[220:223], v[244:247]
ds_read_b128 a[188:191], v5 offset:6144
v_cvt_pk_bf16_f32 v38, v52, v53
v_mfma_f32_16x16x32_bf16 v[244:247], a[232:235], a[216:219], v[244:247]
v_accvgpr_write_b32 a90, v38
s_waitcnt lgkmcnt(7)
v_mfma_f32_16x16x32_bf16 v[152:155], a[240:243], a[192:195], v[152:155]
s_add_u32 s50, s47, 512
s_add_u32 m0, s53, 102400
v_mfma_f32_16x16x32_bf16 v[152:155], a[244:247], a[196:199], v[152:155]
buffer_load_dwordx4 v24, s[16:19], s50 offen offset:0 lds
v_mfma_f32_16x16x32_bf16 v[184:187], a[244:247], a[204:207], v[184:187]
ds_read_b64_tr_b16 a[224:225], v16 offset:32768
v_accvgpr_read_b32 v54, a94
v_mfma_f32_16x16x32_bf16 v[184:187], a[240:243], a[200:203], v[184:187]
ds_read_b64_tr_b16 a[226:227], v16 offset:33792
v_accvgpr_read_b32 v55, a95
v_mfma_f32_16x16x32_bf16 v[216:219], a[240:243], a[208:211], v[216:219]
ds_read_b64_tr_b16 a[228:229], v16 offset:40960
v_cvt_pk_bf16_f32 v39, v54, v55
v_mfma_f32_16x16x32_bf16 v[216:219], a[244:247], a[212:215], v[216:219]
buffer_load_dwordx4 v25, s[16:19], s50 offen offset:1024 lds
v_mfma_f32_16x16x32_bf16 v[248:251], a[244:247], a[220:223], v[248:251]
ds_read_b64_tr_b16 a[230:231], v16 offset:41984
v_accvgpr_write_b32 a91, v39
v_mfma_f32_16x16x32_bf16 v[248:251], a[240:243], a[216:219], v[248:251]
v_cvt_pk_bf16_f32 v64, v64, v65
s_waitcnt lgkmcnt(5)
v_mfma_f32_16x16x32_bf16 v[156:159], a[248:251], a[192:195], v[156:159]
ds_read_b64_tr_b16 a[232:233], v17 offset:32768
v_cvt_pk_bf16_f32 v65, v66, v67
v_mfma_f32_16x16x32_bf16 v[156:159], a[252:255], a[196:199], v[156:159]
buffer_load_dwordx4 v26, s[16:19], s50 offen offset:2048 lds
v_mfma_f32_16x16x32_bf16 v[188:191], a[252:255], a[204:207], v[188:191]
ds_read_b64_tr_b16 a[234:235], v17 offset:33792
v_cvt_pk_bf16_f32 v66, v68, v69
v_mfma_f32_16x16x32_bf16 v[188:191], a[248:251], a[200:203], v[188:191]
ds_read_b64_tr_b16 a[236:237], v17 offset:40960
v_cvt_pk_bf16_f32 v67, v70, v71
v_mfma_f32_16x16x32_bf16 v[220:223], a[248:251], a[208:211], v[220:223]
ds_read_b64_tr_b16 a[238:239], v17 offset:41984
v_accvgpr_read_b32 v52, a96
v_mfma_f32_16x16x32_bf16 v[220:223], a[252:255], a[212:215], v[220:223]
buffer_load_dwordx4 v27, s[16:19], s50 offen offset:3072 lds
v_mfma_f32_16x16x32_bf16 v[252:255], a[252:255], a[220:223], v[252:255]
v_accvgpr_read_b32 v53, a97
v_cvt_pk_bf16_f32 v36, v52, v53
v_mfma_f32_16x16x32_bf16 v[252:255], a[248:251], a[216:219], v[252:255]
v_accvgpr_write_b32 a96, v36
s_waitcnt lgkmcnt(4)
v_mfma_f32_16x16x32_bf16 v[128:131], a[224:227], a[160:163], v[128:131]
ds_read_b64_tr_b16 a[240:241], v18 offset:32768
v_accvgpr_read_b32 v54, a98
v_mfma_f32_16x16x32_bf16 v[128:131], a[228:231], a[164:167], v[128:131]
ds_read_b64_tr_b16 a[242:243], v18 offset:33792
v_accvgpr_read_b32 v55, a99
v_mfma_f32_16x16x32_bf16 v[160:163], a[228:231], a[172:175], v[160:163]
ds_read_b64_tr_b16 a[244:245], v18 offset:40960
v_cvt_pk_bf16_f32 v37, v54, v55
v_mfma_f32_16x16x32_bf16 v[160:163], a[224:227], a[168:171], v[160:163]
ds_read_b64_tr_b16 a[246:247], v18 offset:41984
v_accvgpr_write_b32 a97, v37
v_mfma_f32_16x16x32_bf16 v[192:195], a[224:227], a[176:179], v[192:195]
s_add_u32 s52, s49, 4096
v_accvgpr_read_b32 v52, a100
v_mfma_f32_16x16x32_bf16 v[192:195], a[228:231], a[180:183], v[192:195]
buffer_store_dwordx4 v[64:67], v1, s[24:27], s52 offen offset:0 sc1
v_mfma_f32_16x16x32_bf16 v[224:227], a[228:231], a[188:191], v[224:227]
v_accvgpr_read_b32 v53, a101
v_cvt_pk_bf16_f32 v38, v52, v53
v_mfma_f32_16x16x32_bf16 v[224:227], a[224:227], a[184:187], v[224:227]
v_accvgpr_write_b32 a98, v38
s_waitcnt lgkmcnt(4)
v_mfma_f32_16x16x32_bf16 v[132:135], a[232:235], a[160:163], v[132:135]
s_add_u32 s50, s46, 640
s_add_u32 m0, s53, 131072
v_mfma_f32_16x16x32_bf16 v[132:135], a[236:239], a[164:167], v[132:135]
buffer_load_dwordx4 v24, s[16:19], s50 offen offset:0 lds
v_mfma_f32_16x16x32_bf16 v[164:167], a[236:239], a[172:175], v[164:167]
ds_read_b64_tr_b16 a[248:249], v19 offset:32768
v_accvgpr_read_b32 v54, a102
v_mfma_f32_16x16x32_bf16 v[164:167], a[232:235], a[168:171], v[164:167]
ds_read_b64_tr_b16 a[250:251], v19 offset:33792
v_accvgpr_read_b32 v55, a103
v_mfma_f32_16x16x32_bf16 v[196:199], a[232:235], a[176:179], v[196:199]
ds_read_b64_tr_b16 a[252:253], v19 offset:40960
v_cvt_pk_bf16_f32 v39, v54, v55
v_mfma_f32_16x16x32_bf16 v[196:199], a[236:239], a[180:183], v[196:199]
buffer_load_dwordx4 v25, s[16:19], s50 offen offset:1024 lds
v_mfma_f32_16x16x32_bf16 v[228:231], a[236:239], a[188:191], v[228:231]
ds_read_b64_tr_b16 a[254:255], v19 offset:41984
s_waitcnt vmcnt(18) lgkmcnt(4)
v_mfma_f32_16x16x32_bf16 v[228:231], a[232:235], a[184:187], v[228:231]
v_accvgpr_write_b32 a99, v39
s_barrier
v_mfma_f32_16x16x32_bf16 v[136:139], a[240:243], a[160:163], v[136:139]
ds_read_b64_tr_b16 a[224:225], v20 offset:32768
v_cvt_pk_bf16_f32 v72, v72, v73
v_mfma_f32_16x16x32_bf16 v[136:139], a[244:247], a[164:167], v[136:139]
buffer_load_dwordx4 v26, s[16:19], s50 offen offset:2048 lds
v_mfma_f32_16x16x32_bf16 v[168:171], a[244:247], a[172:175], v[168:171]
ds_read_b64_tr_b16 a[226:227], v20 offset:33792
v_cvt_pk_bf16_f32 v73, v74, v75
v_mfma_f32_16x16x32_bf16 v[168:171], a[240:243], a[168:171], v[168:171]
ds_read_b128 a[192:195], v2 offset:0
v_cvt_pk_bf16_f32 v74, v76, v77
v_mfma_f32_16x16x32_bf16 v[200:203], a[240:243], a[176:179], v[200:203]
ds_read_b64_tr_b16 a[228:229], v20 offset:40960
v_cvt_pk_bf16_f32 v75, v78, v79
v_mfma_f32_16x16x32_bf16 v[200:203], a[244:247], a[180:183], v[200:203]
buffer_load_dwordx4 v27, s[16:19], s50 offen offset:3072 lds
v_mfma_f32_16x16x32_bf16 v[232:235], a[244:247], a[188:191], v[232:235]
ds_read_b64_tr_b16 a[230:231], v20 offset:41984
v_accvgpr_read_b32 v52, a104
v_mfma_f32_16x16x32_bf16 v[232:235], a[240:243], a[184:187], v[232:235]
ds_read_b128 a[196:199], v3 offset:0
s_waitcnt lgkmcnt(6)
v_mfma_f32_16x16x32_bf16 v[140:143], a[248:251], a[160:163], v[140:143]
ds_read_b64_tr_b16 a[232:233], v21 offset:32768
v_accvgpr_read_b32 v53, a105
v_mfma_f32_16x16x32_bf16 v[140:143], a[252:255], a[164:167], v[140:143]
ds_read_b64_tr_b16 a[234:235], v21 offset:33792
v_cvt_pk_bf16_f32 v36, v52, v53
v_mfma_f32_16x16x32_bf16 v[172:175], a[252:255], a[172:175], v[172:175]
ds_read_b64_tr_b16 a[236:237], v21 offset:40960
v_accvgpr_write_b32 a104, v36
v_mfma_f32_16x16x32_bf16 v[172:175], a[248:251], a[168:171], v[172:175]
ds_read_b128 a[200:203], v2 offset:2048
v_accvgpr_read_b32 v54, a106
v_mfma_f32_16x16x32_bf16 v[204:207], a[248:251], a[176:179], v[204:207]
s_add_u32 s51, s58, 2621440
s_add_u32 m0, s59, 16384
v_mfma_f32_16x16x32_bf16 v[204:207], a[252:255], a[180:183], v[204:207]
buffer_load_dwordx4 v10, s[20:23], s51 offen offset:0 lds
v_mfma_f32_16x16x32_bf16 v[236:239], a[252:255], a[188:191], v[236:239]
ds_read_b64_tr_b16 a[238:239], v21 offset:41984
v_accvgpr_read_b32 v55, a107
v_mfma_f32_16x16x32_bf16 v[236:239], a[248:251], a[184:187], v[236:239]
ds_read_b128 a[204:207], v3 offset:2048
s_waitcnt lgkmcnt(7)
v_mfma_f32_16x16x32_bf16 v[144:147], a[224:227], a[160:163], v[144:147]
ds_read_b64_tr_b16 a[240:241], v22 offset:32768
v_cvt_pk_bf16_f32 v37, v54, v55
v_mfma_f32_16x16x32_bf16 v[144:147], a[228:231], a[164:167], v[144:147]
buffer_load_dwordx4 v11, s[20:23], s51 offen offset:1024 lds
v_mfma_f32_16x16x32_bf16 v[176:179], a[228:231], a[172:175], v[176:179]
ds_read_b64_tr_b16 a[242:243], v22 offset:33792
v_accvgpr_write_b32 a105, v37
v_mfma_f32_16x16x32_bf16 v[176:179], a[224:227], a[168:171], v[176:179]
ds_read_b64_tr_b16 a[244:245], v22 offset:40960
v_accvgpr_read_b32 v52, a108
v_mfma_f32_16x16x32_bf16 v[208:211], a[224:227], a[176:179], v[208:211]
ds_read_b128 a[208:211], v2 offset:4096
v_accvgpr_read_b32 v53, a109
v_mfma_f32_16x16x32_bf16 v[208:211], a[228:231], a[180:183], v[208:211]
buffer_load_dwordx4 v12, s[20:23], s51 offen offset:2048 lds
v_mfma_f32_16x16x32_bf16 v[240:243], a[228:231], a[188:191], v[240:243]
ds_read_b64_tr_b16 a[246:247], v22 offset:41984
v_cvt_pk_bf16_f32 v38, v52, v53
v_mfma_f32_16x16x32_bf16 v[240:243], a[224:227], a[184:187], v[240:243]
ds_read_b128 a[212:215], v3 offset:4096
s_waitcnt lgkmcnt(7)
v_mfma_f32_16x16x32_bf16 v[148:151], a[232:235], a[160:163], v[148:151]
ds_read_b64_tr_b16 a[248:249], v23 offset:32768
v_accvgpr_write_b32 a106, v38
v_mfma_f32_16x16x32_bf16 v[148:151], a[236:239], a[164:167], v[148:151]
buffer_load_dwordx4 v13, s[20:23], s51 offen offset:3072 lds
v_mfma_f32_16x16x32_bf16 v[180:183], a[236:239], a[172:175], v[180:183]
ds_read_b64_tr_b16 a[250:251], v23 offset:33792
v_accvgpr_read_b32 v54, a110
v_mfma_f32_16x16x32_bf16 v[180:183], a[232:235], a[168:171], v[180:183]
ds_read_b64_tr_b16 a[252:253], v23 offset:40960
v_accvgpr_read_b32 v55, a111
v_mfma_f32_16x16x32_bf16 v[212:215], a[232:235], a[176:179], v[212:215]
ds_read_b64_tr_b16 a[254:255], v23 offset:41984
v_cvt_pk_bf16_f32 v39, v54, v55
v_mfma_f32_16x16x32_bf16 v[212:215], a[236:239], a[180:183], v[212:215]
buffer_store_dwordx4 v[72:75], v1, s[24:27], s52 offen offset:1024 sc1
v_mfma_f32_16x16x32_bf16 v[244:247], a[236:239], a[188:191], v[244:247]
ds_read_b128 a[216:219], v2 offset:6144
v_accvgpr_write_b32 a107, v39
v_mfma_f32_16x16x32_bf16 v[244:247], a[232:235], a[184:187], v[244:247]
ds_read_b128 a[220:223], v3 offset:6144
s_waitcnt lgkmcnt(7)
v_mfma_f32_16x16x32_bf16 v[152:155], a[240:243], a[160:163], v[152:155]
s_add_u32 s50, s47, 640
s_add_u32 m0, s53, 135168
v_mfma_f32_16x16x32_bf16 v[152:155], a[244:247], a[164:167], v[152:155]
buffer_load_dwordx4 v24, s[16:19], s50 offen offset:0 lds
v_mfma_f32_16x16x32_bf16 v[184:187], a[244:247], a[172:175], v[184:187]
ds_read_b64_tr_b16 a[224:225], v16 offset:49152
v_cvt_pk_bf16_f32 v80, v80, v81
v_mfma_f32_16x16x32_bf16 v[184:187], a[240:243], a[168:171], v[184:187]
ds_read_b64_tr_b16 a[226:227], v16 offset:50176
v_cvt_pk_bf16_f32 v81, v82, v83
v_mfma_f32_16x16x32_bf16 v[216:219], a[240:243], a[176:179], v[216:219]
ds_read_b64_tr_b16 a[228:229], v16 offset:57344
v_cvt_pk_bf16_f32 v82, v84, v85
v_mfma_f32_16x16x32_bf16 v[216:219], a[244:247], a[180:183], v[216:219]
buffer_load_dwordx4 v25, s[16:19], s50 offen offset:1024 lds
v_mfma_f32_16x16x32_bf16 v[248:251], a[244:247], a[188:191], v[248:251]
ds_read_b64_tr_b16 a[230:231], v16 offset:58368
v_cvt_pk_bf16_f32 v83, v86, v87
v_mfma_f32_16x16x32_bf16 v[248:251], a[240:243], a[184:187], v[248:251]
v_accvgpr_read_b32 v52, a112
s_waitcnt lgkmcnt(6)
v_mfma_f32_16x16x32_bf16 v[156:159], a[248:251], a[160:163], v[156:159]
ds_read_b64_tr_b16 a[232:233], v17 offset:49152
v_accvgpr_read_b32 v53, a113
v_mfma_f32_16x16x32_bf16 v[156:159], a[252:255], a[164:167], v[156:159]
buffer_load_dwordx4 v26, s[16:19], s50 offen offset:2048 lds
v_mfma_f32_16x16x32_bf16 v[188:191], a[252:255], a[172:175], v[188:191]
ds_read_b64_tr_b16 a[234:235], v17 offset:50176
v_cvt_pk_bf16_f32 v36, v52, v53
v_mfma_f32_16x16x32_bf16 v[188:191], a[248:251], a[168:171], v[188:191]
ds_read_b64_tr_b16 a[236:237], v17 offset:57344
v_accvgpr_write_b32 a112, v36
v_mfma_f32_16x16x32_bf16 v[220:223], a[248:251], a[176:179], v[220:223]
ds_read_b64_tr_b16 a[238:239], v17 offset:58368
v_accvgpr_read_b32 v54, a114
v_mfma_f32_16x16x32_bf16 v[220:223], a[252:255], a[180:183], v[220:223]
buffer_load_dwordx4 v27, s[16:19], s50 offen offset:3072 lds
v_mfma_f32_16x16x32_bf16 v[252:255], a[252:255], a[188:191], v[252:255]
v_accvgpr_read_b32 v55, a115
v_cvt_pk_bf16_f32 v37, v54, v55
v_mfma_f32_16x16x32_bf16 v[252:255], a[248:251], a[184:187], v[252:255]
v_accvgpr_write_b32 a113, v37
s_waitcnt lgkmcnt(4)
v_mfma_f32_16x16x32_bf16 v[128:131], a[224:227], a[192:195], v[128:131]
ds_read_b64_tr_b16 a[240:241], v18 offset:49152
v_accvgpr_read_b32 v52, a116
v_mfma_f32_16x16x32_bf16 v[128:131], a[228:231], a[196:199], v[128:131]
ds_read_b64_tr_b16 a[242:243], v18 offset:50176
v_accvgpr_read_b32 v53, a117
v_mfma_f32_16x16x32_bf16 v[160:163], a[228:231], a[204:207], v[160:163]
ds_read_b64_tr_b16 a[244:245], v18 offset:57344
v_cvt_pk_bf16_f32 v38, v52, v53
v_mfma_f32_16x16x32_bf16 v[160:163], a[224:227], a[200:203], v[160:163]
ds_read_b64_tr_b16 a[246:247], v18 offset:58368
v_accvgpr_write_b32 a114, v38
v_mfma_f32_16x16x32_bf16 v[192:195], a[224:227], a[208:211], v[192:195]
v_accvgpr_read_b32 v54, a118
v_accvgpr_read_b32 v55, a119
v_mfma_f32_16x16x32_bf16 v[192:195], a[228:231], a[212:215], v[192:195]
buffer_store_dwordx4 v[80:83], v1, s[24:27], s52 offen offset:2048 sc1
v_mfma_f32_16x16x32_bf16 v[224:227], a[228:231], a[220:223], v[224:227]
v_cvt_pk_bf16_f32 v39, v54, v55
v_accvgpr_write_b32 a115, v39
v_mfma_f32_16x16x32_bf16 v[224:227], a[224:227], a[216:219], v[224:227]
v_accvgpr_read_b32 v52, a120
s_waitcnt lgkmcnt(4)
v_mfma_f32_16x16x32_bf16 v[132:135], a[232:235], a[192:195], v[132:135]
s_add_u32 s50, s46, 768
s_add_u32 m0, s53, 65536
v_mfma_f32_16x16x32_bf16 v[132:135], a[236:239], a[196:199], v[132:135]
buffer_load_dwordx4 v24, s[16:19], s50 offen offset:0 lds
v_mfma_f32_16x16x32_bf16 v[164:167], a[236:239], a[204:207], v[164:167]
ds_read_b64_tr_b16 a[248:249], v19 offset:49152
v_accvgpr_read_b32 v53, a121
v_mfma_f32_16x16x32_bf16 v[164:167], a[232:235], a[200:203], v[164:167]
ds_read_b64_tr_b16 a[250:251], v19 offset:50176
v_cvt_pk_bf16_f32 v36, v52, v53
v_mfma_f32_16x16x32_bf16 v[196:199], a[232:235], a[208:211], v[196:199]
ds_read_b64_tr_b16 a[252:253], v19 offset:57344
v_accvgpr_write_b32 a120, v36
v_mfma_f32_16x16x32_bf16 v[196:199], a[236:239], a[212:215], v[196:199]
buffer_load_dwordx4 v25, s[16:19], s50 offen offset:1024 lds
v_mfma_f32_16x16x32_bf16 v[228:231], a[236:239], a[220:223], v[228:231]
ds_read_b64_tr_b16 a[254:255], v19 offset:58368
s_waitcnt vmcnt(17) lgkmcnt(4)
v_mfma_f32_16x16x32_bf16 v[228:231], a[232:235], a[216:219], v[228:231]
v_accvgpr_read_b32 v54, a122
s_barrier
v_mfma_f32_16x16x32_bf16 v[136:139], a[240:243], a[192:195], v[136:139]
ds_read_b64_tr_b16 a[224:225], v20 offset:49152
v_accvgpr_read_b32 v55, a123
v_mfma_f32_16x16x32_bf16 v[136:139], a[244:247], a[196:199], v[136:139]
buffer_load_dwordx4 v26, s[16:19], s50 offen offset:2048 lds
v_mfma_f32_16x16x32_bf16 v[168:171], a[244:247], a[204:207], v[168:171]
ds_read_b64_tr_b16 a[226:227], v20 offset:50176
v_cvt_pk_bf16_f32 v37, v54, v55
v_mfma_f32_16x16x32_bf16 v[168:171], a[240:243], a[200:203], v[168:171]
ds_read_b128 a[160:163], v2 offset:32768
v_accvgpr_write_b32 a121, v37
v_mfma_f32_16x16x32_bf16 v[200:203], a[240:243], a[208:211], v[200:203]
ds_read_b64_tr_b16 a[228:229], v20 offset:57344
v_accvgpr_read_b32 v52, a124
v_mfma_f32_16x16x32_bf16 v[200:203], a[244:247], a[212:215], v[200:203]
buffer_load_dwordx4 v27, s[16:19], s50 offen offset:3072 lds
v_mfma_f32_16x16x32_bf16 v[232:235], a[244:247], a[220:223], v[232:235]
ds_read_b64_tr_b16 a[230:231], v20 offset:58368
v_accvgpr_read_b32 v53, a125
v_mfma_f32_16x16x32_bf16 v[232:235], a[240:243], a[216:219], v[232:235]
ds_read_b128 a[164:167], v3 offset:32768
s_waitcnt lgkmcnt(6)
v_mfma_f32_16x16x32_bf16 v[140:143], a[248:251], a[192:195], v[140:143]
ds_read_b64_tr_b16 a[232:233], v21 offset:49152
v_cvt_pk_bf16_f32 v38, v52, v53
v_mfma_f32_16x16x32_bf16 v[140:143], a[252:255], a[196:199], v[140:143]
ds_read_b64_tr_b16 a[234:235], v21 offset:50176
v_accvgpr_write_b32 a122, v38
v_mfma_f32_16x16x32_bf16 v[172:175], a[252:255], a[204:207], v[172:175]
ds_read_b64_tr_b16 a[236:237], v21 offset:57344
v_accvgpr_read_b32 v54, a126
v_mfma_f32_16x16x32_bf16 v[172:175], a[248:251], a[200:203], v[172:175]
ds_read_b128 a[168:171], v2 offset:34816
v_accvgpr_read_b32 v55, a127
v_mfma_f32_16x16x32_bf16 v[204:207], a[248:251], a[208:211], v[204:207]
s_add_u32 s51, s58, 3145728
s_add_u32 m0, s59, 32768
v_mfma_f32_16x16x32_bf16 v[204:207], a[252:255], a[212:215], v[204:207]
buffer_load_dwordx4 v10, s[20:23], s51 offen offset:0 lds
v_mfma_f32_16x16x32_bf16 v[236:239], a[252:255], a[220:223], v[236:239]
ds_read_b64_tr_b16 a[238:239], v21 offset:58368
v_cvt_pk_bf16_f32 v39, v54, v55
v_mfma_f32_16x16x32_bf16 v[236:239], a[248:251], a[216:219], v[236:239]
ds_read_b128 a[172:175], v3 offset:34816
s_waitcnt lgkmcnt(7)
v_mfma_f32_16x16x32_bf16 v[144:147], a[224:227], a[192:195], v[144:147]
ds_read_b64_tr_b16 a[240:241], v22 offset:49152
v_accvgpr_write_b32 a123, v39
v_mfma_f32_16x16x32_bf16 v[144:147], a[228:231], a[196:199], v[144:147]
buffer_load_dwordx4 v11, s[20:23], s51 offen offset:1024 lds
v_mfma_f32_16x16x32_bf16 v[176:179], a[228:231], a[204:207], v[176:179]
ds_read_b64_tr_b16 a[242:243], v22 offset:50176
v_cvt_pk_bf16_f32 v88, v88, v89
v_mfma_f32_16x16x32_bf16 v[176:179], a[224:227], a[200:203], v[176:179]
ds_read_b64_tr_b16 a[244:245], v22 offset:57344
v_cvt_pk_bf16_f32 v89, v90, v91
v_mfma_f32_16x16x32_bf16 v[208:211], a[224:227], a[208:211], v[208:211]
ds_read_b128 a[176:179], v2 offset:36864
v_cvt_pk_bf16_f32 v90, v92, v93
v_mfma_f32_16x16x32_bf16 v[208:211], a[228:231], a[212:215], v[208:211]
buffer_load_dwordx4 v12, s[20:23], s51 offen offset:2048 lds
v_mfma_f32_16x16x32_bf16 v[240:243], a[228:231], a[220:223], v[240:243]
ds_read_b64_tr_b16 a[246:247], v22 offset:58368
v_cvt_pk_bf16_f32 v91, v94, v95
v_mfma_f32_16x16x32_bf16 v[240:243], a[224:227], a[216:219], v[240:243]
ds_read_b128 a[180:183], v3 offset:36864
s_waitcnt lgkmcnt(7)
v_mfma_f32_16x16x32_bf16 v[148:151], a[232:235], a[192:195], v[148:151]
ds_read_b64_tr_b16 a[248:249], v23 offset:49152
v_accvgpr_read_b32 v52, a128
v_mfma_f32_16x16x32_bf16 v[148:151], a[236:239], a[196:199], v[148:151]
buffer_load_dwordx4 v13, s[20:23], s51 offen offset:3072 lds
v_mfma_f32_16x16x32_bf16 v[180:183], a[236:239], a[204:207], v[180:183]
ds_read_b64_tr_b16 a[250:251], v23 offset:50176
v_accvgpr_read_b32 v53, a129
v_mfma_f32_16x16x32_bf16 v[180:183], a[232:235], a[200:203], v[180:183]
ds_read_b64_tr_b16 a[252:253], v23 offset:57344
v_cvt_pk_bf16_f32 v60, v52, v53
v_mfma_f32_16x16x32_bf16 v[212:215], a[232:235], a[208:211], v[212:215]
ds_read_b64_tr_b16 a[254:255], v23 offset:58368
v_accvgpr_read_b32 v54, a130
v_mfma_f32_16x16x32_bf16 v[212:215], a[236:239], a[212:215], v[212:215]
buffer_store_dwordx4 v[88:91], v1, s[24:27], s52 offen offset:3072 sc1
v_mfma_f32_16x16x32_bf16 v[244:247], a[236:239], a[220:223], v[244:247]
ds_read_b128 a[184:187], v2 offset:38912
v_accvgpr_read_b32 v55, a131
v_mfma_f32_16x16x32_bf16 v[244:247], a[232:235], a[216:219], v[244:247]
ds_read_b128 a[188:191], v3 offset:38912
s_waitcnt lgkmcnt(7)
v_mfma_f32_16x16x32_bf16 v[152:155], a[240:243], a[192:195], v[152:155]
s_add_u32 s50, s47, 768
s_add_u32 m0, s53, 69632
v_mfma_f32_16x16x32_bf16 v[152:155], a[244:247], a[196:199], v[152:155]
buffer_load_dwordx4 v24, s[16:19], s50 offen offset:0 lds
v_mfma_f32_16x16x32_bf16 v[184:187], a[244:247], a[204:207], v[184:187]
ds_read_b64_tr_b16 a[224:225], v16 offset:0
v_cvt_pk_bf16_f32 v61, v54, v55
v_mfma_f32_16x16x32_bf16 v[184:187], a[240:243], a[200:203], v[184:187]
ds_read_b64_tr_b16 a[226:227], v16 offset:1024
v_accvgpr_read_b32 v52, a132
v_mfma_f32_16x16x32_bf16 v[216:219], a[240:243], a[208:211], v[216:219]
ds_read_b64_tr_b16 a[228:229], v16 offset:8192
v_accvgpr_read_b32 v53, a133
v_mfma_f32_16x16x32_bf16 v[216:219], a[244:247], a[212:215], v[216:219]
buffer_load_dwordx4 v25, s[16:19], s50 offen offset:1024 lds
v_mfma_f32_16x16x32_bf16 v[248:251], a[244:247], a[220:223], v[248:251]
ds_read_b64_tr_b16 a[230:231], v16 offset:9216
v_cvt_pk_bf16_f32 v62, v52, v53
v_mfma_f32_16x16x32_bf16 v[248:251], a[240:243], a[216:219], v[248:251]
v_accvgpr_read_b32 v54, a134
s_waitcnt lgkmcnt(6)
v_mfma_f32_16x16x32_bf16 v[156:159], a[248:251], a[192:195], v[156:159]
ds_read_b64_tr_b16 a[232:233], v17 offset:0
v_accvgpr_read_b32 v55, a135
v_mfma_f32_16x16x32_bf16 v[156:159], a[252:255], a[196:199], v[156:159]
buffer_load_dwordx4 v26, s[16:19], s50 offen offset:2048 lds
v_mfma_f32_16x16x32_bf16 v[188:191], a[252:255], a[204:207], v[188:191]
ds_read_b64_tr_b16 a[234:235], v17 offset:1024
v_cvt_pk_bf16_f32 v63, v54, v55
v_mfma_f32_16x16x32_bf16 v[188:191], a[248:251], a[200:203], v[188:191]
ds_read_b64_tr_b16 a[236:237], v17 offset:8192
v_cvt_pk_bf16_f32 v96, v96, v97
v_mfma_f32_16x16x32_bf16 v[220:223], a[248:251], a[208:211], v[220:223]
ds_read_b64_tr_b16 a[238:239], v17 offset:9216
v_cvt_pk_bf16_f32 v97, v98, v99
v_mfma_f32_16x16x32_bf16 v[220:223], a[252:255], a[212:215], v[220:223]
buffer_load_dwordx4 v27, s[16:19], s50 offen offset:3072 lds
v_mfma_f32_16x16x32_bf16 v[252:255], a[252:255], a[220:223], v[252:255]
v_cvt_pk_bf16_f32 v98, v100, v101
v_cvt_pk_bf16_f32 v99, v102, v103
v_mfma_f32_16x16x32_bf16 v[252:255], a[248:251], a[216:219], v[252:255]
v_accvgpr_read_b32 v52, a136
s_waitcnt lgkmcnt(4)
v_mfma_f32_16x16x32_bf16 v[128:131], a[224:227], a[160:163], v[128:131]
ds_read_b64_tr_b16 a[240:241], v18 offset:0
v_accvgpr_read_b32 v53, a137
v_mfma_f32_16x16x32_bf16 v[128:131], a[228:231], a[164:167], v[128:131]
ds_read_b64_tr_b16 a[242:243], v18 offset:1024
v_cvt_pk_bf16_f32 v68, v52, v53
v_mfma_f32_16x16x32_bf16 v[160:163], a[228:231], a[172:175], v[160:163]
ds_read_b64_tr_b16 a[244:245], v18 offset:8192
v_accvgpr_read_b32 v54, a138
v_mfma_f32_16x16x32_bf16 v[160:163], a[224:227], a[168:171], v[160:163]
ds_read_b64_tr_b16 a[246:247], v18 offset:9216
v_accvgpr_read_b32 v55, a139
v_mfma_f32_16x16x32_bf16 v[192:195], a[224:227], a[176:179], v[192:195]
s_add_u32 s52, s49, 8192
v_cvt_pk_bf16_f32 v69, v54, v55
v_mfma_f32_16x16x32_bf16 v[192:195], a[228:231], a[180:183], v[192:195]
buffer_store_dwordx4 v[96:99], v1, s[24:27], s52 offen offset:0 sc1
v_mfma_f32_16x16x32_bf16 v[224:227], a[228:231], a[188:191], v[224:227]
v_accvgpr_read_b32 v52, a140
v_accvgpr_read_b32 v53, a141
v_mfma_f32_16x16x32_bf16 v[224:227], a[224:227], a[184:187], v[224:227]
v_cvt_pk_bf16_f32 v70, v52, v53
s_waitcnt lgkmcnt(4)
v_mfma_f32_16x16x32_bf16 v[132:135], a[232:235], a[160:163], v[132:135]
s_add_u32 s50, s46, 896
s_add_u32 m0, s53, 98304
v_mfma_f32_16x16x32_bf16 v[132:135], a[236:239], a[164:167], v[132:135]
buffer_load_dwordx4 v24, s[16:19], s50 offen offset:0 lds
v_mfma_f32_16x16x32_bf16 v[164:167], a[236:239], a[172:175], v[164:167]
ds_read_b64_tr_b16 a[248:249], v19 offset:0
v_accvgpr_read_b32 v54, a142
v_mfma_f32_16x16x32_bf16 v[164:167], a[232:235], a[168:171], v[164:167]
ds_read_b64_tr_b16 a[250:251], v19 offset:1024
v_accvgpr_read_b32 v55, a143
v_mfma_f32_16x16x32_bf16 v[196:199], a[232:235], a[176:179], v[196:199]
ds_read_b64_tr_b16 a[252:253], v19 offset:8192
v_cvt_pk_bf16_f32 v71, v54, v55
v_mfma_f32_16x16x32_bf16 v[196:199], a[236:239], a[180:183], v[196:199]
buffer_load_dwordx4 v25, s[16:19], s50 offen offset:1024 lds
v_mfma_f32_16x16x32_bf16 v[228:231], a[236:239], a[188:191], v[228:231]
ds_read_b64_tr_b16 a[254:255], v19 offset:9216
s_waitcnt vmcnt(17) lgkmcnt(4)
v_mfma_f32_16x16x32_bf16 v[228:231], a[232:235], a[184:187], v[228:231]
v_accvgpr_read_b32 v52, a144
s_barrier
v_mfma_f32_16x16x32_bf16 v[136:139], a[240:243], a[160:163], v[136:139]
ds_read_b64_tr_b16 a[224:225], v20 offset:0
v_accvgpr_read_b32 v53, a145
v_mfma_f32_16x16x32_bf16 v[136:139], a[244:247], a[164:167], v[136:139]
buffer_load_dwordx4 v26, s[16:19], s50 offen offset:2048 lds
v_mfma_f32_16x16x32_bf16 v[168:171], a[244:247], a[172:175], v[168:171]
ds_read_b64_tr_b16 a[226:227], v20 offset:1024
v_cvt_pk_bf16_f32 v76, v52, v53
v_mfma_f32_16x16x32_bf16 v[168:171], a[240:243], a[168:171], v[168:171]
ds_read_b128 a[192:195], v4 offset:0
v_accvgpr_read_b32 v54, a146
v_mfma_f32_16x16x32_bf16 v[200:203], a[240:243], a[176:179], v[200:203]
ds_read_b64_tr_b16 a[228:229], v20 offset:8192
v_accvgpr_read_b32 v55, a147
v_mfma_f32_16x16x32_bf16 v[200:203], a[244:247], a[180:183], v[200:203]
buffer_load_dwordx4 v27, s[16:19], s50 offen offset:3072 lds
v_mfma_f32_16x16x32_bf16 v[232:235], a[244:247], a[188:191], v[232:235]
ds_read_b64_tr_b16 a[230:231], v20 offset:9216
v_cvt_pk_bf16_f32 v77, v54, v55
v_mfma_f32_16x16x32_bf16 v[232:235], a[240:243], a[184:187], v[232:235]
ds_read_b128 a[196:199], v5 offset:0
s_waitcnt lgkmcnt(6)
v_mfma_f32_16x16x32_bf16 v[140:143], a[248:251], a[160:163], v[140:143]
ds_read_b64_tr_b16 a[232:233], v21 offset:0
v_accvgpr_read_b32 v52, a148
v_mfma_f32_16x16x32_bf16 v[140:143], a[252:255], a[164:167], v[140:143]
ds_read_b64_tr_b16 a[234:235], v21 offset:1024
v_accvgpr_read_b32 v53, a149
v_mfma_f32_16x16x32_bf16 v[172:175], a[252:255], a[172:175], v[172:175]
ds_read_b64_tr_b16 a[236:237], v21 offset:8192
v_cvt_pk_bf16_f32 v78, v52, v53
v_mfma_f32_16x16x32_bf16 v[172:175], a[248:251], a[168:171], v[172:175]
ds_read_b128 a[200:203], v4 offset:2048
v_accvgpr_read_b32 v54, a150
v_mfma_f32_16x16x32_bf16 v[204:207], a[248:251], a[176:179], v[204:207]
s_add_u32 s51, s58, 3670016
s_add_u32 m0, s59, 49152
v_mfma_f32_16x16x32_bf16 v[204:207], a[252:255], a[180:183], v[204:207]
buffer_load_dwordx4 v10, s[20:23], s51 offen offset:0 lds
v_mfma_f32_16x16x32_bf16 v[236:239], a[252:255], a[188:191], v[236:239]
ds_read_b64_tr_b16 a[238:239], v21 offset:9216
v_accvgpr_read_b32 v55, a151
v_mfma_f32_16x16x32_bf16 v[236:239], a[248:251], a[184:187], v[236:239]
ds_read_b128 a[204:207], v5 offset:2048
s_waitcnt lgkmcnt(7)
v_mfma_f32_16x16x32_bf16 v[144:147], a[224:227], a[160:163], v[144:147]
ds_read_b64_tr_b16 a[240:241], v22 offset:0
v_cvt_pk_bf16_f32 v79, v54, v55
v_mfma_f32_16x16x32_bf16 v[144:147], a[228:231], a[164:167], v[144:147]
buffer_load_dwordx4 v11, s[20:23], s51 offen offset:1024 lds
v_mfma_f32_16x16x32_bf16 v[176:179], a[228:231], a[172:175], v[176:179]
ds_read_b64_tr_b16 a[242:243], v22 offset:1024
v_cvt_pk_bf16_f32 v104, v104, v105
v_mfma_f32_16x16x32_bf16 v[176:179], a[224:227], a[168:171], v[176:179]
ds_read_b64_tr_b16 a[244:245], v22 offset:8192
v_cvt_pk_bf16_f32 v105, v106, v107
v_mfma_f32_16x16x32_bf16 v[208:211], a[224:227], a[176:179], v[208:211]
ds_read_b128 a[208:211], v4 offset:4096
v_cvt_pk_bf16_f32 v106, v108, v109
v_mfma_f32_16x16x32_bf16 v[208:211], a[228:231], a[180:183], v[208:211]
buffer_load_dwordx4 v12, s[20:23], s51 offen offset:2048 lds
v_mfma_f32_16x16x32_bf16 v[240:243], a[228:231], a[188:191], v[240:243]
ds_read_b64_tr_b16 a[246:247], v22 offset:9216
v_cvt_pk_bf16_f32 v107, v110, v111
v_mfma_f32_16x16x32_bf16 v[240:243], a[224:227], a[184:187], v[240:243]
ds_read_b128 a[212:215], v5 offset:4096
s_waitcnt lgkmcnt(7)
v_mfma_f32_16x16x32_bf16 v[148:151], a[232:235], a[160:163], v[148:151]
ds_read_b64_tr_b16 a[248:249], v23 offset:0
v_cvt_pk_bf16_f32 v112, v112, v113
v_mfma_f32_16x16x32_bf16 v[148:151], a[236:239], a[164:167], v[148:151]
buffer_load_dwordx4 v13, s[20:23], s51 offen offset:3072 lds
v_mfma_f32_16x16x32_bf16 v[180:183], a[236:239], a[172:175], v[180:183]
ds_read_b64_tr_b16 a[250:251], v23 offset:1024
v_cvt_pk_bf16_f32 v113, v114, v115
v_mfma_f32_16x16x32_bf16 v[180:183], a[232:235], a[168:171], v[180:183]
ds_read_b64_tr_b16 a[252:253], v23 offset:8192
v_cvt_pk_bf16_f32 v114, v116, v117
v_mfma_f32_16x16x32_bf16 v[212:215], a[232:235], a[176:179], v[212:215]
ds_read_b64_tr_b16 a[254:255], v23 offset:9216
v_cvt_pk_bf16_f32 v115, v118, v119
v_mfma_f32_16x16x32_bf16 v[212:215], a[236:239], a[180:183], v[212:215]
buffer_store_dwordx4 v[104:107], v1, s[24:27], s52 offen offset:1024 sc1
v_mfma_f32_16x16x32_bf16 v[244:247], a[236:239], a[188:191], v[244:247]
ds_read_b128 a[216:219], v4 offset:6144
v_accvgpr_read_b32 v52, a152
v_mfma_f32_16x16x32_bf16 v[244:247], a[232:235], a[184:187], v[244:247]
ds_read_b128 a[220:223], v5 offset:6144
s_waitcnt lgkmcnt(7)
v_mfma_f32_16x16x32_bf16 v[152:155], a[240:243], a[160:163], v[152:155]
s_add_u32 s50, s47, 896
s_add_u32 m0, s53, 102400
v_mfma_f32_16x16x32_bf16 v[152:155], a[244:247], a[164:167], v[152:155]
buffer_load_dwordx4 v24, s[16:19], s50 offen offset:0 lds
v_mfma_f32_16x16x32_bf16 v[184:187], a[244:247], a[172:175], v[184:187]
ds_read_b64_tr_b16 a[224:225], v16 offset:16384
v_accvgpr_read_b32 v53, a153
v_mfma_f32_16x16x32_bf16 v[184:187], a[240:243], a[168:171], v[184:187]
ds_read_b64_tr_b16 a[226:227], v16 offset:17408
v_cvt_pk_bf16_f32 v84, v52, v53
v_mfma_f32_16x16x32_bf16 v[216:219], a[240:243], a[176:179], v[216:219]
ds_read_b64_tr_b16 a[228:229], v16 offset:24576
v_accvgpr_read_b32 v54, a154
v_mfma_f32_16x16x32_bf16 v[216:219], a[244:247], a[180:183], v[216:219]
buffer_load_dwordx4 v25, s[16:19], s50 offen offset:1024 lds
v_mfma_f32_16x16x32_bf16 v[248:251], a[244:247], a[188:191], v[248:251]
ds_read_b64_tr_b16 a[230:231], v16 offset:25600
v_accvgpr_read_b32 v55, a155
v_mfma_f32_16x16x32_bf16 v[248:251], a[240:243], a[184:187], v[248:251]
v_cvt_pk_bf16_f32 v85, v54, v55
s_waitcnt lgkmcnt(6)
v_mfma_f32_16x16x32_bf16 v[156:159], a[248:251], a[160:163], v[156:159]
ds_read_b64_tr_b16 a[232:233], v17 offset:16384
v_accvgpr_read_b32 v52, a156
v_mfma_f32_16x16x32_bf16 v[156:159], a[252:255], a[164:167], v[156:159]
buffer_load_dwordx4 v26, s[16:19], s50 offen offset:2048 lds
v_mfma_f32_16x16x32_bf16 v[188:191], a[252:255], a[172:175], v[188:191]
ds_read_b64_tr_b16 a[234:235], v17 offset:17408
v_accvgpr_read_b32 v53, a157
v_mfma_f32_16x16x32_bf16 v[188:191], a[248:251], a[168:171], v[188:191]
ds_read_b64_tr_b16 a[236:237], v17 offset:24576
v_cvt_pk_bf16_f32 v86, v52, v53
v_mfma_f32_16x16x32_bf16 v[220:223], a[248:251], a[176:179], v[220:223]
ds_read_b64_tr_b16 a[238:239], v17 offset:25600
v_accvgpr_read_b32 v54, a158
v_mfma_f32_16x16x32_bf16 v[220:223], a[252:255], a[180:183], v[220:223]
buffer_load_dwordx4 v27, s[16:19], s50 offen offset:3072 lds
v_mfma_f32_16x16x32_bf16 v[252:255], a[252:255], a[188:191], v[252:255]
v_accvgpr_read_b32 v55, a159
v_cvt_pk_bf16_f32 v87, v54, v55
v_mfma_f32_16x16x32_bf16 v[252:255], a[248:251], a[184:187], v[252:255]
v_accvgpr_read_b32 v52, a0
s_waitcnt lgkmcnt(4)
v_mfma_f32_16x16x32_bf16 v[128:131], a[224:227], a[192:195], v[128:131]
ds_read_b64_tr_b16 a[240:241], v18 offset:16384
v_accvgpr_read_b32 v53, a1
v_mfma_f32_16x16x32_bf16 v[128:131], a[228:231], a[196:199], v[128:131]
ds_read_b64_tr_b16 a[242:243], v18 offset:17408
v_cvt_pk_bf16_f32 v36, v52, v53
v_mfma_f32_16x16x32_bf16 v[160:163], a[228:231], a[204:207], v[160:163]
ds_read_b64_tr_b16 a[244:245], v18 offset:24576
v_accvgpr_write_b32 a68, v36
v_mfma_f32_16x16x32_bf16 v[160:163], a[224:227], a[200:203], v[160:163]
ds_read_b64_tr_b16 a[246:247], v18 offset:25600
v_accvgpr_read_b32 v54, a2
v_mfma_f32_16x16x32_bf16 v[192:195], a[224:227], a[208:211], v[192:195]
v_accvgpr_read_b32 v55, a3
v_cvt_pk_bf16_f32 v37, v54, v55
v_mfma_f32_16x16x32_bf16 v[192:195], a[228:231], a[212:215], v[192:195]
buffer_store_dwordx4 v[112:115], v1, s[24:27], s52 offen offset:2048 sc1
v_mfma_f32_16x16x32_bf16 v[224:227], a[228:231], a[220:223], v[224:227]
v_accvgpr_write_b32 a69, v37
v_accvgpr_read_b32 v52, a4
v_mfma_f32_16x16x32_bf16 v[224:227], a[224:227], a[216:219], v[224:227]
v_accvgpr_read_b32 v53, a5
s_waitcnt lgkmcnt(4)
v_mfma_f32_16x16x32_bf16 v[132:135], a[232:235], a[192:195], v[132:135]
s_add_u32 s50, s46, 1024
s_add_u32 m0, s53, 131072
v_mfma_f32_16x16x32_bf16 v[132:135], a[236:239], a[196:199], v[132:135]
buffer_load_dwordx4 v24, s[16:19], s50 offen offset:0 lds
v_mfma_f32_16x16x32_bf16 v[164:167], a[236:239], a[204:207], v[164:167]
ds_read_b64_tr_b16 a[248:249], v19 offset:16384
v_cvt_pk_bf16_f32 v38, v52, v53
v_mfma_f32_16x16x32_bf16 v[164:167], a[232:235], a[200:203], v[164:167]
ds_read_b64_tr_b16 a[250:251], v19 offset:17408
v_accvgpr_write_b32 a70, v38
v_mfma_f32_16x16x32_bf16 v[196:199], a[232:235], a[208:211], v[196:199]
ds_read_b64_tr_b16 a[252:253], v19 offset:24576
v_accvgpr_read_b32 v54, a6
v_mfma_f32_16x16x32_bf16 v[196:199], a[236:239], a[212:215], v[196:199]
buffer_load_dwordx4 v25, s[16:19], s50 offen offset:1024 lds
v_mfma_f32_16x16x32_bf16 v[228:231], a[236:239], a[220:223], v[228:231]
ds_read_b64_tr_b16 a[254:255], v19 offset:25600
s_waitcnt vmcnt(17) lgkmcnt(4)
v_mfma_f32_16x16x32_bf16 v[228:231], a[232:235], a[216:219], v[228:231]
v_accvgpr_read_b32 v55, a7
s_barrier
v_mfma_f32_16x16x32_bf16 v[136:139], a[240:243], a[192:195], v[136:139]
ds_read_b64_tr_b16 a[224:225], v20 offset:16384
v_cvt_pk_bf16_f32 v39, v54, v55
v_mfma_f32_16x16x32_bf16 v[136:139], a[244:247], a[196:199], v[136:139]
buffer_load_dwordx4 v26, s[16:19], s50 offen offset:2048 lds
v_mfma_f32_16x16x32_bf16 v[168:171], a[244:247], a[204:207], v[168:171]
ds_read_b64_tr_b16 a[226:227], v20 offset:17408
v_accvgpr_write_b32 a71, v39
v_mfma_f32_16x16x32_bf16 v[168:171], a[240:243], a[200:203], v[168:171]
ds_read_b128 a[160:163], v2 offset:0
v_cvt_pk_bf16_f32 v120, v120, v121
v_mfma_f32_16x16x32_bf16 v[200:203], a[240:243], a[208:211], v[200:203]
ds_read_b64_tr_b16 a[228:229], v20 offset:24576
v_cvt_pk_bf16_f32 v121, v122, v123
v_mfma_f32_16x16x32_bf16 v[200:203], a[244:247], a[212:215], v[200:203]
buffer_load_dwordx4 v27, s[16:19], s50 offen offset:3072 lds
v_mfma_f32_16x16x32_bf16 v[232:235], a[244:247], a[220:223], v[232:235]
ds_read_b64_tr_b16 a[230:231], v20 offset:25600
v_cvt_pk_bf16_f32 v122, v124, v125
v_mfma_f32_16x16x32_bf16 v[232:235], a[240:243], a[216:219], v[232:235]
ds_read_b128 a[164:167], v3 offset:0
s_waitcnt lgkmcnt(6)
v_mfma_f32_16x16x32_bf16 v[140:143], a[248:251], a[192:195], v[140:143]
ds_read_b64_tr_b16 a[232:233], v21 offset:16384
v_cvt_pk_bf16_f32 v123, v126, v127
v_mfma_f32_16x16x32_bf16 v[140:143], a[252:255], a[196:199], v[140:143]
ds_read_b64_tr_b16 a[234:235], v21 offset:17408
v_accvgpr_read_b32 v52, a8
v_mfma_f32_16x16x32_bf16 v[172:175], a[252:255], a[204:207], v[172:175]
ds_read_b64_tr_b16 a[236:237], v21 offset:24576
v_accvgpr_read_b32 v53, a9
v_mfma_f32_16x16x32_bf16 v[172:175], a[248:251], a[200:203], v[172:175]
ds_read_b128 a[168:171], v2 offset:2048
v_cvt_pk_bf16_f32 v36, v52, v53
v_mfma_f32_16x16x32_bf16 v[204:207], a[248:251], a[208:211], v[204:207]
s_add_u32 s51, s58, 4194304
s_add_u32 m0, s59, 0
v_mfma_f32_16x16x32_bf16 v[204:207], a[252:255], a[212:215], v[204:207]
buffer_load_dwordx4 v10, s[20:23], s51 offen offset:0 lds
v_mfma_f32_16x16x32_bf16 v[236:239], a[252:255], a[220:223], v[236:239]
ds_read_b64_tr_b16 a[238:239], v21 offset:25600
v_accvgpr_write_b32 a76, v36
v_mfma_f32_16x16x32_bf16 v[236:239], a[248:251], a[216:219], v[236:239]
ds_read_b128 a[172:175], v3 offset:2048
s_waitcnt lgkmcnt(7)
v_mfma_f32_16x16x32_bf16 v[144:147], a[224:227], a[192:195], v[144:147]
ds_read_b64_tr_b16 a[240:241], v22 offset:16384
v_accvgpr_read_b32 v54, a10
v_mfma_f32_16x16x32_bf16 v[144:147], a[228:231], a[196:199], v[144:147]
buffer_load_dwordx4 v11, s[20:23], s51 offen offset:1024 lds
v_mfma_f32_16x16x32_bf16 v[176:179], a[228:231], a[204:207], v[176:179]
ds_read_b64_tr_b16 a[242:243], v22 offset:17408
v_accvgpr_read_b32 v55, a11
v_mfma_f32_16x16x32_bf16 v[176:179], a[224:227], a[200:203], v[176:179]
ds_read_b64_tr_b16 a[244:245], v22 offset:24576
v_cvt_pk_bf16_f32 v37, v54, v55
v_mfma_f32_16x16x32_bf16 v[208:211], a[224:227], a[208:211], v[208:211]
ds_read_b128 a[176:179], v2 offset:4096
v_accvgpr_write_b32 a77, v37
v_mfma_f32_16x16x32_bf16 v[208:211], a[228:231], a[212:215], v[208:211]
buffer_load_dwordx4 v12, s[20:23], s51 offen offset:2048 lds
v_mfma_f32_16x16x32_bf16 v[240:243], a[228:231], a[220:223], v[240:243]
ds_read_b64_tr_b16 a[246:247], v22 offset:25600
v_accvgpr_read_b32 v52, a12
v_mfma_f32_16x16x32_bf16 v[240:243], a[224:227], a[216:219], v[240:243]
ds_read_b128 a[180:183], v3 offset:4096
s_waitcnt lgkmcnt(7)
v_mfma_f32_16x16x32_bf16 v[148:151], a[232:235], a[192:195], v[148:151]
ds_read_b64_tr_b16 a[248:249], v23 offset:16384
v_accvgpr_read_b32 v53, a13
v_mfma_f32_16x16x32_bf16 v[148:151], a[236:239], a[196:199], v[148:151]
buffer_load_dwordx4 v13, s[20:23], s51 offen offset:3072 lds
v_mfma_f32_16x16x32_bf16 v[180:183], a[236:239], a[204:207], v[180:183]
ds_read_b64_tr_b16 a[250:251], v23 offset:17408
v_cvt_pk_bf16_f32 v38, v52, v53
v_mfma_f32_16x16x32_bf16 v[180:183], a[232:235], a[200:203], v[180:183]
ds_read_b64_tr_b16 a[252:253], v23 offset:24576
v_accvgpr_write_b32 a78, v38
v_mfma_f32_16x16x32_bf16 v[212:215], a[232:235], a[208:211], v[212:215]
ds_read_b64_tr_b16 a[254:255], v23 offset:25600
v_accvgpr_read_b32 v54, a14
v_mfma_f32_16x16x32_bf16 v[212:215], a[236:239], a[212:215], v[212:215]
buffer_store_dwordx4 v[120:123], v1, s[24:27], s52 offen offset:3072 sc1
v_mfma_f32_16x16x32_bf16 v[244:247], a[236:239], a[220:223], v[244:247]
ds_read_b128 a[184:187], v2 offset:6144
v_accvgpr_read_b32 v55, a15
v_mfma_f32_16x16x32_bf16 v[244:247], a[232:235], a[216:219], v[244:247]
ds_read_b128 a[188:191], v3 offset:6144
s_waitcnt lgkmcnt(7)
v_mfma_f32_16x16x32_bf16 v[152:155], a[240:243], a[192:195], v[152:155]
s_add_u32 s50, s47, 1024
s_add_u32 m0, s53, 135168
v_mfma_f32_16x16x32_bf16 v[152:155], a[244:247], a[196:199], v[152:155]
buffer_load_dwordx4 v24, s[16:19], s50 offen offset:0 lds
v_mfma_f32_16x16x32_bf16 v[184:187], a[244:247], a[204:207], v[184:187]
ds_read_b64_tr_b16 a[224:225], v16 offset:32768
v_cvt_pk_bf16_f32 v39, v54, v55
v_mfma_f32_16x16x32_bf16 v[184:187], a[240:243], a[200:203], v[184:187]
ds_read_b64_tr_b16 a[226:227], v16 offset:33792
v_accvgpr_write_b32 a79, v39
v_mfma_f32_16x16x32_bf16 v[216:219], a[240:243], a[208:211], v[216:219]
ds_read_b64_tr_b16 a[228:229], v16 offset:40960
v_accvgpr_read_b32 v52, a16
v_mfma_f32_16x16x32_bf16 v[216:219], a[244:247], a[212:215], v[216:219]
buffer_load_dwordx4 v25, s[16:19], s50 offen offset:1024 lds
v_mfma_f32_16x16x32_bf16 v[248:251], a[244:247], a[220:223], v[248:251]
ds_read_b64_tr_b16 a[230:231], v16 offset:41984
v_accvgpr_read_b32 v53, a17
v_mfma_f32_16x16x32_bf16 v[248:251], a[240:243], a[216:219], v[248:251]
v_cvt_pk_bf16_f32 v36, v52, v53
s_waitcnt lgkmcnt(6)
v_mfma_f32_16x16x32_bf16 v[156:159], a[248:251], a[192:195], v[156:159]
ds_read_b64_tr_b16 a[232:233], v17 offset:32768
v_accvgpr_write_b32 a84, v36
v_mfma_f32_16x16x32_bf16 v[156:159], a[252:255], a[196:199], v[156:159]
buffer_load_dwordx4 v26, s[16:19], s50 offen offset:2048 lds
v_mfma_f32_16x16x32_bf16 v[188:191], a[252:255], a[204:207], v[188:191]
ds_read_b64_tr_b16 a[234:235], v17 offset:33792
v_accvgpr_read_b32 v54, a18
v_mfma_f32_16x16x32_bf16 v[188:191], a[248:251], a[200:203], v[188:191]
ds_read_b64_tr_b16 a[236:237], v17 offset:40960
v_accvgpr_read_b32 v55, a19
v_mfma_f32_16x16x32_bf16 v[220:223], a[248:251], a[208:211], v[220:223]
ds_read_b64_tr_b16 a[238:239], v17 offset:41984
v_cvt_pk_bf16_f32 v37, v54, v55
v_mfma_f32_16x16x32_bf16 v[220:223], a[252:255], a[212:215], v[220:223]
buffer_load_dwordx4 v27, s[16:19], s50 offen offset:3072 lds
v_mfma_f32_16x16x32_bf16 v[252:255], a[252:255], a[220:223], v[252:255]
v_accvgpr_write_b32 a85, v37
v_accvgpr_read_b32 v52, a20
v_mfma_f32_16x16x32_bf16 v[252:255], a[248:251], a[216:219], v[252:255]
v_accvgpr_read_b32 v53, a21
s_waitcnt lgkmcnt(4)
v_mfma_f32_16x16x32_bf16 v[128:131], a[224:227], a[160:163], v[128:131]
v_and_b32 v125, 31, v0
v_lshlrev_b32 v125, 3, v125
v_mfma_f32_16x16x32_bf16 v[128:131], a[228:231], a[164:167], v[128:131]
buffer_load_dword v30, v125, s[32:35], 0 offen sc1
v_mfma_f32_16x16x32_bf16 v[160:163], a[228:231], a[172:175], v[160:163]
ds_read_b64_tr_b16 a[240:241], v18 offset:32768
v_cvt_pk_bf16_f32 v38, v52, v53
v_mfma_f32_16x16x32_bf16 v[160:163], a[224:227], a[168:171], v[160:163]
ds_read_b64_tr_b16 a[242:243], v18 offset:33792
v_accvgpr_write_b32 a86, v38
v_mfma_f32_16x16x32_bf16 v[192:195], a[224:227], a[176:179], v[192:195]
ds_read_b64_tr_b16 a[244:245], v18 offset:40960
v_accvgpr_read_b32 v54, a22
v_mfma_f32_16x16x32_bf16 v[192:195], a[228:231], a[180:183], v[192:195]
ds_read_b64_tr_b16 a[246:247], v18 offset:41984
v_accvgpr_read_b32 v55, a23
v_mfma_f32_16x16x32_bf16 v[224:227], a[228:231], a[188:191], v[224:227]
s_getpc_b64 s[36:37]
L_cp1:
s_add_u32 s36, s36, L_t2_K-L_cp1
s_addc_u32 s37, s37, 0
v_mfma_f32_16x16x32_bf16 v[224:227], a[224:227], a[184:187], v[224:227]
v_cvt_pk_bf16_f32 v39, v54, v55
s_waitcnt lgkmcnt(4)
v_mfma_f32_16x16x32_bf16 v[132:135], a[232:235], a[160:163], v[132:135]
ds_read_b64_tr_b16 a[248:249], v19 offset:32768
s_add_u32 s52, s49, 12288
v_mfma_f32_16x16x32_bf16 v[132:135], a[236:239], a[164:167], v[132:135]
buffer_store_dwordx4 v[60:63], v1, s[24:27], s52 offen offset:0 sc1
v_mfma_f32_16x16x32_bf16 v[164:167], a[236:239], a[172:175], v[164:167]
ds_read_b64_tr_b16 a[250:251], v19 offset:33792
v_accvgpr_write_b32 a87, v39
v_mfma_f32_16x16x32_bf16 v[164:167], a[232:235], a[168:171], v[164:167]
ds_read_b64_tr_b16 a[252:253], v19 offset:40960
v_add_u32 v110, s61, v1
v_mfma_f32_16x16x32_bf16 v[196:199], a[232:235], a[176:179], v[196:199]
v_lshl_add_u32 v126, v0, 6, s59
v_mov_b32 v127, s37
v_add_co_u32 v126, vcc, s36, v126
s_nop 1
v_addc_co_u32 v127, vcc, 0, v127, vcc
v_mfma_f32_16x16x32_bf16 v[196:199], a[236:239], a[180:183], v[196:199]
global_load_dword v124, v[126:127], off
v_mfma_f32_16x16x32_bf16 v[228:231], a[236:239], a[188:191], v[228:231]
ds_read_b64_tr_b16 a[254:255], v19 offset:41984
s_waitcnt vmcnt(17) lgkmcnt(4)
v_mfma_f32_16x16x32_bf16 v[228:231], a[232:235], a[184:187], v[228:231]
v_accvgpr_read_b32 v52, a24
s_barrier
v_mfma_f32_16x16x32_bf16 v[136:139], a[240:243], a[160:163], v[136:139]
ds_read_b64_tr_b16 a[224:225], v20 offset:32768
v_accvgpr_read_b32 v53, a25
v_mfma_f32_16x16x32_bf16 v[136:139], a[244:247], a[164:167], v[136:139]
ds_read_b64_tr_b16 a[226:227], v20 offset:33792
v_cvt_pk_bf16_f32 v36, v52, v53
v_mfma_f32_16x16x32_bf16 v[168:171], a[244:247], a[172:175], v[168:171]
ds_read_b128 a[192:195], v2 offset:32768
v_accvgpr_write_b32 a92, v36
v_mfma_f32_16x16x32_bf16 v[168:171], a[240:243], a[168:171], v[168:171]
ds_read_b64_tr_b16 a[228:229], v20 offset:40960
v_accvgpr_read_b32 v54, a26
v_mfma_f32_16x16x32_bf16 v[200:203], a[240:243], a[176:179], v[200:203]
ds_read_b64_tr_b16 a[230:231], v20 offset:41984
v_accvgpr_read_b32 v55, a27
v_mfma_f32_16x16x32_bf16 v[200:203], a[244:247], a[180:183], v[200:203]
ds_read_b128 a[196:199], v3 offset:32768
v_cvt_pk_bf16_f32 v37, v54, v55
v_mfma_f32_16x16x32_bf16 v[232:235], a[244:247], a[188:191], v[232:235]
ds_read_b128 a[200:203], v2 offset:34816
v_accvgpr_write_b32 a93, v37
v_mfma_f32_16x16x32_bf16 v[232:235], a[240:243], a[184:187], v[232:235]
ds_read_b128 a[204:207], v3 offset:34816
s_waitcnt lgkmcnt(8)
v_mfma_f32_16x16x32_bf16 v[140:143], a[248:251], a[160:163], v[140:143]
ds_read_b64_tr_b16 a[232:233], v21 offset:32768
v_accvgpr_read_b32 v52, a28
v_mfma_f32_16x16x32_bf16 v[140:143], a[252:255], a[164:167], v[140:143]
buffer_store_dwordx4 v[68:71], v1, s[24:27], s52 offen offset:1024 sc1
v_mfma_f32_16x16x32_bf16 v[172:175], a[252:255], a[172:175], v[172:175]
ds_read_b64_tr_b16 a[234:235], v21 offset:33792
v_accvgpr_read_b32 v53, a29
v_mfma_f32_16x16x32_bf16 v[172:175], a[248:251], a[168:171], v[172:175]
ds_read_b64_tr_b16 a[236:237], v21 offset:40960
v_cvt_pk_bf16_f32 v38, v52, v53
v_mfma_f32_16x16x32_bf16 v[204:207], a[248:251], a[176:179], v[204:207]
ds_read_b64_tr_b16 a[238:239], v21 offset:41984
v_accvgpr_write_b32 a94, v38
v_mfma_f32_16x16x32_bf16 v[204:207], a[252:255], a[180:183], v[204:207]
ds_read_b128 a[208:211], v2 offset:36864
v_accvgpr_read_b32 v54, a30
v_mfma_f32_16x16x32_bf16 v[236:239], a[252:255], a[188:191], v[236:239]
ds_read_b128 a[212:215], v3 offset:36864
v_accvgpr_read_b32 v55, a31
v_mfma_f32_16x16x32_bf16 v[236:239], a[248:251], a[184:187], v[236:239]
ds_read_b128 a[216:219], v2 offset:38912
s_waitcnt lgkmcnt(10)
v_mfma_f32_16x16x32_bf16 v[144:147], a[224:227], a[160:163], v[144:147]
ds_read_b64_tr_b16 a[240:241], v22 offset:32768
v_cvt_pk_bf16_f32 v39, v54, v55
v_mfma_f32_16x16x32_bf16 v[144:147], a[228:231], a[164:167], v[144:147]
ds_read_b64_tr_b16 a[242:243], v22 offset:33792
v_accvgpr_write_b32 a95, v39
v_mfma_f32_16x16x32_bf16 v[176:179], a[228:231], a[172:175], v[176:179]
ds_read_b64_tr_b16 a[244:245], v22 offset:40960
v_accvgpr_read_b32 v52, a32
v_mfma_f32_16x16x32_bf16 v[176:179], a[224:227], a[168:171], v[176:179]
ds_read_b64_tr_b16 a[246:247], v22 offset:41984
v_accvgpr_read_b32 v53, a33
v_mfma_f32_16x16x32_bf16 v[208:211], a[224:227], a[176:179], v[208:211]
ds_read_b128 a[220:223], v3 offset:38912
v_cvt_pk_bf16_f32 v36, v52, v53
v_mfma_f32_16x16x32_bf16 v[208:211], a[228:231], a[180:183], v[208:211]
v_accvgpr_write_b32 a100, v36
v_accvgpr_read_b32 v54, a34
v_mfma_f32_16x16x32_bf16 v[240:243], a[228:231], a[188:191], v[240:243]
v_accvgpr_read_b32 v55, a35
v_cvt_pk_bf16_f32 v37, v54, v55
v_mfma_f32_16x16x32_bf16 v[240:243], a[224:227], a[184:187], v[240:243]
v_accvgpr_write_b32 a101, v37
s_waitcnt lgkmcnt(8)
v_mfma_f32_16x16x32_bf16 v[148:151], a[232:235], a[160:163], v[148:151]
ds_read_b64_tr_b16 a[248:249], v23 offset:32768
v_accvgpr_read_b32 v52, a36
v_mfma_f32_16x16x32_bf16 v[148:151], a[236:239], a[164:167], v[148:151]
buffer_store_dwordx4 v[76:79], v1, s[24:27], s52 offen offset:2048 sc1
v_mfma_f32_16x16x32_bf16 v[180:183], a[236:239], a[172:175], v[180:183]
ds_read_b64_tr_b16 a[250:251], v23 offset:33792
v_accvgpr_read_b32 v53, a37
v_mfma_f32_16x16x32_bf16 v[180:183], a[232:235], a[168:171], v[180:183]
ds_read_b64_tr_b16 a[252:253], v23 offset:40960
v_cvt_pk_bf16_f32 v38, v52, v53
v_mfma_f32_16x16x32_bf16 v[212:215], a[232:235], a[176:179], v[212:215]
ds_read_b64_tr_b16 a[254:255], v23 offset:41984
v_accvgpr_write_b32 a102, v38
v_mfma_f32_16x16x32_bf16 v[212:215], a[236:239], a[180:183], v[212:215]
v_accvgpr_read_b32 v54, a38
v_accvgpr_read_b32 v55, a39
v_mfma_f32_16x16x32_bf16 v[244:247], a[236:239], a[188:191], v[244:247]
v_cvt_pk_bf16_f32 v39, v54, v55
v_accvgpr_write_b32 a103, v39
v_mfma_f32_16x16x32_bf16 v[244:247], a[232:235], a[184:187], v[244:247]
s_waitcnt lgkmcnt(5)
s_mul_i32 s36, s67, 7282
v_mfma_f32_16x16x32_bf16 v[152:155], a[240:243], a[160:163], v[152:155]
ds_read_b64_tr_b16 a[224:225], v16 offset:49152
s_lshr_b32 s36, s36, 16
v_mfma_f32_16x16x32_bf16 v[152:155], a[244:247], a[164:167], v[152:155]
ds_read_b64_tr_b16 a[226:227], v16 offset:50176
s_mul_i32 s37, s36, 9
v_mfma_f32_16x16x32_bf16 v[184:187], a[244:247], a[172:175], v[184:187]
ds_read_b64_tr_b16 a[228:229], v16 offset:57344
s_sub_u32 s37, s67, s37
v_mfma_f32_16x16x32_bf16 v[184:187], a[240:243], a[168:171], v[184:187]
ds_read_b64_tr_b16 a[230:231], v16 offset:58368
s_lshl_b32 s36, s36, 5
v_mfma_f32_16x16x32_bf16 v[216:219], a[240:243], a[176:179], v[216:219]
s_lshl_b32 s37, s37, 6
v_min_u32 v92, 34, v0
v_mfma_f32_16x16x32_bf16 v[216:219], a[244:247], a[180:183], v[216:219]
s_waitcnt lgkmcnt(4)
v_add_u32 v92, s36, v92
v_mfma_f32_16x16x32_bf16 v[248:251], a[244:247], a[188:191], v[248:251]
v_mul_u32_u24 v92, 1152, v92
s_lshl_b32 s37, s37, 1
v_mfma_f32_16x16x32_bf16 v[248:251], a[240:243], a[184:187], v[248:251]
v_add_u32 v92, s37, v92
v_subrev_u32 v92, 3456, v92
v_mfma_f32_16x16x32_bf16 v[156:159], a[248:251], a[160:163], v[156:159]
ds_read_b64_tr_b16 a[232:233], v17 offset:49152
s_lshl_b32 s37, s37, 2
v_mfma_f32_16x16x32_bf16 v[156:159], a[252:255], a[164:167], v[156:159]
buffer_store_dwordx4 v[84:87], v1, s[24:27], s52 offen offset:3072 sc1
v_mfma_f32_16x16x32_bf16 v[188:191], a[252:255], a[172:175], v[188:191]
ds_read_b64_tr_b16 a[234:235], v17 offset:50176
v_and_b32 v93, 7, v0
v_mfma_f32_16x16x32_bf16 v[188:191], a[248:251], a[168:171], v[188:191]
ds_read_b64_tr_b16 a[236:237], v17 offset:57344
v_min_u32 v95, 5, v93
v_mfma_f32_16x16x32_bf16 v[220:223], a[248:251], a[176:179], v[220:223]
ds_read_b64_tr_b16 a[238:239], v17 offset:58368
v_lshl_add_u32 v93, v93, 6, s37
v_mfma_f32_16x16x32_bf16 v[220:223], a[252:255], a[180:183], v[220:223]
v_lshrrev_b32 v94, 3, v0
v_mul_u32_u24 v94, 1152, v94
v_mfma_f32_16x16x32_bf16 v[252:255], a[252:255], a[188:191], v[252:255]
v_mad_u32_u24 v94, v95, 64, v94
v_mad_u32_u24 v94, v95, 50, v94
v_mfma_f32_16x16x32_bf16 v[252:255], a[248:251], a[184:187], v[252:255]
s_waitcnt lgkmcnt(4)
s_lshr_b32 s45, s2, 1
v_mfma_f32_16x16x32_bf16 v[128:131], a[224:227], a[192:195], v[128:131]
ds_read_b64_tr_b16 a[240:241], v18 offset:49152
s_lshl_b32 s45, s45, 2
v_mfma_f32_16x16x32_bf16 v[128:131], a[228:231], a[196:199], v[128:131]
ds_read_b64_tr_b16 a[242:243], v18 offset:50176
s_add_u32 s45, s45, s3
v_mfma_f32_16x16x32_bf16 v[160:163], a[228:231], a[204:207], v[160:163]
ds_read_b64_tr_b16 a[244:245], v18 offset:57344
s_mul_i32 s45, s45, 9216
v_mfma_f32_16x16x32_bf16 v[160:163], a[224:227], a[200:203], v[160:163]
ds_read_b64_tr_b16 a[246:247], v18 offset:58368
s_and_b32 s36, s2, 1
v_mfma_f32_16x16x32_bf16 v[192:195], a[224:227], a[208:211], v[192:195]
s_mul_i32 s36, s36, 576
s_add_u32 s45, s45, s36
v_mfma_f32_16x16x32_bf16 v[192:195], a[228:231], a[212:215], v[192:195]
v_accvgpr_read_b32 v52, a40
v_accvgpr_read_b32 v53, a41
v_mfma_f32_16x16x32_bf16 v[224:227], a[228:231], a[220:223], v[224:227]
v_cvt_pk_bf16_f32 v36, v52, v53
v_accvgpr_write_b32 a108, v36
v_mfma_f32_16x16x32_bf16 v[224:227], a[224:227], a[216:219], v[224:227]
v_accvgpr_read_b32 v54, a42
s_waitcnt lgkmcnt(4)
v_mfma_f32_16x16x32_bf16 v[132:135], a[232:235], a[192:195], v[132:135]
ds_read_b64_tr_b16 a[248:249], v19 offset:49152
s_add_u32 s52, s60, 8192
v_mfma_f32_16x16x32_bf16 v[132:135], a[236:239], a[196:199], v[132:135]
buffer_store_dwordx4 a[64:67], v1, s[24:27], s52 offen offset:0 sc1
v_mfma_f32_16x16x32_bf16 v[164:167], a[236:239], a[204:207], v[164:167]
ds_read_b64_tr_b16 a[250:251], v19 offset:50176
v_accvgpr_read_b32 v55, a43
v_mfma_f32_16x16x32_bf16 v[164:167], a[232:235], a[200:203], v[164:167]
ds_read_b64_tr_b16 a[252:253], v19 offset:57344
v_cvt_pk_bf16_f32 v37, v54, v55
v_mfma_f32_16x16x32_bf16 v[196:199], a[232:235], a[208:211], v[196:199]
ds_read_b64_tr_b16 a[254:255], v19 offset:58368
v_accvgpr_write_b32 a109, v37
v_mfma_f32_16x16x32_bf16 v[196:199], a[236:239], a[212:215], v[196:199]
v_accvgpr_read_b32 v52, a44
v_accvgpr_read_b32 v53, a45
v_mfma_f32_16x16x32_bf16 v[228:231], a[236:239], a[220:223], v[228:231]
v_cvt_pk_bf16_f32 v38, v52, v53
s_waitcnt vmcnt(7) lgkmcnt(4)
v_mfma_f32_16x16x32_bf16 v[228:231], a[232:235], a[216:219], v[228:231]
v_accvgpr_write_b32 a110, v38
s_barrier
v_mfma_f32_16x16x32_bf16 v[136:139], a[240:243], a[192:195], v[136:139]
ds_read_b64_tr_b16 a[224:225], v20 offset:49152
v_accvgpr_read_b32 v54, a46
v_mfma_f32_16x16x32_bf16 v[136:139], a[244:247], a[196:199], v[136:139]
ds_read_b64_tr_b16 a[226:227], v20 offset:50176
v_accvgpr_read_b32 v55, a47
v_mfma_f32_16x16x32_bf16 v[168:171], a[244:247], a[204:207], v[168:171]
ds_read_b128 a[160:163], v4 offset:0
v_cvt_pk_bf16_f32 v39, v54, v55
v_mfma_f32_16x16x32_bf16 v[168:171], a[240:243], a[200:203], v[168:171]
ds_read_b64_tr_b16 a[228:229], v20 offset:57344
v_accvgpr_write_b32 a111, v39
v_mfma_f32_16x16x32_bf16 v[200:203], a[240:243], a[208:211], v[200:203]
ds_read_b64_tr_b16 a[230:231], v20 offset:58368
s_lshl_b32 s42, s3, 2
v_mfma_f32_16x16x32_bf16 v[200:203], a[244:247], a[212:215], v[200:203]
buffer_load_dword v95, v94, s[80:83], s45 offen
v_mfma_f32_16x16x32_bf16 v[232:235], a[244:247], a[220:223], v[232:235]
ds_read_b128 a[164:167], v5 offset:0
s_lshr_b32 s42, 0x2133, s42
v_mfma_f32_16x16x32_bf16 v[232:235], a[240:243], a[216:219], v[232:235]
ds_read_b128 a[168:171], v4 offset:2048
s_waitcnt lgkmcnt(7)
v_mfma_f32_16x16x32_bf16 v[140:143], a[248:251], a[192:195], v[140:143]
ds_read_b64_tr_b16 a[232:233], v21 offset:49152
s_and_b32 s42, s42, 15
v_mfma_f32_16x16x32_bf16 v[140:143], a[252:255], a[196:199], v[140:143]
buffer_store_dwordx4 a[72:75], v1, s[24:27], s52 offen offset:1024 sc1
v_mfma_f32_16x16x32_bf16 v[172:175], a[252:255], a[204:207], v[172:175]
ds_read_b64_tr_b16 a[234:235], v21 offset:50176
v_add_u32 v14, s42, v0
v_mfma_f32_16x16x32_bf16 v[172:175], a[248:251], a[200:203], v[172:175]
ds_read_b64_tr_b16 a[236:237], v21 offset:57344
s_lshl_b32 s43, s5, 1
v_mfma_f32_16x16x32_bf16 v[204:207], a[248:251], a[208:211], v[204:207]
ds_read_b64_tr_b16 a[238:239], v21 offset:58368
s_sub_u32 s44, 28, s43
v_mfma_f32_16x16x32_bf16 v[204:207], a[252:255], a[212:215], v[204:207]
ds_read_b128 a[172:175], v5 offset:2048
v_subrev_u32 v14, 4, v14
v_mfma_f32_16x16x32_bf16 v[236:239], a[252:255], a[220:223], v[236:239]
ds_read_b128 a[176:179], v4 offset:4096
v_cmp_le_u32 vcc, s43, v14
v_mfma_f32_16x16x32_bf16 v[236:239], a[248:251], a[216:219], v[236:239]
ds_read_b128 a[180:183], v5 offset:4096
s_waitcnt lgkmcnt(9)
v_mfma_f32_16x16x32_bf16 v[144:147], a[224:227], a[192:195], v[144:147]
ds_read_b64_tr_b16 a[240:241], v22 offset:49152
v_add_u32 v108, 2, v14
v_mfma_f32_16x16x32_bf16 v[144:147], a[228:231], a[196:199], v[144:147]
ds_read_b64_tr_b16 a[242:243], v22 offset:50176
s_nop 0
v_mfma_f32_16x16x32_bf16 v[176:179], a[228:231], a[204:207], v[176:179]
ds_read_b64_tr_b16 a[244:245], v22 offset:57344
v_cndmask_b32 v29, v14, v108, vcc
v_mfma_f32_16x16x32_bf16 v[176:179], a[224:227], a[200:203], v[176:179]
ds_read_b64_tr_b16 a[246:247], v22 offset:58368
v_cmp_eq_u32 vcc, -1, v14
v_mfma_f32_16x16x32_bf16 v[208:211], a[224:227], a[208:211], v[208:211]
ds_read_b128 a[184:187], v4 offset:6144
v_mov_b32 v108, s43
v_mfma_f32_16x16x32_bf16 v[208:211], a[228:231], a[212:215], v[208:211]
ds_read_b128 a[188:191], v5 offset:6144
v_add_u32 v14, 1, v14
v_mfma_f32_16x16x32_bf16 v[240:243], a[228:231], a[220:223], v[240:243]
v_cndmask_b32 v29, v29, v108, vcc
v_lshl_add_u32 v29, v29, 15, s53
v_mfma_f32_16x16x32_bf16 v[240:243], a[224:227], a[216:219], v[240:243]
s_waitcnt lgkmcnt(9)
v_cmp_lt_u32 vcc, s44, v14
v_mfma_f32_16x16x32_bf16 v[148:151], a[232:235], a[192:195], v[148:151]
ds_read_b64_tr_b16 a[248:249], v23 offset:49152
v_mov_b32 v108, 2146435072
v_mfma_f32_16x16x32_bf16 v[148:151], a[236:239], a[196:199], v[148:151]
buffer_store_dwordx4 a[80:83], v1, s[24:27], s52 offen offset:2048 sc1
v_mfma_f32_16x16x32_bf16 v[180:183], a[236:239], a[204:207], v[180:183]
ds_read_b64_tr_b16 a[250:251], v23 offset:50176
s_nop 0
v_mfma_f32_16x16x32_bf16 v[180:183], a[232:235], a[200:203], v[180:183]
ds_read_b64_tr_b16 a[252:253], v23 offset:57344
v_cndmask_b32 v29, v29, v108, vcc
v_mfma_f32_16x16x32_bf16 v[212:215], a[232:235], a[208:211], v[212:215]
ds_read_b64_tr_b16 a[254:255], v23 offset:58368
v_lshrrev_b32 v14, 4, v0
v_mfma_f32_16x16x32_bf16 v[212:215], a[236:239], a[212:215], v[212:215]
v_lshlrev_b32 v14, 2, v14
v_and_b32 v108, 15, v0
v_mfma_f32_16x16x32_bf16 v[244:247], a[236:239], a[220:223], v[244:247]
v_sub_u32 v14, v108, v14
v_mov_b32 v108, 0xff800000
v_mfma_f32_16x16x32_bf16 v[244:247], a[232:235], a[216:219], v[244:247]
s_waitcnt lgkmcnt(6)
v_cmp_gt_i32 vcc, 0, v14
v_mfma_f32_16x16x32_bf16 v[152:155], a[240:243], a[192:195], v[152:155]
s_nop 1
v_mfma_f32_16x16x32_bf16 v[152:155], a[244:247], a[196:199], v[152:155]
ds_read_b64_tr_b16 a[224:225], v16 offset:0
v_cndmask_b32 v6, 0, v108, vcc
v_mfma_f32_16x16x32_bf16 v[184:187], a[244:247], a[204:207], v[184:187]
ds_read_b64_tr_b16 a[226:227], v16 offset:1024
v_cmp_gt_i32 vcc, 1, v14
v_mfma_f32_16x16x32_bf16 v[184:187], a[240:243], a[200:203], v[184:187]
s_nop 1
v_mfma_f32_16x16x32_bf16 v[216:219], a[240:243], a[208:211], v[216:219]
ds_read_b64_tr_b16 a[228:229], v16 offset:8192
v_cndmask_b32 v7, 0, v108, vcc
v_mfma_f32_16x16x32_bf16 v[216:219], a[244:247], a[212:215], v[216:219]
ds_read_b64_tr_b16 a[230:231], v16 offset:9216
v_cmp_gt_i32 vcc, 2, v14
v_mfma_f32_16x16x32_bf16 v[248:251], a[244:247], a[220:223], v[248:251]
s_nop 1
v_mfma_f32_16x16x32_bf16 v[248:251], a[240:243], a[216:219], v[248:251]
s_waitcnt lgkmcnt(4)
v_cndmask_b32 v8, 0, v108, vcc
v_mfma_f32_16x16x32_bf16 v[156:159], a[248:251], a[192:195], v[156:159]
ds_read_b64_tr_b16 a[232:233], v17 offset:0
v_cmp_gt_i32 vcc, 3, v14
v_mfma_f32_16x16x32_bf16 v[156:159], a[252:255], a[196:199], v[156:159]
buffer_store_dwordx4 a[88:91], v1, s[24:27], s52 offen offset:3072 sc1
v_mfma_f32_16x16x32_bf16 v[188:191], a[252:255], a[204:207], v[188:191]
s_nop 1
v_mfma_f32_16x16x32_bf16 v[188:191], a[248:251], a[200:203], v[188:191]
ds_read_b64_tr_b16 a[234:235], v17 offset:1024
v_cndmask_b32 v9, 0, v108, vcc
v_mfma_f32_16x16x32_bf16 v[220:223], a[248:251], a[208:211], v[220:223]
ds_read_b64_tr_b16 a[236:237], v17 offset:8192
v_accvgpr_read_b32 v52, a48
v_mfma_f32_16x16x32_bf16 v[220:223], a[252:255], a[212:215], v[220:223]
ds_read_b64_tr_b16 a[238:239], v17 offset:9216
v_accvgpr_read_b32 v53, a49
v_mfma_f32_16x16x32_bf16 v[252:255], a[252:255], a[220:223], v[252:255]
v_cvt_pk_bf16_f32 v36, v52, v53
v_accvgpr_write_b32 a116, v36
v_mfma_f32_16x16x32_bf16 v[252:255], a[248:251], a[216:219], v[252:255]
v_accvgpr_read_b32 v54, a50
s_waitcnt lgkmcnt(4)
v_mfma_f32_16x16x32_bf16 v[128:131], a[224:227], a[160:163], v[128:131]
ds_read_b64_tr_b16 a[240:241], v18 offset:0
v_accvgpr_read_b32 v55, a51
v_mfma_f32_16x16x32_bf16 v[128:131], a[228:231], a[164:167], v[128:131]
ds_read_b64_tr_b16 a[242:243], v18 offset:1024
v_cvt_pk_bf16_f32 v37, v54, v55
v_mfma_f32_16x16x32_bf16 v[160:163], a[228:231], a[172:175], v[160:163]
ds_read_b64_tr_b16 a[244:245], v18 offset:8192
v_accvgpr_write_b32 a117, v37
v_mfma_f32_16x16x32_bf16 v[160:163], a[224:227], a[168:171], v[160:163]
ds_read_b64_tr_b16 a[246:247], v18 offset:9216
v_accvgpr_read_b32 v52, a52
v_mfma_f32_16x16x32_bf16 v[192:195], a[224:227], a[176:179], v[192:195]
v_accvgpr_read_b32 v53, a53
v_cvt_pk_bf16_f32 v38, v52, v53
v_mfma_f32_16x16x32_bf16 v[192:195], a[228:231], a[180:183], v[192:195]
v_accvgpr_write_b32 a118, v38
v_accvgpr_read_b32 v54, a54
v_mfma_f32_16x16x32_bf16 v[224:227], a[228:231], a[188:191], v[224:227]
v_accvgpr_read_b32 v55, a55
v_cvt_pk_bf16_f32 v39, v54, v55
v_mfma_f32_16x16x32_bf16 v[224:227], a[224:227], a[184:187], v[224:227]
v_accvgpr_write_b32 a119, v39
s_waitcnt lgkmcnt(4)
v_mfma_f32_16x16x32_bf16 v[132:135], a[232:235], a[160:163], v[132:135]
ds_read_b64_tr_b16 a[248:249], v19 offset:0
s_add_u32 s52, s60, 12288
v_mfma_f32_16x16x32_bf16 v[132:135], a[236:239], a[164:167], v[132:135]
buffer_store_dwordx4 a[96:99], v1, s[24:27], s52 offen offset:0 sc1
v_mfma_f32_16x16x32_bf16 v[164:167], a[236:239], a[172:175], v[164:167]
ds_read_b64_tr_b16 a[250:251], v19 offset:1024
v_accvgpr_read_b32 v52, a56
v_mfma_f32_16x16x32_bf16 v[164:167], a[232:235], a[168:171], v[164:167]
ds_read_b64_tr_b16 a[252:253], v19 offset:8192
v_accvgpr_read_b32 v53, a57
v_mfma_f32_16x16x32_bf16 v[196:199], a[232:235], a[176:179], v[196:199]
ds_read_b64_tr_b16 a[254:255], v19 offset:9216
v_cvt_pk_bf16_f32 v36, v52, v53
v_mfma_f32_16x16x32_bf16 v[196:199], a[236:239], a[180:183], v[196:199]
v_accvgpr_write_b32 a124, v36
v_accvgpr_read_b32 v54, a58
v_mfma_f32_16x16x32_bf16 v[228:231], a[236:239], a[188:191], v[228:231]
v_accvgpr_read_b32 v55, a59
s_waitcnt vmcnt(11) lgkmcnt(4)
v_mfma_f32_16x16x32_bf16 v[228:231], a[232:235], a[184:187], v[228:231]
v_cvt_pk_bf16_f32 v37, v54, v55
s_barrier
v_mfma_f32_16x16x32_bf16 v[136:139], a[240:243], a[160:163], v[136:139]
ds_read_b64_tr_b16 a[224:225], v20 offset:0
v_accvgpr_write_b32 a125, v37
v_mfma_f32_16x16x32_bf16 v[136:139], a[244:247], a[164:167], v[136:139]
ds_read_b64_tr_b16 a[226:227], v20 offset:1024
v_accvgpr_read_b32 v52, a60
v_mfma_f32_16x16x32_bf16 v[168:171], a[244:247], a[172:175], v[168:171]
v_accvgpr_read_b32 v53, a61
v_cvt_pk_bf16_f32 v38, v52, v53
v_accvgpr_write_b32 a126, v38
v_accvgpr_read_b32 v54, a62
v_accvgpr_read_b32 v55, a63
v_cvt_pk_bf16_f32 v39, v54, v55
v_accvgpr_write_b32 a127, v39
s_mov_b32 s8, s98
s_mov_b32 s9, s64
s_mov_b32 s10, 2359296
s_mov_b32 s64, 1040356334
s_mov_b32 s65, 1040356334
v_mfma_f32_16x16x32_bf16 v[168:171], a[240:243], a[168:171], v[168:171]
ds_read_b64_tr_b16 a[228:229], v20 offset:8192
v_mfma_f32_16x16x32_bf16 v[200:203], a[240:243], a[176:179], v[200:203]
ds_read_b64_tr_b16 a[230:231], v20 offset:9216
v_mfma_f32_16x16x32_bf16 v[200:203], a[244:247], a[180:183], v[200:203]
s_waitcnt lgkmcnt(4)
v_mfma_f32_16x16x32_bf16 v[232:235], a[244:247], a[188:191], v[232:235]
v_mul_f32 v128, s64, v128
v_mul_f32 v129, s64, v129
v_mfma_f32_16x16x32_bf16 v[232:235], a[240:243], a[184:187], v[232:235]
v_cvt_pk_bf16_f32 v128, v128, v129
v_mul_f32 v130, s64, v130
v_mfma_f32_16x16x32_bf16 v[140:143], a[248:251], a[160:163], v[140:143]
ds_read_b64_tr_b16 a[232:233], v21 offset:0
v_mul_f32 v131, s64, v131
v_mfma_f32_16x16x32_bf16 v[140:143], a[252:255], a[164:167], v[140:143]
buffer_store_dwordx4 a[104:107], v1, s[24:27], s52 offen offset:1024 sc1
v_mfma_f32_16x16x32_bf16 v[172:175], a[252:255], a[172:175], v[172:175]
ds_read_b64_tr_b16 a[234:235], v21 offset:1024
v_cvt_pk_bf16_f32 v129, v130, v131
v_mfma_f32_16x16x32_bf16 v[172:175], a[248:251], a[168:171], v[172:175]
ds_read_b64_tr_b16 a[236:237], v21 offset:8192
v_mul_f32 v132, s64, v132
v_mfma_f32_16x16x32_bf16 v[204:207], a[248:251], a[176:179], v[204:207]
ds_read_b64_tr_b16 a[238:239], v21 offset:9216
v_mul_f32 v133, s64, v133
v_mfma_f32_16x16x32_bf16 v[204:207], a[252:255], a[180:183], v[204:207]
v_cvt_pk_bf16_f32 v130, v132, v133
v_mul_f32 v134, s64, v134
v_mfma_f32_16x16x32_bf16 v[236:239], a[252:255], a[188:191], v[236:239]
v_mul_f32 v135, s64, v135
v_cvt_pk_bf16_f32 v131, v134, v135
v_mfma_f32_16x16x32_bf16 v[236:239], a[248:251], a[184:187], v[236:239]
v_accvgpr_write_b32 a0, v128
s_waitcnt lgkmcnt(4)
v_mfma_f32_16x16x32_bf16 v[144:147], a[224:227], a[160:163], v[144:147]
ds_read_b64_tr_b16 a[240:241], v22 offset:0
v_accvgpr_write_b32 a1, v129
v_mfma_f32_16x16x32_bf16 v[144:147], a[228:231], a[164:167], v[144:147]
ds_read_b64_tr_b16 a[242:243], v22 offset:1024
v_accvgpr_write_b32 a2, v130
v_mfma_f32_16x16x32_bf16 v[176:179], a[228:231], a[172:175], v[176:179]
ds_read_b64_tr_b16 a[244:245], v22 offset:8192
v_accvgpr_write_b32 a3, v131
v_mfma_f32_16x16x32_bf16 v[176:179], a[224:227], a[168:171], v[176:179]
ds_read_b64_tr_b16 a[246:247], v22 offset:9216
v_mul_f32 v160, s64, v160
v_mfma_f32_16x16x32_bf16 v[208:211], a[224:227], a[176:179], v[208:211]
v_mul_f32 v161, s64, v161
v_cvt_pk_bf16_f32 v160, v160, v161
v_mfma_f32_16x16x32_bf16 v[208:211], a[228:231], a[180:183], v[208:211]
v_mul_f32 v162, s64, v162
v_mul_f32 v163, s64, v163
v_mfma_f32_16x16x32_bf16 v[240:243], a[228:231], a[188:191], v[240:243]
v_cvt_pk_bf16_f32 v161, v162, v163
v_mul_f32 v164, s64, v164
v_mfma_f32_16x16x32_bf16 v[240:243], a[224:227], a[184:187], v[240:243]
v_mul_f32 v165, s64, v165
s_waitcnt lgkmcnt(4)
v_mfma_f32_16x16x32_bf16 v[148:151], a[232:235], a[160:163], v[148:151]
ds_read_b64_tr_b16 a[248:249], v23 offset:0
v_cvt_pk_bf16_f32 v162, v164, v165
v_mfma_f32_16x16x32_bf16 v[148:151], a[236:239], a[164:167], v[148:151]
buffer_store_dwordx4 a[112:115], v1, s[24:27], s52 offen offset:2048 sc1
v_mfma_f32_16x16x32_bf16 v[180:183], a[236:239], a[172:175], v[180:183]
ds_read_b64_tr_b16 a[250:251], v23 offset:1024
v_mul_f32 v166, s64, v166
v_mfma_f32_16x16x32_bf16 v[180:183], a[232:235], a[168:171], v[180:183]
ds_read_b64_tr_b16 a[252:253], v23 offset:8192
v_mul_f32 v167, s64, v167
v_mfma_f32_16x16x32_bf16 v[212:215], a[232:235], a[176:179], v[212:215]
ds_read_b64_tr_b16 a[254:255], v23 offset:9216
v_cvt_pk_bf16_f32 v163, v166, v167
v_mfma_f32_16x16x32_bf16 v[212:215], a[236:239], a[180:183], v[212:215]
v_accvgpr_write_b32 a16, v160
v_accvgpr_write_b32 a17, v161
v_mfma_f32_16x16x32_bf16 v[244:247], a[236:239], a[188:191], v[244:247]
v_accvgpr_write_b32 a18, v162
v_accvgpr_write_b32 a19, v163
v_mfma_f32_16x16x32_bf16 v[244:247], a[232:235], a[184:187], v[244:247]
v_mul_f32 v192, s64, v192
s_waitcnt lgkmcnt(4)
v_mfma_f32_16x16x32_bf16 v[152:155], a[240:243], a[160:163], v[152:155]
v_mul_f32 v193, s64, v193
v_cvt_pk_bf16_f32 v192, v192, v193
v_mfma_f32_16x16x32_bf16 v[152:155], a[244:247], a[164:167], v[152:155]
v_mul_f32 v194, s64, v194
v_mul_f32 v195, s64, v195
v_mfma_f32_16x16x32_bf16 v[184:187], a[244:247], a[172:175], v[184:187]
v_cvt_pk_bf16_f32 v193, v194, v195
v_mul_f32 v196, s64, v196
v_mfma_f32_16x16x32_bf16 v[184:187], a[240:243], a[168:171], v[184:187]
v_mul_f32 v197, s64, v197
v_cvt_pk_bf16_f32 v194, v196, v197
v_mfma_f32_16x16x32_bf16 v[216:219], a[240:243], a[176:179], v[216:219]
v_mul_f32 v198, s64, v198
v_mul_f32 v199, s64, v199
v_mfma_f32_16x16x32_bf16 v[216:219], a[244:247], a[180:183], v[216:219]
v_cvt_pk_bf16_f32 v195, v198, v199
v_accvgpr_write_b32 a32, v192
v_mfma_f32_16x16x32_bf16 v[248:251], a[244:247], a[188:191], v[248:251]
v_accvgpr_write_b32 a33, v193
v_accvgpr_write_b32 a34, v194
v_mfma_f32_16x16x32_bf16 v[248:251], a[240:243], a[184:187], v[248:251]
v_accvgpr_write_b32 a35, v195
s_waitcnt lgkmcnt(0)
v_mfma_f32_16x16x32_bf16 v[156:159], a[248:251], a[160:163], v[156:159]
v_mfma_f32_16x16x32_bf16 v[156:159], a[252:255], a[164:167], v[156:159]
buffer_store_dwordx4 a[120:123], v1, s[24:27], s52 offen offset:3072 sc1
v_mfma_f32_16x16x32_bf16 v[188:191], a[252:255], a[172:175], v[188:191]
v_mfma_f32_16x16x32_bf16 v[188:191], a[248:251], a[168:171], v[188:191]
v_mfma_f32_16x16x32_bf16 v[220:223], a[248:251], a[176:179], v[220:223]
v_mfma_f32_16x16x32_bf16 v[220:223], a[252:255], a[180:183], v[220:223]
v_mfma_f32_16x16x32_bf16 v[252:255], a[252:255], a[188:191], v[252:255]
v_mfma_f32_16x16x32_bf16 v[252:255], a[248:251], a[184:187], v[252:255]
L_t2_K:
s_load_dwordx4 s[92:95], s[0:1], 96
s_load_dwordx2 s[96:97], s[0:1], 40
ds_write_b128 v110, a[68:71] offset:0
v_pk_mul_f32 v[224:225], v[224:225], s[64:65]
v_pk_mul_f32 v[226:227], v[226:227], s[64:65]
v_pk_mul_f32 v[228:229], v[228:229], s[64:65]
v_pk_mul_f32 v[230:231], v[230:231], s[64:65]
v_cvt_pk_bf16_f32 v224, v224, v225
v_cvt_pk_bf16_f32 v225, v226, v227
v_cvt_pk_bf16_f32 v226, v228, v229
v_cvt_pk_bf16_f32 v227, v230, v231
ds_write_b128 v110, a[76:79] offset:1024
v_accvgpr_write_b32 a48, v224
v_accvgpr_write_b32 a49, v225
v_accvgpr_write_b32 a50, v226
v_accvgpr_write_b32 a51, v227
v_pk_mul_f32 v[136:137], v[136:137], s[64:65]
v_pk_mul_f32 v[138:139], v[138:139], s[64:65]
v_pk_mul_f32 v[140:141], v[140:141], s[64:65]
v_pk_mul_f32 v[142:143], v[142:143], s[64:65]
s_mul_i32 s51, s3, 5120
s_add_u32 m0, s51, 131072
s_nop 0
buffer_load_dwordx4 v24, s[80:83], s45 offen offset:0 lds
v_cvt_pk_bf16_f32 v136, v136, v137
v_cvt_pk_bf16_f32 v137, v138, v139
v_cvt_pk_bf16_f32 v138, v140, v141
v_cvt_pk_bf16_f32 v139, v142, v143
v_accvgpr_write_b32 a4, v136
v_accvgpr_write_b32 a5, v137
v_accvgpr_write_b32 a6, v138
v_accvgpr_write_b32 a7, v139
ds_write_b128 v110, a[84:87] offset:2048
v_pk_mul_f32 v[168:169], v[168:169], s[64:65]
v_pk_mul_f32 v[170:171], v[170:171], s[64:65]
v_pk_mul_f32 v[172:173], v[172:173], s[64:65]
v_pk_mul_f32 v[174:175], v[174:175], s[64:65]
v_cvt_pk_bf16_f32 v168, v168, v169
v_cvt_pk_bf16_f32 v169, v170, v171
v_cvt_pk_bf16_f32 v170, v172, v173
v_cvt_pk_bf16_f32 v171, v174, v175
ds_write_b128 v110, a[92:95] offset:3072
v_accvgpr_write_b32 a20, v168
v_accvgpr_write_b32 a21, v169
v_accvgpr_write_b32 a22, v170
v_accvgpr_write_b32 a23, v171
v_pk_mul_f32 v[200:201], v[200:201], s[64:65]
v_pk_mul_f32 v[202:203], v[202:203], s[64:65]
v_pk_mul_f32 v[204:205], v[204:205], s[64:65]
v_pk_mul_f32 v[206:207], v[206:207], s[64:65]
s_add_u32 m0, m0, 1024
s_add_u32 s45, s45, 128
buffer_load_dwordx4 v24, s[80:83], s45 offen offset:0 lds
v_cvt_pk_bf16_f32 v200, v200, v201
v_cvt_pk_bf16_f32 v201, v202, v203
v_cvt_pk_bf16_f32 v202, v204, v205
v_cvt_pk_bf16_f32 v203, v206, v207
v_accvgpr_write_b32 a36, v200
v_accvgpr_write_b32 a37, v201
v_accvgpr_write_b32 a38, v202
v_accvgpr_write_b32 a39, v203
ds_write_b128 v110, a[100:103] offset:4096
v_pk_mul_f32 v[232:233], v[232:233], s[64:65]
v_pk_mul_f32 v[234:235], v[234:235], s[64:65]
v_pk_mul_f32 v[236:237], v[236:237], s[64:65]
v_pk_mul_f32 v[238:239], v[238:239], s[64:65]
v_cvt_pk_bf16_f32 v232, v232, v233
v_cvt_pk_bf16_f32 v233, v234, v235
v_cvt_pk_bf16_f32 v234, v236, v237
v_cvt_pk_bf16_f32 v235, v238, v239
ds_write_b128 v110, a[108:111] offset:5120
v_accvgpr_write_b32 a52, v232
v_accvgpr_write_b32 a53, v233
v_accvgpr_write_b32 a54, v234
v_accvgpr_write_b32 a55, v235
v_pk_mul_f32 v[144:145], v[144:145], s[64:65]
v_pk_mul_f32 v[146:147], v[146:147], s[64:65]
v_pk_mul_f32 v[148:149], v[148:149], s[64:65]
v_pk_mul_f32 v[150:151], v[150:151], s[64:65]
s_add_u32 m0, m0, 1024
s_add_u32 s45, s45, 128
buffer_load_dwordx4 v24, s[80:83], s45 offen offset:0 lds
v_cvt_pk_bf16_f32 v144, v144, v145
v_cvt_pk_bf16_f32 v145, v146, v147
v_cvt_pk_bf16_f32 v146, v148, v149
v_cvt_pk_bf16_f32 v147, v150, v151
v_accvgpr_write_b32 a8, v144
v_accvgpr_write_b32 a9, v145
v_accvgpr_write_b32 a10, v146
v_accvgpr_write_b32 a11, v147
ds_write_b128 v110, a[116:119] offset:6144
v_pk_mul_f32 v[176:177], v[176:177], s[64:65]
v_pk_mul_f32 v[178:179], v[178:179], s[64:65]
v_pk_mul_f32 v[180:181], v[180:181], s[64:65]
v_pk_mul_f32 v[182:183], v[182:183], s[64:65]
v_cvt_pk_bf16_f32 v176, v176, v177
v_cvt_pk_bf16_f32 v177, v178, v179
v_cvt_pk_bf16_f32 v178, v180, v181
v_cvt_pk_bf16_f32 v179, v182, v183
ds_write_b128 v110, a[124:127] offset:7168
v_accvgpr_write_b32 a24, v176
v_accvgpr_write_b32 a25, v177
v_accvgpr_write_b32 a26, v178
v_accvgpr_write_b32 a27, v179
v_pk_mul_f32 v[208:209], v[208:209], s[64:65]
v_pk_mul_f32 v[210:211], v[210:211], s[64:65]
v_pk_mul_f32 v[212:213], v[212:213], s[64:65]
v_pk_mul_f32 v[214:215], v[214:215], s[64:65]
s_add_u32 m0, m0, 1024
s_add_u32 s45, s45, 128
buffer_load_dwordx4 v24, s[80:83], s45 offen offset:0 lds
v_cvt_pk_bf16_f32 v208, v208, v209
v_cvt_pk_bf16_f32 v209, v210, v211
v_cvt_pk_bf16_f32 v210, v212, v213
v_cvt_pk_bf16_f32 v211, v214, v215
v_accvgpr_write_b32 a40, v208
v_accvgpr_write_b32 a41, v209
v_accvgpr_write_b32 a42, v210
v_accvgpr_write_b32 a43, v211
ds_write_b128 v110, a[64:67] offset:8192
v_pk_mul_f32 v[240:241], v[240:241], s[64:65]
v_pk_mul_f32 v[242:243], v[242:243], s[64:65]
v_pk_mul_f32 v[244:245], v[244:245], s[64:65]
v_pk_mul_f32 v[246:247], v[246:247], s[64:65]
v_cvt_pk_bf16_f32 v240, v240, v241
v_cvt_pk_bf16_f32 v241, v242, v243
v_cvt_pk_bf16_f32 v242, v244, v245
v_cvt_pk_bf16_f32 v243, v246, v247
ds_write_b128 v110, a[72:75] offset:9216
v_accvgpr_write_b32 a56, v240
v_accvgpr_write_b32 a57, v241
v_accvgpr_write_b32 a58, v242
v_accvgpr_write_b32 a59, v243
v_and_b32 v14, 3, v0
v_cmp_eq_u32 vcc, 0, v14
v_mov_b32 v14, 0x3f803f80
s_nop 0
s_add_u32 m0, m0, 1024
s_add_u32 s45, s45, 128
buffer_load_dwordx4 v24, s[80:83], s45 offen offset:0 lds
v_cndmask_b32 v14, 0, v14, vcc
v_accvgpr_write_b32 a144, v14
v_accvgpr_write_b32 a145, v14
v_accvgpr_write_b32 a146, v14
v_accvgpr_write_b32 a147, v14
v_accvgpr_write_b32 a128, 0
v_accvgpr_write_b32 a129, 0
v_accvgpr_write_b32 a130, 0
ds_write_b128 v110, a[80:83] offset:10240
v_accvgpr_write_b32 a131, 0
v_accvgpr_write_b32 a132, 0
v_accvgpr_write_b32 a133, 0
v_accvgpr_write_b32 a134, 0
v_accvgpr_write_b32 a135, 0
v_pk_mul_f32 v[152:153], v[152:153], s[64:65]
v_pk_mul_f32 v[154:155], v[154:155], s[64:65]
v_pk_mul_f32 v[156:157], v[156:157], s[64:65]
ds_write_b128 v110, a[88:91] offset:11264
v_pk_mul_f32 v[158:159], v[158:159], s[64:65]
v_cvt_pk_bf16_f32 v152, v152, v153
v_cvt_pk_bf16_f32 v153, v154, v155
v_cvt_pk_bf16_f32 v154, v156, v157
v_cvt_pk_bf16_f32 v155, v158, v159
v_accvgpr_write_b32 a12, v152
v_accvgpr_write_b32 a13, v153
v_accvgpr_write_b32 a14, v154
ds_write_b128 v110, a[96:99] offset:12288
v_accvgpr_write_b32 a15, v155
v_pk_mul_f32 v[184:185], v[184:185], s[64:65]
v_pk_mul_f32 v[186:187], v[186:187], s[64:65]
v_pk_mul_f32 v[188:189], v[188:189], s[64:65]
v_pk_mul_f32 v[190:191], v[190:191], s[64:65]
v_cvt_pk_bf16_f32 v184, v184, v185
v_cvt_pk_bf16_f32 v185, v186, v187
v_cvt_pk_bf16_f32 v186, v188, v189
ds_write_b128 v110, a[104:107] offset:13312
v_cvt_pk_bf16_f32 v187, v190, v191
v_accvgpr_write_b32 a28, v184
v_accvgpr_write_b32 a29, v185
v_accvgpr_write_b32 a30, v186
v_accvgpr_write_b32 a31, v187
v_pk_mul_f32 v[216:217], v[216:217], s[64:65]
v_pk_mul_f32 v[218:219], v[218:219], s[64:65]
v_pk_mul_f32 v[220:221], v[220:221], s[64:65]
ds_write_b128 v110, a[112:115] offset:14336
v_pk_mul_f32 v[222:223], v[222:223], s[64:65]
v_cvt_pk_bf16_f32 v216, v216, v217
v_cvt_pk_bf16_f32 v217, v218, v219
v_cvt_pk_bf16_f32 v218, v220, v221
v_cvt_pk_bf16_f32 v219, v222, v223
v_accvgpr_write_b32 a44, v216
v_accvgpr_write_b32 a45, v217
v_accvgpr_write_b32 a46, v218
ds_write_b128 v110, a[120:123] offset:15360
v_accvgpr_write_b32 a47, v219
v_pk_mul_f32 v[248:249], v[248:249], s[64:65]
v_pk_mul_f32 v[250:251], v[250:251], s[64:65]
v_pk_mul_f32 v[252:253], v[252:253], s[64:65]
v_pk_mul_f32 v[254:255], v[254:255], s[64:65]
v_cvt_pk_bf16_f32 v248, v248, v249
v_cvt_pk_bf16_f32 v249, v250, v251
v_cvt_pk_bf16_f32 v250, v252, v253
v_cvt_pk_bf16_f32 v251, v254, v255
v_accvgpr_write_b32 a60, v248
v_accvgpr_write_b32 a61, v249
v_accvgpr_write_b32 a62, v250
v_accvgpr_write_b32 a63, v251
v_cmp_gt_u32 vcc, 8, v30
s_cbranch_vccnz L_spj_K
L_spjb_K:
s_lshl_b32 s50, s5, 2
s_lshr_b32 s51, 0xaaa99caa, s50
s_and_b32 s51, s51, 15
s_lshr_b32 s6, 0xcccbeecc, s50
s_and_b32 s6, s6, 15
s_lshr_b32 s61, 1984038193, s50
s_and_b32 s61, s61, 7
s_cmp_lt_u32 s51, s54
s_cselect_b32 s39, s51, s54
s_cselect_b32 s41, s55, s51
s_mov_b32 s36, 0
s_mov_b64 s[42:43], 0
s_mov_b64 s[44:45], 0
v_readlane_b32 s37, v29, 0
v_mov_b32 v2, v1
s_lshl_b32 s38, s3, 13
s_cmp_eq_u32 s3, 3
s_cselect_b32 s38, 0xa000, s38
s_mov_b32 s40, 196608
s_waitcnt lgkmcnt(0)
s_barrier
s_mov_b32 s12, s96
s_mov_b32 s13, s97
s_mov_b32 s14, 1152
s_mov_b32 s15, 0x20000
s_mov_b32 s20, s92
s_mov_b32 s21, s93
s_mov_b32 s22, 1152
s_mov_b32 s23, 0x20000
s_cmp_lg_u32 s3, 3
s_cbranch_scc1 L_i0_K
v_add_u32 v2, 0x4000, v2
v_and_b32 v2, 0xffff, v2
v_xor_b32 v3, 0x18000, v2
s_mov_b32 m0, 196608
ds_read_b128 a[160:163], v2 offset:8192
ds_read_b128 a[164:167], v2 offset:9216
ds_read_b128 a[168:171], v2 offset:10240
ds_read_b128 a[172:175], v2 offset:11264
ds_read_b128 a[176:179], v2 offset:12288
ds_read_b128 a[180:183], v2 offset:13312
ds_read_b128 a[184:187], v2 offset:14336
ds_read_b128 a[188:191], v2 offset:15360
s_waitcnt lgkmcnt(0)
s_branch L_head1_K
L_i0_K:
v_add_u32 v2, 0x4000, v2
v_and_b32 v2, 0xffff, v2
v_xor_b32 v3, 0x18000, v2
s_mov_b32 m0, 196608
s_cmp_lg_u32 s3, 2
s_cbranch_scc1 L_i1_K
ds_read_b128 a[160:163], v2 offset:0
ds_read_b128 a[164:167], v2 offset:1024
ds_read_b128 a[168:171], v2 offset:2048
ds_read_b128 a[172:175], v2 offset:3072
ds_read_b128 a[176:179], v2 offset:4096
ds_read_b128 a[180:183], v2 offset:5120
ds_read_b128 a[184:187], v2 offset:6144
ds_read_b128 a[188:191], v2 offset:7168
s_add_u32 s36, s36, 1
s_add_u32 s38, s38, 0x4000
s_and_b32 s38, s38, 0xffff
s_cmp_ge_u32 s36, s63
s_cselect_b32 s40, s62, 196608
v_readlane_b32 s37, v29, s36
s_waitcnt vmcnt(5) lgkmcnt(0)
s_barrier
s_cmp_ge_u32 s67, 576
s_cbranch_scc1 L_w2n_K
s_mul_i32 s50, s67, 7282
s_lshr_b32 s50, s50, 16
s_mul_i32 s51, s50, 9
s_sub_u32 s51, s67, s51
s_lshl_b32 s50, s50, 5
s_lshl_b32 s51, s51, 6
v_lshrrev_b32 v100, 3, v0
v_lshl_add_u32 v100, v100, 2, s50
v_and_b32 v101, 7, v0
v_lshl_add_u32 v101, v101, 3, s51
v_mul_u32_u24 v102, 1152, v100
v_lshl_add_u32 v102, v101, 1, v102
v_subrev_u32 v103, 3456, v102
v_subrev_u32 v116, 2304, v102
v_subrev_u32 v117, 1152, v102
v_lshlrev_b32 v118, 3, v101
buffer_load_dwordx4 v[128:131], v103, s[68:71], 0 offen
buffer_load_dwordx4 v[132:135], v116, s[68:71], 0 offen
buffer_load_dwordx4 v[136:139], v117, s[68:71], 0 offen
buffer_load_dwordx4 v[140:143], v102, s[68:71], 0 offen offset:0
buffer_load_dwordx4 v[144:147], v102, s[68:71], 0 offen offset:1152
buffer_load_dwordx4 v[148:151], v102, s[68:71], 0 offen offset:2304
buffer_load_dwordx4 v[152:155], v102, s[68:71], 0 offen offset:3456
buffer_load_dwordx4 v[156:159], v102, s[72:75], 0 offen offset:0
buffer_load_dwordx4 v[160:163], v102, s[72:75], 0 offen offset:1152
buffer_load_dwordx4 v[164:167], v102, s[72:75], 0 offen offset:2304
buffer_load_dwordx4 v[168:171], v102, s[72:75], 0 offen offset:3456
buffer_load_dwordx4 v[172:175], v118, s[76:79], 0 offen offset:0
buffer_load_dwordx4 v[176:179], v118, s[76:79], 0 offen offset:16
buffer_load_dwordx4 v[180:183], v118, s[76:79], 0 offen offset:32
buffer_load_dwordx4 v[184:187], v118, s[76:79], 0 offen offset:48
L_w2n_K:
v_xor_b32 v110, 0x8000, v110
ds_write_b128 v110, v[32:35] offset:0
ds_write_b128 v110, v[40:43] offset:1024
ds_write_b128 v110, v[48:51] offset:2048
ds_write_b128 v110, v[56:59] offset:3072
ds_write_b128 v110, v[64:67] offset:4096
ds_write_b128 v110, v[72:75] offset:5120
ds_write_b128 v110, v[80:83] offset:6144
ds_write_b128 v110, v[88:91] offset:7168
ds_write_b128 v110, v[96:99] offset:8192
ds_write_b128 v110, v[104:107] offset:9216
ds_write_b128 v110, v[112:115] offset:10240
ds_write_b128 v110, v[120:123] offset:11264
ds_write_b128 v110, v[60:63] offset:12288
ds_write_b128 v110, v[68:71] offset:13312
ds_write_b128 v110, v[76:79] offset:14336
ds_write_b128 v110, v[84:87] offset:15360
s_waitcnt vmcnt(15) lgkmcnt(0)
s_cmp_lt_u32 s67, 576
s_cbranch_scc1 L_head0_K
s_waitcnt vmcnt(0)
s_branch L_head0_K
L_i1_K:
buffer_load_dword v111, v15, s[28:31], s99 offen sc1
s_mul_i32 s50, s67, 7282
s_lshr_b32 s50, s50, 16
s_mul_i32 s51, s50, 9
s_sub_u32 s51, s67, s51
s_lshl_b32 s50, s50, 5
s_lshl_b32 s51, s51, 6
v_lshrrev_b32 v100, 3, v0
v_lshl_add_u32 v100, v100, 2, s50
v_and_b32 v101, 7, v0
v_lshl_add_u32 v101, v101, 3, s51
v_mul_u32_u24 v102, 1152, v100
v_lshl_add_u32 v102, v101, 1, v102
v_subrev_u32 v103, 3456, v102
v_subrev_u32 v116, 2304, v102
v_subrev_u32 v117, 1152, v102
v_lshlrev_b32 v118, 3, v101
buffer_load_dwordx4 v[128:131], v103, s[68:71], 0 offen
buffer_load_dwordx4 v[132:135], v116, s[68:71], 0 offen
buffer_load_dwordx4 v[136:139], v117, s[68:71], 0 offen
buffer_load_dwordx4 v[140:143], v102, s[68:71], 0 offen offset:0
buffer_load_dwordx4 v[144:147], v102, s[68:71], 0 offen offset:1152
buffer_load_dwordx4 v[148:151], v102, s[68:71], 0 offen offset:2304
buffer_load_dwordx4 v[152:155], v102, s[68:71], 0 offen offset:3456
buffer_load_dwordx4 v[156:159], v102, s[72:75], 0 offen offset:0
buffer_load_dwordx4 v[160:163], v102, s[72:75], 0 offen offset:1152
buffer_load_dwordx4 v[164:167], v102, s[72:75], 0 offen offset:2304
buffer_load_dwordx4 v[168:171], v102, s[72:75], 0 offen offset:3456
buffer_load_dwordx4 v[172:175], v118, s[76:79], 0 offen offset:0
buffer_load_dwordx4 v[176:179], v118, s[76:79], 0 offen offset:16
buffer_load_dwordx4 v[180:183], v118, s[76:79], 0 offen offset:32
buffer_load_dwordx4 v[184:187], v118, s[76:79], 0 offen offset:48
v_xor_b32 v110, 0x8000, v110
ds_write_b128 v110, v[32:35] offset:0
ds_write_b128 v110, v[40:43] offset:1024
ds_write_b128 v110, v[48:51] offset:2048
ds_write_b128 v110, v[56:59] offset:3072
ds_write_b128 v110, v[64:67] offset:4096
ds_write_b128 v110, v[72:75] offset:5120
ds_write_b128 v110, v[80:83] offset:6144
ds_write_b128 v110, v[88:91] offset:7168
ds_write_b128 v110, v[96:99] offset:8192
ds_write_b128 v110, v[104:107] offset:9216
ds_write_b128 v110, v[112:115] offset:10240
ds_write_b128 v110, v[120:123] offset:11264
ds_write_b128 v110, v[60:63] offset:12288
ds_write_b128 v110, v[68:71] offset:13312
ds_write_b128 v110, v[76:79] offset:14336
ds_write_b128 v110, v[84:87] offset:15360
s_add_u32 s36, s36, 1
s_add_u32 s38, s38, 0x4000
s_and_b32 s38, s38, 0xffff
s_cmp_ge_u32 s36, s63
s_cselect_b32 s40, s62, 196608
v_readlane_b32 s37, v29, s36
s_waitcnt vmcnt(21) lgkmcnt(0)
s_barrier
s_cmp_eq_u32 s3, 0
s_cbranch_scc1 L_w0_K
v_add_u32 v2, 0x4000, v2
v_and_b32 v2, 0xffff, v2
v_xor_b32 v3, 0x18000, v2
s_mov_b32 m0, 196608
ds_read_b128 a[160:163], v2 offset:8192
ds_read_b128 a[164:167], v2 offset:9216
ds_read_b128 a[168:171], v2 offset:10240
ds_read_b128 a[172:175], v2 offset:11264
ds_read_b128 a[176:179], v2 offset:12288
ds_read_b128 a[180:183], v2 offset:13312
ds_read_b128 a[184:187], v2 offset:14336
ds_read_b128 a[188:191], v2 offset:15360
s_waitcnt vmcnt(0) lgkmcnt(0)
s_call_b64 s[84:85], L_ua_K
s_branch L_head1_K
L_w0_K:
v_mov_b32 v92, s66
buffer_store_dword v92, v15, s[28:31], s99 offen
v_add_u32 v2, 0x4000, v2
v_and_b32 v2, 0xffff, v2
v_xor_b32 v3, 0x18000, v2
s_mov_b32 m0, 196608
ds_read_b128 a[160:163], v2 offset:0
ds_read_b128 a[164:167], v2 offset:1024
ds_read_b128 a[168:171], v2 offset:2048
ds_read_b128 a[172:175], v2 offset:3072
ds_read_b128 a[176:179], v2 offset:4096
ds_read_b128 a[180:183], v2 offset:5120
ds_read_b128 a[184:187], v2 offset:6144
ds_read_b128 a[188:191], v2 offset:7168
s_add_u32 s36, s36, 1
s_add_u32 s38, s38, 0x4000
s_and_b32 s38, s38, 0xffff
s_cmp_ge_u32 s36, s63
s_cselect_b32 s40, s62, 196608
v_readlane_b32 s37, v29, s36
s_and_b32 s50, s99, 0xffffff80
v_and_b32 v48, 7, v0
v_lshlrev_b32 v48, 2, v48
s_mov_b32 s51, 0
L_sp0_K:
buffer_load_dword v49, v48, s[28:31], s50 offen sc1
s_waitcnt vmcnt(0)
v_cmp_ne_u32 vcc, s66, v49
s_cbranch_vccnz L_mix_K
L_mixr_K:
v_readlane_b32 s50, v29, 1
s_mov_b32 m0, 16384
s_nop 3
buffer_load_dwordx4 v1, s[24:27], s50 offen offset:0 sc1 lds
buffer_load_dwordx4 v1, s[24:27], s50 offen offset:1024 sc1 lds
buffer_load_dwordx4 v1, s[24:27], s50 offen offset:2048 sc1 lds
buffer_load_dwordx4 v1, s[24:27], s50 offen offset:3072 sc1 lds
s_add_u32 m0, m0, 4096
s_add_u32 s50, s50, 4096
buffer_load_dwordx4 v1, s[24:27], s50 offen offset:0 sc1 lds
buffer_load_dwordx4 v1, s[24:27], s50 offen offset:1024 sc1 lds
buffer_load_dwordx4 v1, s[24:27], s50 offen offset:2048 sc1 lds
buffer_load_dwordx4 v1, s[24:27], s50 offen offset:3072 sc1 lds
s_add_u32 m0, m0, 4096
s_add_u32 s50, s50, 4096
buffer_load_dwordx4 v1, s[24:27], s50 offen offset:0 sc1 lds
buffer_load_dwordx4 v1, s[24:27], s50 offen offset:1024 sc1 lds
buffer_load_dwordx4 v1, s[24:27], s50 offen offset:2048 sc1 lds
buffer_load_dwordx4 v1, s[24:27], s50 offen offset:3072 sc1 lds
s_add_u32 m0, m0, 4096
s_add_u32 s50, s50, 4096
buffer_load_dwordx4 v1, s[24:27], s50 offen offset:0 sc1 lds
buffer_load_dwordx4 v1, s[24:27], s50 offen offset:1024 sc1 lds
buffer_load_dwordx4 v1, s[24:27], s50 offen offset:2048 sc1 lds
buffer_load_dwordx4 v1, s[24:27], s50 offen offset:3072 sc1 lds
s_waitcnt lgkmcnt(0)
s_barrier
s_call_b64 s[84:85], L_ua_K
s_call_b64 s[84:85], L_ub_K
s_branch L_head0_K
L_wo_K:
v_lshrrev_b32 v22, 2, v0
v_and_b32 v23, 7, v22
v_lshrrev_b32 v22, 3, v22
v_mul_u32_u24 v22, 5120, v22
v_lshl_add_u32 v22, v23, 7, v22
v_lshrrev_b32 v23, 1, v23
v_bfe_u32 v24, v0, 1, 1
v_xor_b32 v23, v23, v24
v_lshl_add_u32 v22, v23, 4, v22
v_and_b32 v24, 1, v0
v_lshl_add_u32 v22, v24, 3, v22
v_add_u32 v22, 131072, v22
v_xor_b32 v23, 32, v22
v_xor_b32 v24, 64, v22
v_xor_b32 v25, 96, v22
s_mul_i32 s50, s2, 18432
s_add_u32 s50, s50, 56623104
ds_read_b64_tr_b16 a[64:65], v22 offset:0
ds_read_b64_tr_b16 a[66:67], v22 offset:10240
ds_read_b64_tr_b16 a[68:69], v23 offset:0
ds_read_b64_tr_b16 a[70:71], v23 offset:10240
ds_read_b64_tr_b16 a[72:73], v24 offset:0
ds_read_b64_tr_b16 a[74:75], v24 offset:10240
ds_read_b64_tr_b16 a[76:77], v25 offset:0
ds_read_b64_tr_b16 a[78:79], v25 offset:10240
ds_read_b64_tr_b16 a[80:81], v22 offset:1024
ds_read_b64_tr_b16 a[82:83], v22 offset:11264
ds_read_b64_tr_b16 a[84:85], v23 offset:1024
ds_read_b64_tr_b16 a[86:87], v23 offset:11264
ds_read_b64_tr_b16 a[88:89], v24 offset:1024
ds_read_b64_tr_b16 a[90:91], v24 offset:11264
ds_read_b64_tr_b16 a[92:93], v25 offset:1024
ds_read_b64_tr_b16 a[94:95], v25 offset:11264
ds_read_b64_tr_b16 a[96:97], v22 offset:2048
ds_read_b64_tr_b16 a[98:99], v22 offset:12288
ds_read_b64_tr_b16 a[100:101], v23 offset:2048
ds_read_b64_tr_b16 a[102:103], v23 offset:12288
ds_read_b64_tr_b16 a[104:105], v24 offset:2048
ds_read_b64_tr_b16 a[106:107], v24 offset:12288
ds_read_b64_tr_b16 a[108:109], v25 offset:2048
ds_read_b64_tr_b16 a[110:111], v25 offset:12288
ds_read_b64_tr_b16 a[112:113], v22 offset:3072
ds_read_b64_tr_b16 a[114:115], v22 offset:13312
ds_read_b64_tr_b16 a[116:117], v23 offset:3072
ds_read_b64_tr_b16 a[118:119], v23 offset:13312
ds_read_b64_tr_b16 a[120:121], v24 offset:3072
ds_read_b64_tr_b16 a[122:123], v24 offset:13312
ds_read_b64_tr_b16 a[124:125], v25 offset:3072
ds_read_b64_tr_b16 a[126:127], v25 offset:13312
ds_read_b64_tr_b16 a[224:225], v22 offset:4096
ds_read_b64_tr_b16 a[226:227], v22 offset:14336
ds_read_b64_tr_b16 a[228:229], v23 offset:4096
ds_read_b64_tr_b16 a[230:231], v23 offset:14336
s_waitcnt lgkmcnt(14)
buffer_store_dwordx4 a[64:67], v1, s[28:31], s50 offen offset:0 sc1
buffer_store_dwordx4 a[68:71], v1, s[28:31], s50 offen offset:1024 sc1
buffer_store_dwordx4 a[72:75], v1, s[28:31], s50 offen offset:2048 sc1
buffer_store_dwordx4 a[76:79], v1, s[28:31], s50 offen offset:3072 sc1
s_add_u32 s50, s50, 4096
buffer_store_dwordx4 a[80:83], v1, s[28:31], s50 offen offset:0 sc1
buffer_store_dwordx4 a[84:87], v1, s[28:31], s50 offen offset:1024 sc1
buffer_store_dwordx4 a[88:91], v1, s[28:31], s50 offen offset:2048 sc1
buffer_store_dwordx4 a[92:95], v1, s[28:31], s50 offen offset:3072 sc1
s_add_u32 s50, s50, 4096
buffer_store_dwordx4 a[96:99], v1, s[28:31], s50 offen offset:0 sc1
buffer_store_dwordx4 a[100:103], v1, s[28:31], s50 offen offset:1024 sc1
buffer_store_dwordx4 a[104:107], v1, s[28:31], s50 offen offset:2048 sc1
s_waitcnt lgkmcnt(0)
buffer_store_dwordx4 a[108:111], v1, s[28:31], s50 offen offset:3072 sc1
s_add_u32 s50, s50, 4096
buffer_store_dwordx4 a[112:115], v1, s[28:31], s50 offen offset:0 sc1
buffer_store_dwordx4 a[116:119], v1, s[28:31], s50 offen offset:1024 sc1
buffer_store_dwordx4 a[120:123], v1, s[28:31], s50 offen offset:2048 sc1
buffer_store_dwordx4 a[124:127], v1, s[28:31], s50 offen offset:3072 sc1
s_add_u32 s50, s50, 4096
buffer_store_dwordx4 a[224:227], v1, s[28:31], s50 offen offset:0 sc1
buffer_store_dwordx4 a[228:231], v1, s[28:31], s50 offen offset:1024 sc1
s_branch L_r03_K
L_ua_K:
s_mov_b32 s51, 0x07060302
s_mov_b32 s52, 0x05040100
v_perm_b32 v32, v128, v132, s52
v_perm_b32 v33, v132, v136, s52
v_perm_b32 v34, v136, v140, s52
v_perm_b32 v35, v140, v144, s52
v_perm_b32 v36, v144, v148, s52
v_perm_b32 v37, v148, v152, s52
v_dot2_f32_bf16 v38, v32, v173, 0
v_dot2_f32_bf16 v39, v33, v173, 0
v_dot2_f32_bf16 v40, v34, v173, 0
v_dot2_f32_bf16 v41, v35, v173, 0
v_dot2_f32_bf16 v38, v34, v172, v38
v_dot2_f32_bf16 v39, v35, v172, v39
v_dot2_f32_bf16 v40, v36, v172, v40
v_dot2_f32_bf16 v41, v37, v172, v41
v_lshlrev_b32 v42, 16, v156
v_lshlrev_b32 v43, 16, v160
v_lshlrev_b32 v44, 16, v164
v_lshlrev_b32 v45, 16, v168
v_pk_mul_f32 v[38:39], v[38:39], v[42:43]
v_pk_mul_f32 v[40:41], v[40:41], v[44:45]
v_cvt_pk_bf16_f32 v64, v41, v40
v_cvt_pk_bf16_f32 v65, v39, v38
v_perm_b32 v32, v128, v132, s51
v_perm_b32 v33, v132, v136, s51
v_perm_b32 v34, v136, v140, s51
v_perm_b32 v35, v140, v144, s51
v_perm_b32 v36, v144, v148, s51
v_perm_b32 v37, v148, v152, s51
v_dot2_f32_bf16 v38, v32, v175, 0
v_dot2_f32_bf16 v39, v33, v175, 0
v_dot2_f32_bf16 v40, v34, v175, 0
v_dot2_f32_bf16 v41, v35, v175, 0
v_dot2_f32_bf16 v38, v34, v174, v38
v_dot2_f32_bf16 v39, v35, v174, v39
v_dot2_f32_bf16 v40, v36, v174, v40
v_dot2_f32_bf16 v41, v37, v174, v41
v_and_b32 v42, 0xffff0000, v156
v_and_b32 v43, 0xffff0000, v160
v_and_b32 v44, 0xffff0000, v164
v_and_b32 v45, 0xffff0000, v168
v_pk_mul_f32 v[38:39], v[38:39], v[42:43]
v_pk_mul_f32 v[40:41], v[40:41], v[44:45]
v_cvt_pk_bf16_f32 v66, v41, v40
v_cvt_pk_bf16_f32 v67, v39, v38
v_perm_b32 v32, v129, v133, s52
v_perm_b32 v33, v133, v137, s52
v_perm_b32 v34, v137, v141, s52
v_perm_b32 v35, v141, v145, s52
v_perm_b32 v36, v145, v149, s52
v_perm_b32 v37, v149, v153, s52
v_dot2_f32_bf16 v38, v32, v177, 0
v_dot2_f32_bf16 v39, v33, v177, 0
v_dot2_f32_bf16 v40, v34, v177, 0
v_dot2_f32_bf16 v41, v35, v177, 0
v_dot2_f32_bf16 v38, v34, v176, v38
v_dot2_f32_bf16 v39, v35, v176, v39
v_dot2_f32_bf16 v40, v36, v176, v40
v_dot2_f32_bf16 v41, v37, v176, v41
v_lshlrev_b32 v42, 16, v157
v_lshlrev_b32 v43, 16, v161
v_lshlrev_b32 v44, 16, v165
v_lshlrev_b32 v45, 16, v169
v_pk_mul_f32 v[38:39], v[38:39], v[42:43]
v_pk_mul_f32 v[40:41], v[40:41], v[44:45]
v_cvt_pk_bf16_f32 v68, v41, v40
v_cvt_pk_bf16_f32 v69, v39, v38
v_perm_b32 v32, v129, v133, s51
v_perm_b32 v33, v133, v137, s51
v_perm_b32 v34, v137, v141, s51
v_perm_b32 v35, v141, v145, s51
v_perm_b32 v36, v145, v149, s51
v_perm_b32 v37, v149, v153, s51
v_dot2_f32_bf16 v38, v32, v179, 0
v_dot2_f32_bf16 v39, v33, v179, 0
v_dot2_f32_bf16 v40, v34, v179, 0
v_dot2_f32_bf16 v41, v35, v179, 0
v_dot2_f32_bf16 v38, v34, v178, v38
v_dot2_f32_bf16 v39, v35, v178, v39
v_dot2_f32_bf16 v40, v36, v178, v40
v_dot2_f32_bf16 v41, v37, v178, v41
v_and_b32 v42, 0xffff0000, v157
v_and_b32 v43, 0xffff0000, v161
v_and_b32 v44, 0xffff0000, v165
v_and_b32 v45, 0xffff0000, v169
v_pk_mul_f32 v[38:39], v[38:39], v[42:43]
v_pk_mul_f32 v[40:41], v[40:41], v[44:45]
v_cvt_pk_bf16_f32 v70, v41, v40
v_cvt_pk_bf16_f32 v71, v39, v38
s_setpc_b64 s[84:85]
L_ub_K:
s_mov_b32 s51, 0x07060302
s_mov_b32 s52, 0x05040100
v_perm_b32 v32, v130, v134, s52
v_perm_b32 v33, v134, v138, s52
v_perm_b32 v34, v138, v142, s52
v_perm_b32 v35, v142, v146, s52
v_perm_b32 v36, v146, v150, s52
v_perm_b32 v37, v150, v154, s52
v_dot2_f32_bf16 v38, v32, v181, 0
v_dot2_f32_bf16 v39, v33, v181, 0
v_dot2_f32_bf16 v40, v34, v181, 0
v_dot2_f32_bf16 v41, v35, v181, 0
v_dot2_f32_bf16 v38, v34, v180, v38
v_dot2_f32_bf16 v39, v35, v180, v39
v_dot2_f32_bf16 v40, v36, v180, v40
v_dot2_f32_bf16 v41, v37, v180, v41
v_lshlrev_b32 v42, 16, v158
v_lshlrev_b32 v43, 16, v162
v_lshlrev_b32 v44, 16, v166
v_lshlrev_b32 v45, 16, v170
v_pk_mul_f32 v[38:39], v[38:39], v[42:43]
v_pk_mul_f32 v[40:41], v[40:41], v[44:45]
v_cvt_pk_bf16_f32 v72, v41, v40
v_cvt_pk_bf16_f32 v73, v39, v38
v_perm_b32 v32, v130, v134, s51
v_perm_b32 v33, v134, v138, s51
v_perm_b32 v34, v138, v142, s51
v_perm_b32 v35, v142, v146, s51
v_perm_b32 v36, v146, v150, s51
v_perm_b32 v37, v150, v154, s51
v_dot2_f32_bf16 v38, v32, v183, 0
v_dot2_f32_bf16 v39, v33, v183, 0
v_dot2_f32_bf16 v40, v34, v183, 0
v_dot2_f32_bf16 v41, v35, v183, 0
v_dot2_f32_bf16 v38, v34, v182, v38
v_dot2_f32_bf16 v39, v35, v182, v39
v_dot2_f32_bf16 v40, v36, v182, v40
v_dot2_f32_bf16 v41, v37, v182, v41
v_and_b32 v42, 0xffff0000, v158
v_and_b32 v43, 0xffff0000, v162
v_and_b32 v44, 0xffff0000, v166
v_and_b32 v45, 0xffff0000, v170
v_pk_mul_f32 v[38:39], v[38:39], v[42:43]
v_pk_mul_f32 v[40:41], v[40:41], v[44:45]
v_cvt_pk_bf16_f32 v74, v41, v40
v_cvt_pk_bf16_f32 v75, v39, v38
v_perm_b32 v32, v131, v135, s52
v_perm_b32 v33, v135, v139, s52
v_perm_b32 v34, v139, v143, s52
v_perm_b32 v35, v143, v147, s52
v_perm_b32 v36, v147, v151, s52
v_perm_b32 v37, v151, v155, s52
v_dot2_f32_bf16 v38, v32, v185, 0
v_dot2_f32_bf16 v39, v33, v185, 0
v_dot2_f32_bf16 v40, v34, v185, 0
v_dot2_f32_bf16 v41, v35, v185, 0
v_dot2_f32_bf16 v38, v34, v184, v38
v_dot2_f32_bf16 v39, v35, v184, v39
v_dot2_f32_bf16 v40, v36, v184, v40
v_dot2_f32_bf16 v41, v37, v184, v41
v_lshlrev_b32 v42, 16, v159
v_lshlrev_b32 v43, 16, v163
v_lshlrev_b32 v44, 16, v167
v_lshlrev_b32 v45, 16, v171
v_pk_mul_f32 v[38:39], v[38:39], v[42:43]
v_pk_mul_f32 v[40:41], v[40:41], v[44:45]
v_cvt_pk_bf16_f32 v76, v41, v40
v_cvt_pk_bf16_f32 v77, v39, v38
v_perm_b32 v32, v131, v135, s51
v_perm_b32 v33, v135, v139, s51
v_perm_b32 v34, v139, v143, s51
v_perm_b32 v35, v143, v147, s51
v_perm_b32 v36, v147, v151, s51
v_perm_b32 v37, v151, v155, s51
v_dot2_f32_bf16 v38, v32, v187, 0
v_dot2_f32_bf16 v39, v33, v187, 0
v_dot2_f32_bf16 v40, v34, v187, 0
v_dot2_f32_bf16 v41, v35, v187, 0
v_dot2_f32_bf16 v38, v34, v186, v38
v_dot2_f32_bf16 v39, v35, v186, v39
v_dot2_f32_bf16 v40, v36, v186, v40
v_dot2_f32_bf16 v41, v37, v186, v41
v_and_b32 v42, 0xffff0000, v159
v_and_b32 v43, 0xffff0000, v163
v_and_b32 v44, 0xffff0000, v167
v_and_b32 v45, 0xffff0000, v171
v_pk_mul_f32 v[38:39], v[38:39], v[42:43]
v_pk_mul_f32 v[40:41], v[40:41], v[44:45]
v_cvt_pk_bf16_f32 v78, v41, v40
v_cvt_pk_bf16_f32 v79, v39, v38
s_setpc_b64 s[84:85]
L_us_K:
v_or_b32 v119, 4, v100
v_sub_u32 v119, 2044, v119
v_lshlrev_b32 v119, 1, v119
v_bfe_u32 v118, v0, 3, 1
v_xor_b32 v118, 1, v118
v_add_u32 v118, v118, v101
v_lshl_add_u32 v119, v118, 12, v119
s_mov_b32 s50, 50331648
v_mov_b64 v[32:33], v[64:65]
s_nop 0
v_mov_b32_dpp v64, v66 row_ror:8 row_mask:0xf bank_mask:0x3
v_mov_b32_dpp v65, v67 row_ror:8 row_mask:0xf bank_mask:0x3
v_mov_b32_dpp v66, v32 row_ror:8 row_mask:0xf bank_mask:0xc
v_mov_b32_dpp v67, v33 row_ror:8 row_mask:0xf bank_mask:0xc
buffer_store_dwordx4 v[64:67], v119, s[28:31], s50 offen sc1
s_add_u32 s50, s50, 8192
v_mov_b64 v[32:33], v[68:69]
s_nop 0
v_mov_b32_dpp v68, v70 row_ror:8 row_mask:0xf bank_mask:0x3
v_mov_b32_dpp v69, v71 row_ror:8 row_mask:0xf bank_mask:0x3
v_mov_b32_dpp v70, v32 row_ror:8 row_mask:0xf bank_mask:0xc
v_mov_b32_dpp v71, v33 row_ror:8 row_mask:0xf bank_mask:0xc
buffer_store_dwordx4 v[68:71], v119, s[28:31], s50 offen sc1
s_add_u32 s50, s50, 8192
v_mov_b64 v[32:33], v[72:73]
s_nop 0
v_mov_b32_dpp v72, v74 row_ror:8 row_mask:0xf bank_mask:0x3
v_mov_b32_dpp v73, v75 row_ror:8 row_mask:0xf bank_mask:0x3
v_mov_b32_dpp v74, v32 row_ror:8 row_mask:0xf bank_mask:0xc
v_mov_b32_dpp v75, v33 row_ror:8 row_mask:0xf bank_mask:0xc
buffer_store_dwordx4 v[72:75], v119, s[28:31], s50 offen sc1
s_add_u32 s50, s50, 8192
v_mov_b64 v[32:33], v[76:77]
s_nop 0
v_mov_b32_dpp v76, v78 row_ror:8 row_mask:0xf bank_mask:0x3
v_mov_b32_dpp v77, v79 row_ror:8 row_mask:0xf bank_mask:0x3
v_mov_b32_dpp v78, v32 row_ror:8 row_mask:0xf bank_mask:0xc
v_mov_b32_dpp v79, v33 row_ror:8 row_mask:0xf bank_mask:0xc
buffer_store_dwordx4 v[76:79], v119, s[28:31], s50 offen sc1
s_setpc_b64 s[84:85]
L_h01_K:
s_waitcnt vmcnt(10)
s_cmp_eq_u32 s3, 0
s_cbranch_scc1 L_h01a_K
s_call_b64 s[84:85], L_ua_K
s_branch L_r01_K
L_h01a_K:
s_call_b64 s[84:85], L_us_K
s_branch L_r01_K
L_h03_K:
s_cmp_eq_u32 s3, 0
s_cbranch_scc1 L_wo_K
s_call_b64 s[84:85], L_ub_K
s_call_b64 s[84:85], L_us_K
s_branch L_r03_K
L_h10_K:
s_call_b64 s[84:85], L_ub_K
s_branch L_r10_K
L_h12_K:
s_call_b64 s[84:85], L_us_K
s_branch L_r12_K
L_head0_K:
v_mfma_f32_16x16x32_bf16 v[80:83], a[160:163], a[32:35], v[6:9]
s_or_b32 m0, s38, s40
s_add_u32 s53, s60, 0
v_mfma_f32_16x16x32_bf16 v[80:83], a[164:167], a[36:39], v[80:83]
buffer_load_dwordx4 v1, s[24:27], s37 offen offset:0 sc1 lds
v_mfma_f32_16x16x32_bf16 v[80:83], a[168:171], a[40:43], v[80:83]
buffer_store_dwordx4 a[68:71], v1, s[24:27], s53 offen offset:0 sc1
v_mfma_f32_16x16x32_bf16 v[80:83], a[172:175], a[44:47], v[80:83]
buffer_load_dwordx4 v1, s[24:27], s37 offen offset:1024 sc1 lds
v_mfma_f32_16x16x32_bf16 v[88:91], a[160:163], a[48:51], 0
v_add_u32 v2, 0x4000, v2
v_and_b32 v2, 0xffff, v2
ds_read_b128 a[160:163], v2 offset:8192
v_mfma_f32_16x16x32_bf16 v[88:91], a[164:167], a[52:55], v[88:91]
ds_read_b128 a[164:167], v2 offset:9216
v_xor_b32 v3, 0x18000, v2
v_mfma_f32_16x16x32_bf16 v[88:91], a[168:171], a[56:59], v[88:91]
ds_read_b128 a[168:171], v2 offset:10240
buffer_load_dwordx4 v1, s[24:27], s37 offen offset:2048 sc1 lds
v_mfma_f32_16x16x32_bf16 v[88:91], a[172:175], a[60:63], v[88:91]
ds_read_b128 a[172:175], v2 offset:11264
v_mfma_f32_16x16x32_bf16 v[92:95], a[176:179], a[48:51], v[6:9]
ds_read_b128 a[176:179], v2 offset:12288
buffer_load_dwordx4 v1, s[24:27], s37 offen offset:3072 sc1 lds
v_mfma_f32_16x16x32_bf16 v[92:95], a[180:183], a[52:55], v[92:95]
ds_read_b128 a[180:183], v2 offset:13312
v_mfma_f32_16x16x32_bf16 v[92:95], a[184:187], a[56:59], v[92:95]
ds_read_b128 a[184:187], v2 offset:14336
v_mfma_f32_16x16x32_bf16 v[92:95], a[188:191], a[60:63], v[92:95]
ds_read_b128 a[188:191], v2 offset:15360
s_waitcnt lgkmcnt(0)
v_mfma_f32_16x16x32_bf16 v[48:51], a[160:163], a[32:35], 0
v_exp_f32 v10, v80
s_add_u32 m0, m0, 4096
v_mov_b64 v[122:123], 0
v_mfma_f32_16x16x32_bf16 v[48:51], a[164:167], a[36:39], v[48:51]
buffer_load_dwordx4 v28, s[24:27], s37 offen offset:0 sc1 lds
s_add_u32 s36, s36, 1
v_mfma_f32_16x16x32_bf16 v[48:51], a[168:171], a[40:43], v[48:51]
buffer_store_dwordx4 a[76:79], v1, s[24:27], s53 offen offset:1024 sc1
v_exp_f32 v11, v81
v_mfma_f32_16x16x32_bf16 v[48:51], a[172:175], a[44:47], v[48:51]
v_exp_f32 v12, v82
v_cvt_pk_bf16_f32 v120, v10, v11
s_add_u32 s38, s38, 0x4000
v_mfma_f32_16x16x32_bf16 v[56:59], a[160:163], a[48:51], 0
ds_read_b128 a[160:163], v2 offset:0
v_exp_f32 v13, v83
v_mfma_f32_16x16x32_bf16 v[56:59], a[164:167], a[52:55], v[56:59]
ds_read_b128 a[164:167], v2 offset:1024
buffer_load_dwordx4 v28, s[24:27], s37 offen offset:1024 sc1 lds
s_and_b32 s38, s38, 0xffff
v_mfma_f32_16x16x32_bf16 v[56:59], a[168:171], a[56:59], v[56:59]
ds_read_b128 a[168:171], v2 offset:2048
v_exp_f32 v14, v88
v_cvt_pk_bf16_f32 v121, v12, v13
v_mfma_f32_16x16x32_bf16 v[56:59], a[172:175], a[60:63], v[56:59]
ds_read_b128 a[172:175], v2 offset:3072
v_exp_f32 v15, v89
v_mfma_f32_16x16x32_bf16 v[52:55], a[176:179], a[32:35], 0
buffer_load_dwordx4 v28, s[24:27], s37 offen offset:2048 sc1 lds
v_exp_f32 v16, v90
v_mfma_f32_16x16x32_bf16 v[52:55], a[180:183], a[36:39], v[52:55]
v_exp_f32 v17, v91
v_cvt_pk_bf16_f32 v124, v14, v15
v_mfma_f32_16x16x32_bf16 v[52:55], a[184:187], a[40:43], v[52:55]
v_exp_f32 v18, v92
v_exp_f32 v19, v93
v_cvt_pk_bf16_f32 v125, v16, v17
v_mfma_f32_16x16x32_bf16 v[52:55], a[188:191], a[44:47], v[52:55]
buffer_load_dwordx4 v28, s[24:27], s37 offen offset:3072 sc1 lds
v_cvt_pk_bf16_f32 v126, v18, v19
v_mfma_f32_16x16x32_bf16 v[60:63], a[176:179], a[48:51], 0
ds_read_b128 a[176:179], v2 offset:4096
v_readlane_b32 s37, v29, s36
v_mfma_f32_16x16x32_bf16 v[60:63], a[180:183], a[52:55], v[60:63]
ds_read_b128 a[180:183], v2 offset:5120
v_exp_f32 v20, v94
v_exp_f32 v21, v95
v_mfma_f32_16x16x32_bf16 v[60:63], a[184:187], a[56:59], v[60:63]
ds_read_b128 a[184:187], v2 offset:6144
s_cmp_ge_u32 s36, s63
s_cselect_b32 s40, s62, 196608
v_cvt_pk_bf16_f32 v127, v20, v21
v_mfma_f32_16x16x32_bf16 v[60:63], a[188:191], a[60:63], v[60:63]
ds_read_b128 a[188:191], v2 offset:7168
s_waitcnt vmcnt(18) lgkmcnt(0)
s_barrier
s_cmp_lt_u32 s67, 576
s_cbranch_scc1 L_h01_K
L_r01_K:
v_mfma_f32_16x16x32_bf16 v[80:83], a[160:163], a[32:35], 0
ds_read_b128 a[192:195], v3 offset:0
s_or_b32 m0, s38, s40
v_mfma_f32_16x16x32_bf16 v[80:83], a[164:167], a[36:39], v[80:83]
ds_read_b128 a[196:199], v3 offset:1024
v_exp_f32 v10, v48
v_mfma_f32_16x16x32_bf16 v[80:83], a[168:171], a[40:43], v[80:83]
ds_read_b128 a[200:203], v3 offset:2048
v_add_u32 v2, 0x4000, v2
v_mfma_f32_16x16x32_bf16 v[80:83], a[172:175], a[44:47], v[80:83]
ds_read_b128 a[204:207], v3 offset:3072
v_and_b32 v2, 0xffff, v2
v_mfma_f32_16x16x32_bf16 v[88:91], a[172:175], a[60:63], 0
v_exp_f32 v11, v49
v_mfma_f32_16x16x32_bf16 v[88:91], a[168:171], a[56:59], v[88:91]
ds_read_b128 a[208:211], v3 offset:4096
buffer_load_dwordx4 v1, s[24:27], s37 offen offset:0 sc1 lds
v_mfma_f32_16x16x32_bf16 v[88:91], a[164:167], a[52:55], v[88:91]
buffer_store_dwordx4 a[84:87], v1, s[24:27], s53 offen offset:2048 sc1
v_mfma_f32_16x16x32_bf16 v[88:91], a[160:163], a[48:51], v[88:91]
v_exp_f32 v12, v50
v_mfma_f32_16x16x32_bf16 v[84:87], a[176:179], a[32:35], 0
ds_read_b128 a[212:215], v3 offset:5120
v_cvt_pk_bf16_f32 v104, v10, v11
v_mfma_f32_16x16x32_bf16 v[84:87], a[180:183], a[36:39], v[84:87]
ds_read_b128 a[216:219], v3 offset:6144
v_exp_f32 v13, v51
v_mfma_f32_16x16x32_bf16 v[84:87], a[184:187], a[40:43], v[84:87]
v_exp_f32 v14, v52
v_mfma_f32_16x16x32_bf16 v[84:87], a[188:191], a[44:47], v[84:87]
ds_read_b128 a[220:223], v3 offset:7168
v_xor_b32 v3, 0x18000, v2
v_mfma_f32_16x16x32_bf16 v[92:95], a[188:191], a[60:63], 0
buffer_load_dwordx4 v1, s[24:27], s37 offen offset:1024 sc1 lds
v_mfma_f32_16x16x32_bf16 v[92:95], a[184:187], a[56:59], v[92:95]
ds_read_b128 a[160:163], v2 offset:8192
v_cvt_pk_bf16_f32 v105, v12, v13
v_mfma_f32_16x16x32_bf16 v[92:95], a[180:183], a[52:55], v[92:95]
ds_read_b128 a[164:167], v2 offset:9216
v_exp_f32 v15, v53
v_mfma_f32_16x16x32_bf16 v[92:95], a[176:179], a[48:51], v[92:95]
v_exp_f32 v16, v54
v_mfma_f32_16x16x32_bf16 a[136:139], a[144:147], v[120:123], 0
ds_read_b128 a[168:171], v2 offset:10240
v_cvt_pk_bf16_f32 v106, v14, v15
s_waitcnt lgkmcnt(3)
v_mfma_f32_16x16x32_bf16 a[140:143], a[144:147], v[124:127], 0
buffer_store_dwordx4 a[92:95], v1, s[24:27], s53 offen offset:3072 sc1
v_mfma_f32_16x16x32_bf16 v[224:227], a[192:195], v[124:127], 0
v_exp_f32 v17, v55
v_mfma_f32_16x16x32_bf16 v[192:195], a[192:195], v[120:123], 0
v_exp_f32 v18, v56
v_mfma_f32_16x16x32_bf16 v[196:199], a[196:199], v[120:123], 0
ds_read_b128 a[172:175], v2 offset:11264
buffer_load_dwordx4 v1, s[24:27], s37 offen offset:2048 sc1 lds
v_mfma_f32_16x16x32_bf16 v[228:231], a[196:199], v[124:127], 0
ds_read_b128 a[176:179], v2 offset:12288
v_cvt_pk_bf16_f32 v107, v16, v17
v_mfma_f32_16x16x32_bf16 v[232:235], a[200:203], v[124:127], 0
v_exp_f32 v19, v57
v_mfma_f32_16x16x32_bf16 v[200:203], a[200:203], v[120:123], 0
v_exp_f32 v20, v58
v_mfma_f32_16x16x32_bf16 v[204:207], a[204:207], v[120:123], 0
ds_read_b128 a[180:183], v2 offset:13312
v_cvt_pk_bf16_f32 v108, v18, v19
s_add_u32 s53, s60, 4096
v_mfma_f32_16x16x32_bf16 v[236:239], a[204:207], v[124:127], 0
v_exp_f32 v21, v59
v_mfma_f32_16x16x32_bf16 v[240:243], a[208:211], v[124:127], 0
buffer_store_dwordx4 a[100:103], v1, s[24:27], s53 offen offset:0 sc1
v_mfma_f32_16x16x32_bf16 v[208:211], a[208:211], v[120:123], 0
ds_read_b128 a[184:187], v2 offset:14336
v_cvt_pk_bf16_f32 v109, v20, v21
v_mfma_f32_16x16x32_bf16 v[212:215], a[212:215], v[120:123], 0
ds_read_b128 a[188:191], v2 offset:15360
buffer_load_dwordx4 v1, s[24:27], s37 offen offset:3072 sc1 lds
v_mfma_f32_16x16x32_bf16 v[244:247], a[212:215], v[124:127], 0
v_exp_f32 v10, v60
v_mfma_f32_16x16x32_bf16 v[248:251], a[216:219], v[124:127], 0
v_exp_f32 v11, v61
v_mfma_f32_16x16x32_bf16 v[216:219], a[216:219], v[120:123], 0
v_exp_f32 v12, v62
v_cvt_pk_bf16_f32 v110, v10, v11
v_mfma_f32_16x16x32_bf16 v[220:223], a[220:223], v[120:123], 0
v_exp_f32 v13, v63
v_mfma_f32_16x16x32_bf16 v[252:255], a[220:223], v[124:127], 0
v_cvt_pk_bf16_f32 v111, v12, v13
s_waitcnt lgkmcnt(0)
v_mfma_f32_16x16x32_bf16 v[48:51], a[160:163], a[32:35], 0
ds_read_b128 a[192:195], v3 offset:8192
s_add_u32 m0, m0, 4096
v_mfma_f32_16x16x32_bf16 v[48:51], a[164:167], a[36:39], v[48:51]
ds_read_b128 a[196:199], v3 offset:9216
v_exp_f32 v10, v80
v_mfma_f32_16x16x32_bf16 v[48:51], a[168:171], a[40:43], v[48:51]
v_exp_f32 v11, v81
v_mfma_f32_16x16x32_bf16 v[48:51], a[172:175], a[44:47], v[48:51]
ds_read_b128 a[200:203], v3 offset:10240
buffer_load_dwordx4 v28, s[24:27], s37 offen offset:0 sc1 lds
v_mfma_f32_16x16x32_bf16 v[56:59], a[172:175], a[60:63], 0
buffer_store_dwordx4 a[108:111], v1, s[24:27], s53 offen offset:1024 sc1
v_mfma_f32_16x16x32_bf16 v[56:59], a[168:171], a[56:59], v[56:59]
ds_read_b128 a[204:207], v3 offset:11264
s_add_u32 s36, s36, 1
v_mfma_f32_16x16x32_bf16 v[56:59], a[164:167], a[52:55], v[56:59]
ds_read_b128 a[208:211], v3 offset:12288
v_exp_f32 v12, v82
v_mfma_f32_16x16x32_bf16 v[56:59], a[160:163], a[48:51], v[56:59]
ds_read_b128 a[212:215], v3 offset:13312
v_cvt_pk_bf16_f32 v120, v10, v11
v_mfma_f32_16x16x32_bf16 v[52:55], a[176:179], a[32:35], 0
ds_read_b128 a[216:219], v3 offset:14336
s_add_u32 s38, s38, 0x4000
v_mfma_f32_16x16x32_bf16 v[52:55], a[180:183], a[36:39], v[52:55]
ds_read_b128 a[220:223], v3 offset:15360
s_and_b32 s38, s38, 0xffff
v_mfma_f32_16x16x32_bf16 v[52:55], a[184:187], a[40:43], v[52:55]
ds_read_b128 a[160:163], v2 offset:0
v_exp_f32 v13, v83
v_mfma_f32_16x16x32_bf16 v[52:55], a[188:191], a[44:47], v[52:55]
ds_read_b128 a[164:167], v2 offset:1024
v_exp_f32 v14, v84
v_mfma_f32_16x16x32_bf16 v[60:63], a[188:191], a[60:63], 0
buffer_load_dwordx4 v28, s[24:27], s37 offen offset:1024 sc1 lds
v_mfma_f32_16x16x32_bf16 v[60:63], a[184:187], a[56:59], v[60:63]
ds_read_b128 a[168:171], v2 offset:2048
v_cvt_pk_bf16_f32 v121, v12, v13
v_mfma_f32_16x16x32_bf16 v[60:63], a[180:183], a[52:55], v[60:63]
ds_read_b128 a[172:175], v2 offset:3072
v_exp_f32 v15, v85
v_mfma_f32_16x16x32_bf16 v[60:63], a[176:179], a[48:51], v[60:63]
v_exp_f32 v16, v86
v_mfma_f32_16x16x32_bf16 a[136:139], a[144:147], v[104:107], a[136:139]
ds_read_b128 a[176:179], v2 offset:4096
v_cvt_pk_bf16_f32 v122, v14, v15
s_waitcnt lgkmcnt(5)
v_mfma_f32_16x16x32_bf16 a[140:143], a[144:147], v[108:111], a[140:143]
buffer_store_dwordx4 a[116:119], v1, s[24:27], s53 offen offset:2048 sc1
v_mfma_f32_16x16x32_bf16 v[224:227], a[192:195], v[108:111], v[224:227]
v_exp_f32 v17, v87
v_mfma_f32_16x16x32_bf16 v[192:195], a[192:195], v[104:107], v[192:195]
ds_read_b128 a[180:183], v2 offset:5120
v_exp_f32 v18, v88
v_mfma_f32_16x16x32_bf16 v[196:199], a[196:199], v[104:107], v[196:199]
buffer_load_dwordx4 v28, s[24:27], s37 offen offset:2048 sc1 lds
v_mfma_f32_16x16x32_bf16 v[228:231], a[196:199], v[108:111], v[228:231]
ds_read_b128 a[184:187], v2 offset:6144
v_cvt_pk_bf16_f32 v123, v16, v17
v_mfma_f32_16x16x32_bf16 v[232:235], a[200:203], v[108:111], v[232:235]
ds_read_b128 a[188:191], v2 offset:7168
v_exp_f32 v19, v89
v_mfma_f32_16x16x32_bf16 v[200:203], a[200:203], v[104:107], v[200:203]
v_exp_f32 v20, v90
v_mfma_f32_16x16x32_bf16 v[204:207], a[204:207], v[104:107], v[204:207]
v_exp_f32 v21, v91
v_cvt_pk_bf16_f32 v124, v18, v19
v_mfma_f32_16x16x32_bf16 v[236:239], a[204:207], v[108:111], v[236:239]
buffer_store_dwordx4 a[124:127], v1, s[24:27], s53 offen offset:3072 sc1
v_mfma_f32_16x16x32_bf16 v[240:243], a[208:211], v[108:111], v[240:243]
v_exp_f32 v10, v92
v_mfma_f32_16x16x32_bf16 v[208:211], a[208:211], v[104:107], v[208:211]
buffer_load_dwordx4 v28, s[24:27], s37 offen offset:3072 sc1 lds
v_cvt_pk_bf16_f32 v125, v20, v21
v_mfma_f32_16x16x32_bf16 v[212:215], a[212:215], v[104:107], v[212:215]
v_readlane_b32 s37, v29, s36
v_mfma_f32_16x16x32_bf16 v[244:247], a[212:215], v[108:111], v[244:247]
v_exp_f32 v11, v93
v_mfma_f32_16x16x32_bf16 v[248:251], a[216:219], v[108:111], v[248:251]
v_exp_f32 v12, v94
v_cvt_pk_bf16_f32 v126, v10, v11
v_mfma_f32_16x16x32_bf16 v[216:219], a[216:219], v[104:107], v[216:219]
v_exp_f32 v13, v95
v_mfma_f32_16x16x32_bf16 v[220:223], a[220:223], v[104:107], v[220:223]
s_waitcnt vmcnt(24) lgkmcnt(0)
s_cmp_ge_u32 s36, s63
s_cselect_b32 s40, s62, 196608
v_mfma_f32_16x16x32_bf16 v[252:255], a[220:223], v[108:111], v[252:255]
v_cvt_pk_bf16_f32 v127, v12, v13
s_barrier
s_cmp_lt_u32 s67, 576
s_cbranch_scc1 L_h03_K
L_r03_K:
v_mfma_f32_16x16x32_bf16 v[80:83], a[160:163], a[32:35], 0
ds_read_b128 a[192:195], v3 offset:0
s_or_b32 m0, s38, s40
v_mfma_f32_16x16x32_bf16 v[80:83], a[164:167], a[36:39], v[80:83]
v_exp_f32 v10, v48
v_mfma_f32_16x16x32_bf16 v[80:83], a[168:171], a[40:43], v[80:83]
ds_read_b128 a[196:199], v3 offset:1024
v_mov_b64 v[128:129], 0
v_mfma_f32_16x16x32_bf16 v[80:83], a[172:175], a[44:47], v[80:83]
ds_read_b128 a[200:203], v3 offset:2048
v_add_u32 v2, 0x4000, v2
v_mfma_f32_16x16x32_bf16 v[88:91], a[172:175], a[60:63], 0
ds_read_b128 a[204:207], v3 offset:3072
v_and_b32 v2, 0xffff, v2
v_mfma_f32_16x16x32_bf16 v[88:91], a[168:171], a[56:59], v[88:91]
ds_read_b128 a[208:211], v3 offset:4096
buffer_load_dwordx4 v1, s[24:27], s37 offen offset:0 sc1 lds
v_mfma_f32_16x16x32_bf16 v[88:91], a[164:167], a[52:55], v[88:91]
ds_read_b128 a[212:215], v3 offset:5120
v_mov_b64 v[130:131], 0
v_mfma_f32_16x16x32_bf16 v[88:91], a[160:163], a[48:51], v[88:91]
v_exp_f32 v11, v49
v_mfma_f32_16x16x32_bf16 v[64:67], a[160:163], a[0:3], v[6:9]
ds_read_b128 a[216:219], v3 offset:6144
v_mov_b64 v[132:133], 0
v_mfma_f32_16x16x32_bf16 v[64:67], a[164:167], a[4:7], v[64:67]
ds_read_b128 a[220:223], v3 offset:7168
v_xor_b32 v3, 0x18000, v2
v_mfma_f32_16x16x32_bf16 v[64:67], a[168:171], a[8:11], v[64:67]
v_cvt_pk_bf16_f32 v104, v10, v11
v_mov_b64 v[134:135], 0
v_mfma_f32_16x16x32_bf16 v[64:67], a[172:175], a[12:15], v[64:67]
v_exp_f32 v12, v50
v_mfma_f32_16x16x32_bf16 v[72:75], a[172:175], a[28:31], 0
v_mov_b64 v[136:137], 0
v_mov_b64 v[138:139], 0
v_mfma_f32_16x16x32_bf16 v[72:75], a[168:171], a[24:27], v[72:75]
v_exp_f32 v13, v51
v_mfma_f32_16x16x32_bf16 v[72:75], a[164:167], a[20:23], v[72:75]
v_cvt_pk_bf16_f32 v105, v12, v13
v_mov_b64 v[140:141], 0
v_mfma_f32_16x16x32_bf16 v[72:75], a[160:163], a[16:19], v[72:75]
buffer_load_dwordx4 v1, s[24:27], s37 offen offset:1024 sc1 lds
v_mfma_f32_16x16x32_bf16 v[84:87], a[176:179], a[32:35], 0
ds_read_b128 a[160:163], v2 offset:8192
v_exp_f32 v14, v52
v_mfma_f32_16x16x32_bf16 v[84:87], a[180:183], a[36:39], v[84:87]
ds_read_b128 a[164:167], v2 offset:9216
v_mov_b64 v[142:143], 0
v_mfma_f32_16x16x32_bf16 v[84:87], a[184:187], a[40:43], v[84:87]
v_exp_f32 v15, v53
v_mfma_f32_16x16x32_bf16 v[84:87], a[188:191], a[44:47], v[84:87]
ds_read_b128 a[168:171], v2 offset:10240
v_mov_b64 v[144:145], 0
v_mfma_f32_16x16x32_bf16 v[92:95], a[188:191], a[60:63], 0
ds_read_b128 a[172:175], v2 offset:11264
v_mov_b64 v[146:147], 0
v_mfma_f32_16x16x32_bf16 v[92:95], a[184:187], a[56:59], v[92:95]
v_cvt_pk_bf16_f32 v106, v14, v15
v_mov_b64 v[148:149], 0
v_mfma_f32_16x16x32_bf16 v[92:95], a[180:183], a[52:55], v[92:95]
v_exp_f32 v16, v54
v_mfma_f32_16x16x32_bf16 v[92:95], a[176:179], a[48:51], v[92:95]
v_mov_b64 v[150:151], 0
v_mov_b64 v[152:153], 0
v_mfma_f32_16x16x32_bf16 v[76:79], a[188:191], a[28:31], v[6:9]
v_exp_f32 v17, v55
v_mfma_f32_16x16x32_bf16 v[76:79], a[184:187], a[24:27], v[76:79]
v_cvt_pk_bf16_f32 v107, v16, v17
v_mov_b64 v[154:155], 0
v_mfma_f32_16x16x32_bf16 v[76:79], a[180:183], a[20:23], v[76:79]
buffer_load_dwordx4 v1, s[24:27], s37 offen offset:2048 sc1 lds
v_mfma_f32_16x16x32_bf16 v[76:79], a[176:179], a[16:19], v[76:79]
v_exp_f32 v18, v56
v_mfma_f32_16x16x32_bf16 a[136:139], a[144:147], v[120:123], a[136:139]
ds_read_b128 a[176:179], v2 offset:12288
v_mov_b64 v[156:157], 0
v_mov_b64 v[158:159], 0
v_mfma_f32_16x16x32_bf16 a[140:143], a[144:147], v[124:127], a[140:143]
ds_read_b128 a[180:183], v2 offset:13312
s_waitcnt lgkmcnt(6)
v_mfma_f32_16x16x32_bf16 v[224:227], a[192:195], v[124:127], v[224:227]
v_exp_f32 v19, v57
v_mfma_f32_16x16x32_bf16 v[192:195], a[192:195], v[120:123], v[192:195]
ds_read_b128 a[184:187], v2 offset:14336
v_cvt_pk_bf16_f32 v108, v18, v19
v_mfma_f32_16x16x32_bf16 v[196:199], a[196:199], v[120:123], v[196:199]
v_exp_f32 v20, v58
v_mfma_f32_16x16x32_bf16 v[228:231], a[196:199], v[124:127], v[228:231]
ds_read_b128 a[188:191], v2 offset:15360
v_mov_b64 v[160:161], 0
v_mfma_f32_16x16x32_bf16 v[232:235], a[200:203], v[124:127], v[232:235]
v_mov_b64 v[162:163], 0
v_mov_b64 v[164:165], 0
v_mfma_f32_16x16x32_bf16 v[200:203], a[200:203], v[120:123], v[200:203]
v_exp_f32 v21, v59
v_mfma_f32_16x16x32_bf16 v[204:207], a[204:207], v[120:123], v[204:207]
v_cvt_pk_bf16_f32 v109, v20, v21
v_mov_b64 v[166:167], 0
v_mfma_f32_16x16x32_bf16 v[236:239], a[204:207], v[124:127], v[236:239]
buffer_load_dwordx4 v1, s[24:27], s37 offen offset:3072 sc1 lds
v_mfma_f32_16x16x32_bf16 v[240:243], a[208:211], v[124:127], v[240:243]
v_exp_f32 v10, v60
v_mfma_f32_16x16x32_bf16 v[208:211], a[208:211], v[120:123], v[208:211]
v_exp_f32 v11, v61
v_mov_b64 v[168:169], 0
v_mfma_f32_16x16x32_bf16 v[212:215], a[212:215], v[120:123], v[212:215]
v_mov_b64 v[170:171], 0
v_cvt_pk_bf16_f32 v110, v10, v11
v_mfma_f32_16x16x32_bf16 v[244:247], a[212:215], v[124:127], v[244:247]
v_mov_b64 v[172:173], 0
v_mov_b64 v[174:175], 0
v_mfma_f32_16x16x32_bf16 v[248:251], a[216:219], v[124:127], v[248:251]
v_exp_f32 v12, v62
v_mfma_f32_16x16x32_bf16 v[216:219], a[216:219], v[120:123], v[216:219]
v_exp_f32 v13, v63
v_mfma_f32_16x16x32_bf16 v[220:223], a[220:223], v[120:123], v[220:223]
v_mov_b64 v[176:177], 0
v_mov_b64 v[178:179], 0
v_mfma_f32_16x16x32_bf16 v[252:255], a[220:223], v[124:127], v[252:255]
v_cvt_pk_bf16_f32 v111, v12, v13
s_waitcnt lgkmcnt(0)
v_mfma_f32_16x16x32_bf16 v[48:51], a[160:163], a[32:35], 0
v_exp_f32 v10, v80
v_mfma_f32_16x16x32_bf16 v[48:51], a[164:167], a[36:39], v[48:51]
ds_read_b128 a[192:195], v3 offset:8192
s_add_u32 m0, m0, 4096
v_mfma_f32_16x16x32_bf16 v[48:51], a[168:171], a[40:43], v[48:51]
buffer_load_dwordx4 v28, s[24:27], s37 offen offset:0 sc1 lds
v_mfma_f32_16x16x32_bf16 v[48:51], a[172:175], a[44:47], v[48:51]
ds_read_b128 a[196:199], v3 offset:9216
v_mov_b64 v[114:115], 0
v_mfma_f32_16x16x32_bf16 v[56:59], a[172:175], a[60:63], 0
ds_read_b128 a[200:203], v3 offset:10240
v_mov_b64 v[180:181], 0
s_add_u32 s36, s36, 1
v_mfma_f32_16x16x32_bf16 v[56:59], a[168:171], a[56:59], v[56:59]
ds_read_b128 a[204:207], v3 offset:11264
s_add_u32 s38, s38, 0x4000
v_mfma_f32_16x16x32_bf16 v[56:59], a[164:167], a[52:55], v[56:59]
v_exp_f32 v11, v81
v_mfma_f32_16x16x32_bf16 v[56:59], a[160:163], a[48:51], v[56:59]
ds_read_b128 a[208:211], v3 offset:12288
s_and_b32 s38, s38, 0xffff
v_mfma_f32_16x16x32_bf16 v[32:35], a[160:163], a[0:3], 0
ds_read_b128 a[212:215], v3 offset:13312
v_exp_f32 v12, v82
v_mfma_f32_16x16x32_bf16 v[32:35], a[164:167], a[4:7], v[32:35]
ds_read_b128 a[216:219], v3 offset:14336
v_cvt_pk_bf16_f32 v120, v10, v11
v_mfma_f32_16x16x32_bf16 v[32:35], a[168:171], a[8:11], v[32:35]
v_exp_f32 v13, v83
v_mfma_f32_16x16x32_bf16 v[32:35], a[172:175], a[12:15], v[32:35]
v_exp_f32 v14, v84
v_mfma_f32_16x16x32_bf16 v[40:43], a[172:175], a[28:31], 0
ds_read_b128 a[220:223], v3 offset:15360
v_cvt_pk_bf16_f32 v121, v12, v13
v_mfma_f32_16x16x32_bf16 v[40:43], a[168:171], a[24:27], v[40:43]
v_exp_f32 v15, v85
v_mov_b64 v[182:183], 0
v_mfma_f32_16x16x32_bf16 v[40:43], a[164:167], a[20:23], v[40:43]
v_cvt_pk_bf16_f32 v122, v14, v15
v_mov_b64 v[184:185], 0
v_mfma_f32_16x16x32_bf16 v[40:43], a[160:163], a[16:19], v[40:43]
v_exp_f32 v16, v86
v_mfma_f32_16x16x32_bf16 v[52:55], a[176:179], a[32:35], 0
buffer_load_dwordx4 v28, s[24:27], s37 offen offset:1024 sc1 lds
v_mfma_f32_16x16x32_bf16 v[52:55], a[180:183], a[36:39], v[52:55]
v_exp_f32 v17, v87
v_mfma_f32_16x16x32_bf16 v[52:55], a[184:187], a[40:43], v[52:55]
ds_read_b128 a[160:163], v2 offset:0
v_exp_f32 v18, v88
v_mfma_f32_16x16x32_bf16 v[52:55], a[188:191], a[44:47], v[52:55]
ds_read_b128 a[164:167], v2 offset:1024
v_cvt_pk_bf16_f32 v123, v16, v17
v_mfma_f32_16x16x32_bf16 v[60:63], a[188:191], a[60:63], 0
v_exp_f32 v19, v89
v_mfma_f32_16x16x32_bf16 v[60:63], a[184:187], a[56:59], v[60:63]
v_exp_f32 v20, v90
v_mfma_f32_16x16x32_bf16 v[60:63], a[180:183], a[52:55], v[60:63]
ds_read_b128 a[168:171], v2 offset:2048
v_cvt_pk_bf16_f32 v124, v18, v19
v_mfma_f32_16x16x32_bf16 v[60:63], a[176:179], a[48:51], v[60:63]
ds_read_b128 a[172:175], v2 offset:3072
v_exp_f32 v21, v91
v_mfma_f32_16x16x32_bf16 v[36:39], a[176:179], a[0:3], 0
v_exp_f32 v10, v92
v_mfma_f32_16x16x32_bf16 v[36:39], a[180:183], a[4:7], v[36:39]
v_cvt_pk_bf16_f32 v125, v20, v21
v_mov_b64 v[186:187], 0
v_mfma_f32_16x16x32_bf16 v[36:39], a[184:187], a[8:11], v[36:39]
v_exp_f32 v11, v93
v_mfma_f32_16x16x32_bf16 v[36:39], a[188:191], a[12:15], v[36:39]
v_cvt_pk_bf16_f32 v126, v10, v11
v_mov_b64 v[188:189], 0
v_mfma_f32_16x16x32_bf16 v[44:47], a[188:191], a[28:31], 0
buffer_load_dwordx4 v28, s[24:27], s37 offen offset:2048 sc1 lds
v_mov_b64 v[190:191], 0
v_mfma_f32_16x16x32_bf16 v[44:47], a[184:187], a[24:27], v[44:47]
v_exp_f32 v12, v94
v_mfma_f32_16x16x32_bf16 v[44:47], a[180:183], a[20:23], v[44:47]
v_exp_f32 v13, v95
v_mfma_f32_16x16x32_bf16 v[44:47], a[176:179], a[16:19], v[44:47]
ds_read_b128 a[176:179], v2 offset:4096
v_cvt_pk_bf16_f32 v127, v12, v13
v_mfma_f32_16x16x32_bf16 a[136:139], a[144:147], v[104:107], a[136:139]
ds_read_b128 a[180:183], v2 offset:5120
v_exp_f32 v14, v64
v_mfma_f32_16x16x32_bf16 a[140:143], a[144:147], v[108:111], a[140:143]
ds_read_b128 a[184:187], v2 offset:6144
s_waitcnt lgkmcnt(7)
v_mfma_f32_16x16x32_bf16 v[224:227], a[192:195], v[108:111], v[224:227]
v_exp_f32 v15, v65
v_mfma_f32_16x16x32_bf16 v[192:195], a[192:195], v[104:107], v[192:195]
ds_read_b128 a[188:191], v2 offset:7168
v_cvt_pk_bf16_f32 v112, v14, v15
v_mfma_f32_16x16x32_bf16 v[196:199], a[196:199], v[104:107], v[196:199]
v_exp_f32 v16, v66
v_mfma_f32_16x16x32_bf16 v[228:231], a[196:199], v[108:111], v[228:231]
v_exp_f32 v17, v67
v_mfma_f32_16x16x32_bf16 v[232:235], a[200:203], v[108:111], v[232:235]
v_exp_f32 v18, v72
v_cvt_pk_bf16_f32 v113, v16, v17
v_mfma_f32_16x16x32_bf16 v[200:203], a[200:203], v[104:107], v[200:203]
v_exp_f32 v19, v73
v_mfma_f32_16x16x32_bf16 v[204:207], a[204:207], v[104:107], v[204:207]
buffer_load_dwordx4 v28, s[24:27], s37 offen offset:3072 sc1 lds
v_mfma_f32_16x16x32_bf16 v[236:239], a[204:207], v[108:111], v[236:239]
v_readlane_b32 s37, v29, s36
v_mfma_f32_16x16x32_bf16 v[240:243], a[208:211], v[108:111], v[240:243]
v_exp_f32 v20, v74
v_cvt_pk_bf16_f32 v116, v18, v19
v_mfma_f32_16x16x32_bf16 v[208:211], a[208:211], v[104:107], v[208:211]
v_exp_f32 v21, v75
v_mfma_f32_16x16x32_bf16 v[212:215], a[212:215], v[104:107], v[212:215]
v_exp_f32 v10, v76
v_mfma_f32_16x16x32_bf16 v[244:247], a[212:215], v[108:111], v[244:247]
v_exp_f32 v11, v77
v_mfma_f32_16x16x32_bf16 v[248:251], a[216:219], v[108:111], v[248:251]
v_cvt_pk_bf16_f32 v117, v20, v21
v_cvt_pk_bf16_f32 v118, v10, v11
v_mfma_f32_16x16x32_bf16 v[216:219], a[216:219], v[104:107], v[216:219]
v_exp_f32 v12, v78
v_mfma_f32_16x16x32_bf16 v[220:223], a[220:223], v[104:107], v[220:223]
v_exp_f32 v13, v79
s_waitcnt vmcnt(22) lgkmcnt(0)
v_mfma_f32_16x16x32_bf16 v[252:255], a[220:223], v[108:111], v[252:255]
v_cvt_pk_bf16_f32 v119, v12, v13
s_barrier
s_lshl_b32 s50, s5, 5
s_add_u32 s50, s50, s4
s_lshl_b32 s50, s50, 2
s_add_u32 s50, s50, s3
s_lshl_b32 s50, s50, 2
s_add_u32 s50, s50, 69222400
v_mul_u32_u24 v26, 0x400000, v0
v_mov_b32 v27, 1
s_waitcnt vmcnt(8)
buffer_store_dword v27, v26, s[28:31], s50 offen sc1
s_cmp_gt_u32 s36, s54
s_cbranch_scc1 L_da2_K
s_branch L_g2e_K
L_ev_K:
s_cmp_eq_u32 s36, s6
s_cbranch_scc1 L_ev2_K
s_lshl_b32 s64, s3, 10
s_add_u32 s64, s64, 69222400
v_add_u32 v26, s3, v0
v_lshlrev_b32 v26, 12, v26
v_mov_b32 v27, 1
s_lshl_b32 s50, s5, 5
s_add_u32 s50, s50, 4
buffer_atomic_add v27, v26, s[32:35], s50 offen sc0 sc1
buffer_load_dwordx4 v[22:25], v1, s[28:31], s64 offen sc1
s_lshl_b32 s50, s2, 2
s_add_u32 s50, s50, s3
s_mul_i32 s50, s50, 2304
v_min_u32 v26, 17, v0
v_lshlrev_b32 v26, 7, v26
buffer_load_dword v30, v26, s[8:11], s50 offen
s_cmp_lg_u32 s3, 3
s_cbranch_scc1 L_ev1_K
buffer_load_dword v30, v26, s[12:15], 0 offen
buffer_load_dword v30, v26, s[20:23], 0 offen
L_ev1_K:
s_cmp_lt_u32 s6, s54
s_cselect_b32 s39, s6, s54
s_cselect_b32 s41, s55, s6
s_branch L_evr_K
L_ev2_K:
s_waitcnt vmcnt(17)
s_cmp_lg_u32 s3, 0
s_cbranch_scc1 L_ev3_K
v_readfirstlane_b32 s50, v27
v_mov_b32 v26, 163836
s_nop 0
v_mov_b32 v27, s50
ds_write_b32 v26, v27
L_ev3_K:
v_min_u32 v22, v22, v23
v_min3_u32 v22, v22, v24, v25
v_cmp_eq_u32 vcc, 0, v22
s_mov_b32 s41, s55
s_mov_b32 s39, s54
s_cbranch_vccnz L_sp2_K
L_evr_K:
s_cmp_lt_u32 s36, s54
s_cbranch_scc1 L_g2o_K
s_branch L_g1o_K
L_head1_K:
v_mfma_f32_16x16x32_bf16 v[48:51], a[160:163], a[32:35], v[6:9]
s_add_u32 m0, m0, 4096
s_add_u32 s53, s60, 0
v_mfma_f32_16x16x32_bf16 v[48:51], a[164:167], a[36:39], v[48:51]
s_add_u32 s36, s36, 1
s_add_u32 s38, s38, 0x4000
v_mfma_f32_16x16x32_bf16 v[48:51], a[168:171], a[40:43], v[48:51]
v_readlane_b32 s37, v29, s36
v_mfma_f32_16x16x32_bf16 v[48:51], a[172:175], a[44:47], v[48:51]
buffer_store_dwordx4 a[68:71], v1, s[24:27], s53 offen offset:0 sc1
v_mfma_f32_16x16x32_bf16 v[56:59], a[160:163], a[48:51], 0
ds_read_b128 a[160:163], v2 offset:0
s_and_b32 s38, s38, 0xffff
v_mfma_f32_16x16x32_bf16 v[56:59], a[164:167], a[52:55], v[56:59]
ds_read_b128 a[164:167], v2 offset:1024
v_mfma_f32_16x16x32_bf16 v[56:59], a[168:171], a[56:59], v[56:59]
ds_read_b128 a[168:171], v2 offset:2048
v_mfma_f32_16x16x32_bf16 v[56:59], a[172:175], a[60:63], v[56:59]
ds_read_b128 a[172:175], v2 offset:3072
v_mfma_f32_16x16x32_bf16 v[60:63], a[176:179], a[48:51], v[6:9]
ds_read_b128 a[176:179], v2 offset:4096
v_mfma_f32_16x16x32_bf16 v[60:63], a[180:183], a[52:55], v[60:63]
ds_read_b128 a[180:183], v2 offset:5120
v_mfma_f32_16x16x32_bf16 v[60:63], a[184:187], a[56:59], v[60:63]
ds_read_b128 a[184:187], v2 offset:6144
s_cmp_ge_u32 s36, s63
s_cselect_b32 s40, s62, 196608
v_mfma_f32_16x16x32_bf16 v[60:63], a[188:191], a[60:63], v[60:63]
ds_read_b128 a[188:191], v2 offset:7168
s_waitcnt vmcnt(6) lgkmcnt(0)
s_barrier
s_cmp_eq_u32 s3, 1
s_cbranch_scc1 L_h10_K
L_r10_K:
v_mfma_f32_16x16x32_bf16 v[80:83], a[160:163], a[32:35], 0
v_exp_f32 v10, v48
s_or_b32 m0, s38, s40
v_mfma_f32_16x16x32_bf16 v[80:83], a[164:167], a[36:39], v[80:83]
buffer_load_dwordx4 v1, s[24:27], s37 offen offset:0 sc1 lds
v_mov_b64 v[106:107], 0
v_add_u32 v2, 0x4000, v2
v_mfma_f32_16x16x32_bf16 v[80:83], a[168:171], a[40:43], v[80:83]
v_exp_f32 v11, v49
v_and_b32 v2, 0xffff, v2
v_mfma_f32_16x16x32_bf16 v[80:83], a[172:175], a[44:47], v[80:83]
buffer_store_dwordx4 a[76:79], v1, s[24:27], s53 offen offset:1024 sc1
v_exp_f32 v12, v50
v_mfma_f32_16x16x32_bf16 v[88:91], a[160:163], a[48:51], 0
ds_read_b128 a[160:163], v2 offset:8192
v_exp_f32 v13, v51
v_mfma_f32_16x16x32_bf16 v[88:91], a[164:167], a[52:55], v[88:91]
ds_read_b128 a[164:167], v2 offset:9216
buffer_load_dwordx4 v1, s[24:27], s37 offen offset:1024 sc1 lds
v_mfma_f32_16x16x32_bf16 v[88:91], a[168:171], a[56:59], v[88:91]
ds_read_b128 a[168:171], v2 offset:10240
v_exp_f32 v14, v56
v_xor_b32 v3, 0x18000, v2
v_mfma_f32_16x16x32_bf16 v[88:91], a[172:175], a[60:63], v[88:91]
ds_read_b128 a[172:175], v2 offset:11264
v_cvt_pk_bf16_f32 v104, v10, v11
v_cvt_pk_bf16_f32 v105, v12, v13
v_mfma_f32_16x16x32_bf16 v[84:87], a[176:179], a[32:35], 0
buffer_load_dwordx4 v1, s[24:27], s37 offen offset:2048 sc1 lds
v_exp_f32 v15, v57
v_mfma_f32_16x16x32_bf16 v[84:87], a[180:183], a[36:39], v[84:87]
v_exp_f32 v16, v58
v_exp_f32 v17, v59
v_mfma_f32_16x16x32_bf16 v[84:87], a[184:187], a[40:43], v[84:87]
v_exp_f32 v18, v60
v_cvt_pk_bf16_f32 v108, v14, v15
v_mfma_f32_16x16x32_bf16 v[84:87], a[188:191], a[44:47], v[84:87]
buffer_load_dwordx4 v1, s[24:27], s37 offen offset:3072 sc1 lds
v_cvt_pk_bf16_f32 v109, v16, v17
v_mfma_f32_16x16x32_bf16 v[92:95], a[176:179], a[48:51], 0
ds_read_b128 a[176:179], v2 offset:12288
v_exp_f32 v19, v61
v_mfma_f32_16x16x32_bf16 v[92:95], a[180:183], a[52:55], v[92:95]
ds_read_b128 a[180:183], v2 offset:13312
v_exp_f32 v20, v62
v_cvt_pk_bf16_f32 v110, v18, v19
v_mfma_f32_16x16x32_bf16 v[92:95], a[184:187], a[56:59], v[92:95]
ds_read_b128 a[184:187], v2 offset:14336
v_exp_f32 v21, v63
v_mfma_f32_16x16x32_bf16 v[92:95], a[188:191], a[60:63], v[92:95]
ds_read_b128 a[188:191], v2 offset:15360
v_cvt_pk_bf16_f32 v111, v20, v21
s_waitcnt lgkmcnt(0)
v_mfma_f32_16x16x32_bf16 v[48:51], a[160:163], a[32:35], 0
ds_read_b128 a[192:195], v3 offset:8192
v_exp_f32 v10, v80
v_mfma_f32_16x16x32_bf16 v[48:51], a[164:167], a[36:39], v[48:51]
ds_read_b128 a[196:199], v3 offset:9216
s_add_u32 m0, m0, 4096
v_mfma_f32_16x16x32_bf16 v[48:51], a[168:171], a[40:43], v[48:51]
buffer_load_dwordx4 v28, s[24:27], s37 offen offset:0 sc1 lds
v_mfma_f32_16x16x32_bf16 v[48:51], a[172:175], a[44:47], v[48:51]
ds_read_b128 a[200:203], v3 offset:10240
s_add_u32 s36, s36, 1
s_add_u32 s38, s38, 0x4000
v_mfma_f32_16x16x32_bf16 v[56:59], a[172:175], a[60:63], 0
buffer_store_dwordx4 a[84:87], v1, s[24:27], s53 offen offset:2048 sc1
v_mfma_f32_16x16x32_bf16 v[56:59], a[168:171], a[56:59], v[56:59]
ds_read_b128 a[204:207], v3 offset:11264
v_exp_f32 v11, v81
v_mfma_f32_16x16x32_bf16 v[56:59], a[164:167], a[52:55], v[56:59]
ds_read_b128 a[208:211], v3 offset:12288
v_cvt_pk_bf16_f32 v120, v10, v11
v_mfma_f32_16x16x32_bf16 v[56:59], a[160:163], a[48:51], v[56:59]
v_exp_f32 v12, v82
v_mfma_f32_16x16x32_bf16 v[52:55], a[176:179], a[32:35], 0
ds_read_b128 a[212:215], v3 offset:13312
v_exp_f32 v13, v83
v_mfma_f32_16x16x32_bf16 v[52:55], a[180:183], a[36:39], v[52:55]
ds_read_b128 a[216:219], v3 offset:14336
v_cvt_pk_bf16_f32 v121, v12, v13
v_mfma_f32_16x16x32_bf16 v[52:55], a[184:187], a[40:43], v[52:55]
ds_read_b128 a[220:223], v3 offset:15360
s_and_b32 s38, s38, 0xffff
v_mfma_f32_16x16x32_bf16 v[52:55], a[188:191], a[44:47], v[52:55]
ds_read_b128 a[160:163], v2 offset:0
v_exp_f32 v14, v84
v_mfma_f32_16x16x32_bf16 v[60:63], a[188:191], a[60:63], 0
ds_read_b128 a[164:167], v2 offset:1024
buffer_load_dwordx4 v28, s[24:27], s37 offen offset:1024 sc1 lds
v_mfma_f32_16x16x32_bf16 v[60:63], a[184:187], a[56:59], v[60:63]
v_exp_f32 v15, v85
v_mfma_f32_16x16x32_bf16 v[60:63], a[180:183], a[52:55], v[60:63]
v_exp_f32 v16, v86
v_mfma_f32_16x16x32_bf16 v[60:63], a[176:179], a[48:51], v[60:63]
ds_read_b128 a[168:171], v2 offset:2048
buffer_store_dwordx4 a[92:95], v1, s[24:27], s53 offen offset:3072 sc1
v_mfma_f32_16x16x32_bf16 a[136:139], a[144:147], v[104:107], 0
ds_read_b128 a[172:175], v2 offset:3072
v_cvt_pk_bf16_f32 v122, v14, v15
v_mfma_f32_16x16x32_bf16 a[140:143], a[144:147], v[108:111], 0
s_waitcnt lgkmcnt(4)
buffer_load_dwordx4 v28, s[24:27], s37 offen offset:2048 sc1 lds
v_mfma_f32_16x16x32_bf16 v[224:227], a[192:195], v[108:111], 0
v_exp_f32 v17, v87
v_mfma_f32_16x16x32_bf16 v[192:195], a[192:195], v[104:107], 0
v_exp_f32 v18, v88
v_mfma_f32_16x16x32_bf16 v[196:199], a[196:199], v[104:107], 0
ds_read_b128 a[176:179], v2 offset:4096
v_cvt_pk_bf16_f32 v123, v16, v17
s_add_u32 s53, s60, 4096
v_mfma_f32_16x16x32_bf16 v[228:231], a[196:199], v[108:111], 0
v_exp_f32 v19, v89
v_mfma_f32_16x16x32_bf16 v[232:235], a[200:203], v[108:111], 0
ds_read_b128 a[180:183], v2 offset:5120
v_exp_f32 v20, v90
v_mfma_f32_16x16x32_bf16 v[200:203], a[200:203], v[104:107], 0
ds_read_b128 a[184:187], v2 offset:6144
v_cvt_pk_bf16_f32 v124, v18, v19
v_mfma_f32_16x16x32_bf16 v[204:207], a[204:207], v[104:107], 0
buffer_store_dwordx4 a[100:103], v1, s[24:27], s53 offen offset:0 sc1
v_mfma_f32_16x16x32_bf16 v[236:239], a[204:207], v[108:111], 0
ds_read_b128 a[188:191], v2 offset:7168
v_exp_f32 v21, v91
v_mfma_f32_16x16x32_bf16 v[240:243], a[208:211], v[108:111], 0
v_exp_f32 v10, v92
v_mfma_f32_16x16x32_bf16 v[208:211], a[208:211], v[104:107], 0
buffer_load_dwordx4 v28, s[24:27], s37 offen offset:3072 sc1 lds
v_cvt_pk_bf16_f32 v125, v20, v21
v_mfma_f32_16x16x32_bf16 v[212:215], a[212:215], v[104:107], 0
v_readlane_b32 s37, v29, s36
v_mfma_f32_16x16x32_bf16 v[244:247], a[212:215], v[108:111], 0
v_exp_f32 v11, v93
v_mfma_f32_16x16x32_bf16 v[248:251], a[216:219], v[108:111], 0
v_exp_f32 v12, v94
v_cvt_pk_bf16_f32 v126, v10, v11
v_mfma_f32_16x16x32_bf16 v[216:219], a[216:219], v[104:107], 0
v_exp_f32 v13, v95
v_mfma_f32_16x16x32_bf16 v[220:223], a[220:223], v[104:107], 0
s_waitcnt vmcnt(13) lgkmcnt(0)
s_cmp_ge_u32 s36, s63
s_cselect_b32 s40, s62, 196608
v_mfma_f32_16x16x32_bf16 v[252:255], a[220:223], v[108:111], 0
v_cvt_pk_bf16_f32 v127, v12, v13
s_barrier
s_cmp_eq_u32 s3, 1
s_cbranch_scc1 L_h12_K
L_r12_K:
v_mfma_f32_16x16x32_bf16 v[80:83], a[160:163], a[32:35], 0
ds_read_b128 a[192:195], v3 offset:0
s_or_b32 m0, s38, s40
v_mfma_f32_16x16x32_bf16 v[80:83], a[164:167], a[36:39], v[80:83]
v_exp_f32 v10, v48
v_mfma_f32_16x16x32_bf16 v[80:83], a[168:171], a[40:43], v[80:83]
ds_read_b128 a[196:199], v3 offset:1024
v_exp_f32 v11, v49
v_mfma_f32_16x16x32_bf16 v[80:83], a[172:175], a[44:47], v[80:83]
ds_read_b128 a[200:203], v3 offset:2048
v_add_u32 v2, 0x4000, v2
v_mfma_f32_16x16x32_bf16 v[88:91], a[172:175], a[60:63], 0
ds_read_b128 a[204:207], v3 offset:3072
v_and_b32 v2, 0xffff, v2
v_mfma_f32_16x16x32_bf16 v[88:91], a[168:171], a[56:59], v[88:91]
buffer_load_dwordx4 v1, s[24:27], s37 offen offset:0 sc1 lds
v_mfma_f32_16x16x32_bf16 v[88:91], a[164:167], a[52:55], v[88:91]
ds_read_b128 a[208:211], v3 offset:4096
buffer_store_dwordx4 a[108:111], v1, s[24:27], s53 offen offset:1024 sc1
v_mfma_f32_16x16x32_bf16 v[88:91], a[160:163], a[48:51], v[88:91]
v_exp_f32 v12, v50
v_mfma_f32_16x16x32_bf16 v[84:87], a[176:179], a[32:35], 0
ds_read_b128 a[212:215], v3 offset:5120
v_cvt_pk_bf16_f32 v104, v10, v11
v_mfma_f32_16x16x32_bf16 v[84:87], a[180:183], a[36:39], v[84:87]
v_exp_f32 v13, v51
v_mfma_f32_16x16x32_bf16 v[84:87], a[184:187], a[40:43], v[84:87]
ds_read_b128 a[216:219], v3 offset:6144
v_exp_f32 v14, v52
v_mfma_f32_16x16x32_bf16 v[84:87], a[188:191], a[44:47], v[84:87]
ds_read_b128 a[220:223], v3 offset:7168
v_xor_b32 v3, 0x18000, v2
v_mfma_f32_16x16x32_bf16 v[92:95], a[188:191], a[60:63], 0
buffer_load_dwordx4 v1, s[24:27], s37 offen offset:1024 sc1 lds
v_mfma_f32_16x16x32_bf16 v[92:95], a[184:187], a[56:59], v[92:95]
ds_read_b128 a[160:163], v2 offset:8192
v_cvt_pk_bf16_f32 v105, v12, v13
v_mfma_f32_16x16x32_bf16 v[92:95], a[180:183], a[52:55], v[92:95]
ds_read_b128 a[164:167], v2 offset:9216
v_exp_f32 v15, v53
v_mfma_f32_16x16x32_bf16 v[92:95], a[176:179], a[48:51], v[92:95]
v_exp_f32 v16, v54
v_mfma_f32_16x16x32_bf16 a[136:139], a[144:147], v[120:123], a[136:139]
ds_read_b128 a[168:171], v2 offset:10240
v_cvt_pk_bf16_f32 v106, v14, v15
v_mfma_f32_16x16x32_bf16 a[140:143], a[144:147], v[124:127], a[140:143]
ds_read_b128 a[172:175], v2 offset:11264
s_waitcnt lgkmcnt(4)
v_mfma_f32_16x16x32_bf16 v[224:227], a[192:195], v[124:127], v[224:227]
buffer_store_dwordx4 a[116:119], v1, s[24:27], s53 offen offset:2048 sc1
v_mfma_f32_16x16x32_bf16 v[192:195], a[192:195], v[120:123], v[192:195]
ds_read_b128 a[176:179], v2 offset:12288
v_exp_f32 v17, v55
v_mfma_f32_16x16x32_bf16 v[196:199], a[196:199], v[120:123], v[196:199]
buffer_load_dwordx4 v1, s[24:27], s37 offen offset:2048 sc1 lds
v_mfma_f32_16x16x32_bf16 v[228:231], a[196:199], v[124:127], v[228:231]
v_exp_f32 v18, v56
v_mfma_f32_16x16x32_bf16 v[232:235], a[200:203], v[124:127], v[232:235]
ds_read_b128 a[180:183], v2 offset:13312
v_cvt_pk_bf16_f32 v107, v16, v17
v_mfma_f32_16x16x32_bf16 v[200:203], a[200:203], v[120:123], v[200:203]
ds_read_b128 a[184:187], v2 offset:14336
v_exp_f32 v19, v57
v_mfma_f32_16x16x32_bf16 v[204:207], a[204:207], v[120:123], v[204:207]
v_exp_f32 v20, v58
v_mfma_f32_16x16x32_bf16 v[236:239], a[204:207], v[124:127], v[236:239]
ds_read_b128 a[188:191], v2 offset:15360
v_cvt_pk_bf16_f32 v108, v18, v19
v_mfma_f32_16x16x32_bf16 v[240:243], a[208:211], v[124:127], v[240:243]
v_exp_f32 v21, v59
v_mfma_f32_16x16x32_bf16 v[208:211], a[208:211], v[120:123], v[208:211]
buffer_store_dwordx4 a[124:127], v1, s[24:27], s53 offen offset:3072 sc1
v_cvt_pk_bf16_f32 v109, v20, v21
v_mfma_f32_16x16x32_bf16 v[212:215], a[212:215], v[120:123], v[212:215]
buffer_load_dwordx4 v1, s[24:27], s37 offen offset:3072 sc1 lds
v_mfma_f32_16x16x32_bf16 v[244:247], a[212:215], v[124:127], v[244:247]
v_exp_f32 v10, v60
v_mfma_f32_16x16x32_bf16 v[248:251], a[216:219], v[124:127], v[248:251]
v_exp_f32 v11, v61
v_mfma_f32_16x16x32_bf16 v[216:219], a[216:219], v[120:123], v[216:219]
v_exp_f32 v12, v62
v_cvt_pk_bf16_f32 v110, v10, v11
v_mfma_f32_16x16x32_bf16 v[220:223], a[220:223], v[120:123], v[220:223]
v_exp_f32 v13, v63
v_mfma_f32_16x16x32_bf16 v[252:255], a[220:223], v[124:127], v[252:255]
v_cvt_pk_bf16_f32 v111, v12, v13
s_waitcnt lgkmcnt(0)
v_mfma_f32_16x16x32_bf16 v[48:51], a[160:163], a[32:35], 0
ds_read_b128 a[192:195], v3 offset:8192
s_add_u32 m0, m0, 4096
v_mfma_f32_16x16x32_bf16 v[48:51], a[164:167], a[36:39], v[48:51]
ds_read_b128 a[196:199], v3 offset:9216
v_exp_f32 v10, v80
v_mfma_f32_16x16x32_bf16 v[48:51], a[168:171], a[40:43], v[48:51]
buffer_load_dwordx4 v28, s[24:27], s37 offen offset:0 sc1 lds
v_mfma_f32_16x16x32_bf16 v[48:51], a[172:175], a[44:47], v[48:51]
ds_read_b128 a[200:203], v3 offset:10240
v_mov_b64 v[128:129], 0
v_mfma_f32_16x16x32_bf16 v[56:59], a[172:175], a[60:63], 0
v_exp_f32 v11, v81
v_mfma_f32_16x16x32_bf16 v[56:59], a[168:171], a[56:59], v[56:59]
ds_read_b128 a[204:207], v3 offset:11264
v_mov_b64 v[130:131], 0
v_mfma_f32_16x16x32_bf16 v[56:59], a[164:167], a[52:55], v[56:59]
ds_read_b128 a[208:211], v3 offset:12288
v_mov_b64 v[132:133], 0
s_add_u32 s36, s36, 1
v_mfma_f32_16x16x32_bf16 v[56:59], a[160:163], a[48:51], v[56:59]
ds_read_b128 a[212:215], v3 offset:13312
s_add_u32 s38, s38, 0x4000
v_mfma_f32_16x16x32_bf16 v[32:35], a[160:163], a[0:3], v[6:9]
ds_read_b128 a[216:219], v3 offset:14336
s_and_b32 s38, s38, 0xffff
v_mfma_f32_16x16x32_bf16 v[32:35], a[164:167], a[4:7], v[32:35]
ds_read_b128 a[220:223], v3 offset:15360
v_mov_b64 v[134:135], 0
v_mfma_f32_16x16x32_bf16 v[32:35], a[168:171], a[8:11], v[32:35]
v_exp_f32 v12, v82
v_mfma_f32_16x16x32_bf16 v[32:35], a[172:175], a[12:15], v[32:35]
v_exp_f32 v13, v83
v_cvt_pk_bf16_f32 v120, v10, v11
v_mfma_f32_16x16x32_bf16 v[40:43], a[172:175], a[28:31], 0
v_mov_b64 v[136:137], 0
v_mov_b64 v[138:139], 0
v_mfma_f32_16x16x32_bf16 v[40:43], a[168:171], a[24:27], v[40:43]
v_mov_b64 v[140:141], 0
v_cvt_pk_bf16_f32 v121, v12, v13
v_mfma_f32_16x16x32_bf16 v[40:43], a[164:167], a[20:23], v[40:43]
v_exp_f32 v14, v84
v_mfma_f32_16x16x32_bf16 v[40:43], a[160:163], a[16:19], v[40:43]
buffer_load_dwordx4 v28, s[24:27], s37 offen offset:1024 sc1 lds
v_mfma_f32_16x16x32_bf16 v[52:55], a[176:179], a[32:35], 0
ds_read_b128 a[160:163], v2 offset:0
v_exp_f32 v15, v85
v_mfma_f32_16x16x32_bf16 v[52:55], a[180:183], a[36:39], v[52:55]
ds_read_b128 a[164:167], v2 offset:1024
v_mov_b64 v[142:143], 0
v_mfma_f32_16x16x32_bf16 v[52:55], a[184:187], a[40:43], v[52:55]
ds_read_b128 a[168:171], v2 offset:2048
v_mov_b64 v[144:145], 0
v_mfma_f32_16x16x32_bf16 v[52:55], a[188:191], a[44:47], v[52:55]
ds_read_b128 a[172:175], v2 offset:3072
v_mov_b64 v[146:147], 0
v_mfma_f32_16x16x32_bf16 v[60:63], a[188:191], a[60:63], 0
v_mov_b64 v[148:149], 0
v_cvt_pk_bf16_f32 v122, v14, v15
v_mfma_f32_16x16x32_bf16 v[60:63], a[184:187], a[56:59], v[60:63]
v_exp_f32 v16, v86
v_mfma_f32_16x16x32_bf16 v[60:63], a[180:183], a[52:55], v[60:63]
v_exp_f32 v17, v87
v_mov_b64 v[150:151], 0
v_mfma_f32_16x16x32_bf16 v[60:63], a[176:179], a[48:51], v[60:63]
v_mov_b64 v[152:153], 0
v_cvt_pk_bf16_f32 v123, v16, v17
v_mfma_f32_16x16x32_bf16 v[44:47], a[188:191], a[28:31], v[6:9]
v_exp_f32 v18, v88
v_mfma_f32_16x16x32_bf16 v[44:47], a[184:187], a[24:27], v[44:47]
v_exp_f32 v19, v89
v_mfma_f32_16x16x32_bf16 v[44:47], a[180:183], a[20:23], v[44:47]
buffer_load_dwordx4 v28, s[24:27], s37 offen offset:2048 sc1 lds
v_mfma_f32_16x16x32_bf16 v[44:47], a[176:179], a[16:19], v[44:47]
ds_read_b128 a[176:179], v2 offset:4096
v_mov_b64 v[154:155], 0
v_mov_b64 v[156:157], 0
v_mfma_f32_16x16x32_bf16 a[136:139], a[144:147], v[104:107], a[136:139]
ds_read_b128 a[180:183], v2 offset:5120
v_mov_b64 v[158:159], 0
v_mfma_f32_16x16x32_bf16 a[140:143], a[144:147], v[108:111], a[140:143]
ds_read_b128 a[184:187], v2 offset:6144
s_waitcnt lgkmcnt(7)
v_mfma_f32_16x16x32_bf16 v[224:227], a[192:195], v[108:111], v[224:227]
ds_read_b128 a[188:191], v2 offset:7168
v_cvt_pk_bf16_f32 v124, v18, v19
v_mfma_f32_16x16x32_bf16 v[192:195], a[192:195], v[104:107], v[192:195]
v_mov_b64 v[160:161], 0
v_mov_b64 v[162:163], 0
v_mfma_f32_16x16x32_bf16 v[196:199], a[196:199], v[104:107], v[196:199]
v_exp_f32 v20, v90
v_mov_b64 v[164:165], 0
v_mfma_f32_16x16x32_bf16 v[228:231], a[196:199], v[108:111], v[228:231]
v_exp_f32 v21, v91
v_mfma_f32_16x16x32_bf16 v[232:235], a[200:203], v[108:111], v[232:235]
v_exp_f32 v10, v92
v_mfma_f32_16x16x32_bf16 v[200:203], a[200:203], v[104:107], v[200:203]
v_cvt_pk_bf16_f32 v125, v20, v21
v_mov_b64 v[166:167], 0
v_mfma_f32_16x16x32_bf16 v[204:207], a[204:207], v[104:107], v[204:207]
buffer_load_dwordx4 v28, s[24:27], s37 offen offset:3072 sc1 lds
v_mfma_f32_16x16x32_bf16 v[236:239], a[204:207], v[108:111], v[236:239]
v_readlane_b32 s37, v29, s36
v_mfma_f32_16x16x32_bf16 v[240:243], a[208:211], v[108:111], v[240:243]
v_exp_f32 v11, v93
v_mov_b64 v[168:169], 0
v_mfma_f32_16x16x32_bf16 v[208:211], a[208:211], v[104:107], v[208:211]
v_mov_b64 v[170:171], 0
v_mov_b64 v[172:173], 0
v_mfma_f32_16x16x32_bf16 v[212:215], a[212:215], v[104:107], v[212:215]
v_mov_b64 v[174:175], 0
v_cvt_pk_bf16_f32 v126, v10, v11
v_mfma_f32_16x16x32_bf16 v[244:247], a[212:215], v[108:111], v[244:247]
v_exp_f32 v12, v94
v_mfma_f32_16x16x32_bf16 v[248:251], a[216:219], v[108:111], v[248:251]
v_mov_b64 v[176:177], 0
v_mov_b64 v[178:179], 0
v_mfma_f32_16x16x32_bf16 v[216:219], a[216:219], v[104:107], v[216:219]
v_exp_f32 v13, v95
v_mfma_f32_16x16x32_bf16 v[220:223], a[220:223], v[104:107], v[220:223]
s_waitcnt vmcnt(23) lgkmcnt(0)
s_cmp_ge_u32 s36, s63
s_cselect_b32 s40, s62, 196608
v_mfma_f32_16x16x32_bf16 v[252:255], a[220:223], v[108:111], v[252:255]
v_cvt_pk_bf16_f32 v127, v12, v13
s_barrier
v_mfma_f32_16x16x32_bf16 v[80:83], a[160:163], a[32:35], 0
ds_read_b128 a[192:195], v3 offset:0
s_or_b32 m0, s38, s40
v_mov_b64 v[98:99], 0
v_mfma_f32_16x16x32_bf16 v[80:83], a[164:167], a[36:39], v[80:83]
ds_read_b128 a[196:199], v3 offset:1024
v_add_u32 v2, 0x4000, v2
v_mfma_f32_16x16x32_bf16 v[80:83], a[168:171], a[40:43], v[80:83]
buffer_load_dwordx4 v1, s[24:27], s37 offen offset:0 sc1 lds
v_mfma_f32_16x16x32_bf16 v[80:83], a[172:175], a[44:47], v[80:83]
ds_read_b128 a[200:203], v3 offset:2048
v_and_b32 v2, 0xffff, v2
v_mfma_f32_16x16x32_bf16 v[88:91], a[172:175], a[60:63], 0
v_exp_f32 v10, v48
v_mfma_f32_16x16x32_bf16 v[88:91], a[168:171], a[56:59], v[88:91]
v_exp_f32 v11, v49
v_mfma_f32_16x16x32_bf16 v[88:91], a[164:167], a[52:55], v[88:91]
ds_read_b128 a[204:207], v3 offset:3072
v_cvt_pk_bf16_f32 v104, v10, v11
v_mfma_f32_16x16x32_bf16 v[88:91], a[160:163], a[48:51], v[88:91]
ds_read_b128 a[208:211], v3 offset:4096
v_mov_b64 v[180:181], 0
v_mfma_f32_16x16x32_bf16 v[64:67], a[160:163], a[0:3], 0
ds_read_b128 a[212:215], v3 offset:5120
v_exp_f32 v12, v50
v_mfma_f32_16x16x32_bf16 v[64:67], a[164:167], a[4:7], v[64:67]
v_exp_f32 v13, v51
v_mfma_f32_16x16x32_bf16 v[64:67], a[168:171], a[8:11], v[64:67]
ds_read_b128 a[216:219], v3 offset:6144
v_mov_b64 v[182:183], 0
v_mfma_f32_16x16x32_bf16 v[64:67], a[172:175], a[12:15], v[64:67]
v_exp_f32 v14, v52
v_mfma_f32_16x16x32_bf16 v[72:75], a[172:175], a[28:31], 0
ds_read_b128 a[220:223], v3 offset:7168
v_xor_b32 v3, 0x18000, v2
v_mfma_f32_16x16x32_bf16 v[72:75], a[168:171], a[24:27], v[72:75]
v_cvt_pk_bf16_f32 v105, v12, v13
v_mov_b64 v[184:185], 0
v_mfma_f32_16x16x32_bf16 v[72:75], a[164:167], a[20:23], v[72:75]
v_exp_f32 v15, v53
v_mfma_f32_16x16x32_bf16 v[72:75], a[160:163], a[16:19], v[72:75]
ds_read_b128 a[160:163], v2 offset:8192
v_exp_f32 v16, v54
v_mfma_f32_16x16x32_bf16 v[84:87], a[176:179], a[32:35], 0
buffer_load_dwordx4 v1, s[24:27], s37 offen offset:1024 sc1 lds
v_mfma_f32_16x16x32_bf16 v[84:87], a[180:183], a[36:39], v[84:87]
ds_read_b128 a[164:167], v2 offset:9216
v_cvt_pk_bf16_f32 v106, v14, v15
v_mfma_f32_16x16x32_bf16 v[84:87], a[184:187], a[40:43], v[84:87]
v_exp_f32 v17, v55
v_mfma_f32_16x16x32_bf16 v[84:87], a[188:191], a[44:47], v[84:87]
v_exp_f32 v18, v56
v_mfma_f32_16x16x32_bf16 v[92:95], a[188:191], a[60:63], 0
v_exp_f32 v19, v57
v_mfma_f32_16x16x32_bf16 v[92:95], a[184:187], a[56:59], v[92:95]
ds_read_b128 a[168:171], v2 offset:10240
v_cvt_pk_bf16_f32 v107, v16, v17
v_mfma_f32_16x16x32_bf16 v[92:95], a[180:183], a[52:55], v[92:95]
v_exp_f32 v20, v58
v_mfma_f32_16x16x32_bf16 v[92:95], a[176:179], a[48:51], v[92:95]
ds_read_b128 a[172:175], v2 offset:11264
v_exp_f32 v21, v59
v_mfma_f32_16x16x32_bf16 v[68:71], a[176:179], a[0:3], 0
v_cvt_pk_bf16_f32 v108, v18, v19
v_cvt_pk_bf16_f32 v109, v20, v21
v_mfma_f32_16x16x32_bf16 v[68:71], a[180:183], a[4:7], v[68:71]
v_exp_f32 v10, v60
v_mfma_f32_16x16x32_bf16 v[68:71], a[184:187], a[8:11], v[68:71]
buffer_load_dwordx4 v1, s[24:27], s37 offen offset:2048 sc1 lds
v_mfma_f32_16x16x32_bf16 v[68:71], a[188:191], a[12:15], v[68:71]
v_exp_f32 v11, v61
v_mfma_f32_16x16x32_bf16 v[76:79], a[188:191], a[28:31], 0
v_exp_f32 v12, v62
v_mfma_f32_16x16x32_bf16 v[76:79], a[184:187], a[24:27], v[76:79]
v_mov_b64 v[186:187], 0
v_cvt_pk_bf16_f32 v110, v10, v11
v_mfma_f32_16x16x32_bf16 v[76:79], a[180:183], a[20:23], v[76:79]
v_exp_f32 v13, v63
v_mov_b64 v[188:189], 0
v_mfma_f32_16x16x32_bf16 v[76:79], a[176:179], a[16:19], v[76:79]
v_exp_f32 v14, v32
v_mfma_f32_16x16x32_bf16 a[136:139], a[144:147], v[120:123], a[136:139]
v_exp_f32 v15, v33
v_mfma_f32_16x16x32_bf16 a[140:143], a[144:147], v[124:127], a[140:143]
ds_read_b128 a[176:179], v2 offset:12288
s_waitcnt lgkmcnt(5)
v_mfma_f32_16x16x32_bf16 v[224:227], a[192:195], v[124:127], v[224:227]
ds_read_b128 a[180:183], v2 offset:13312
v_cvt_pk_bf16_f32 v111, v12, v13
v_mfma_f32_16x16x32_bf16 v[192:195], a[192:195], v[120:123], v[192:195]
ds_read_b128 a[184:187], v2 offset:14336
v_cvt_pk_bf16_f32 v96, v14, v15
v_mfma_f32_16x16x32_bf16 v[196:199], a[196:199], v[120:123], v[196:199]
v_exp_f32 v16, v34
v_mfma_f32_16x16x32_bf16 v[228:231], a[196:199], v[124:127], v[228:231]
v_exp_f32 v17, v35
v_mfma_f32_16x16x32_bf16 v[232:235], a[200:203], v[124:127], v[232:235]
ds_read_b128 a[188:191], v2 offset:15360
v_exp_f32 v18, v40
v_mfma_f32_16x16x32_bf16 v[200:203], a[200:203], v[120:123], v[200:203]
v_exp_f32 v19, v41
v_mfma_f32_16x16x32_bf16 v[204:207], a[204:207], v[120:123], v[204:207]
buffer_load_dwordx4 v1, s[24:27], s37 offen offset:3072 sc1 lds
v_mfma_f32_16x16x32_bf16 v[236:239], a[204:207], v[124:127], v[236:239]
v_cvt_pk_bf16_f32 v97, v16, v17
v_cvt_pk_bf16_f32 v100, v18, v19
v_mfma_f32_16x16x32_bf16 v[240:243], a[208:211], v[124:127], v[240:243]
v_exp_f32 v20, v42
v_mfma_f32_16x16x32_bf16 v[208:211], a[208:211], v[120:123], v[208:211]
v_exp_f32 v21, v43
v_mfma_f32_16x16x32_bf16 v[212:215], a[212:215], v[120:123], v[212:215]
v_cvt_pk_bf16_f32 v101, v20, v21
v_mov_b64 v[190:191], 0
v_mfma_f32_16x16x32_bf16 v[244:247], a[212:215], v[124:127], v[244:247]
v_exp_f32 v10, v44
v_mfma_f32_16x16x32_bf16 v[248:251], a[216:219], v[124:127], v[248:251]
v_exp_f32 v11, v45
v_mfma_f32_16x16x32_bf16 v[216:219], a[216:219], v[120:123], v[216:219]
v_exp_f32 v12, v46
v_cvt_pk_bf16_f32 v102, v10, v11
v_mfma_f32_16x16x32_bf16 v[220:223], a[220:223], v[120:123], v[220:223]
v_exp_f32 v13, v47
v_mfma_f32_16x16x32_bf16 v[252:255], a[220:223], v[124:127], v[252:255]
v_cvt_pk_bf16_f32 v103, v12, v13
s_waitcnt lgkmcnt(0)
s_lshl_b32 s50, s5, 5
s_add_u32 s50, s50, s4
s_lshl_b32 s50, s50, 2
s_add_u32 s50, s50, s3
s_lshl_b32 s50, s50, 2
s_add_u32 s50, s50, 69222400
v_mul_u32_u24 v26, 0x400000, v0
v_mov_b32 v27, 1
s_waitcnt vmcnt(8)
buffer_store_dword v27, v26, s[28:31], s50 offen sc1
s_cmp_eq_u32 s36, s54
s_cbranch_scc1 L_g2x_K
L_g2o_K:
v_mfma_f32_16x16x32_bf16 v[48:51], a[160:163], a[32:35], 0
ds_read_b128 a[192:195], v3 offset:8192
s_add_u32 m0, m0, 4096
v_mfma_f32_16x16x32_bf16 v[48:51], a[164:167], a[36:39], v[48:51]
v_exp_f32 v10, v80
v_mfma_f32_16x16x32_bf16 v[48:51], a[168:171], a[40:43], v[48:51]
buffer_load_dwordx4 v28, s[24:27], s37 offen offset:0 sc1 lds
v_mfma_f32_16x16x32_bf16 v[48:51], a[172:175], a[44:47], v[48:51]
v_exp_f32 v11, v81
v_mfma_f32_16x16x32_bf16 v[56:59], a[172:175], a[60:63], 0
ds_read_b128 a[196:199], v3 offset:9216
s_add_u32 s36, s36, 1
v_mfma_f32_16x16x32_bf16 v[56:59], a[168:171], a[56:59], v[56:59]
v_cvt_pk_bf16_f32 v120, v10, v11
s_add_u32 s38, s38, 0x4000
v_mfma_f32_16x16x32_bf16 v[56:59], a[164:167], a[52:55], v[56:59]
v_exp_f32 v12, v82
v_mfma_f32_16x16x32_bf16 v[56:59], a[160:163], a[48:51], v[56:59]
ds_read_b128 a[200:203], v3 offset:10240
s_and_b32 s38, s38, 0xffff
v_mfma_f32_16x16x32_bf16 v[32:35], a[160:163], a[0:3], 0
v_exp_f32 v13, v83
v_mfma_f32_16x16x32_bf16 v[32:35], a[164:167], a[4:7], v[32:35]
v_cvt_pk_bf16_f32 v121, v12, v13
v_mfma_f32_16x16x32_bf16 v[32:35], a[168:171], a[8:11], v[32:35]
v_exp_f32 v14, v84
v_mfma_f32_16x16x32_bf16 v[32:35], a[172:175], a[12:15], v[32:35]
v_exp_f32 v15, v85
v_mfma_f32_16x16x32_bf16 v[40:43], a[172:175], a[28:31], 0
ds_read_b128 a[204:207], v3 offset:11264
v_cvt_pk_bf16_f32 v122, v14, v15
v_mfma_f32_16x16x32_bf16 v[40:43], a[168:171], a[24:27], v[40:43]
v_exp_f32 v16, v86
v_mfma_f32_16x16x32_bf16 v[40:43], a[164:167], a[20:23], v[40:43]
v_exp_f32 v17, v87
v_mfma_f32_16x16x32_bf16 v[40:43], a[160:163], a[16:19], v[40:43]
ds_read_b128 a[208:211], v3 offset:12288
v_mfma_f32_16x16x32_bf16 v[52:55], a[176:179], a[32:35], 0
v_cvt_pk_bf16_f32 v123, v16, v17
v_mfma_f32_16x16x32_bf16 v[52:55], a[180:183], a[36:39], v[52:55]
v_exp_f32 v18, v88
v_mfma_f32_16x16x32_bf16 v[52:55], a[184:187], a[40:43], v[52:55]
buffer_load_dwordx4 v28, s[24:27], s37 offen offset:1024 sc1 lds
v_mfma_f32_16x16x32_bf16 v[52:55], a[188:191], a[44:47], v[52:55]
v_exp_f32 v19, v89
v_mfma_f32_16x16x32_bf16 v[60:63], a[188:191], a[60:63], 0
ds_read_b128 a[212:215], v3 offset:13312
v_cvt_pk_bf16_f32 v124, v18, v19
v_mfma_f32_16x16x32_bf16 v[60:63], a[184:187], a[56:59], v[60:63]
v_exp_f32 v20, v90
v_mfma_f32_16x16x32_bf16 v[60:63], a[180:183], a[52:55], v[60:63]
v_exp_f32 v21, v91
v_mfma_f32_16x16x32_bf16 v[60:63], a[176:179], a[48:51], v[60:63]
ds_read_b128 a[216:219], v3 offset:14336
v_mfma_f32_16x16x32_bf16 v[36:39], a[176:179], a[0:3], 0
v_cvt_pk_bf16_f32 v125, v20, v21
v_mfma_f32_16x16x32_bf16 v[36:39], a[180:183], a[4:7], v[36:39]
v_exp_f32 v10, v92
v_mfma_f32_16x16x32_bf16 v[36:39], a[184:187], a[8:11], v[36:39]
ds_read_b128 a[220:223], v3 offset:15360
v_mfma_f32_16x16x32_bf16 v[36:39], a[188:191], a[12:15], v[36:39]
v_exp_f32 v11, v93
v_mfma_f32_16x16x32_bf16 v[44:47], a[188:191], a[28:31], 0
v_cvt_pk_bf16_f32 v126, v10, v11
v_mfma_f32_16x16x32_bf16 v[44:47], a[184:187], a[24:27], v[44:47]
v_exp_f32 v12, v94
v_mfma_f32_16x16x32_bf16 v[44:47], a[180:183], a[20:23], v[44:47]
v_exp_f32 v13, v95
v_mfma_f32_16x16x32_bf16 v[44:47], a[176:179], a[16:19], v[44:47]
v_mfma_f32_16x16x32_bf16 a[136:139], a[144:147], v[104:107], a[136:139]
ds_read_b128 a[160:163], v2 offset:0
v_cvt_pk_bf16_f32 v127, v12, v13
v_mfma_f32_16x16x32_bf16 a[140:143], a[144:147], v[108:111], a[140:143]
v_exp_f32 v14, v64
v_mfma_f32_16x16x32_bf16 a[128:131], a[144:147], v[96:99], a[128:131]
s_waitcnt lgkmcnt(1)
v_mfma_f32_16x16x32_bf16 a[132:135], a[144:147], v[100:103], a[132:135]
buffer_load_dwordx4 v28, s[24:27], s37 offen offset:2048 sc1 lds
v_mfma_f32_16x16x32_bf16 v[160:163], a[192:195], v[100:103], v[160:163]
v_exp_f32 v15, v65
v_mfma_f32_16x16x32_bf16 v[128:131], a[192:195], v[96:99], v[128:131]
ds_read_b128 a[164:167], v2 offset:1024
v_cvt_pk_bf16_f32 v112, v14, v15
v_mfma_f32_16x16x32_bf16 v[224:227], a[192:195], v[108:111], v[224:227]
v_exp_f32 v16, v66
v_mfma_f32_16x16x32_bf16 v[192:195], a[192:195], v[104:107], v[192:195]
v_exp_f32 v17, v67
v_mfma_f32_16x16x32_bf16 v[196:199], a[196:199], v[104:107], v[196:199]
ds_read_b128 a[168:171], v2 offset:2048
v_mfma_f32_16x16x32_bf16 v[228:231], a[196:199], v[108:111], v[228:231]
v_cvt_pk_bf16_f32 v113, v16, v17
v_mfma_f32_16x16x32_bf16 v[132:135], a[196:199], v[96:99], v[132:135]
v_exp_f32 v18, v68
v_mfma_f32_16x16x32_bf16 v[164:167], a[196:199], v[100:103], v[164:167]
v_exp_f32 v19, v69
v_mfma_f32_16x16x32_bf16 v[168:171], a[200:203], v[100:103], v[168:171]
ds_read_b128 a[172:175], v2 offset:3072
v_mfma_f32_16x16x32_bf16 v[136:139], a[200:203], v[96:99], v[136:139]
v_cvt_pk_bf16_f32 v114, v18, v19
v_mfma_f32_16x16x32_bf16 v[232:235], a[200:203], v[108:111], v[232:235]
v_exp_f32 v20, v70
v_mfma_f32_16x16x32_bf16 v[200:203], a[200:203], v[104:107], v[200:203]
ds_read_b128 a[176:179], v2 offset:4096
v_mfma_f32_16x16x32_bf16 v[204:207], a[204:207], v[104:107], v[204:207]
v_exp_f32 v21, v71
v_mfma_f32_16x16x32_bf16 v[236:239], a[204:207], v[108:111], v[236:239]
v_cvt_pk_bf16_f32 v115, v20, v21
v_mfma_f32_16x16x32_bf16 v[140:143], a[204:207], v[96:99], v[140:143]
v_exp_f32 v10, v72
v_mfma_f32_16x16x32_bf16 v[172:175], a[204:207], v[100:103], v[172:175]
buffer_load_dwordx4 v28, s[24:27], s37 offen offset:3072 sc1 lds
v_mfma_f32_16x16x32_bf16 v[176:179], a[208:211], v[100:103], v[176:179]
v_readlane_b32 s37, v29, s36
v_mfma_f32_16x16x32_bf16 v[144:147], a[208:211], v[96:99], v[144:147]
ds_read_b128 a[180:183], v2 offset:5120
v_mfma_f32_16x16x32_bf16 v[240:243], a[208:211], v[108:111], v[240:243]
v_exp_f32 v11, v73
v_mfma_f32_16x16x32_bf16 v[208:211], a[208:211], v[104:107], v[208:211]
ds_read_b128 a[184:187], v2 offset:6144
v_cvt_pk_bf16_f32 v116, v10, v11
v_mfma_f32_16x16x32_bf16 v[212:215], a[212:215], v[104:107], v[212:215]
v_exp_f32 v12, v74
v_mfma_f32_16x16x32_bf16 v[244:247], a[212:215], v[108:111], v[244:247]
v_exp_f32 v13, v75
v_mfma_f32_16x16x32_bf16 v[148:151], a[212:215], v[96:99], v[148:151]
ds_read_b128 a[188:191], v2 offset:7168
v_cvt_pk_bf16_f32 v117, v12, v13
v_mfma_f32_16x16x32_bf16 v[180:183], a[212:215], v[100:103], v[180:183]
v_exp_f32 v14, v76
v_mfma_f32_16x16x32_bf16 v[184:187], a[216:219], v[100:103], v[184:187]
v_exp_f32 v15, v77
v_mfma_f32_16x16x32_bf16 v[152:155], a[216:219], v[96:99], v[152:155]
v_cvt_pk_bf16_f32 v118, v14, v15
v_mfma_f32_16x16x32_bf16 v[248:251], a[216:219], v[108:111], v[248:251]
v_exp_f32 v16, v78
v_mfma_f32_16x16x32_bf16 v[216:219], a[216:219], v[104:107], v[216:219]
v_exp_f32 v17, v79
v_mfma_f32_16x16x32_bf16 v[220:223], a[220:223], v[104:107], v[220:223]
v_mfma_f32_16x16x32_bf16 v[252:255], a[220:223], v[108:111], v[252:255]
v_cvt_pk_bf16_f32 v119, v16, v17
v_mfma_f32_16x16x32_bf16 v[156:159], a[220:223], v[96:99], v[156:159]
s_waitcnt vmcnt(16) lgkmcnt(0)
v_mfma_f32_16x16x32_bf16 v[188:191], a[220:223], v[100:103], v[188:191]
s_barrier
L_g2e_K:
v_mfma_f32_16x16x32_bf16 v[80:83], a[160:163], a[32:35], 0
ds_read_b128 a[192:195], v3 offset:0
s_or_b32 m0, s38, s40
v_mfma_f32_16x16x32_bf16 v[80:83], a[164:167], a[36:39], v[80:83]
v_exp_f32 v10, v48
v_mfma_f32_16x16x32_bf16 v[80:83], a[168:171], a[40:43], v[80:83]
v_add_u32 v2, 0x4000, v2
v_and_b32 v2, 0xffff, v2
v_mfma_f32_16x16x32_bf16 v[80:83], a[172:175], a[44:47], v[80:83]
buffer_load_dwordx4 v1, s[24:27], s37 offen offset:0 sc1 lds
v_mfma_f32_16x16x32_bf16 v[88:91], a[172:175], a[60:63], 0
v_exp_f32 v11, v49
v_mfma_f32_16x16x32_bf16 v[88:91], a[168:171], a[56:59], v[88:91]
ds_read_b128 a[196:199], v3 offset:1024
v_cvt_pk_bf16_f32 v104, v10, v11
v_mfma_f32_16x16x32_bf16 v[88:91], a[164:167], a[52:55], v[88:91]
v_exp_f32 v12, v50
v_mfma_f32_16x16x32_bf16 v[88:91], a[160:163], a[48:51], v[88:91]
v_exp_f32 v13, v51
v_mfma_f32_16x16x32_bf16 v[64:67], a[160:163], a[0:3], 0
ds_read_b128 a[200:203], v3 offset:2048
v_cvt_pk_bf16_f32 v105, v12, v13
v_mfma_f32_16x16x32_bf16 v[64:67], a[164:167], a[4:7], v[64:67]
v_exp_f32 v14, v52
v_mfma_f32_16x16x32_bf16 v[64:67], a[168:171], a[8:11], v[64:67]
v_exp_f32 v15, v53
v_mfma_f32_16x16x32_bf16 v[64:67], a[172:175], a[12:15], v[64:67]
ds_read_b128 a[204:207], v3 offset:3072
v_mfma_f32_16x16x32_bf16 v[72:75], a[172:175], a[28:31], 0
v_cvt_pk_bf16_f32 v106, v14, v15
v_mfma_f32_16x16x32_bf16 v[72:75], a[168:171], a[24:27], v[72:75]
v_exp_f32 v16, v54
v_mfma_f32_16x16x32_bf16 v[72:75], a[164:167], a[20:23], v[72:75]
v_exp_f32 v17, v55
v_mfma_f32_16x16x32_bf16 v[72:75], a[160:163], a[16:19], v[72:75]
ds_read_b128 a[208:211], v3 offset:4096
v_mfma_f32_16x16x32_bf16 v[84:87], a[176:179], a[32:35], 0
v_cvt_pk_bf16_f32 v107, v16, v17
v_mfma_f32_16x16x32_bf16 v[84:87], a[180:183], a[36:39], v[84:87]
v_exp_f32 v18, v56
v_mfma_f32_16x16x32_bf16 v[84:87], a[184:187], a[40:43], v[84:87]
buffer_load_dwordx4 v1, s[24:27], s37 offen offset:1024 sc1 lds
v_mfma_f32_16x16x32_bf16 v[84:87], a[188:191], a[44:47], v[84:87]
v_exp_f32 v19, v57
v_mfma_f32_16x16x32_bf16 v[92:95], a[188:191], a[60:63], 0
ds_read_b128 a[212:215], v3 offset:5120
v_cvt_pk_bf16_f32 v108, v18, v19
v_mfma_f32_16x16x32_bf16 v[92:95], a[184:187], a[56:59], v[92:95]
v_exp_f32 v20, v58
v_mfma_f32_16x16x32_bf16 v[92:95], a[180:183], a[52:55], v[92:95]
v_exp_f32 v21, v59
v_mfma_f32_16x16x32_bf16 v[92:95], a[176:179], a[48:51], v[92:95]
ds_read_b128 a[216:219], v3 offset:6144
v_mfma_f32_16x16x32_bf16 v[68:71], a[176:179], a[0:3], 0
v_cvt_pk_bf16_f32 v109, v20, v21
v_mfma_f32_16x16x32_bf16 v[68:71], a[180:183], a[4:7], v[68:71]
v_exp_f32 v10, v60
v_mfma_f32_16x16x32_bf16 v[68:71], a[184:187], a[8:11], v[68:71]
ds_read_b128 a[220:223], v3 offset:7168
v_xor_b32 v3, 0x18000, v2
v_mfma_f32_16x16x32_bf16 v[68:71], a[188:191], a[12:15], v[68:71]
v_exp_f32 v11, v61
v_mfma_f32_16x16x32_bf16 v[76:79], a[188:191], a[28:31], 0
v_cvt_pk_bf16_f32 v110, v10, v11
v_mfma_f32_16x16x32_bf16 v[76:79], a[184:187], a[24:27], v[76:79]
v_exp_f32 v12, v62
v_mfma_f32_16x16x32_bf16 v[76:79], a[180:183], a[20:23], v[76:79]
v_exp_f32 v13, v63
v_mfma_f32_16x16x32_bf16 v[76:79], a[176:179], a[16:19], v[76:79]
v_mfma_f32_16x16x32_bf16 a[136:139], a[144:147], v[120:123], a[136:139]
ds_read_b128 a[160:163], v2 offset:8192
v_cvt_pk_bf16_f32 v111, v12, v13
v_mfma_f32_16x16x32_bf16 a[140:143], a[144:147], v[124:127], a[140:143]
v_exp_f32 v14, v32
v_mfma_f32_16x16x32_bf16 a[128:131], a[144:147], v[112:115], a[128:131]
s_waitcnt lgkmcnt(1)
v_mfma_f32_16x16x32_bf16 a[132:135], a[144:147], v[116:119], a[132:135]
buffer_load_dwordx4 v1, s[24:27], s37 offen offset:2048 sc1 lds
v_mfma_f32_16x16x32_bf16 v[160:163], a[192:195], v[116:119], v[160:163]
v_exp_f32 v15, v33
v_mfma_f32_16x16x32_bf16 v[128:131], a[192:195], v[112:115], v[128:131]
ds_read_b128 a[164:167], v2 offset:9216
v_cvt_pk_bf16_f32 v96, v14, v15
v_mfma_f32_16x16x32_bf16 v[224:227], a[192:195], v[124:127], v[224:227]
v_exp_f32 v16, v34
v_mfma_f32_16x16x32_bf16 v[192:195], a[192:195], v[120:123], v[192:195]
v_exp_f32 v17, v35
v_mfma_f32_16x16x32_bf16 v[196:199], a[196:199], v[120:123], v[196:199]
ds_read_b128 a[168:171], v2 offset:10240
v_mfma_f32_16x16x32_bf16 v[228:231], a[196:199], v[124:127], v[228:231]
v_cvt_pk_bf16_f32 v97, v16, v17
v_mfma_f32_16x16x32_bf16 v[132:135], a[196:199], v[112:115], v[132:135]
v_exp_f32 v18, v36
v_mfma_f32_16x16x32_bf16 v[164:167], a[196:199], v[116:119], v[164:167]
v_exp_f32 v19, v37
v_mfma_f32_16x16x32_bf16 v[168:171], a[200:203], v[116:119], v[168:171]
ds_read_b128 a[172:175], v2 offset:11264
v_mfma_f32_16x16x32_bf16 v[136:139], a[200:203], v[112:115], v[136:139]
v_cvt_pk_bf16_f32 v98, v18, v19
v_mfma_f32_16x16x32_bf16 v[232:235], a[200:203], v[124:127], v[232:235]
v_exp_f32 v20, v38
v_mfma_f32_16x16x32_bf16 v[200:203], a[200:203], v[120:123], v[200:203]
ds_read_b128 a[176:179], v2 offset:12288
v_mfma_f32_16x16x32_bf16 v[204:207], a[204:207], v[120:123], v[204:207]
v_exp_f32 v21, v39
v_mfma_f32_16x16x32_bf16 v[236:239], a[204:207], v[124:127], v[236:239]
v_cvt_pk_bf16_f32 v99, v20, v21
v_mfma_f32_16x16x32_bf16 v[140:143], a[204:207], v[112:115], v[140:143]
v_exp_f32 v10, v40
v_mfma_f32_16x16x32_bf16 v[172:175], a[204:207], v[116:119], v[172:175]
buffer_load_dwordx4 v1, s[24:27], s37 offen offset:3072 sc1 lds
v_mfma_f32_16x16x32_bf16 v[176:179], a[208:211], v[116:119], v[176:179]
ds_read_b128 a[180:183], v2 offset:13312
v_mfma_f32_16x16x32_bf16 v[144:147], a[208:211], v[112:115], v[144:147]
v_exp_f32 v11, v41
v_mfma_f32_16x16x32_bf16 v[240:243], a[208:211], v[124:127], v[240:243]
ds_read_b128 a[184:187], v2 offset:14336
v_cvt_pk_bf16_f32 v100, v10, v11
v_mfma_f32_16x16x32_bf16 v[208:211], a[208:211], v[120:123], v[208:211]
v_exp_f32 v12, v42
v_mfma_f32_16x16x32_bf16 v[212:215], a[212:215], v[120:123], v[212:215]
v_exp_f32 v13, v43
v_mfma_f32_16x16x32_bf16 v[244:247], a[212:215], v[124:127], v[244:247]
ds_read_b128 a[188:191], v2 offset:15360
v_cvt_pk_bf16_f32 v101, v12, v13
v_mfma_f32_16x16x32_bf16 v[148:151], a[212:215], v[112:115], v[148:151]
v_exp_f32 v14, v44
v_mfma_f32_16x16x32_bf16 v[180:183], a[212:215], v[116:119], v[180:183]
v_exp_f32 v15, v45
v_mfma_f32_16x16x32_bf16 v[184:187], a[216:219], v[116:119], v[184:187]
v_mfma_f32_16x16x32_bf16 v[152:155], a[216:219], v[112:115], v[152:155]
v_cvt_pk_bf16_f32 v102, v14, v15
v_mfma_f32_16x16x32_bf16 v[248:251], a[216:219], v[124:127], v[248:251]
v_exp_f32 v16, v46
v_mfma_f32_16x16x32_bf16 v[216:219], a[216:219], v[120:123], v[216:219]
v_exp_f32 v17, v47
v_mfma_f32_16x16x32_bf16 v[220:223], a[220:223], v[120:123], v[220:223]
v_mfma_f32_16x16x32_bf16 v[252:255], a[220:223], v[124:127], v[252:255]
v_cvt_pk_bf16_f32 v103, v16, v17
v_mfma_f32_16x16x32_bf16 v[156:159], a[220:223], v[112:115], v[156:159]
s_waitcnt lgkmcnt(0)
v_mfma_f32_16x16x32_bf16 v[188:191], a[220:223], v[116:119], v[188:191]
s_cmp_lg_u32 s36, s39
s_cbranch_scc1 L_g2o_K
s_cmp_lg_u32 s36, s54
s_cbranch_scc1 L_ev_K
L_g2x_K:
s_cmp_eq_u32 s5, 7
s_cbranch_scc1 L_dc_K
v_mfma_f32_16x16x32_bf16 v[48:51], a[160:163], a[32:35], 0
ds_read_b128 a[192:195], v3 offset:8192
s_add_u32 m0, m0, 4096
v_mfma_f32_16x16x32_bf16 v[48:51], a[164:167], a[36:39], v[48:51]
ds_read_b128 a[196:199], v3 offset:9216
buffer_load_dwordx4 v28, s[24:27], s37 offen offset:0 sc1 lds
v_mfma_f32_16x16x32_bf16 v[48:51], a[168:171], a[40:43], v[48:51]
v_exp_f32 v10, v80
v_mfma_f32_16x16x32_bf16 v[48:51], a[172:175], a[44:47], v[48:51]
v_exp_f32 v11, v81
v_mfma_f32_16x16x32_bf16 v[56:59], a[172:175], a[60:63], 0
v_exp_f32 v12, v82
v_mfma_f32_16x16x32_bf16 v[56:59], a[168:171], a[56:59], v[56:59]
ds_read_b128 a[200:203], v3 offset:10240
v_cvt_pk_bf16_f32 v120, v10, v11
v_mfma_f32_16x16x32_bf16 v[56:59], a[164:167], a[52:55], v[56:59]
ds_read_b128 a[204:207], v3 offset:11264
s_add_u32 s36, s36, 1
v_mfma_f32_16x16x32_bf16 v[56:59], a[160:163], a[48:51], v[56:59]
ds_read_b128 a[208:211], v3 offset:12288
v_exp_f32 v13, v83
v_mfma_f32_16x16x32_bf16 v[52:55], a[176:179], a[32:35], 0
ds_read_b128 a[212:215], v3 offset:13312
v_cvt_pk_bf16_f32 v121, v12, v13
v_mfma_f32_16x16x32_bf16 v[52:55], a[180:183], a[36:39], v[52:55]
v_exp_f32 v14, v84
v_mfma_f32_16x16x32_bf16 v[52:55], a[184:187], a[40:43], v[52:55]
ds_read_b128 a[216:219], v3 offset:14336
s_add_u32 s38, s38, 0x4000
v_mfma_f32_16x16x32_bf16 v[52:55], a[188:191], a[44:47], v[52:55]
ds_read_b128 a[220:223], v3 offset:15360
s_and_b32 s38, s38, 0xffff
v_mfma_f32_16x16x32_bf16 v[60:63], a[188:191], a[60:63], 0
v_exp_f32 v15, v85
v_mfma_f32_16x16x32_bf16 v[60:63], a[184:187], a[56:59], v[60:63]
ds_read_b128 a[160:163], v2 offset:0
v_exp_f32 v16, v86
v_mfma_f32_16x16x32_bf16 v[60:63], a[180:183], a[52:55], v[60:63]
ds_read_b128 a[164:167], v2 offset:1024
v_cvt_pk_bf16_f32 v122, v14, v15
v_mfma_f32_16x16x32_bf16 v[60:63], a[176:179], a[48:51], v[60:63]
v_exp_f32 v17, v87
v_mfma_f32_16x16x32_bf16 a[136:139], a[144:147], v[104:107], a[136:139]
ds_read_b128 a[168:171], v2 offset:2048
v_cvt_pk_bf16_f32 v123, v16, v17
v_mfma_f32_16x16x32_bf16 a[140:143], a[144:147], v[108:111], a[140:143]
buffer_load_dwordx4 v28, s[24:27], s37 offen offset:1024 sc1 lds
v_mfma_f32_16x16x32_bf16 a[128:131], a[144:147], v[96:99], a[128:131]
v_exp_f32 v18, v88
v_mfma_f32_16x16x32_bf16 a[132:135], a[144:147], v[100:103], a[132:135]
v_exp_f32 v19, v89
s_waitcnt lgkmcnt(3)
v_mfma_f32_16x16x32_bf16 v[160:163], a[192:195], v[100:103], v[160:163]
ds_read_b128 a[172:175], v2 offset:3072
v_cvt_pk_bf16_f32 v124, v18, v19
v_mfma_f32_16x16x32_bf16 v[128:131], a[192:195], v[96:99], v[128:131]
v_exp_f32 v20, v90
v_mfma_f32_16x16x32_bf16 v[224:227], a[192:195], v[108:111], v[224:227]
v_exp_f32 v21, v91
v_mfma_f32_16x16x32_bf16 v[192:195], a[192:195], v[104:107], v[192:195]
v_exp_f32 v10, v92
v_mfma_f32_16x16x32_bf16 v[196:199], a[196:199], v[104:107], v[196:199]
v_exp_f32 v11, v93
v_mfma_f32_16x16x32_bf16 v[228:231], a[196:199], v[108:111], v[228:231]
ds_read_b128 a[176:179], v2 offset:4096
v_cvt_pk_bf16_f32 v125, v20, v21
v_cvt_pk_bf16_f32 v126, v10, v11
v_mfma_f32_16x16x32_bf16 v[132:135], a[196:199], v[96:99], v[132:135]
v_exp_f32 v12, v94
v_mfma_f32_16x16x32_bf16 v[164:167], a[196:199], v[100:103], v[164:167]
v_exp_f32 v13, v95
v_mfma_f32_16x16x32_bf16 v[168:171], a[200:203], v[100:103], v[168:171]
v_exp_f32 v14, v64
v_mfma_f32_16x16x32_bf16 v[136:139], a[200:203], v[96:99], v[136:139]
buffer_load_dwordx4 v28, s[24:27], s37 offen offset:2048 sc1 lds
v_mfma_f32_16x16x32_bf16 v[232:235], a[200:203], v[108:111], v[232:235]
v_exp_f32 v15, v65
v_mfma_f32_16x16x32_bf16 v[200:203], a[200:203], v[104:107], v[200:203]
ds_read_b128 a[180:183], v2 offset:5120
v_cvt_pk_bf16_f32 v127, v12, v13
v_cvt_pk_bf16_f32 v112, v14, v15
v_mfma_f32_16x16x32_bf16 v[204:207], a[204:207], v[104:107], v[204:207]
v_exp_f32 v16, v66
v_mfma_f32_16x16x32_bf16 v[236:239], a[204:207], v[108:111], v[236:239]
v_exp_f32 v17, v67
v_mfma_f32_16x16x32_bf16 v[140:143], a[204:207], v[96:99], v[140:143]
ds_read_b128 a[184:187], v2 offset:6144
v_cvt_pk_bf16_f32 v113, v16, v17
v_mfma_f32_16x16x32_bf16 v[172:175], a[204:207], v[100:103], v[172:175]
v_exp_f32 v18, v68
v_mfma_f32_16x16x32_bf16 v[176:179], a[208:211], v[100:103], v[176:179]
v_exp_f32 v19, v69
v_mfma_f32_16x16x32_bf16 v[144:147], a[208:211], v[96:99], v[144:147]
ds_read_b128 a[188:191], v2 offset:7168
v_cvt_pk_bf16_f32 v114, v18, v19
v_mfma_f32_16x16x32_bf16 v[240:243], a[208:211], v[108:111], v[240:243]
v_exp_f32 v20, v70
v_mfma_f32_16x16x32_bf16 v[208:211], a[208:211], v[104:107], v[208:211]
v_exp_f32 v21, v71
v_mfma_f32_16x16x32_bf16 v[212:215], a[212:215], v[104:107], v[212:215]
v_exp_f32 v10, v72
v_cvt_pk_bf16_f32 v115, v20, v21
v_mfma_f32_16x16x32_bf16 v[244:247], a[212:215], v[108:111], v[244:247]
buffer_load_dwordx4 v28, s[24:27], s37 offen offset:3072 sc1 lds
v_mfma_f32_16x16x32_bf16 v[148:151], a[212:215], v[96:99], v[148:151]
v_readlane_b32 s37, v29, s36
v_mfma_f32_16x16x32_bf16 v[180:183], a[212:215], v[100:103], v[180:183]
v_exp_f32 v11, v73
v_mfma_f32_16x16x32_bf16 v[184:187], a[216:219], v[100:103], v[184:187]
v_exp_f32 v12, v74
v_cvt_pk_bf16_f32 v116, v10, v11
v_mfma_f32_16x16x32_bf16 v[152:155], a[216:219], v[96:99], v[152:155]
v_exp_f32 v13, v75
v_mfma_f32_16x16x32_bf16 v[248:251], a[216:219], v[108:111], v[248:251]
v_exp_f32 v14, v76
v_cvt_pk_bf16_f32 v117, v12, v13
v_mfma_f32_16x16x32_bf16 v[216:219], a[216:219], v[104:107], v[216:219]
v_exp_f32 v15, v77
v_mfma_f32_16x16x32_bf16 v[220:223], a[220:223], v[104:107], v[220:223]
v_exp_f32 v16, v78
v_mfma_f32_16x16x32_bf16 v[252:255], a[220:223], v[108:111], v[252:255]
v_exp_f32 v17, v79
v_mfma_f32_16x16x32_bf16 v[156:159], a[220:223], v[96:99], v[156:159]
v_cvt_pk_bf16_f32 v118, v14, v15
s_waitcnt vmcnt(16) lgkmcnt(0)
v_mfma_f32_16x16x32_bf16 v[188:191], a[220:223], v[100:103], v[188:191]
v_cvt_pk_bf16_f32 v119, v16, v17
s_barrier
L_da2_K:
v_mfma_f32_16x16x32_bf16 v[80:83], a[160:163], a[32:35], 0
ds_read_b128 a[192:195], v3 offset:0
s_or_b32 m0, s38, s40
v_mfma_f32_16x16x32_bf16 v[80:83], a[164:167], a[36:39], v[80:83]
v_exp_f32 v10, v48
v_mfma_f32_16x16x32_bf16 v[80:83], a[168:171], a[40:43], v[80:83]
v_add_u32 v2, 0x4000, v2
v_and_b32 v2, 0xffff, v2
v_mfma_f32_16x16x32_bf16 v[80:83], a[172:175], a[44:47], v[80:83]
ds_read_b128 a[196:199], v3 offset:1024
v_mfma_f32_16x16x32_bf16 v[88:91], a[172:175], a[60:63], 0
buffer_load_dwordx4 v1, s[24:27], s37 offen offset:0 sc1 lds
v_mfma_f32_16x16x32_bf16 v[88:91], a[168:171], a[56:59], v[88:91]
v_exp_f32 v11, v49
v_mfma_f32_16x16x32_bf16 v[88:91], a[164:167], a[52:55], v[88:91]
ds_read_b128 a[200:203], v3 offset:2048
v_cvt_pk_bf16_f32 v104, v10, v11
v_mfma_f32_16x16x32_bf16 v[88:91], a[160:163], a[48:51], v[88:91]
ds_read_b128 a[204:207], v3 offset:3072
v_mfma_f32_16x16x32_bf16 v[84:87], a[176:179], a[32:35], 0
v_exp_f32 v12, v50
v_mfma_f32_16x16x32_bf16 v[84:87], a[180:183], a[36:39], v[84:87]
ds_read_b128 a[208:211], v3 offset:4096
v_mfma_f32_16x16x32_bf16 v[84:87], a[184:187], a[40:43], v[84:87]
ds_read_b128 a[212:215], v3 offset:5120
v_mfma_f32_16x16x32_bf16 v[84:87], a[188:191], a[44:47], v[84:87]
v_exp_f32 v13, v51
v_mfma_f32_16x16x32_bf16 v[92:95], a[188:191], a[60:63], 0
ds_read_b128 a[216:219], v3 offset:6144
v_cvt_pk_bf16_f32 v105, v12, v13
v_mfma_f32_16x16x32_bf16 v[92:95], a[184:187], a[56:59], v[92:95]
ds_read_b128 a[220:223], v3 offset:7168
v_xor_b32 v3, 0x18000, v2
v_mfma_f32_16x16x32_bf16 v[92:95], a[180:183], a[52:55], v[92:95]
v_exp_f32 v14, v52
v_mfma_f32_16x16x32_bf16 v[92:95], a[176:179], a[48:51], v[92:95]
buffer_load_dwordx4 v1, s[24:27], s37 offen offset:1024 sc1 lds
v_mfma_f32_16x16x32_bf16 a[136:139], a[144:147], v[120:123], a[136:139]
v_exp_f32 v15, v53
v_mfma_f32_16x16x32_bf16 a[140:143], a[144:147], v[124:127], a[140:143]
ds_read_b128 a[160:163], v2 offset:8192
v_cvt_pk_bf16_f32 v106, v14, v15
v_mfma_f32_16x16x32_bf16 a[128:131], a[144:147], v[112:115], a[128:131]
s_waitcnt lgkmcnt(1)
v_mfma_f32_16x16x32_bf16 a[132:135], a[144:147], v[116:119], a[132:135]
v_exp_f32 v16, v54
v_mfma_f32_16x16x32_bf16 v[160:163], a[192:195], v[116:119], v[160:163]
ds_read_b128 a[164:167], v2 offset:9216
v_mfma_f32_16x16x32_bf16 v[128:131], a[192:195], v[112:115], v[128:131]
v_exp_f32 v17, v55
v_mfma_f32_16x16x32_bf16 v[224:227], a[192:195], v[124:127], v[224:227]
v_mfma_f32_16x16x32_bf16 v[192:195], a[192:195], v[120:123], v[192:195]
ds_read_b128 a[168:171], v2 offset:10240
v_cvt_pk_bf16_f32 v107, v16, v17
v_mfma_f32_16x16x32_bf16 v[196:199], a[196:199], v[120:123], v[196:199]
v_exp_f32 v18, v56
v_mfma_f32_16x16x32_bf16 v[228:231], a[196:199], v[124:127], v[228:231]
v_mfma_f32_16x16x32_bf16 v[132:135], a[196:199], v[112:115], v[132:135]
buffer_load_dwordx4 v1, s[24:27], s37 offen offset:2048 sc1 lds
v_mfma_f32_16x16x32_bf16 v[164:167], a[196:199], v[116:119], v[164:167]
ds_read_b128 a[172:175], v2 offset:11264
v_mfma_f32_16x16x32_bf16 v[168:171], a[200:203], v[116:119], v[168:171]
v_exp_f32 v19, v57
v_mfma_f32_16x16x32_bf16 v[136:139], a[200:203], v[112:115], v[136:139]
v_mfma_f32_16x16x32_bf16 v[232:235], a[200:203], v[124:127], v[232:235]
ds_read_b128 a[176:179], v2 offset:12288
v_cvt_pk_bf16_f32 v108, v18, v19
v_mfma_f32_16x16x32_bf16 v[200:203], a[200:203], v[120:123], v[200:203]
v_exp_f32 v20, v58
v_mfma_f32_16x16x32_bf16 v[204:207], a[204:207], v[120:123], v[204:207]
v_mfma_f32_16x16x32_bf16 v[236:239], a[204:207], v[124:127], v[236:239]
v_mfma_f32_16x16x32_bf16 v[140:143], a[204:207], v[112:115], v[140:143]
v_exp_f32 v21, v59
v_mfma_f32_16x16x32_bf16 v[172:175], a[204:207], v[116:119], v[172:175]
ds_read_b128 a[180:183], v2 offset:13312
v_mfma_f32_16x16x32_bf16 v[176:179], a[208:211], v[116:119], v[176:179]
v_cvt_pk_bf16_f32 v109, v20, v21
v_mfma_f32_16x16x32_bf16 v[144:147], a[208:211], v[112:115], v[144:147]
v_exp_f32 v10, v60
v_mfma_f32_16x16x32_bf16 v[240:243], a[208:211], v[124:127], v[240:243]
ds_read_b128 a[184:187], v2 offset:14336
v_mfma_f32_16x16x32_bf16 v[208:211], a[208:211], v[120:123], v[208:211]
buffer_load_dwordx4 v1, s[24:27], s37 offen offset:3072 sc1 lds
v_mfma_f32_16x16x32_bf16 v[212:215], a[212:215], v[120:123], v[212:215]
v_exp_f32 v11, v61
v_mfma_f32_16x16x32_bf16 v[244:247], a[212:215], v[124:127], v[244:247]
ds_read_b128 a[188:191], v2 offset:15360
v_mfma_f32_16x16x32_bf16 v[148:151], a[212:215], v[112:115], v[148:151]
v_cvt_pk_bf16_f32 v110, v10, v11
v_mfma_f32_16x16x32_bf16 v[180:183], a[212:215], v[116:119], v[180:183]
v_exp_f32 v12, v62
v_mfma_f32_16x16x32_bf16 v[184:187], a[216:219], v[116:119], v[184:187]
v_mfma_f32_16x16x32_bf16 v[152:155], a[216:219], v[112:115], v[152:155]
v_mfma_f32_16x16x32_bf16 v[248:251], a[216:219], v[124:127], v[248:251]
v_exp_f32 v13, v63
v_mfma_f32_16x16x32_bf16 v[216:219], a[216:219], v[120:123], v[216:219]
v_mfma_f32_16x16x32_bf16 v[220:223], a[220:223], v[120:123], v[220:223]
v_cvt_pk_bf16_f32 v111, v12, v13
v_mfma_f32_16x16x32_bf16 v[252:255], a[220:223], v[124:127], v[252:255]
v_mfma_f32_16x16x32_bf16 v[156:159], a[220:223], v[112:115], v[156:159]
s_waitcnt lgkmcnt(0)
v_mfma_f32_16x16x32_bf16 v[188:191], a[220:223], v[116:119], v[188:191]
s_nop 7
v_accvgpr_read_b32 v10, a128
v_accvgpr_read_b32 v11, a132
v_rcp_f32 v12, v10
v_rcp_f32 v14, v11
v_max_f32 v16, v10, v11
v_min_f32 v17, v10, v11
v_cmp_u_f32 s[50:51], v10, v11
v_cmp_lt_f32 vcc, 0x5d800000, v16
s_or_b64 s[42:43], s[50:51], vcc
v_cmp_gt_f32 vcc, 0x21800000, v17
s_or_b64 s[42:43], s[42:43], vcc
v_mov_b32 v13, v12
v_mov_b32 v15, v14
v_pk_mul_f32 v[128:129], v[128:129], v[12:13]
v_pk_mul_f32 v[130:131], v[130:131], v[12:13]
v_pk_mul_f32 v[132:133], v[132:133], v[12:13]
v_pk_mul_f32 v[134:135], v[134:135], v[12:13]
v_cvt_pk_bf16_f32 v128, v128, v129
v_cvt_pk_bf16_f32 v129, v130, v131
v_cvt_pk_bf16_f32 v130, v132, v133
v_cvt_pk_bf16_f32 v131, v134, v135
v_pk_mul_f32 v[160:161], v[160:161], v[14:15]
v_pk_mul_f32 v[162:163], v[162:163], v[14:15]
v_pk_mul_f32 v[164:165], v[164:165], v[14:15]
v_pk_mul_f32 v[166:167], v[166:167], v[14:15]
v_cvt_pk_bf16_f32 v160, v160, v161
v_cvt_pk_bf16_f32 v161, v162, v163
v_cvt_pk_bf16_f32 v162, v164, v165
v_cvt_pk_bf16_f32 v163, v166, v167
v_pk_mul_f32 v[136:137], v[136:137], v[12:13]
v_pk_mul_f32 v[138:139], v[138:139], v[12:13]
v_pk_mul_f32 v[140:141], v[140:141], v[12:13]
v_pk_mul_f32 v[142:143], v[142:143], v[12:13]
v_cvt_pk_bf16_f32 v136, v136, v137
v_cvt_pk_bf16_f32 v137, v138, v139
v_cvt_pk_bf16_f32 v138, v140, v141
v_cvt_pk_bf16_f32 v139, v142, v143
v_pk_mul_f32 v[168:169], v[168:169], v[14:15]
v_pk_mul_f32 v[170:171], v[170:171], v[14:15]
v_pk_mul_f32 v[172:173], v[172:173], v[14:15]
v_pk_mul_f32 v[174:175], v[174:175], v[14:15]
v_cvt_pk_bf16_f32 v168, v168, v169
v_cvt_pk_bf16_f32 v169, v170, v171
v_cvt_pk_bf16_f32 v170, v172, v173
v_cvt_pk_bf16_f32 v171, v174, v175
v_pk_mul_f32 v[144:145], v[144:145], v[12:13]
v_pk_mul_f32 v[146:147], v[146:147], v[12:13]
v_pk_mul_f32 v[148:149], v[148:149], v[12:13]
v_pk_mul_f32 v[150:151], v[150:151], v[12:13]
v_cvt_pk_bf16_f32 v144, v144, v145
v_cvt_pk_bf16_f32 v145, v146, v147
v_cvt_pk_bf16_f32 v146, v148, v149
v_cvt_pk_bf16_f32 v147, v150, v151
v_pk_mul_f32 v[176:177], v[176:177], v[14:15]
v_pk_mul_f32 v[178:179], v[178:179], v[14:15]
v_pk_mul_f32 v[180:181], v[180:181], v[14:15]
v_pk_mul_f32 v[182:183], v[182:183], v[14:15]
v_cvt_pk_bf16_f32 v176, v176, v177
v_cvt_pk_bf16_f32 v177, v178, v179
v_cvt_pk_bf16_f32 v178, v180, v181
v_cvt_pk_bf16_f32 v179, v182, v183
v_pk_mul_f32 v[152:153], v[152:153], v[12:13]
v_pk_mul_f32 v[154:155], v[154:155], v[12:13]
v_pk_mul_f32 v[156:157], v[156:157], v[12:13]
v_pk_mul_f32 v[158:159], v[158:159], v[12:13]
v_cvt_pk_bf16_f32 v152, v152, v153
v_cvt_pk_bf16_f32 v153, v154, v155
v_cvt_pk_bf16_f32 v154, v156, v157
v_cvt_pk_bf16_f32 v155, v158, v159
v_pk_mul_f32 v[184:185], v[184:185], v[14:15]
v_pk_mul_f32 v[186:187], v[186:187], v[14:15]
v_pk_mul_f32 v[188:189], v[188:189], v[14:15]
v_pk_mul_f32 v[190:191], v[190:191], v[14:15]
v_cvt_pk_bf16_f32 v184, v184, v185
v_cvt_pk_bf16_f32 v185, v186, v187
v_cvt_pk_bf16_f32 v186, v188, v189
v_cvt_pk_bf16_f32 v187, v190, v191
v_mfma_f32_16x16x32_bf16 v[48:51], a[160:163], a[32:35], 0
ds_read_b128 a[192:195], v3 offset:8192
v_exp_f32 v10, v80
v_mfma_f32_16x16x32_bf16 v[48:51], a[164:167], a[36:39], v[48:51]
ds_read_b128 a[196:199], v3 offset:9216
s_add_u32 m0, m0, 4096
v_mfma_f32_16x16x32_bf16 v[48:51], a[168:171], a[40:43], v[48:51]
ds_read_b128 a[200:203], v3 offset:10240
s_add_u32 s36, s36, 1
v_mfma_f32_16x16x32_bf16 v[48:51], a[172:175], a[44:47], v[48:51]
ds_read_b128 a[204:207], v3 offset:11264
s_add_u32 s52, s56, 0
s_add_u32 s38, s38, 0x4000
v_mfma_f32_16x16x32_bf16 v[56:59], a[172:175], a[60:63], 0
buffer_store_dwordx4 v[128:131], v1, s[28:31], s52 offen offset:0 sc1
v_mfma_f32_16x16x32_bf16 v[56:59], a[168:171], a[56:59], v[56:59]
ds_read_b128 a[208:211], v3 offset:12288
buffer_load_dwordx4 v28, s[24:27], s37 offen offset:0 sc1 lds
v_mfma_f32_16x16x32_bf16 v[56:59], a[164:167], a[52:55], v[56:59]
v_exp_f32 v11, v81
v_mfma_f32_16x16x32_bf16 v[56:59], a[160:163], a[48:51], v[56:59]
ds_read_b128 a[212:215], v3 offset:13312
v_cvt_pk_bf16_f32 v120, v10, v11
s_and_b32 s38, s38, 0xffff
v_mfma_f32_16x16x32_bf16 v[52:55], a[176:179], a[32:35], 0
v_exp_f32 v12, v82
v_mfma_f32_16x16x32_bf16 v[52:55], a[180:183], a[36:39], v[52:55]
ds_read_b128 a[216:219], v3 offset:14336
v_exp_f32 v13, v83
v_mfma_f32_16x16x32_bf16 v[52:55], a[184:187], a[40:43], v[52:55]
ds_read_b128 a[220:223], v3 offset:15360
v_cvt_pk_bf16_f32 v121, v12, v13
v_mfma_f32_16x16x32_bf16 v[52:55], a[188:191], a[44:47], v[52:55]
buffer_store_dwordx4 v[160:163], v1, s[28:31], s52 offen offset:1024 sc1
v_mfma_f32_16x16x32_bf16 v[60:63], a[188:191], a[60:63], 0
ds_read_b128 a[160:163], v2 offset:0
buffer_load_dwordx4 v28, s[24:27], s37 offen offset:1024 sc1 lds
v_mfma_f32_16x16x32_bf16 v[60:63], a[184:187], a[56:59], v[60:63]
v_exp_f32 v14, v84
v_mfma_f32_16x16x32_bf16 v[60:63], a[180:183], a[52:55], v[60:63]
ds_read_b128 a[164:167], v2 offset:1024
v_exp_f32 v15, v85
v_mfma_f32_16x16x32_bf16 v[60:63], a[176:179], a[48:51], v[60:63]
v_exp_f32 v16, v86
v_mfma_f32_16x16x32_bf16 a[136:139], a[144:147], v[104:107], a[136:139]
ds_read_b128 a[168:171], v2 offset:2048
v_cvt_pk_bf16_f32 v122, v14, v15
s_add_u32 s52, s56, 4096
v_mfma_f32_16x16x32_bf16 a[140:143], a[144:147], v[108:111], a[140:143]
ds_read_b128 a[172:175], v2 offset:3072
s_waitcnt lgkmcnt(4)
v_mfma_f32_16x16x32_bf16 v[224:227], a[192:195], v[108:111], v[224:227]
v_exp_f32 v17, v87
v_mfma_f32_16x16x32_bf16 v[192:195], a[192:195], v[104:107], v[192:195]
ds_read_b128 a[176:179], v2 offset:4096
buffer_store_dwordx4 v[136:139], v1, s[28:31], s52 offen offset:0 sc1
v_mfma_f32_16x16x32_bf16 v[196:199], a[196:199], v[104:107], v[196:199]
buffer_load_dwordx4 v28, s[24:27], s37 offen offset:2048 sc1 lds
v_mfma_f32_16x16x32_bf16 v[228:231], a[196:199], v[108:111], v[228:231]
ds_read_b128 a[180:183], v2 offset:5120
v_exp_f32 v18, v88
v_mfma_f32_16x16x32_bf16 v[232:235], a[200:203], v[108:111], v[232:235]
v_exp_f32 v19, v89
v_mfma_f32_16x16x32_bf16 v[200:203], a[200:203], v[104:107], v[200:203]
ds_read_b128 a[184:187], v2 offset:6144
v_cvt_pk_bf16_f32 v123, v16, v17
v_cvt_pk_bf16_f32 v124, v18, v19
v_mfma_f32_16x16x32_bf16 v[204:207], a[204:207], v[104:107], v[204:207]
v_exp_f32 v20, v90
v_mfma_f32_16x16x32_bf16 v[236:239], a[204:207], v[108:111], v[236:239]
ds_read_b128 a[188:191], v2 offset:7168
buffer_store_dwordx4 v[168:171], v1, s[28:31], s52 offen offset:1024 sc1
v_mfma_f32_16x16x32_bf16 v[240:243], a[208:211], v[108:111], v[240:243]
v_exp_f32 v21, v91
v_mfma_f32_16x16x32_bf16 v[208:211], a[208:211], v[104:107], v[208:211]
buffer_load_dwordx4 v28, s[24:27], s37 offen offset:3072 sc1 lds
v_mfma_f32_16x16x32_bf16 v[212:215], a[212:215], v[104:107], v[212:215]
v_readlane_b32 s37, v29, s36
v_cvt_pk_bf16_f32 v125, v20, v21
v_mfma_f32_16x16x32_bf16 v[244:247], a[212:215], v[108:111], v[244:247]
v_exp_f32 v10, v92
v_mfma_f32_16x16x32_bf16 v[248:251], a[216:219], v[108:111], v[248:251]
v_exp_f32 v11, v93
v_mfma_f32_16x16x32_bf16 v[216:219], a[216:219], v[104:107], v[216:219]
v_exp_f32 v12, v94
v_cvt_pk_bf16_f32 v126, v10, v11
v_mfma_f32_16x16x32_bf16 v[220:223], a[220:223], v[104:107], v[220:223]
v_exp_f32 v13, v95
s_waitcnt vmcnt(20) lgkmcnt(0)
v_mfma_f32_16x16x32_bf16 v[252:255], a[220:223], v[108:111], v[252:255]
v_cvt_pk_bf16_f32 v127, v12, v13
s_barrier
v_mfma_f32_16x16x32_bf16 v[80:83], a[160:163], a[32:35], 0
ds_read_b128 a[192:195], v3 offset:0
s_or_b32 m0, s38, s40
v_mfma_f32_16x16x32_bf16 v[80:83], a[164:167], a[36:39], v[80:83]
ds_read_b128 a[196:199], v3 offset:1024
v_exp_f32 v10, v48
v_mfma_f32_16x16x32_bf16 v[80:83], a[168:171], a[40:43], v[80:83]
ds_read_b128 a[200:203], v3 offset:2048
s_add_u32 s52, s56, 8192
v_mfma_f32_16x16x32_bf16 v[80:83], a[172:175], a[44:47], v[80:83]
buffer_store_dwordx4 v[144:147], v1, s[28:31], s52 offen offset:0 sc1
v_mfma_f32_16x16x32_bf16 v[88:91], a[172:175], a[60:63], 0
ds_read_b128 a[204:207], v3 offset:3072
v_exp_f32 v11, v49
v_mfma_f32_16x16x32_bf16 v[88:91], a[168:171], a[56:59], v[88:91]
buffer_load_dwordx4 v1, s[24:27], s37 offen offset:0 sc1 lds
v_mfma_f32_16x16x32_bf16 v[88:91], a[164:167], a[52:55], v[88:91]
ds_read_b128 a[208:211], v3 offset:4096
v_add_u32 v2, 0x4000, v2
v_mfma_f32_16x16x32_bf16 v[88:91], a[160:163], a[48:51], v[88:91]
ds_read_b128 a[212:215], v3 offset:5120
v_and_b32 v2, 0xffff, v2
v_cvt_pk_bf16_f32 v104, v10, v11
v_mfma_f32_16x16x32_bf16 v[84:87], a[176:179], a[32:35], 0
v_exp_f32 v12, v50
v_mfma_f32_16x16x32_bf16 v[84:87], a[180:183], a[36:39], v[84:87]
ds_read_b128 a[216:219], v3 offset:6144
v_exp_f32 v13, v51
v_mfma_f32_16x16x32_bf16 v[84:87], a[184:187], a[40:43], v[84:87]
v_exp_f32 v14, v52
v_mfma_f32_16x16x32_bf16 v[84:87], a[188:191], a[44:47], v[84:87]
ds_read_b128 a[220:223], v3 offset:7168
v_xor_b32 v3, 0x18000, v2
v_mfma_f32_16x16x32_bf16 v[92:95], a[188:191], a[60:63], 0
ds_read_b128 a[160:163], v2 offset:8192
buffer_load_dwordx4 v1, s[24:27], s37 offen offset:1024 sc1 lds
v_mfma_f32_16x16x32_bf16 v[92:95], a[184:187], a[56:59], v[92:95]
ds_read_b128 a[164:167], v2 offset:9216
v_cvt_pk_bf16_f32 v105, v12, v13
v_mfma_f32_16x16x32_bf16 v[92:95], a[180:183], a[52:55], v[92:95]
buffer_store_dwordx4 v[176:179], v1, s[28:31], s52 offen offset:1024 sc1
v_mfma_f32_16x16x32_bf16 v[92:95], a[176:179], a[48:51], v[92:95]
ds_read_b128 a[168:171], v2 offset:10240
v_exp_f32 v15, v53
v_mfma_f32_16x16x32_bf16 a[136:139], a[144:147], v[120:123], a[136:139]
v_exp_f32 v16, v54
v_mfma_f32_16x16x32_bf16 a[140:143], a[144:147], v[124:127], a[140:143]
ds_read_b128 a[172:175], v2 offset:11264
s_waitcnt lgkmcnt(4)
v_mfma_f32_16x16x32_bf16 v[224:227], a[192:195], v[124:127], v[224:227]
ds_read_b128 a[176:179], v2 offset:12288
v_cvt_pk_bf16_f32 v106, v14, v15
s_add_u32 s52, s56, 12288
v_mfma_f32_16x16x32_bf16 v[192:195], a[192:195], v[120:123], v[192:195]
v_exp_f32 v17, v55
v_mfma_f32_16x16x32_bf16 v[196:199], a[196:199], v[120:123], v[196:199]
buffer_load_dwordx4 v1, s[24:27], s37 offen offset:2048 sc1 lds
v_mfma_f32_16x16x32_bf16 v[228:231], a[196:199], v[124:127], v[228:231]
ds_read_b128 a[180:183], v2 offset:13312
v_exp_f32 v18, v56
v_mfma_f32_16x16x32_bf16 v[232:235], a[200:203], v[124:127], v[232:235]
ds_read_b128 a[184:187], v2 offset:14336
v_cvt_pk_bf16_f32 v107, v16, v17
v_mfma_f32_16x16x32_bf16 v[200:203], a[200:203], v[120:123], v[200:203]
buffer_store_dwordx4 v[152:155], v1, s[28:31], s52 offen offset:0 sc1
v_mfma_f32_16x16x32_bf16 v[204:207], a[204:207], v[120:123], v[204:207]
ds_read_b128 a[188:191], v2 offset:15360
v_exp_f32 v19, v57
v_mfma_f32_16x16x32_bf16 v[236:239], a[204:207], v[124:127], v[236:239]
v_exp_f32 v20, v58
v_mfma_f32_16x16x32_bf16 v[240:243], a[208:211], v[124:127], v[240:243]
v_exp_f32 v21, v59
v_cvt_pk_bf16_f32 v108, v18, v19
v_mfma_f32_16x16x32_bf16 v[208:211], a[208:211], v[120:123], v[208:211]
v_exp_f32 v10, v60
v_mfma_f32_16x16x32_bf16 v[212:215], a[212:215], v[120:123], v[212:215]
buffer_load_dwordx4 v1, s[24:27], s37 offen offset:3072 sc1 lds
v_mfma_f32_16x16x32_bf16 v[244:247], a[212:215], v[124:127], v[244:247]
buffer_store_dwordx4 v[184:187], v1, s[28:31], s52 offen offset:1024 sc1
v_cvt_pk_bf16_f32 v109, v20, v21
v_mfma_f32_16x16x32_bf16 v[248:251], a[216:219], v[124:127], v[248:251]
v_exp_f32 v11, v61
v_mfma_f32_16x16x32_bf16 v[216:219], a[216:219], v[120:123], v[216:219]
v_exp_f32 v12, v62
v_mfma_f32_16x16x32_bf16 v[220:223], a[220:223], v[120:123], v[220:223]
v_exp_f32 v13, v63
v_cvt_pk_bf16_f32 v110, v10, v11
v_mfma_f32_16x16x32_bf16 v[252:255], a[220:223], v[124:127], v[252:255]
v_cvt_pk_bf16_f32 v111, v12, v13
s_waitcnt lgkmcnt(0)
s_cmp_eq_u32 s36, s55
s_cbranch_scc1 L_g1x_K
v_xor_b32 v2, 0x4000, v2
v_xor_b32 v3, 0x4000, v3
s_sub_u32 s50, s38, 0x4000
s_and_b32 s50, s50, 0xffff
s_or_b32 s51, s38, s40
s_or_b32 s38, s50, s40
s_mov_b32 s40, s51
s_lshl_b32 s26, s55, 15
L_g1o_K:
v_mfma_f32_16x16x32_bf16 v[48:51], a[160:163], a[32:35], 0
ds_read_b128 a[192:195], v3 offset:24576
s_add_u32 m0, m0, 4096
v_mfma_f32_16x16x32_bf16 v[48:51], a[164:167], a[36:39], v[48:51]
v_exp_f32 v10, v80
v_mfma_f32_16x16x32_bf16 v[48:51], a[168:171], a[40:43], v[48:51]
v_exp_f32 v11, v81
v_mfma_f32_16x16x32_bf16 v[48:51], a[172:175], a[44:47], v[48:51]
ds_read_b128 a[196:199], v3 offset:25600
s_xor_b32 s38, s38, 0x8000
v_mfma_f32_16x16x32_bf16 v[56:59], a[172:175], a[60:63], 0
buffer_load_dwordx4 v28, s[24:27], s37 offen offset:0 sc1 lds
v_mfma_f32_16x16x32_bf16 v[56:59], a[168:171], a[56:59], v[56:59]
ds_read_b128 a[200:203], v3 offset:26624
v_exp_f32 v12, v82
v_mfma_f32_16x16x32_bf16 v[56:59], a[164:167], a[52:55], v[56:59]
ds_read_b128 a[204:207], v3 offset:27648
v_cvt_pk_bf16_f32 v120, v10, v11
v_mfma_f32_16x16x32_bf16 v[56:59], a[160:163], a[48:51], v[56:59]
ds_read_b128 a[208:211], v3 offset:28672
s_add_u32 s36, s36, 2
v_mfma_f32_16x16x32_bf16 v[52:55], a[176:179], a[32:35], 0
v_exp_f32 v13, v83
v_mfma_f32_16x16x32_bf16 v[52:55], a[180:183], a[36:39], v[52:55]
ds_read_b128 a[212:215], v3 offset:29696
v_cvt_pk_bf16_f32 v121, v12, v13
v_mfma_f32_16x16x32_bf16 v[52:55], a[184:187], a[40:43], v[52:55]
v_exp_f32 v14, v88
v_mfma_f32_16x16x32_bf16 v[52:55], a[188:191], a[44:47], v[52:55]
v_exp_f32 v15, v89
v_mfma_f32_16x16x32_bf16 v[60:63], a[188:191], a[60:63], 0
ds_read_b128 a[216:219], v3 offset:30720
v_cvt_pk_bf16_f32 v124, v14, v15
v_mfma_f32_16x16x32_bf16 v[60:63], a[184:187], a[56:59], v[60:63]
ds_read_b128 a[220:223], v3 offset:31744
buffer_load_dwordx4 v28, s[24:27], s37 offen offset:1024 sc1 lds
v_mfma_f32_16x16x32_bf16 v[60:63], a[180:183], a[52:55], v[60:63]
v_exp_f32 v16, v90
v_mfma_f32_16x16x32_bf16 v[60:63], a[176:179], a[48:51], v[60:63]
v_exp_f32 v17, v91
v_mfma_f32_16x16x32_bf16 a[136:139], a[144:147], v[104:107], a[136:139]
v_exp_f32 v18, v84
v_mfma_f32_16x16x32_bf16 a[140:143], a[144:147], v[108:111], a[140:143]
ds_read_b128 a[160:163], v2 offset:16384
s_waitcnt lgkmcnt(1)
v_mfma_f32_16x16x32_bf16 v[224:227], a[192:195], v[108:111], v[224:227]
buffer_load_dwordx4 v28, s[24:27], s37 offen offset:2048 sc1 lds
v_mfma_f32_16x16x32_bf16 v[192:195], a[192:195], v[104:107], v[192:195]
ds_read_b128 a[164:167], v2 offset:17408
v_cvt_pk_bf16_f32 v125, v16, v17
v_mfma_f32_16x16x32_bf16 v[196:199], a[196:199], v[104:107], v[196:199]
v_exp_f32 v19, v85
v_mfma_f32_16x16x32_bf16 v[228:231], a[196:199], v[108:111], v[228:231]
ds_read_b128 a[168:171], v2 offset:18432
v_cvt_pk_bf16_f32 v122, v18, v19
v_mfma_f32_16x16x32_bf16 v[232:235], a[200:203], v[108:111], v[232:235]
v_exp_f32 v20, v86
v_mfma_f32_16x16x32_bf16 v[200:203], a[200:203], v[104:107], v[200:203]
v_exp_f32 v21, v87
v_mfma_f32_16x16x32_bf16 v[204:207], a[204:207], v[104:107], v[204:207]
ds_read_b128 a[172:175], v2 offset:19456
v_cvt_pk_bf16_f32 v123, v20, v21
v_mfma_f32_16x16x32_bf16 v[236:239], a[204:207], v[108:111], v[236:239]
v_exp_f32 v10, v92
v_mfma_f32_16x16x32_bf16 v[240:243], a[208:211], v[108:111], v[240:243]
ds_read_b128 a[176:179], v2 offset:20480
v_mfma_f32_16x16x32_bf16 v[208:211], a[208:211], v[104:107], v[208:211]
ds_read_b128 a[180:183], v2 offset:21504
buffer_load_dwordx4 v28, s[24:27], s37 offen offset:3072 sc1 lds
v_mfma_f32_16x16x32_bf16 v[212:215], a[212:215], v[104:107], v[212:215]
ds_read_b128 a[184:187], v2 offset:22528
s_add_u32 s37, s37, 0x8000
v_mfma_f32_16x16x32_bf16 v[244:247], a[212:215], v[108:111], v[244:247]
ds_read_b128 a[188:191], v2 offset:23552
v_mfma_f32_16x16x32_bf16 v[248:251], a[216:219], v[108:111], v[248:251]
v_exp_f32 v11, v93
v_mfma_f32_16x16x32_bf16 v[216:219], a[216:219], v[104:107], v[216:219]
v_exp_f32 v12, v94
v_mfma_f32_16x16x32_bf16 v[220:223], a[220:223], v[104:107], v[220:223]
v_exp_f32 v13, v95
v_mfma_f32_16x16x32_bf16 v[252:255], a[220:223], v[108:111], v[252:255]
s_waitcnt vmcnt(16) lgkmcnt(0)
s_barrier
v_mfma_f32_16x16x32_bf16 v[80:83], a[160:163], a[32:35], 0
ds_read_b128 a[192:195], v3 offset:16384
v_cvt_pk_bf16_f32 v126, v10, v11
v_mfma_f32_16x16x32_bf16 v[80:83], a[164:167], a[36:39], v[80:83]
ds_read_b128 a[196:199], v3 offset:17408
s_mov_b32 m0, s38
v_mfma_f32_16x16x32_bf16 v[80:83], a[168:171], a[40:43], v[80:83]
ds_read_b128 a[200:203], v3 offset:18432
v_xor_b32 v2, 0x8000, v2
v_mfma_f32_16x16x32_bf16 v[80:83], a[172:175], a[44:47], v[80:83]
v_exp_f32 v14, v48
v_mfma_f32_16x16x32_bf16 v[88:91], a[172:175], a[60:63], 0
v_exp_f32 v15, v49
v_mfma_f32_16x16x32_bf16 v[88:91], a[168:171], a[56:59], v[88:91]
buffer_load_dwordx4 v1, s[24:27], s37 offen offset:0 sc1 lds
v_mfma_f32_16x16x32_bf16 v[88:91], a[164:167], a[52:55], v[88:91]
ds_read_b128 a[204:207], v3 offset:19456
v_cvt_pk_bf16_f32 v127, v12, v13
v_mfma_f32_16x16x32_bf16 v[88:91], a[160:163], a[48:51], v[88:91]
v_exp_f32 v16, v50
v_mfma_f32_16x16x32_bf16 v[84:87], a[176:179], a[32:35], 0
ds_read_b128 a[208:211], v3 offset:20480
v_cvt_pk_bf16_f32 v104, v14, v15
v_mfma_f32_16x16x32_bf16 v[84:87], a[180:183], a[36:39], v[84:87]
v_exp_f32 v17, v51
v_mfma_f32_16x16x32_bf16 v[84:87], a[184:187], a[40:43], v[84:87]
ds_read_b128 a[212:215], v3 offset:21504
v_exp_f32 v18, v56
v_mfma_f32_16x16x32_bf16 v[84:87], a[188:191], a[44:47], v[84:87]
ds_read_b128 a[216:219], v3 offset:22528
v_cvt_pk_bf16_f32 v105, v16, v17
v_mfma_f32_16x16x32_bf16 v[92:95], a[188:191], a[60:63], 0
buffer_load_dwordx4 v1, s[24:27], s37 offen offset:1024 sc1 lds
v_mfma_f32_16x16x32_bf16 v[92:95], a[184:187], a[56:59], v[92:95]
ds_read_b128 a[220:223], v3 offset:23552
v_xor_b32 v3, 0x8000, v3
v_mfma_f32_16x16x32_bf16 v[92:95], a[180:183], a[52:55], v[92:95]
v_exp_f32 v19, v57
v_mfma_f32_16x16x32_bf16 v[92:95], a[176:179], a[48:51], v[92:95]
v_exp_f32 v20, v58
v_mfma_f32_16x16x32_bf16 a[136:139], a[144:147], v[120:123], a[136:139]
v_exp_f32 v21, v59
v_mfma_f32_16x16x32_bf16 a[140:143], a[144:147], v[124:127], a[140:143]
ds_read_b128 a[160:163], v2 offset:8192
s_waitcnt lgkmcnt(1)
v_mfma_f32_16x16x32_bf16 v[224:227], a[192:195], v[124:127], v[224:227]
ds_read_b128 a[164:167], v2 offset:9216
v_cvt_pk_bf16_f32 v108, v18, v19
v_mfma_f32_16x16x32_bf16 v[192:195], a[192:195], v[120:123], v[192:195]
v_exp_f32 v10, v52
v_mfma_f32_16x16x32_bf16 v[196:199], a[196:199], v[120:123], v[196:199]
ds_read_b128 a[168:171], v2 offset:10240
v_cvt_pk_bf16_f32 v109, v20, v21
v_mfma_f32_16x16x32_bf16 v[228:231], a[196:199], v[124:127], v[228:231]
buffer_load_dwordx4 v1, s[24:27], s37 offen offset:2048 sc1 lds
v_mfma_f32_16x16x32_bf16 v[232:235], a[200:203], v[124:127], v[232:235]
v_exp_f32 v11, v53
v_mfma_f32_16x16x32_bf16 v[200:203], a[200:203], v[120:123], v[200:203]
v_exp_f32 v12, v54
v_mfma_f32_16x16x32_bf16 v[204:207], a[204:207], v[120:123], v[204:207]
ds_read_b128 a[172:175], v2 offset:11264
v_cvt_pk_bf16_f32 v106, v10, v11
v_mfma_f32_16x16x32_bf16 v[236:239], a[204:207], v[124:127], v[236:239]
buffer_load_dwordx4 v1, s[24:27], s37 offen offset:3072 sc1 lds
v_mfma_f32_16x16x32_bf16 v[240:243], a[208:211], v[124:127], v[240:243]
ds_read_b128 a[176:179], v2 offset:12288
v_mfma_f32_16x16x32_bf16 v[208:211], a[208:211], v[120:123], v[208:211]
ds_read_b128 a[180:183], v2 offset:13312
v_exp_f32 v13, v55
v_mfma_f32_16x16x32_bf16 v[212:215], a[212:215], v[120:123], v[212:215]
ds_read_b128 a[184:187], v2 offset:14336
v_cvt_pk_bf16_f32 v107, v12, v13
v_mfma_f32_16x16x32_bf16 v[244:247], a[212:215], v[124:127], v[244:247]
ds_read_b128 a[188:191], v2 offset:15360
v_mfma_f32_16x16x32_bf16 v[248:251], a[216:219], v[124:127], v[248:251]
v_exp_f32 v14, v60
v_mfma_f32_16x16x32_bf16 v[216:219], a[216:219], v[120:123], v[216:219]
v_exp_f32 v15, v61
v_mfma_f32_16x16x32_bf16 v[220:223], a[220:223], v[120:123], v[220:223]
v_exp_f32 v16, v62
v_mfma_f32_16x16x32_bf16 v[252:255], a[220:223], v[124:127], v[252:255]
ds_read_b128 a[192:195], v3 offset:8192
s_waitcnt lgkmcnt(1)
v_mfma_f32_16x16x32_bf16 v[48:51], a[160:163], a[32:35], 0
v_exp_f32 v17, v63
v_mfma_f32_16x16x32_bf16 v[48:51], a[164:167], a[36:39], v[48:51]
ds_read_b128 a[196:199], v3 offset:9216
v_cvt_pk_bf16_f32 v110, v14, v15
v_mfma_f32_16x16x32_bf16 v[48:51], a[168:171], a[40:43], v[48:51]
ds_read_b128 a[200:203], v3 offset:10240
s_add_u32 m0, m0, 4096
v_mfma_f32_16x16x32_bf16 v[48:51], a[172:175], a[44:47], v[48:51]
ds_read_b128 a[204:207], v3 offset:11264
v_cvt_pk_bf16_f32 v111, v16, v17
v_mfma_f32_16x16x32_bf16 v[56:59], a[172:175], a[60:63], 0
buffer_load_dwordx4 v28, s[24:27], s37 offen offset:0 sc1 lds
v_mfma_f32_16x16x32_bf16 v[56:59], a[168:171], a[56:59], v[56:59]
ds_read_b128 a[208:211], v3 offset:12288
v_exp_f32 v18, v80
v_mfma_f32_16x16x32_bf16 v[56:59], a[164:167], a[52:55], v[56:59]
v_exp_f32 v19, v81
v_mfma_f32_16x16x32_bf16 v[56:59], a[160:163], a[48:51], v[56:59]
v_exp_f32 v20, v82
v_mfma_f32_16x16x32_bf16 v[52:55], a[176:179], a[32:35], 0
ds_read_b128 a[212:215], v3 offset:13312
v_cvt_pk_bf16_f32 v120, v18, v19
v_mfma_f32_16x16x32_bf16 v[52:55], a[180:183], a[36:39], v[52:55]
ds_read_b128 a[216:219], v3 offset:14336
s_xor_b32 s40, s40, 0x8000
v_mfma_f32_16x16x32_bf16 v[52:55], a[184:187], a[40:43], v[52:55]
v_exp_f32 v21, v83
v_mfma_f32_16x16x32_bf16 v[52:55], a[188:191], a[44:47], v[52:55]
ds_read_b128 a[220:223], v3 offset:15360
v_cvt_pk_bf16_f32 v121, v20, v21
v_mfma_f32_16x16x32_bf16 v[60:63], a[188:191], a[60:63], 0
v_exp_f32 v10, v88
v_mfma_f32_16x16x32_bf16 v[60:63], a[184:187], a[56:59], v[60:63]
buffer_load_dwordx4 v28, s[24:27], s37 offen offset:1024 sc1 lds
v_mfma_f32_16x16x32_bf16 v[60:63], a[180:183], a[52:55], v[60:63]
v_exp_f32 v11, v89
v_mfma_f32_16x16x32_bf16 v[60:63], a[176:179], a[48:51], v[60:63]
ds_read_b128 a[160:163], v2 offset:0
s_waitcnt lgkmcnt(1)
v_mfma_f32_16x16x32_bf16 a[136:139], a[144:147], v[104:107], a[136:139]
ds_read_b128 a[164:167], v2 offset:1024
v_exp_f32 v12, v90
v_mfma_f32_16x16x32_bf16 a[140:143], a[144:147], v[108:111], a[140:143]
ds_read_b128 a[168:171], v2 offset:2048
v_cvt_pk_bf16_f32 v124, v10, v11
v_mfma_f32_16x16x32_bf16 v[224:227], a[192:195], v[108:111], v[224:227]
v_exp_f32 v13, v91
v_mfma_f32_16x16x32_bf16 v[192:195], a[192:195], v[104:107], v[192:195]
ds_read_b128 a[172:175], v2 offset:3072
v_cvt_pk_bf16_f32 v125, v12, v13
v_mfma_f32_16x16x32_bf16 v[196:199], a[196:199], v[104:107], v[196:199]
v_exp_f32 v14, v84
v_mfma_f32_16x16x32_bf16 v[228:231], a[196:199], v[108:111], v[228:231]
buffer_load_dwordx4 v28, s[24:27], s37 offen offset:2048 sc1 lds
v_mfma_f32_16x16x32_bf16 v[232:235], a[200:203], v[108:111], v[232:235]
v_exp_f32 v15, v85
v_mfma_f32_16x16x32_bf16 v[200:203], a[200:203], v[104:107], v[200:203]
v_exp_f32 v16, v86
v_mfma_f32_16x16x32_bf16 v[204:207], a[204:207], v[104:107], v[204:207]
v_exp_f32 v17, v87
v_mfma_f32_16x16x32_bf16 v[236:239], a[204:207], v[108:111], v[236:239]
ds_read_b128 a[176:179], v2 offset:4096
v_cvt_pk_bf16_f32 v122, v14, v15
v_mfma_f32_16x16x32_bf16 v[240:243], a[208:211], v[108:111], v[240:243]
ds_read_b128 a[180:183], v2 offset:5120
v_cvt_pk_bf16_f32 v123, v16, v17
v_mfma_f32_16x16x32_bf16 v[208:211], a[208:211], v[104:107], v[208:211]
ds_read_b128 a[184:187], v2 offset:6144
v_exp_f32 v18, v92
v_mfma_f32_16x16x32_bf16 v[212:215], a[212:215], v[104:107], v[212:215]
buffer_load_dwordx4 v28, s[24:27], s37 offen offset:3072 sc1 lds
v_mfma_f32_16x16x32_bf16 v[244:247], a[212:215], v[108:111], v[244:247]
ds_read_b128 a[188:191], v2 offset:7168
s_add_u32 s37, s37, 0x8000
v_mfma_f32_16x16x32_bf16 v[248:251], a[216:219], v[108:111], v[248:251]
v_exp_f32 v19, v93
v_mfma_f32_16x16x32_bf16 v[216:219], a[216:219], v[104:107], v[216:219]
v_exp_f32 v20, v94
v_mfma_f32_16x16x32_bf16 v[220:223], a[220:223], v[104:107], v[220:223]
v_exp_f32 v21, v95
v_mfma_f32_16x16x32_bf16 v[252:255], a[220:223], v[108:111], v[252:255]
s_waitcnt vmcnt(16) lgkmcnt(0)
s_barrier
v_mfma_f32_16x16x32_bf16 v[80:83], a[160:163], a[32:35], 0
ds_read_b128 a[192:195], v3 offset:0
v_cvt_pk_bf16_f32 v126, v18, v19
v_mfma_f32_16x16x32_bf16 v[80:83], a[164:167], a[36:39], v[80:83]
ds_read_b128 a[196:199], v3 offset:1024
v_cvt_pk_bf16_f32 v127, v20, v21
v_mfma_f32_16x16x32_bf16 v[80:83], a[168:171], a[40:43], v[80:83]
ds_read_b128 a[200:203], v3 offset:2048
s_mov_b32 m0, s40
v_mfma_f32_16x16x32_bf16 v[80:83], a[172:175], a[44:47], v[80:83]
v_exp_f32 v10, v48
v_mfma_f32_16x16x32_bf16 v[88:91], a[172:175], a[60:63], 0
v_exp_f32 v11, v49
v_mfma_f32_16x16x32_bf16 v[88:91], a[168:171], a[56:59], v[88:91]
ds_read_b128 a[204:207], v3 offset:3072
buffer_load_dwordx4 v1, s[24:27], s37 offen offset:0 sc1 lds
v_mfma_f32_16x16x32_bf16 v[88:91], a[164:167], a[52:55], v[88:91]
ds_read_b128 a[208:211], v3 offset:4096
v_cvt_pk_bf16_f32 v104, v10, v11
v_mfma_f32_16x16x32_bf16 v[88:91], a[160:163], a[48:51], v[88:91]
v_exp_f32 v12, v50
v_mfma_f32_16x16x32_bf16 v[84:87], a[176:179], a[32:35], 0
v_exp_f32 v13, v51
v_mfma_f32_16x16x32_bf16 v[84:87], a[180:183], a[36:39], v[84:87]
v_exp_f32 v14, v56
v_mfma_f32_16x16x32_bf16 v[84:87], a[184:187], a[40:43], v[84:87]
ds_read_b128 a[212:215], v3 offset:5120
v_cvt_pk_bf16_f32 v105, v12, v13
v_mfma_f32_16x16x32_bf16 v[84:87], a[188:191], a[44:47], v[84:87]
buffer_load_dwordx4 v1, s[24:27], s37 offen offset:1024 sc1 lds
v_mfma_f32_16x16x32_bf16 v[92:95], a[188:191], a[60:63], 0
ds_read_b128 a[216:219], v3 offset:6144
v_mfma_f32_16x16x32_bf16 v[92:95], a[184:187], a[56:59], v[92:95]
ds_read_b128 a[220:223], v3 offset:7168
v_mfma_f32_16x16x32_bf16 v[92:95], a[180:183], a[52:55], v[92:95]
v_exp_f32 v15, v57
v_mfma_f32_16x16x32_bf16 v[92:95], a[176:179], a[48:51], v[92:95]
ds_read_b128 a[160:163], v2 offset:24576
v_exp_f32 v16, v58
v_mfma_f32_16x16x32_bf16 a[136:139], a[144:147], v[120:123], a[136:139]
v_exp_f32 v17, v59
v_mfma_f32_16x16x32_bf16 a[140:143], a[144:147], v[124:127], a[140:143]
ds_read_b128 a[164:167], v2 offset:25600
s_waitcnt lgkmcnt(2)
v_mfma_f32_16x16x32_bf16 v[224:227], a[192:195], v[124:127], v[224:227]
ds_read_b128 a[168:171], v2 offset:26624
v_cvt_pk_bf16_f32 v108, v14, v15
v_mfma_f32_16x16x32_bf16 v[192:195], a[192:195], v[120:123], v[192:195]
ds_read_b128 a[172:175], v2 offset:27648
v_cvt_pk_bf16_f32 v109, v16, v17
v_mfma_f32_16x16x32_bf16 v[196:199], a[196:199], v[120:123], v[196:199]
ds_read_b128 a[176:179], v2 offset:28672
v_exp_f32 v18, v52
v_mfma_f32_16x16x32_bf16 v[228:231], a[196:199], v[124:127], v[228:231]
buffer_load_dwordx4 v1, s[24:27], s37 offen offset:2048 sc1 lds
v_mfma_f32_16x16x32_bf16 v[232:235], a[200:203], v[124:127], v[232:235]
v_exp_f32 v19, v53
v_mfma_f32_16x16x32_bf16 v[200:203], a[200:203], v[120:123], v[200:203]
v_exp_f32 v20, v54
v_mfma_f32_16x16x32_bf16 v[204:207], a[204:207], v[120:123], v[204:207]
ds_read_b128 a[180:183], v2 offset:29696
v_cvt_pk_bf16_f32 v106, v18, v19
v_mfma_f32_16x16x32_bf16 v[236:239], a[204:207], v[124:127], v[236:239]
ds_read_b128 a[184:187], v2 offset:30720
v_exp_f32 v21, v55
v_mfma_f32_16x16x32_bf16 v[240:243], a[208:211], v[124:127], v[240:243]
v_exp_f32 v10, v60
v_mfma_f32_16x16x32_bf16 v[208:211], a[208:211], v[120:123], v[208:211]
ds_read_b128 a[188:191], v2 offset:31744
v_cvt_pk_bf16_f32 v107, v20, v21
v_mfma_f32_16x16x32_bf16 v[212:215], a[212:215], v[120:123], v[212:215]
v_exp_f32 v11, v61
v_mfma_f32_16x16x32_bf16 v[244:247], a[212:215], v[124:127], v[244:247]
buffer_load_dwordx4 v1, s[24:27], s37 offen offset:3072 sc1 lds
v_mfma_f32_16x16x32_bf16 v[248:251], a[216:219], v[124:127], v[248:251]
v_exp_f32 v12, v62
v_mfma_f32_16x16x32_bf16 v[216:219], a[216:219], v[120:123], v[216:219]
v_exp_f32 v13, v63
s_waitcnt lgkmcnt(0)
v_mfma_f32_16x16x32_bf16 v[220:223], a[220:223], v[120:123], v[220:223]
v_cvt_pk_bf16_f32 v110, v10, v11
v_cvt_pk_bf16_f32 v111, v12, v13
v_mfma_f32_16x16x32_bf16 v[252:255], a[220:223], v[124:127], v[252:255]
s_cmp_lg_u32 s36, s41
s_cbranch_scc1 L_g1o_K
s_cmp_lg_u32 s36, s55
s_cbranch_scc1 L_ev_K
v_xor_b32 v2, 0x4000, v2
v_xor_b32 v3, 0x4000, v3
L_g1x_K:
v_mov_b32 v22, 163836
ds_read_b32 v23, v22
s_getpc_b64 s[50:51]
L_cp2:
s_add_u32 s50, s50, L_eb_K-L_cp2
s_addc_u32 s51, s51, 0
v_lshl_add_u32 v26, v0, 6, s59
v_mov_b32 v27, s51
v_add_co_u32 v26, vcc, s50, v26
s_nop 1
v_addc_co_u32 v27, vcc, 0, v27, vcc
global_load_dword v30, v[26:27], off
s_lshl_b32 s52, s2, 2
s_add_u32 s52, s52, s3
s_mul_i32 s52, s52, 2304
v_and_b32 v26, 31, v0
v_lshlrev_b32 v26, 4, v26
v_lshrrev_b32 v27, 5, v0
v_mul_u32_u24 v27, 1152, v27
v_min_u32 v4, 112, v26
v_add_u32 v4, v4, v27
v_add_u32 v27, v26, v27
s_lshl_b32 s50, s5, 2
s_lshr_b32 s51, 107303987, s50
s_and_b32 s51, s51, 15
s_add_u32 s51, s51, 16
s_lshr_b32 s50, 105062964, s50
s_and_b32 s50, s50, 15
s_mul_i32 s98, s5, 20
s_add_u32 s98, s98, s50
s_waitcnt lgkmcnt(0)
v_readfirstlane_b32 s53, v23
s_sub_u32 s98, s98, 4
s_and_b32 s53, s53, 31
s_add_u32 s98, s98, s53
s_lshl_b32 s98, s98, 14
s_add_u32 s98, s98, s59
s_cmp_lt_u32 s53, s51
s_cselect_b32 s7, 1, 0
s_cselect_b32 s98, s98, 2146435072
s_bfe_u32 s50, s61, 0x10001
s_bfe_u32 s51, s4, 0x10003
s_lshl_b32 s51, s51, 1
s_add_u32 s50, s50, s51
s_mul_i32 s85, s50, 9
s_and_b32 s50, s61, 1
s_mul_i32 s51, s50, 5
s_add_u32 s85, s85, s51
s_mul_i32 s91, s50, 2146435072
s_and_b32 s50, s4, 4
s_add_u32 s50, s50, s3
s_mul_i32 s84, s50, 589824
s_lshl_b32 s86, s50, 16
s_lshl_b32 s51, s85, 10
s_add_u32 s84, s84, s51
s_add_u32 s84, s84, 56623104
s_add_u32 s65, s98, 50331648
v_mfma_f32_16x16x32_bf16 v[48:51], a[160:163], a[32:35], 0
ds_read_b128 a[192:195], v3 offset:8192
v_exp_f32 v10, v80
v_mfma_f32_16x16x32_bf16 v[48:51], a[164:167], a[36:39], v[48:51]
ds_read_b128 a[196:199], v3 offset:9216
s_add_u32 m0, m0, 4096
v_mfma_f32_16x16x32_bf16 v[48:51], a[168:171], a[40:43], v[48:51]
ds_read_b128 a[200:203], v3 offset:10240
v_exp_f32 v11, v81
v_mfma_f32_16x16x32_bf16 v[48:51], a[172:175], a[44:47], v[48:51]
buffer_load_dwordx4 v28, s[24:27], s37 offen offset:0 sc1 lds
v_mfma_f32_16x16x32_bf16 v[56:59], a[172:175], a[60:63], 0
ds_read_b128 a[204:207], v3 offset:11264
buffer_load_dwordx4 a[148:151], v27, s[16:19], s52 offen offset:0
v_mfma_f32_16x16x32_bf16 v[56:59], a[168:171], a[56:59], v[56:59]
ds_read_b128 a[208:211], v3 offset:12288
s_add_u32 s36, s36, 1
v_mfma_f32_16x16x32_bf16 v[56:59], a[164:167], a[52:55], v[56:59]
ds_read_b128 a[212:215], v3 offset:13312
s_add_u32 s38, s38, 0x4000
v_cvt_pk_bf16_f32 v120, v10, v11
v_mfma_f32_16x16x32_bf16 v[56:59], a[160:163], a[48:51], v[56:59]
ds_read_b128 a[216:219], v3 offset:14336
s_and_b32 s38, s38, 0xffff
v_mfma_f32_16x16x32_bf16 v[52:55], a[176:179], a[32:35], 0
ds_read_b128 a[220:223], v3 offset:15360
buffer_load_dwordx4 a[152:155], v27, s[16:19], s52 offen offset:512
v_mfma_f32_16x16x32_bf16 v[52:55], a[180:183], a[36:39], v[52:55]
v_exp_f32 v12, v82
v_mfma_f32_16x16x32_bf16 v[52:55], a[184:187], a[40:43], v[52:55]
ds_read_b128 a[160:163], v2 offset:0
v_exp_f32 v13, v83
v_mfma_f32_16x16x32_bf16 v[52:55], a[188:191], a[44:47], v[52:55]
ds_read_b128 a[164:167], v2 offset:1024
v_cvt_pk_bf16_f32 v121, v12, v13
v_mfma_f32_16x16x32_bf16 v[60:63], a[188:191], a[60:63], 0
ds_read_b128 a[168:171], v2 offset:2048
buffer_load_dwordx4 v28, s[24:27], s37 offen offset:1024 sc1 lds
v_mfma_f32_16x16x32_bf16 v[60:63], a[184:187], a[56:59], v[60:63]
v_exp_f32 v14, v84
v_mfma_f32_16x16x32_bf16 v[60:63], a[180:183], a[52:55], v[60:63]
ds_read_b128 a[172:175], v2 offset:3072
v_exp_f32 v15, v85
v_mfma_f32_16x16x32_bf16 v[60:63], a[176:179], a[48:51], v[60:63]
buffer_load_dwordx4 a[156:159], v4, s[16:19], s52 offen offset:1024
v_mfma_f32_16x16x32_bf16 a[136:139], a[144:147], v[104:107], a[136:139]
ds_read_b128 a[176:179], v2 offset:4096
v_cvt_pk_bf16_f32 v122, v14, v15
s_waitcnt lgkmcnt(5)
v_mfma_f32_16x16x32_bf16 a[140:143], a[144:147], v[108:111], a[140:143]
v_exp_f32 v16, v86
v_mfma_f32_16x16x32_bf16 v[224:227], a[192:195], v[108:111], v[224:227]
ds_read_b128 a[180:183], v2 offset:5120
buffer_load_dwordx4 a[112:115], v26, s[20:23], 0 offen offset:0
v_mfma_f32_16x16x32_bf16 v[192:195], a[192:195], v[104:107], v[192:195]
v_exp_f32 v17, v87
v_mfma_f32_16x16x32_bf16 v[196:199], a[196:199], v[104:107], v[196:199]
ds_read_b128 a[184:187], v2 offset:6144
buffer_load_dwordx4 v28, s[24:27], s37 offen offset:2048 sc1 lds
v_mfma_f32_16x16x32_bf16 v[228:231], a[196:199], v[108:111], v[228:231]
v_exp_f32 v18, v88
v_mfma_f32_16x16x32_bf16 v[232:235], a[200:203], v[108:111], v[232:235]
ds_read_b128 a[188:191], v2 offset:7168
v_exp_f32 v19, v89
v_mfma_f32_16x16x32_bf16 v[200:203], a[200:203], v[104:107], v[200:203]
v_cvt_pk_bf16_f32 v123, v16, v17
v_cvt_pk_bf16_f32 v124, v18, v19
v_mfma_f32_16x16x32_bf16 v[204:207], a[204:207], v[104:107], v[204:207]
v_exp_f32 v20, v90
v_mfma_f32_16x16x32_bf16 v[236:239], a[204:207], v[108:111], v[236:239]
buffer_load_dwordx4 a[116:119], v26, s[20:23], 0 offen offset:512
v_mfma_f32_16x16x32_bf16 v[240:243], a[208:211], v[108:111], v[240:243]
buffer_load_dwordx4 v28, s[24:27], s37 offen offset:3072 sc1 lds
v_exp_f32 v21, v91
v_mfma_f32_16x16x32_bf16 v[208:211], a[208:211], v[104:107], v[208:211]
v_readlane_b32 s37, v29, s36
v_mfma_f32_16x16x32_bf16 v[212:215], a[212:215], v[104:107], v[212:215]
v_exp_f32 v10, v92
v_cvt_pk_bf16_f32 v125, v20, v21
v_mfma_f32_16x16x32_bf16 v[244:247], a[212:215], v[108:111], v[244:247]
v_exp_f32 v11, v93
v_mfma_f32_16x16x32_bf16 v[248:251], a[216:219], v[108:111], v[248:251]
buffer_load_dwordx4 a[120:123], v26, s[20:23], 0 offen offset:1024
v_cvt_pk_bf16_f32 v126, v10, v11
v_mfma_f32_16x16x32_bf16 v[216:219], a[216:219], v[104:107], v[216:219]
v_exp_f32 v12, v94
v_mfma_f32_16x16x32_bf16 v[220:223], a[220:223], v[104:107], v[220:223]
v_exp_f32 v13, v95
s_waitcnt vmcnt(23) lgkmcnt(0)
v_mfma_f32_16x16x32_bf16 v[252:255], a[220:223], v[108:111], v[252:255]
v_cvt_pk_bf16_f32 v127, v12, v13
s_barrier
v_add_u32 v29, s91, v28
v_mfma_f32_16x16x32_bf16 v[80:83], a[160:163], a[32:35], 0
ds_read_b128 a[192:195], v3 offset:0
s_mul_i32 s53, s3, 4160
v_mfma_f32_16x16x32_bf16 v[80:83], a[164:167], a[36:39], v[80:83]
ds_read_b128 a[196:199], v3 offset:1024
v_exp_f32 v10, v48
v_mfma_f32_16x16x32_bf16 v[80:83], a[168:171], a[40:43], v[80:83]
ds_read_b128 a[200:203], v3 offset:2048
v_add_u32 v5, 2, v1
v_mfma_f32_16x16x32_bf16 v[80:83], a[172:175], a[44:47], v[80:83]
ds_read_b128 a[204:207], v3 offset:3072
s_add_u32 m0, s53, 131168
s_nop 0
v_mfma_f32_16x16x32_bf16 v[88:91], a[172:175], a[60:63], 0
buffer_load_dwordx4 v5, s[8:11], s98 offen offset:0 lds
v_mfma_f32_16x16x32_bf16 v[88:91], a[168:171], a[56:59], v[88:91]
ds_read_b128 a[208:211], v3 offset:4096
buffer_load_dwordx4 v5, s[8:11], s98 offen offset:1024 lds
v_mfma_f32_16x16x32_bf16 v[88:91], a[164:167], a[52:55], v[88:91]
v_exp_f32 v11, v49
v_mfma_f32_16x16x32_bf16 v[88:91], a[160:163], a[48:51], v[88:91]
ds_read_b128 a[212:215], v3 offset:5120
v_add_u32 v2, 0x4000, v2
v_and_b32 v2, 0xffff, v2
v_mfma_f32_16x16x32_bf16 v[84:87], a[176:179], a[32:35], 0
v_exp_f32 v12, v50
v_mfma_f32_16x16x32_bf16 v[84:87], a[180:183], a[36:39], v[84:87]
ds_read_b128 a[216:219], v3 offset:6144
v_exp_f32 v13, v51
v_mfma_f32_16x16x32_bf16 v[84:87], a[184:187], a[40:43], v[84:87]
buffer_load_dwordx4 v5, s[8:11], s98 offen offset:2048 lds
v_mfma_f32_16x16x32_bf16 v[84:87], a[188:191], a[44:47], v[84:87]
ds_read_b128 a[220:223], v3 offset:7168
v_xor_b32 v3, 0x18000, v2
v_cvt_pk_bf16_f32 v104, v10, v11
v_mfma_f32_16x16x32_bf16 v[92:95], a[188:191], a[60:63], 0
ds_read_b128 a[160:163], v2 offset:8192
v_cvt_pk_bf16_f32 v105, v12, v13
v_mfma_f32_16x16x32_bf16 v[92:95], a[184:187], a[56:59], v[92:95]
ds_read_b128 a[164:167], v2 offset:9216
v_exp_f32 v14, v52
v_mfma_f32_16x16x32_bf16 v[92:95], a[180:183], a[52:55], v[92:95]
buffer_load_dwordx4 v5, s[8:11], s98 offen offset:3072 lds
v_mfma_f32_16x16x32_bf16 v[92:95], a[176:179], a[48:51], v[92:95]
ds_read_b128 a[168:171], v2 offset:10240
v_exp_f32 v15, v53
v_mfma_f32_16x16x32_bf16 a[136:139], a[144:147], v[120:123], a[136:139]
v_exp_f32 v16, v54
v_mfma_f32_16x16x32_bf16 a[140:143], a[144:147], v[124:127], a[140:143]
ds_read_b128 a[172:175], v2 offset:11264
v_cvt_pk_bf16_f32 v106, v14, v15
s_waitcnt lgkmcnt(4)
v_mfma_f32_16x16x32_bf16 v[224:227], a[192:195], v[124:127], v[224:227]
v_exp_f32 v17, v55
v_mfma_f32_16x16x32_bf16 v[192:195], a[192:195], v[120:123], v[192:195]
ds_read_b128 a[176:179], v2 offset:12288
buffer_load_ushort v4, off, s[8:11], s98
v_mfma_f32_16x16x32_bf16 v[196:199], a[196:199], v[120:123], v[196:199]
ds_read_b128 a[180:183], v2 offset:13312
s_lshr_b32 s53, s98, 11
v_mfma_f32_16x16x32_bf16 v[228:231], a[196:199], v[124:127], v[228:231]
ds_read_b128 a[184:187], v2 offset:14336
v_cvt_pk_bf16_f32 v107, v16, v17
v_mfma_f32_16x16x32_bf16 v[232:235], a[200:203], v[124:127], v[232:235]
ds_read_b128 a[188:191], v2 offset:15360
v_exp_f32 v18, v56
v_mfma_f32_16x16x32_bf16 v[200:203], a[200:203], v[120:123], v[200:203]
buffer_load_ushort v27, off, s[12:15], s53
s_add_u32 s58, s84, 147456
v_mfma_f32_16x16x32_bf16 v[204:207], a[204:207], v[120:123], v[204:207]
v_exp_f32 v19, v57
v_mfma_f32_16x16x32_bf16 v[236:239], a[204:207], v[124:127], v[236:239]
v_exp_f32 v20, v58
v_cvt_pk_bf16_f32 v108, v18, v19
v_mfma_f32_16x16x32_bf16 v[240:243], a[208:211], v[124:127], v[240:243]
v_exp_f32 v21, v59
v_mfma_f32_16x16x32_bf16 v[208:211], a[208:211], v[120:123], v[208:211]
buffer_load_dwordx4 a[64:67], v1, s[28:31], s58 offen offset:0 sc1
v_cvt_pk_bf16_f32 v109, v20, v21
v_mfma_f32_16x16x32_bf16 v[212:215], a[212:215], v[120:123], v[212:215]
buffer_load_dwordx4 a[68:71], v1, s[28:31], s58 offen offset:1024 sc1
v_mfma_f32_16x16x32_bf16 v[244:247], a[212:215], v[124:127], v[244:247]
v_exp_f32 v10, v60
v_mfma_f32_16x16x32_bf16 v[248:251], a[216:219], v[124:127], v[248:251]
v_exp_f32 v11, v61
v_exp_f32 v12, v62
v_mfma_f32_16x16x32_bf16 v[216:219], a[216:219], v[120:123], v[216:219]
buffer_load_dwordx4 a[72:75], v1, s[28:31], s58 offen offset:2048 sc1
v_mfma_f32_16x16x32_bf16 v[220:223], a[220:223], v[120:123], v[220:223]
v_exp_f32 v13, v63
v_cvt_pk_bf16_f32 v110, v10, v11
v_mfma_f32_16x16x32_bf16 v[252:255], a[220:223], v[124:127], v[252:255]
v_cvt_pk_bf16_f32 v111, v12, v13
s_waitcnt lgkmcnt(0)
v_mfma_f32_16x16x32_bf16 v[48:51], a[160:163], a[32:35], 0
buffer_load_dwordx4 a[244:247], v1, s[28:31], s65 offen offset:0 sc1
v_mfma_f32_16x16x32_bf16 v[48:51], a[164:167], a[36:39], v[48:51]
ds_read_b128 a[192:195], v3 offset:8192
v_exp_f32 v10, v80
v_mfma_f32_16x16x32_bf16 v[48:51], a[168:171], a[40:43], v[48:51]
v_exp_f32 v11, v81
v_mfma_f32_16x16x32_bf16 v[48:51], a[172:175], a[44:47], v[48:51]
ds_read_b128 a[196:199], v3 offset:9216
v_cvt_pk_bf16_f32 v120, v10, v11
v_mfma_f32_16x16x32_bf16 v[56:59], a[172:175], a[60:63], 0
ds_read_b128 a[200:203], v3 offset:10240
buffer_load_dwordx4 a[248:251], v1, s[28:31], s65 offen offset:1024 sc1
v_mfma_f32_16x16x32_bf16 v[56:59], a[168:171], a[56:59], v[56:59]
v_exp_f32 v12, v82
v_mfma_f32_16x16x32_bf16 v[56:59], a[164:167], a[52:55], v[56:59]
v_exp_f32 v13, v83
v_mfma_f32_16x16x32_bf16 v[56:59], a[160:163], a[48:51], v[56:59]
ds_read_b128 a[204:207], v3 offset:11264
buffer_load_dwordx4 a[252:255], v1, s[28:31], s65 offen offset:2048 sc1
v_mfma_f32_16x16x32_bf16 v[52:55], a[176:179], a[32:35], 0
ds_read_b128 a[208:211], v3 offset:12288
v_cvt_pk_bf16_f32 v121, v12, v13
v_mfma_f32_16x16x32_bf16 v[52:55], a[180:183], a[36:39], v[52:55]
ds_read_b128 a[212:215], v3 offset:13312
v_exp_f32 v14, v84
v_mfma_f32_16x16x32_bf16 v[52:55], a[184:187], a[40:43], v[52:55]
buffer_load_dwordx4 a[124:127], v1, s[28:31], s65 offen offset:3072 sc1
v_mfma_f32_16x16x32_bf16 v[52:55], a[188:191], a[44:47], v[52:55]
v_exp_f32 v15, v85
v_mfma_f32_16x16x32_bf16 v[60:63], a[188:191], a[60:63], 0
ds_read_b128 a[216:219], v3 offset:14336
v_exp_f32 v16, v86
v_mfma_f32_16x16x32_bf16 v[60:63], a[184:187], a[56:59], v[60:63]
ds_read_b128 a[220:223], v3 offset:15360
v_cvt_pk_bf16_f32 v122, v14, v15
v_mfma_f32_16x16x32_bf16 v[60:63], a[180:183], a[52:55], v[60:63]
buffer_load_dwordx4 a[76:79], v1, s[28:31], s58 offen offset:3072 sc1
v_mfma_f32_16x16x32_bf16 v[60:63], a[176:179], a[48:51], v[60:63]
ds_read_b128 a[160:163], v2 offset:0
v_exp_f32 v17, v87
v_mfma_f32_16x16x32_bf16 a[136:139], a[144:147], v[104:107], a[136:139]
v_exp_f32 v18, v88
v_mfma_f32_16x16x32_bf16 a[140:143], a[144:147], v[108:111], a[140:143]
ds_read_b128 a[164:167], v2 offset:1024
s_waitcnt lgkmcnt(2)
v_mfma_f32_16x16x32_bf16 v[224:227], a[192:195], v[108:111], v[224:227]
ds_read_b128 a[168:171], v2 offset:2048
v_cvt_pk_bf16_f32 v123, v16, v17
v_mfma_f32_16x16x32_bf16 v[192:195], a[192:195], v[104:107], v[192:195]
ds_read_b128 a[172:175], v2 offset:3072
buffer_load_dwordx4 a[80:83], v29, s[28:31], s58 offen offset:0 sc1
v_mfma_f32_16x16x32_bf16 v[196:199], a[196:199], v[104:107], v[196:199]
ds_read_b128 a[176:179], v2 offset:4096
s_add_u32 s58, s84, 184320
v_mfma_f32_16x16x32_bf16 v[228:231], a[196:199], v[108:111], v[228:231]
ds_read_b128 a[180:183], v2 offset:5120
v_exp_f32 v19, v89
v_mfma_f32_16x16x32_bf16 v[232:235], a[200:203], v[108:111], v[232:235]
buffer_load_dwordx4 a[84:87], v1, s[28:31], s58 offen offset:0 sc1
v_mfma_f32_16x16x32_bf16 v[200:203], a[200:203], v[104:107], v[200:203]
ds_read_b128 a[184:187], v2 offset:6144
v_exp_f32 v20, v90
v_mfma_f32_16x16x32_bf16 v[204:207], a[204:207], v[104:107], v[204:207]
ds_read_b128 a[188:191], v2 offset:7168
v_cvt_pk_bf16_f32 v124, v18, v19
v_mfma_f32_16x16x32_bf16 v[236:239], a[204:207], v[108:111], v[236:239]
v_exp_f32 v21, v91
v_mfma_f32_16x16x32_bf16 v[240:243], a[208:211], v[108:111], v[240:243]
buffer_load_dwordx4 a[88:91], v1, s[28:31], s58 offen offset:1024 sc1
v_cvt_pk_bf16_f32 v125, v20, v21
v_mfma_f32_16x16x32_bf16 v[208:211], a[208:211], v[104:107], v[208:211]
v_exp_f32 v10, v92
v_mfma_f32_16x16x32_bf16 v[212:215], a[212:215], v[104:107], v[212:215]
v_exp_f32 v11, v93
v_mfma_f32_16x16x32_bf16 v[244:247], a[212:215], v[108:111], v[244:247]
buffer_load_dwordx4 a[92:95], v1, s[28:31], s58 offen offset:2048 sc1
v_cvt_pk_bf16_f32 v126, v10, v11
v_mfma_f32_16x16x32_bf16 v[248:251], a[216:219], v[108:111], v[248:251]
v_exp_f32 v12, v94
v_mfma_f32_16x16x32_bf16 v[216:219], a[216:219], v[104:107], v[216:219]
buffer_load_dwordx4 a[96:99], v1, s[28:31], s58 offen offset:3072 sc1
v_mfma_f32_16x16x32_bf16 v[220:223], a[220:223], v[104:107], v[220:223]
v_exp_f32 v13, v95
s_waitcnt vmcnt(19) lgkmcnt(0)
v_mfma_f32_16x16x32_bf16 v[252:255], a[220:223], v[108:111], v[252:255]
v_cvt_pk_bf16_f32 v127, v12, v13
s_barrier
v_mfma_f32_16x16x32_bf16 v[80:83], a[160:163], a[32:35], 0
v_exp_f32 v10, v48
v_mfma_f32_16x16x32_bf16 v[80:83], a[164:167], a[36:39], v[80:83]
ds_read_b128 a[192:195], v3 offset:0
s_mul_i32 s53, s3, 8768
v_mfma_f32_16x16x32_bf16 v[80:83], a[168:171], a[40:43], v[80:83]
ds_read_b128 a[196:199], v3 offset:1024
s_add_u32 m0, s53, 32
s_nop 0
v_mfma_f32_16x16x32_bf16 v[80:83], a[172:175], a[44:47], v[80:83]
buffer_load_dwordx4 v1, s[8:11], s98 offen offset:0 lds
v_mfma_f32_16x16x32_bf16 v[88:91], a[172:175], a[60:63], 0
ds_read_b128 a[200:203], v3 offset:2048
v_add_u32 v2, 0x4000, v2
v_mfma_f32_16x16x32_bf16 v[88:91], a[168:171], a[56:59], v[88:91]
buffer_load_dwordx4 v1, s[8:11], s98 offen offset:1024 lds
v_mfma_f32_16x16x32_bf16 v[88:91], a[164:167], a[52:55], v[88:91]
ds_read_b128 a[204:207], v3 offset:3072
v_and_b32 v2, 0xffff, v2
v_mfma_f32_16x16x32_bf16 v[88:91], a[160:163], a[48:51], v[88:91]
ds_read_b128 a[208:211], v3 offset:4096
v_exp_f32 v11, v49
v_mfma_f32_16x16x32_bf16 v[84:87], a[176:179], a[32:35], 0
ds_read_b128 a[212:215], v3 offset:5120
v_cvt_pk_bf16_f32 v104, v10, v11
v_mfma_f32_16x16x32_bf16 v[84:87], a[180:183], a[36:39], v[84:87]
v_exp_f32 v12, v50
v_mfma_f32_16x16x32_bf16 v[84:87], a[184:187], a[40:43], v[84:87]
ds_read_b128 a[216:219], v3 offset:6144
buffer_load_dwordx4 v1, s[8:11], s98 offen offset:2048 lds
v_mfma_f32_16x16x32_bf16 v[84:87], a[188:191], a[44:47], v[84:87]
v_exp_f32 v13, v51
v_mfma_f32_16x16x32_bf16 v[92:95], a[188:191], a[60:63], 0
ds_read_b128 a[220:223], v3 offset:7168
v_xor_b32 v3, 0x18000, v2
v_mfma_f32_16x16x32_bf16 v[92:95], a[184:187], a[56:59], v[92:95]
v_exp_f32 v14, v52
v_mfma_f32_16x16x32_bf16 v[92:95], a[180:183], a[52:55], v[92:95]
v_exp_f32 v15, v53
v_cvt_pk_bf16_f32 v105, v12, v13
v_mfma_f32_16x16x32_bf16 v[92:95], a[176:179], a[48:51], v[92:95]
buffer_load_dwordx4 v1, s[8:11], s98 offen offset:3072 lds
v_mfma_f32_16x16x32_bf16 a[136:139], a[144:147], v[120:123], a[136:139]
buffer_load_dwordx4 a[100:103], v29, s[28:31], s58 offen offset:0 sc1
v_mfma_f32_16x16x32_bf16 a[140:143], a[144:147], v[124:127], a[140:143]
v_cvt_pk_bf16_f32 v106, v14, v15
s_waitcnt lgkmcnt(0)
v_mfma_f32_16x16x32_bf16 v[224:227], a[192:195], v[124:127], v[224:227]
s_add_u32 s58, s84, 221184
v_mfma_f32_16x16x32_bf16 v[192:195], a[192:195], v[120:123], v[192:195]
v_exp_f32 v16, v54
v_mfma_f32_16x16x32_bf16 v[196:199], a[196:199], v[120:123], v[196:199]
v_exp_f32 v17, v55
v_mfma_f32_16x16x32_bf16 v[228:231], a[196:199], v[124:127], v[228:231]
v_exp_f32 v18, v56
v_cvt_pk_bf16_f32 v107, v16, v17
v_mfma_f32_16x16x32_bf16 v[232:235], a[200:203], v[124:127], v[232:235]
buffer_load_dwordx4 a[224:227], v1, s[28:31], s58 offen offset:0 sc1
v_mfma_f32_16x16x32_bf16 v[200:203], a[200:203], v[120:123], v[200:203]
v_exp_f32 v19, v57
v_mfma_f32_16x16x32_bf16 v[204:207], a[204:207], v[120:123], v[204:207]
buffer_load_dwordx4 a[228:231], v1, s[28:31], s58 offen offset:1024 sc1
v_exp_f32 v20, v58
v_mfma_f32_16x16x32_bf16 v[236:239], a[204:207], v[124:127], v[236:239]
v_exp_f32 v21, v59
v_mfma_f32_16x16x32_bf16 v[240:243], a[208:211], v[124:127], v[240:243]
v_cvt_pk_bf16_f32 v108, v18, v19
v_cvt_pk_bf16_f32 v109, v20, v21
v_mfma_f32_16x16x32_bf16 v[208:211], a[208:211], v[120:123], v[208:211]
v_exp_f32 v10, v60
v_mfma_f32_16x16x32_bf16 v[212:215], a[212:215], v[120:123], v[212:215]
buffer_load_dwordx4 a[232:235], v1, s[28:31], s58 offen offset:2048 sc1
v_mfma_f32_16x16x32_bf16 v[244:247], a[212:215], v[124:127], v[244:247]
buffer_load_dwordx4 a[236:239], v1, s[28:31], s58 offen offset:3072 sc1
v_mfma_f32_16x16x32_bf16 v[248:251], a[216:219], v[124:127], v[248:251]
v_exp_f32 v11, v61
v_exp_f32 v12, v62
v_mfma_f32_16x16x32_bf16 v[216:219], a[216:219], v[120:123], v[216:219]
v_exp_f32 v13, v63
v_mfma_f32_16x16x32_bf16 v[220:223], a[220:223], v[120:123], v[220:223]
buffer_load_dwordx4 a[240:243], v29, s[28:31], s58 offen offset:0 sc1
v_mfma_f32_16x16x32_bf16 v[252:255], a[220:223], v[124:127], v[252:255]
v_cvt_pk_bf16_f32 v110, v10, v11
v_cvt_pk_bf16_f32 v111, v12, v13
ds_read_b128 a[192:195], v3 offset:8192
ds_read_b128 a[196:199], v3 offset:9216
ds_read_b128 a[200:203], v3 offset:10240
ds_read_b128 a[204:207], v3 offset:11264
v_mfma_f32_16x16x32_bf16 a[136:139], a[144:147], v[104:107], a[136:139]
ds_read_b128 a[208:211], v3 offset:12288
v_exp_f32 v10, v80
v_mfma_f32_16x16x32_bf16 a[140:143], a[144:147], v[108:111], a[140:143]
ds_read_b128 a[212:215], v3 offset:13312
s_waitcnt lgkmcnt(2)
s_add_u32 s58, s84, 0
v_mfma_f32_16x16x32_bf16 v[224:227], a[192:195], v[108:111], v[224:227]
buffer_load_dwordx4 v[128:131], v1, s[28:31], s58 offen offset:0 sc1
v_exp_f32 v11, v81
v_mfma_f32_16x16x32_bf16 v[192:195], a[192:195], v[104:107], v[192:195]
ds_read_b128 a[216:219], v3 offset:14336
v_exp_f32 v12, v82
v_mfma_f32_16x16x32_bf16 v[196:199], a[196:199], v[104:107], v[196:199]
ds_read_b128 a[220:223], v3 offset:15360
v_exp_f32 v13, v83
v_mfma_f32_16x16x32_bf16 v[228:231], a[196:199], v[108:111], v[228:231]
v_exp_f32 v14, v84
v_cvt_pk_bf16_f32 v120, v10, v11
v_mfma_f32_16x16x32_bf16 v[232:235], a[200:203], v[108:111], v[232:235]
v_exp_f32 v15, v85
v_cvt_pk_bf16_f32 v121, v12, v13
v_mfma_f32_16x16x32_bf16 v[200:203], a[200:203], v[104:107], v[200:203]
v_exp_f32 v16, v86
v_cvt_pk_bf16_f32 v122, v14, v15
v_mfma_f32_16x16x32_bf16 v[204:207], a[204:207], v[104:107], v[204:207]
buffer_load_dwordx4 v[132:135], v1, s[28:31], s58 offen offset:1024 sc1
v_exp_f32 v17, v87
v_mfma_f32_16x16x32_bf16 v[236:239], a[204:207], v[108:111], v[236:239]
v_exp_f32 v18, v88
s_waitcnt lgkmcnt(0)
v_mfma_f32_16x16x32_bf16 v[240:243], a[208:211], v[108:111], v[240:243]
v_exp_f32 v19, v89
v_cvt_pk_bf16_f32 v123, v16, v17
v_mfma_f32_16x16x32_bf16 v[208:211], a[208:211], v[104:107], v[208:211]
v_exp_f32 v20, v90
v_cvt_pk_bf16_f32 v124, v18, v19
v_mfma_f32_16x16x32_bf16 v[212:215], a[212:215], v[104:107], v[212:215]
v_exp_f32 v21, v91
v_mfma_f32_16x16x32_bf16 v[244:247], a[212:215], v[108:111], v[244:247]
buffer_load_dwordx4 v[136:139], v1, s[28:31], s58 offen offset:2048 sc1
v_exp_f32 v10, v92
v_mfma_f32_16x16x32_bf16 v[248:251], a[216:219], v[108:111], v[248:251]
buffer_load_dwordx4 v[140:143], v1, s[28:31], s58 offen offset:3072 sc1
v_exp_f32 v11, v93
v_mfma_f32_16x16x32_bf16 v[216:219], a[216:219], v[104:107], v[216:219]
v_exp_f32 v12, v94
v_cvt_pk_bf16_f32 v125, v20, v21
v_mfma_f32_16x16x32_bf16 v[220:223], a[220:223], v[104:107], v[220:223]
buffer_load_dwordx4 v[144:147], v29, s[28:31], s58 offen offset:0 sc1
v_exp_f32 v13, v95
v_mfma_f32_16x16x32_bf16 v[252:255], a[220:223], v[108:111], v[252:255]
v_cvt_pk_bf16_f32 v126, v10, v11
v_cvt_pk_bf16_f32 v127, v12, v13
ds_read_b128 a[192:195], v3 offset:0
ds_read_b128 a[196:199], v3 offset:1024
ds_read_b128 a[200:203], v3 offset:2048
ds_read_b128 a[204:207], v3 offset:3072
v_mfma_f32_16x16x32_bf16 a[136:139], a[144:147], v[120:123], a[136:139]
ds_read_b128 a[208:211], v3 offset:4096
s_add_u32 s58, s84, 36864
v_mfma_f32_16x16x32_bf16 a[140:143], a[144:147], v[124:127], a[140:143]
s_waitcnt lgkmcnt(1)
buffer_load_dwordx4 v[148:151], v1, s[28:31], s58 offen offset:0 sc1
v_mfma_f32_16x16x32_bf16 v[224:227], a[192:195], v[124:127], v[224:227]
ds_read_b128 a[212:215], v3 offset:5120
s_lshr_b32 s50, s4, 4
v_mfma_f32_16x16x32_bf16 v[192:195], a[192:195], v[120:123], v[192:195]
ds_read_b128 a[216:219], v3 offset:6144
s_lshl_b32 s50, s50, 2
v_mfma_f32_16x16x32_bf16 v[196:199], a[196:199], v[120:123], v[196:199]
ds_read_b128 a[220:223], v3 offset:7168
s_and_b32 s51, s4, 3
s_add_u32 s50, s50, s51
v_mfma_f32_16x16x32_bf16 v[228:231], a[196:199], v[124:127], v[228:231]
s_lshl_b32 s50, s50, 1
s_lshr_b32 s51, s61, 2
v_mfma_f32_16x16x32_bf16 v[232:235], a[200:203], v[124:127], v[232:235]
buffer_load_dwordx4 v[152:155], v1, s[28:31], s58 offen offset:1024 sc1
v_mfma_f32_16x16x32_bf16 v[200:203], a[200:203], v[120:123], v[200:203]
buffer_load_dwordx4 v[156:159], v1, s[28:31], s58 offen offset:2048 sc1
s_add_u32 s50, s50, s51
v_mfma_f32_16x16x32_bf16 v[204:207], a[204:207], v[120:123], v[204:207]
s_lshl_b32 s50, s50, 1
s_bfe_u32 s51, s4, 0x10002
v_mfma_f32_16x16x32_bf16 v[236:239], a[204:207], v[124:127], v[236:239]
s_waitcnt lgkmcnt(0)
s_add_u32 s89, s50, s51
v_mfma_f32_16x16x32_bf16 v[240:243], a[208:211], v[124:127], v[240:243]
buffer_load_dwordx4 v[160:163], v1, s[28:31], s58 offen offset:3072 sc1
s_add_u32 s86, s86, 33554432
v_mfma_f32_16x16x32_bf16 v[208:211], a[208:211], v[120:123], v[208:211]
s_lshl_b32 s50, s89, 19
s_add_u32 s87, s86, s50
v_mfma_f32_16x16x32_bf16 v[212:215], a[212:215], v[120:123], v[212:215]
s_xor_b32 s86, s87, 524288
s_lshl_b32 s88, s5, 5
v_mfma_f32_16x16x32_bf16 v[244:247], a[212:215], v[124:127], v[244:247]
buffer_load_dwordx4 v[164:167], v29, s[28:31], s58 offen offset:0 sc1
s_add_u32 s88, s88, s4
v_mfma_f32_16x16x32_bf16 v[248:251], a[216:219], v[124:127], v[248:251]
s_lshl_b32 s88, s88, 9
s_xor_b32 s50, s2, 1
v_mfma_f32_16x16x32_bf16 v[216:219], a[216:219], v[120:123], v[216:219]
s_lshl_b32 s50, s50, 2
s_add_u32 s50, s50, s3
v_mfma_f32_16x16x32_bf16 v[220:223], a[220:223], v[120:123], v[220:223]
s_mul_i32 s91, s50, 5120
s_add_u32 s91, s91, 62914560
s_xor_b32 s50, s50, 4
s_mul_i32 s90, s50, 5120
s_add_u32 s90, s90, 62914560
v_mfma_f32_16x16x32_bf16 v[252:255], a[220:223], v[124:127], v[252:255]
L_eb_K:
s_nop 7
v_accvgpr_read_b32 v10, a136
v_accvgpr_read_b32 v11, a140
v_max_f32 v16, v10, v11
v_min_f32 v17, v10, v11
v_cmp_u_f32 s[50:51], v10, v11
v_cmp_lt_f32 vcc, 0x5d800000, v16
s_or_b64 s[44:45], s[50:51], vcc
v_cmp_gt_f32 vcc, 0x21800000, v17
s_or_b64 s[44:45], s[44:45], vcc
s_or_b64 s[50:51], s[42:43], s[44:45]
s_cbranch_scc1 L_fix_K
L_tail_K:
v_accvgpr_read_b32 v24, a136
v_accvgpr_read_b32 v22, a140
v_rcp_f32 v24, v24
v_rcp_f32 v22, v22
s_nop 0
v_mov_b32 v25, v24
v_mov_b32 v23, v22
v_lshrrev_b32 v2, 4, v0
v_and_b32 v3, 15, v0
v_mul_u32_u24 v26, 0x400000, v0
v_mov_b32 v21, 1
s_lshl_b32 s36, s3, 7
s_add_u32 s36, s36, s88
s_add_u32 s36, s36, 69337088
s_lshl_b32 s40, s3, 28
s_add_u32 s40, s40, s36
s_cmp_eq_u32 s7, 0
s_cbranch_scc1 L_nc_K
v_pk_mul_f32 v[192:193], v[192:193], v[24:25]
v_pk_mul_f32 v[194:195], v[194:195], v[24:25]
v_pk_mul_f32 v[196:197], v[196:197], v[24:25]
v_pk_mul_f32 v[198:199], v[198:199], v[24:25]
v_cvt_pk_bf16_f32 v192, v192, v193
v_cvt_pk_bf16_f32 v193, v194, v195
v_cvt_pk_bf16_f32 v194, v196, v197
v_cvt_pk_bf16_f32 v195, v198, v199
buffer_store_dwordx4 v[192:195], v1, s[28:31], s57 offen offset:0 sc1
v_pk_mul_f32 v[224:225], v[224:225], v[22:23]
v_pk_mul_f32 v[226:227], v[226:227], v[22:23]
v_pk_mul_f32 v[228:229], v[228:229], v[22:23]
v_pk_mul_f32 v[230:231], v[230:231], v[22:23]
v_cvt_pk_bf16_f32 v224, v224, v225
v_cvt_pk_bf16_f32 v225, v226, v227
v_cvt_pk_bf16_f32 v226, v228, v229
v_cvt_pk_bf16_f32 v227, v230, v231
buffer_store_dwordx4 v[224:227], v1, s[28:31], s57 offen offset:1024 sc1
s_mul_i32 s52, s3, 8768
s_add_u32 s53, s52, 4160
v_add_u32 v18, s53, v1
s_waitcnt vmcnt(18)
ds_write_b128 v18, a[244:247] offset:0
ds_write_b128 v18, a[248:251] offset:1024
ds_write_b128 v18, a[252:255] offset:2048
ds_write_b128 v18, a[124:127] offset:3072
v_pk_mul_f32 v[200:201], v[200:201], v[24:25]
v_pk_mul_f32 v[202:203], v[202:203], v[24:25]
v_pk_mul_f32 v[204:205], v[204:205], v[24:25]
v_pk_mul_f32 v[206:207], v[206:207], v[24:25]
v_cvt_pk_bf16_f32 v200, v200, v201
v_cvt_pk_bf16_f32 v201, v202, v203
v_cvt_pk_bf16_f32 v202, v204, v205
v_cvt_pk_bf16_f32 v203, v206, v207
s_add_u32 s57, s57, 4096
buffer_store_dwordx4 v[200:203], v1, s[28:31], s57 offen offset:0 sc1
s_mul_i32 s51, s3, 4160
s_add_u32 s51, s51, 131136
s_sub_u32 s51, s51, s52
v_lshlrev_b32 v4, 16, v4
v_lshlrev_b32 v27, 16, v27
v_mov_b64 v[32:33], 0
v_mov_b64 v[34:35], 0
v_add_u32 v18, 4096, v18
v_and_b32 v19, 1, v0
v_lshlrev_b32 v19, 4, v19
v_bfe_u32 v20, v0, 1, 1
v_mul_u32_u24 v20, s51, v20
v_add3_u32 v19, v19, v20, s52
v_cmp_gt_u32 vcc, 32, v0
v_and_b32 v20, 35, v0
s_nop 0
v_cndmask_b32 v18, v19, v18, vcc
v_cmp_eq_u32 vcc, 35, v20
s_nop 1
v_cndmask_b32 v35, v35, v4, vcc
ds_write_b128 v18, v[32:35]
v_pk_mul_f32 v[232:233], v[232:233], v[22:23]
v_pk_mul_f32 v[234:235], v[234:235], v[22:23]
v_pk_mul_f32 v[236:237], v[236:237], v[22:23]
v_pk_mul_f32 v[238:239], v[238:239], v[22:23]
v_cvt_pk_bf16_f32 v232, v232, v233
v_cvt_pk_bf16_f32 v233, v234, v235
v_cvt_pk_bf16_f32 v234, v236, v237
v_cvt_pk_bf16_f32 v235, v238, v239
buffer_store_dwordx4 v[232:235], v1, s[28:31], s57 offen offset:1024 sc1
v_and_b32 v18, 1, v3
v_add_u32 v19, v3, v18
v_lshl_add_u32 v19, v2, 3, v19
v_lshlrev_b32 v19, 1, v19
v_xor_b32 v18, 1, v18
v_mul_u32_u24 v18, s51, v18
v_add3_u32 v6, v19, v18, s52
v_add_u32 v7, 1024, v6
v_add_u32 v8, 2048, v6
v_add_u32 v9, 3072, v6
v_pk_mul_f32 v[208:209], v[208:209], v[24:25]
v_pk_mul_f32 v[210:211], v[210:211], v[24:25]
v_pk_mul_f32 v[212:213], v[212:213], v[24:25]
v_pk_mul_f32 v[214:215], v[214:215], v[24:25]
v_cvt_pk_bf16_f32 v208, v208, v209
v_cvt_pk_bf16_f32 v209, v210, v211
v_cvt_pk_bf16_f32 v210, v212, v213
v_cvt_pk_bf16_f32 v211, v214, v215
s_add_u32 s57, s57, 4096
buffer_store_dwordx4 v[208:211], v1, s[28:31], s57 offen offset:0 sc1
v_lshlrev_b32 v18, 4, v2
v_lshlrev_b32 v19, 5, v3
v_sub_u32 v18, v18, v19
s_add_u32 s50, s53, 480
v_add_u32 v10, s50, v18
v_pk_mul_f32 v[240:241], v[240:241], v[22:23]
v_pk_mul_f32 v[242:243], v[242:243], v[22:23]
v_pk_mul_f32 v[244:245], v[244:245], v[22:23]
v_pk_mul_f32 v[246:247], v[246:247], v[22:23]
v_cvt_pk_bf16_f32 v240, v240, v241
v_cvt_pk_bf16_f32 v241, v242, v243
v_cvt_pk_bf16_f32 v242, v244, v245
v_cvt_pk_bf16_f32 v243, v246, v247
buffer_store_dwordx4 v[240:243], v1, s[28:31], s57 offen offset:1024 sc1
v_pk_mul_f32 v[216:217], v[216:217], v[24:25]
v_pk_mul_f32 v[218:219], v[218:219], v[24:25]
v_pk_mul_f32 v[220:221], v[220:221], v[24:25]
v_pk_mul_f32 v[222:223], v[222:223], v[24:25]
v_cvt_pk_bf16_f32 v216, v216, v217
v_cvt_pk_bf16_f32 v217, v218, v219
v_cvt_pk_bf16_f32 v218, v220, v221
v_cvt_pk_bf16_f32 v219, v222, v223
s_add_u32 s57, s57, 4096
buffer_store_dwordx4 v[216:219], v1, s[28:31], s57 offen offset:0 sc1
v_pk_mul_f32 v[248:249], v[248:249], v[22:23]
v_pk_mul_f32 v[250:251], v[250:251], v[22:23]
v_pk_mul_f32 v[252:253], v[252:253], v[22:23]
v_pk_mul_f32 v[254:255], v[254:255], v[22:23]
v_cvt_pk_bf16_f32 v248, v248, v249
v_cvt_pk_bf16_f32 v249, v250, v251
v_cvt_pk_bf16_f32 v250, v252, v253
v_cvt_pk_bf16_f32 v251, v254, v255
buffer_store_dwordx4 v[248:251], v1, s[28:31], s57 offen offset:1024 sc1
s_nop 0
ds_read2_b32 v[192:193], v6 offset0:0 offset1:1
ds_read2_b32 v[194:195], v6 offset0:2 offset1:3
ds_read_b128 v[224:227], v10 offset:3584
ds_read2_b32 v[196:197], v6 offset0:128 offset1:129
ds_read2_b32 v[198:199], v6 offset0:130 offset1:131
ds_read_b128 v[228:231], v10 offset:3072
ds_read2_b32 v[200:201], v7 offset0:0 offset1:1
ds_read2_b32 v[202:203], v7 offset0:2 offset1:3
ds_read_b128 v[232:235], v10 offset:2560
ds_read2_b32 v[204:205], v7 offset0:128 offset1:129
ds_read2_b32 v[206:207], v7 offset0:130 offset1:131
ds_read_b128 v[236:239], v10 offset:2048
ds_read2_b32 v[208:209], v8 offset0:0 offset1:1
ds_read2_b32 v[210:211], v8 offset0:2 offset1:3
ds_read_b128 v[240:243], v10 offset:1536
ds_read2_b32 v[212:213], v8 offset0:128 offset1:129
ds_read2_b32 v[214:215], v8 offset0:130 offset1:131
ds_read_b128 v[244:247], v10 offset:1024
ds_read2_b32 v[216:217], v9 offset0:0 offset1:1
ds_read2_b32 v[218:219], v9 offset0:2 offset1:3
ds_read_b128 v[248:251], v10 offset:512
ds_read2_b32 v[220:221], v9 offset0:128 offset1:129
ds_read2_b32 v[222:223], v9 offset0:130 offset1:131
ds_read_b128 v[252:255], v10 offset:0
s_waitcnt lgkmcnt(0)
v_mfma_f32_16x16x32_bf16 v[96:99], v[192:195], v[224:227], 0
ds_read2_b32 v[32:33], v6 offset0:16 offset1:17
s_add_u32 s58, s84, 73728
v_mfma_f32_16x16x32_bf16 v[100:103], v[192:195], v[228:231], 0
ds_read2_b32 v[34:35], v6 offset0:18 offset1:19
v_mfma_f32_16x16x32_bf16 v[100:103], v[196:199], v[224:227], v[100:103]
buffer_load_dwordx4 v[168:171], v1, s[28:31], s58 offen offset:0 sc1
v_mfma_f32_16x16x32_bf16 v[104:107], v[200:203], v[224:227], 0
ds_read_b128 v[64:67], v10 offset:3648
v_mfma_f32_16x16x32_bf16 v[104:107], v[196:199], v[228:231], v[104:107]
ds_read2_b32 v[36:37], v6 offset0:144 offset1:145
v_mfma_f32_16x16x32_bf16 v[104:107], v[192:195], v[232:235], v[104:107]
v_mfma_f32_16x16x32_bf16 v[108:111], v[192:195], v[236:239], 0
ds_read2_b32 v[38:39], v6 offset0:146 offset1:147
v_mfma_f32_16x16x32_bf16 v[108:111], v[196:199], v[232:235], v[108:111]
buffer_load_dwordx4 v[172:175], v1, s[28:31], s58 offen offset:1024 sc1
v_mfma_f32_16x16x32_bf16 v[108:111], v[200:203], v[228:231], v[108:111]
ds_read_b128 v[68:71], v10 offset:3136
v_mfma_f32_16x16x32_bf16 v[108:111], v[204:207], v[224:227], v[108:111]
ds_read2_b32 v[40:41], v7 offset0:16 offset1:17
v_mfma_f32_16x16x32_bf16 v[112:115], v[208:211], v[224:227], 0
ds_read2_b32 v[42:43], v7 offset0:18 offset1:19
v_lshl_add_u32 v12, v2, 3, v19
v_mfma_f32_16x16x32_bf16 v[112:115], v[204:207], v[228:231], v[112:115]
buffer_load_dwordx4 v[176:179], v1, s[28:31], s58 offen offset:2048 sc1
v_mfma_f32_16x16x32_bf16 v[112:115], v[200:203], v[232:235], v[112:115]
ds_read_b128 v[72:75], v10 offset:2624
s_add_u32 s53, s53, 504
v_mfma_f32_16x16x32_bf16 v[112:115], v[196:199], v[236:239], v[112:115]
ds_read2_b32 v[44:45], v7 offset0:144 offset1:145
v_sub_u32 v11, s53, v12
v_mfma_f32_16x16x32_bf16 v[112:115], v[192:195], v[240:243], v[112:115]
v_and_b32 v20, 1, v2
v_mul_u32_u24 v20, 504, v20
v_mfma_f32_16x16x32_bf16 v[116:119], v[192:195], v[244:247], 0
buffer_load_dwordx4 v[180:183], v1, s[28:31], s58 offen offset:3072 sc1
v_mfma_f32_16x16x32_bf16 v[116:119], v[196:199], v[240:243], v[116:119]
ds_read2_b32 v[46:47], v7 offset0:146 offset1:147
v_add_u32 v20, v20, v12
v_mfma_f32_16x16x32_bf16 v[116:119], v[200:203], v[236:239], v[116:119]
ds_read_b128 v[76:79], v10 offset:2112
s_add_u32 s37, s98, 53477376
v_mfma_f32_16x16x32_bf16 v[116:119], v[204:207], v[232:235], v[116:119]
ds_read2_b32 v[48:49], v8 offset0:16 offset1:17
s_lshr_b32 s50, s89, 1
v_mfma_f32_16x16x32_bf16 v[116:119], v[208:211], v[228:231], v[116:119]
ds_read2_b32 v[50:51], v8 offset0:18 offset1:19
s_sub_u32 s51, 15, s50
v_mfma_f32_16x16x32_bf16 v[116:119], v[212:215], v[224:227], v[116:119]
buffer_load_dwordx4 v[184:187], v29, s[28:31], s58 offen offset:0 sc1
v_mfma_f32_16x16x32_bf16 v[120:123], v[216:219], v[224:227], 0
ds_read_b128 v[80:83], v10 offset:1600
s_min_u32 s50, s50, s51
v_mfma_f32_16x16x32_bf16 v[120:123], v[212:215], v[228:231], v[120:123]
s_lshl_b32 s50, s50, 14
s_add_u32 s58, s84, 258048
v_mfma_f32_16x16x32_bf16 v[120:123], v[208:211], v[232:235], v[120:123]
ds_read2_b32 v[52:53], v8 offset0:144 offset1:145
s_and_b32 s51, s4, 4
v_mfma_f32_16x16x32_bf16 v[120:123], v[204:207], v[236:239], v[120:123]
ds_read2_b32 v[54:55], v8 offset0:146 offset1:147
s_lshl_b32 s51, s51, 11
v_mfma_f32_16x16x32_bf16 v[120:123], v[200:203], v[240:243], v[120:123]
buffer_load_dwordx4 a[0:3], v1, s[28:31], s58 offen offset:0 sc1
v_mfma_f32_16x16x32_bf16 v[120:123], v[196:199], v[244:247], v[120:123]
s_add_u32 s50, s50, s51
s_add_u32 s41, s50, 69337088
v_mfma_f32_16x16x32_bf16 v[120:123], v[192:195], v[248:251], v[120:123]
ds_read_b128 v[84:87], v10 offset:1088
s_add_u32 s42, s36, 131072
v_mfma_f32_16x16x32_bf16 v[124:127], v[192:195], v[252:255], 0
ds_read2_b32 v[56:57], v9 offset0:16 offset1:17
s_xor_b32 s43, s42, 2048
v_mfma_f32_16x16x32_bf16 v[124:127], v[196:199], v[248:251], v[124:127]
buffer_load_dwordx4 a[4:7], v1, s[28:31], s58 offen offset:1024 sc1
v_mfma_f32_16x16x32_bf16 v[124:127], v[200:203], v[244:247], v[124:127]
ds_read2_b32 v[58:59], v9 offset0:18 offset1:19
v_lshrrev_b32 v13, 2, v0
v_mfma_f32_16x16x32_bf16 v[124:127], v[204:207], v[240:243], v[124:127]
ds_read_b128 v[88:91], v10 offset:576
v_and_b32 v14, 0, v0
v_mfma_f32_16x16x32_bf16 v[124:127], v[208:211], v[236:239], v[124:127]
ds_read2_b32 v[60:61], v9 offset0:144 offset1:145
v_lshlrev_b32 v14, 7, v14
v_mfma_f32_16x16x32_bf16 v[124:127], v[212:215], v[232:235], v[124:127]
s_waitcnt lgkmcnt(7)
v_lshl_add_u32 v13, v13, 9, v14
v_mfma_f32_16x16x32_bf16 v[124:127], v[216:219], v[228:231], v[124:127]
buffer_load_dwordx4 a[8:11], v1, s[28:31], s58 offen offset:2048 sc1
v_mfma_f32_16x16x32_bf16 v[124:127], v[220:223], v[224:227], v[124:127]
ds_read2_b32 v[62:63], v9 offset0:146 offset1:147
v_mfma_f32_16x16x32_bf16 v[96:99], v[32:35], v[64:67], v[96:99]
ds_read_b128 v[92:95], v10 offset:64
v_mfma_f32_16x16x32_bf16 v[100:103], v[32:35], v[68:71], v[100:103]
buffer_load_dwordx4 a[12:15], v1, s[28:31], s58 offen offset:3072 sc1
v_mfma_f32_16x16x32_bf16 v[100:103], v[36:39], v[64:67], v[100:103]
ds_read2_b32 v[192:193], v6 offset0:32 offset1:33
v_mfma_f32_16x16x32_bf16 v[104:107], v[40:43], v[64:67], v[104:107]
ds_read2_b32 v[194:195], v6 offset0:34 offset1:35
v_mfma_f32_16x16x32_bf16 v[104:107], v[36:39], v[68:71], v[104:107]
ds_read_b128 v[224:227], v10 offset:3712
s_waitcnt lgkmcnt(3)
v_mfma_f32_16x16x32_bf16 v[104:107], v[32:35], v[72:75], v[104:107]
buffer_load_dwordx4 a[16:19], v29, s[28:31], s58 offen offset:0 sc1
v_mfma_f32_16x16x32_bf16 v[108:111], v[32:35], v[76:79], v[108:111]
ds_read2_b32 v[196:197], v6 offset0:160 offset1:161
v_accvgpr_read_b32 v16, a148
v_mfma_f32_16x16x32_bf16 v[108:111], v[36:39], v[72:75], v[108:111]
s_add_u32 s58, s84, 294912
v_accvgpr_read_b32 v17, a112
v_mfma_f32_16x16x32_bf16 v[108:111], v[40:43], v[68:71], v[108:111]
ds_read2_b32 v[198:199], v6 offset0:162 offset1:163
v_dot2_f32_bf16 v30, v16, v17, 0
v_mfma_f32_16x16x32_bf16 v[108:111], v[44:47], v[64:67], v[108:111]
buffer_load_dwordx4 a[20:23], v1, s[28:31], s58 offen offset:0 sc1
v_mfma_f32_16x16x32_bf16 v[112:115], v[48:51], v[64:67], v[112:115]
ds_read_b128 v[228:231], v10 offset:3200
s_waitcnt vmcnt(11)
v_mfma_f32_16x16x32_bf16 v[112:115], v[44:47], v[68:71], v[112:115]
s_barrier
ds_read2_b32 v[200:201], v7 offset0:32 offset1:33
v_mfma_f32_16x16x32_bf16 v[112:115], v[40:43], v[72:75], v[112:115]
buffer_store_dword v21, v26, s[28:31], s40 offen sc1
v_mfma_f32_16x16x32_bf16 v[112:115], v[36:39], v[76:79], v[112:115]
ds_read2_b32 v[202:203], v7 offset0:34 offset1:35
v_accvgpr_read_b32 v16, a149
v_mfma_f32_16x16x32_bf16 v[112:115], v[32:35], v[80:83], v[112:115]
ds_read_b128 v[232:235], v10 offset:2688
v_accvgpr_read_b32 v17, a113
v_mfma_f32_16x16x32_bf16 v[116:119], v[32:35], v[84:87], v[116:119]
buffer_load_dwordx4 a[24:27], v1, s[28:31], s58 offen offset:1024 sc1
v_mfma_f32_16x16x32_bf16 v[116:119], v[36:39], v[80:83], v[116:119]
ds_read2_b32 v[204:205], v7 offset0:160 offset1:161
v_dot2_f32_bf16 v30, v16, v17, v30
v_mfma_f32_16x16x32_bf16 v[116:119], v[40:43], v[76:79], v[116:119]
ds_read2_b32 v[206:207], v7 offset0:162 offset1:163
v_accvgpr_read_b32 v16, a150
v_mfma_f32_16x16x32_bf16 v[116:119], v[44:47], v[72:75], v[116:119]
ds_read_b128 v[236:239], v10 offset:2176
v_accvgpr_read_b32 v17, a114
v_mfma_f32_16x16x32_bf16 v[116:119], v[48:51], v[68:71], v[116:119]
buffer_load_dwordx4 a[28:31], v1, s[28:31], s58 offen offset:2048 sc1
v_mfma_f32_16x16x32_bf16 v[116:119], v[52:55], v[64:67], v[116:119]
ds_read2_b32 v[208:209], v8 offset0:32 offset1:33
v_dot2_f32_bf16 v30, v16, v17, v30
v_mfma_f32_16x16x32_bf16 v[120:123], v[56:59], v[64:67], v[120:123]
ds_read2_b32 v[210:211], v8 offset0:34 offset1:35
v_accvgpr_read_b32 v16, a151
v_mfma_f32_16x16x32_bf16 v[120:123], v[52:55], v[68:71], v[120:123]
ds_read_b128 v[240:243], v10 offset:1664
v_accvgpr_read_b32 v17, a115
v_mfma_f32_16x16x32_bf16 v[120:123], v[48:51], v[72:75], v[120:123]
buffer_load_dwordx4 a[32:35], v1, s[28:31], s58 offen offset:3072 sc1
v_mfma_f32_16x16x32_bf16 v[120:123], v[44:47], v[76:79], v[120:123]
ds_read2_b32 v[212:213], v8 offset0:160 offset1:161
v_dot2_f32_bf16 v30, v16, v17, v30
v_mfma_f32_16x16x32_bf16 v[120:123], v[40:43], v[80:83], v[120:123]
ds_read2_b32 v[214:215], v8 offset0:162 offset1:163
v_accvgpr_read_b32 v16, a152
v_mfma_f32_16x16x32_bf16 v[120:123], v[36:39], v[84:87], v[120:123]
ds_read_b128 v[244:247], v10 offset:1152
v_accvgpr_read_b32 v17, a116
v_mfma_f32_16x16x32_bf16 v[120:123], v[32:35], v[88:91], v[120:123]
buffer_load_dwordx4 a[36:39], v29, s[28:31], s58 offen offset:0 sc1
v_mfma_f32_16x16x32_bf16 v[124:127], v[32:35], v[92:95], v[124:127]
ds_read2_b32 v[216:217], v9 offset0:32 offset1:33
v_dot2_f32_bf16 v30, v16, v17, v30
v_mfma_f32_16x16x32_bf16 v[124:127], v[36:39], v[88:91], v[124:127]
s_add_u32 s58, s84, 331776
v_accvgpr_read_b32 v16, a153
v_mfma_f32_16x16x32_bf16 v[124:127], v[40:43], v[84:87], v[124:127]
ds_read2_b32 v[218:219], v9 offset0:34 offset1:35
v_accvgpr_read_b32 v17, a117
v_mfma_f32_16x16x32_bf16 v[124:127], v[44:47], v[80:83], v[124:127]
buffer_load_dwordx4 a[40:43], v1, s[28:31], s58 offen offset:0 sc1
v_mfma_f32_16x16x32_bf16 v[124:127], v[48:51], v[76:79], v[124:127]
ds_read_b128 v[248:251], v10 offset:640
v_dot2_f32_bf16 v30, v16, v17, v30
v_mfma_f32_16x16x32_bf16 v[124:127], v[52:55], v[72:75], v[124:127]
ds_read2_b32 v[220:221], v9 offset0:160 offset1:161
s_waitcnt lgkmcnt(7)
v_mfma_f32_16x16x32_bf16 v[124:127], v[56:59], v[68:71], v[124:127]
ds_read2_b32 v[222:223], v9 offset0:162 offset1:163
v_accvgpr_read_b32 v16, a154
v_mfma_f32_16x16x32_bf16 v[124:127], v[60:63], v[64:67], v[124:127]
buffer_load_dwordx4 a[44:47], v1, s[28:31], s58 offen offset:1024 sc1
v_mfma_f32_16x16x32_bf16 v[96:99], v[192:195], v[224:227], v[96:99]
ds_read_b128 v[252:255], v10 offset:128
v_accvgpr_read_b32 v17, a118
v_mfma_f32_16x16x32_bf16 v[100:103], v[192:195], v[228:231], v[100:103]
v_dot2_f32_bf16 v30, v16, v17, v30
v_accvgpr_read_b32 v16, a155
v_mfma_f32_16x16x32_bf16 v[100:103], v[196:199], v[224:227], v[100:103]
ds_read2_b32 v[32:33], v6 offset0:48 offset1:49
v_accvgpr_read_b32 v17, a119
v_mfma_f32_16x16x32_bf16 v[104:107], v[200:203], v[224:227], v[104:107]
buffer_load_dwordx4 a[48:51], v1, s[28:31], s58 offen offset:2048 sc1
v_mfma_f32_16x16x32_bf16 v[104:107], v[196:199], v[228:231], v[104:107]
ds_read2_b32 v[34:35], v6 offset0:50 offset1:51
v_dot2_f32_bf16 v30, v16, v17, v30
v_mfma_f32_16x16x32_bf16 v[104:107], v[192:195], v[232:235], v[104:107]
ds_read_b128 v[64:67], v10 offset:3776
s_waitcnt lgkmcnt(3)
v_mfma_f32_16x16x32_bf16 v[108:111], v[192:195], v[236:239], v[108:111]
ds_read2_b32 v[36:37], v6 offset0:176 offset1:177
v_accvgpr_read_b32 v16, a156
v_mfma_f32_16x16x32_bf16 v[108:111], v[196:199], v[232:235], v[108:111]
buffer_load_dwordx4 a[52:55], v1, s[28:31], s58 offen offset:3072 sc1
v_mfma_f32_16x16x32_bf16 v[108:111], v[200:203], v[228:231], v[108:111]
ds_read2_b32 v[38:39], v6 offset0:178 offset1:179
v_accvgpr_read_b32 v17, a120
v_mfma_f32_16x16x32_bf16 v[108:111], v[204:207], v[224:227], v[108:111]
ds_read_b128 v[68:71], v10 offset:3264
v_dot2_f32_bf16 v30, v16, v17, v30
v_mfma_f32_16x16x32_bf16 v[112:115], v[208:211], v[224:227], v[112:115]
buffer_load_dwordx4 a[56:59], v29, s[28:31], s58 offen offset:0 sc1
v_mfma_f32_16x16x32_bf16 v[112:115], v[204:207], v[228:231], v[112:115]
ds_read2_b32 v[40:41], v7 offset0:48 offset1:49
v_accvgpr_read_b32 v16, a157
v_mfma_f32_16x16x32_bf16 v[112:115], v[200:203], v[232:235], v[112:115]
ds_read2_b32 v[42:43], v7 offset0:50 offset1:51
v_accvgpr_read_b32 v17, a121
v_mfma_f32_16x16x32_bf16 v[112:115], v[196:199], v[236:239], v[112:115]
ds_read_b128 v[72:75], v10 offset:2752
s_add_u32 s58, s84, 368640
v_mfma_f32_16x16x32_bf16 v[112:115], v[192:195], v[240:243], v[112:115]
ds_read2_b32 v[44:45], v7 offset0:176 offset1:177
v_dot2_f32_bf16 v30, v16, v17, v30
v_mfma_f32_16x16x32_bf16 v[116:119], v[192:195], v[244:247], v[116:119]
buffer_load_dwordx4 a[124:127], v1, s[28:31], s58 offen offset:0 sc1
v_mfma_f32_16x16x32_bf16 v[116:119], v[196:199], v[240:243], v[116:119]
ds_read2_b32 v[46:47], v7 offset0:178 offset1:179
v_accvgpr_read_b32 v16, a158
v_mfma_f32_16x16x32_bf16 v[116:119], v[200:203], v[236:239], v[116:119]
ds_read_b128 v[76:79], v10 offset:2240
v_accvgpr_read_b32 v17, a122
v_mfma_f32_16x16x32_bf16 v[116:119], v[204:207], v[232:235], v[116:119]
ds_read2_b32 v[48:49], v8 offset0:48 offset1:49
v_dot2_f32_bf16 v30, v16, v17, v30
v_mfma_f32_16x16x32_bf16 v[116:119], v[208:211], v[228:231], v[116:119]
buffer_load_dwordx4 a[128:131], v1, s[28:31], s58 offen offset:1024 sc1
v_mfma_f32_16x16x32_bf16 v[116:119], v[212:215], v[224:227], v[116:119]
ds_read2_b32 v[50:51], v8 offset0:50 offset1:51
v_accvgpr_read_b32 v16, a159
v_mfma_f32_16x16x32_bf16 v[120:123], v[216:219], v[224:227], v[120:123]
ds_read_b128 v[80:83], v10 offset:1728
v_accvgpr_read_b32 v17, a123
v_mfma_f32_16x16x32_bf16 v[120:123], v[212:215], v[228:231], v[120:123]
ds_read2_b32 v[52:53], v8 offset0:176 offset1:177
v_dot2_f32_bf16 v30, v16, v17, v30
v_mfma_f32_16x16x32_bf16 v[120:123], v[208:211], v[232:235], v[120:123]
buffer_load_dwordx4 a[132:135], v1, s[28:31], s58 offen offset:2048 sc1
v_mfma_f32_16x16x32_bf16 v[120:123], v[204:207], v[236:239], v[120:123]
ds_read2_b32 v[54:55], v8 offset0:178 offset1:179
s_lshl_b32 s50, s2, 5
v_mfma_f32_16x16x32_bf16 v[120:123], v[200:203], v[240:243], v[120:123]
ds_read_b128 v[84:87], v10 offset:1216
s_lshl_b32 s51, s3, 3
v_mfma_f32_16x16x32_bf16 v[120:123], v[196:199], v[244:247], v[120:123]
ds_read2_b32 v[56:57], v9 offset0:48 offset1:49
s_add_u32 s50, s50, s51
v_mfma_f32_16x16x32_bf16 v[120:123], v[192:195], v[248:251], v[120:123]
buffer_load_dwordx4 a[136:139], v1, s[28:31], s58 offen offset:3072 sc1
v_mfma_f32_16x16x32_bf16 v[124:127], v[192:195], v[252:255], v[124:127]
ds_read2_b32 v[58:59], v9 offset0:50 offset1:51
v_mov_b32 v16, v30
v_mfma_f32_16x16x32_bf16 v[124:127], v[196:199], v[248:251], v[124:127]
s_nop 1
v_mfma_f32_16x16x32_bf16 v[124:127], v[200:203], v[244:247], v[124:127]
ds_read_b128 v[88:91], v10 offset:704
v_add_f32_dpp v16, v16, v16 quad_perm:[1,0,3,2] row_mask:0xf bank_mask:0xf
v_mfma_f32_16x16x32_bf16 v[124:127], v[204:207], v[240:243], v[124:127]
buffer_load_dwordx4 a[140:143], v29, s[28:31], s58 offen offset:0 sc1
v_mfma_f32_16x16x32_bf16 v[124:127], v[208:211], v[236:239], v[124:127]
ds_read2_b32 v[60:61], v9 offset0:176 offset1:177
s_waitcnt lgkmcnt(7)
v_mfma_f32_16x16x32_bf16 v[124:127], v[212:215], v[232:235], v[124:127]
s_nop 1
v_mfma_f32_16x16x32_bf16 v[124:127], v[216:219], v[228:231], v[124:127]
ds_read2_b32 v[62:63], v9 offset0:178 offset1:179
s_add_u32 s58, s84, 405504
v_mfma_f32_16x16x32_bf16 v[124:127], v[220:223], v[224:227], v[124:127]
ds_read_b128 v[92:95], v10 offset:192
v_add_f32_dpp v16, v16, v16 quad_perm:[2,3,0,1] row_mask:0xf bank_mask:0xf
v_mfma_f32_16x16x32_bf16 v[96:99], v[32:35], v[64:67], v[96:99]
buffer_load_dwordx4 a[164:167], v1, s[28:31], s58 offen offset:0 sc1
v_mfma_f32_16x16x32_bf16 v[100:103], v[32:35], v[68:71], v[100:103]
s_nop 1
v_mfma_f32_16x16x32_bf16 v[100:103], v[36:39], v[64:67], v[100:103]
ds_read2_b32 v[192:193], v6 offset0:64 offset1:65
v_add_f32_dpp v16, v16, v16 row_half_mirror row_mask:0xf bank_mask:0xf
v_mfma_f32_16x16x32_bf16 v[104:107], v[40:43], v[64:67], v[104:107]
s_nop 1
v_mfma_f32_16x16x32_bf16 v[104:107], v[36:39], v[68:71], v[104:107]
buffer_load_dwordx4 a[168:171], v1, s[28:31], s58 offen offset:1024 sc1
v_mfma_f32_16x16x32_bf16 v[104:107], v[32:35], v[72:75], v[104:107]
ds_read2_b32 v[194:195], v6 offset0:66 offset1:67
v_add_f32_dpp v16, v16, v16 row_mirror row_mask:0xf bank_mask:0xf
v_mfma_f32_16x16x32_bf16 v[108:111], v[32:35], v[76:79], v[108:111]
ds_read_b128 v[224:227], v10 offset:3840
s_waitcnt lgkmcnt(3)
v_mfma_f32_16x16x32_bf16 v[108:111], v[36:39], v[72:75], v[108:111]
ds_read2_b32 v[196:197], v6 offset0:192 offset1:193
v_mov_b32 v17, v16
v_mfma_f32_16x16x32_bf16 v[108:111], v[40:43], v[68:71], v[108:111]
buffer_load_dwordx4 a[172:175], v1, s[28:31], s58 offen offset:2048 sc1
v_mfma_f32_16x16x32_bf16 v[108:111], v[44:47], v[64:67], v[108:111]
ds_read2_b32 v[198:199], v6 offset0:194 offset1:195
s_add_u32 s50, s50, 61865984
v_mfma_f32_16x16x32_bf16 v[112:115], v[48:51], v[64:67], v[112:115]
ds_read_b128 v[228:231], v10 offset:3328
s_nop 0
v_mfma_f32_16x16x32_bf16 v[112:115], v[44:47], v[68:71], v[112:115]
ds_read2_b32 v[200:201], v7 offset0:64 offset1:65
v_permlane16_swap_b32 v16, v17
v_mfma_f32_16x16x32_bf16 v[112:115], v[40:43], v[72:75], v[112:115]
ds_read2_b32 v[202:203], v7 offset0:66 offset1:67
v_add_f32 v16, v16, v17
v_mfma_f32_16x16x32_bf16 v[112:115], v[36:39], v[76:79], v[112:115]
buffer_load_dwordx4 a[176:179], v1, s[28:31], s58 offen offset:3072 sc1
v_mfma_f32_16x16x32_bf16 v[112:115], v[32:35], v[80:83], v[112:115]
ds_read_b128 v[232:235], v10 offset:2816
v_mul_f32 v16, 0xbfb8aa3b, v16
v_mfma_f32_16x16x32_bf16 v[116:119], v[32:35], v[84:87], v[116:119]
ds_read2_b32 v[204:205], v7 offset0:192 offset1:193
v_mfma_f32_16x16x32_bf16 v[116:119], v[36:39], v[80:83], v[116:119]
v_exp_f32 v16, v16
v_mfma_f32_16x16x32_bf16 v[116:119], v[40:43], v[76:79], v[116:119]
buffer_load_dwordx4 a[180:183], v29, s[28:31], s58 offen offset:0 sc1
v_mfma_f32_16x16x32_bf16 v[116:119], v[44:47], v[72:75], v[116:119]
ds_read2_b32 v[206:207], v7 offset0:194 offset1:195
v_lshrrev_b32 v17, 5, v0
v_mfma_f32_16x16x32_bf16 v[116:119], v[48:51], v[68:71], v[116:119]
ds_read_b128 v[236:239], v10 offset:2304
v_add_f32 v16, 1.0, v16
v_mfma_f32_16x16x32_bf16 v[116:119], v[52:55], v[64:67], v[116:119]
ds_read2_b32 v[208:209], v8 offset0:64 offset1:65
s_add_u32 s58, s84, 442368
v_mfma_f32_16x16x32_bf16 v[120:123], v[56:59], v[64:67], v[120:123]
v_rcp_f32 v16, v16
v_mfma_f32_16x16x32_bf16 v[120:123], v[52:55], v[68:71], v[120:123]
buffer_load_dwordx4 a[184:187], v1, s[28:31], s58 offen offset:0 sc1
v_mfma_f32_16x16x32_bf16 v[120:123], v[48:51], v[72:75], v[120:123]
ds_read2_b32 v[210:211], v8 offset0:66 offset1:67
v_lshlrev_b32 v17, 2, v17
v_mfma_f32_16x16x32_bf16 v[120:123], v[44:47], v[76:79], v[120:123]
ds_read_b128 v[240:243], v10 offset:1792
v_mfma_f32_16x16x32_bf16 v[120:123], v[40:43], v[80:83], v[120:123]
ds_read2_b32 v[212:213], v8 offset0:192 offset1:193
v_mfma_f32_16x16x32_bf16 v[120:123], v[36:39], v[84:87], v[120:123]
buffer_load_dwordx4 a[188:191], v1, s[28:31], s58 offen offset:1024 sc1
v_mfma_f32_16x16x32_bf16 v[120:123], v[32:35], v[88:91], v[120:123]
ds_read2_b32 v[214:215], v8 offset0:194 offset1:195
v_mfma_f32_16x16x32_bf16 v[124:127], v[32:35], v[92:95], v[124:127]
ds_read_b128 v[244:247], v10 offset:1280
v_mfma_f32_16x16x32_bf16 v[124:127], v[36:39], v[88:91], v[124:127]
ds_read2_b32 v[216:217], v9 offset0:64 offset1:65
v_mfma_f32_16x16x32_bf16 v[124:127], v[40:43], v[84:87], v[124:127]
buffer_load_dwordx4 a[192:195], v1, s[28:31], s58 offen offset:2048 sc1
v_mfma_f32_16x16x32_bf16 v[124:127], v[44:47], v[80:83], v[124:127]
ds_read2_b32 v[218:219], v9 offset0:66 offset1:67
s_waitcnt lgkmcnt(5)
v_mfma_f32_16x16x32_bf16 v[124:127], v[48:51], v[76:79], v[124:127]
ds_read_b128 v[248:251], v10 offset:768
v_mfma_f32_16x16x32_bf16 v[124:127], v[52:55], v[72:75], v[124:127]
ds_read2_b32 v[220:221], v9 offset0:192 offset1:193
v_mfma_f32_16x16x32_bf16 v[124:127], v[56:59], v[68:71], v[124:127]
buffer_load_dwordx4 a[196:199], v1, s[28:31], s58 offen offset:3072 sc1
v_mfma_f32_16x16x32_bf16 v[124:127], v[60:63], v[64:67], v[124:127]
ds_read2_b32 v[222:223], v9 offset0:194 offset1:195
v_mfma_f32_16x16x32_bf16 v[96:99], v[192:195], v[224:227], v[96:99]
ds_read_b128 v[252:255], v10 offset:256
v_mfma_f32_16x16x32_bf16 v[100:103], v[192:195], v[228:231], v[100:103]
buffer_load_dwordx4 a[200:203], v29, s[28:31], s58 offen offset:0 sc1
v_mfma_f32_16x16x32_bf16 v[100:103], v[196:199], v[224:227], v[100:103]
ds_read2_b32 v[32:33], v6 offset0:80 offset1:81
s_add_u32 s58, s84, 479232
v_mfma_f32_16x16x32_bf16 v[104:107], v[200:203], v[224:227], v[104:107]
ds_read2_b32 v[34:35], v6 offset0:82 offset1:83
v_mfma_f32_16x16x32_bf16 v[104:107], v[196:199], v[228:231], v[104:107]
ds_read_b128 v[64:67], v10 offset:3904
s_waitcnt lgkmcnt(3)
v_mfma_f32_16x16x32_bf16 v[104:107], v[192:195], v[232:235], v[104:107]
buffer_load_dwordx4 a[204:207], v1, s[28:31], s58 offen offset:0 sc1
v_mfma_f32_16x16x32_bf16 v[108:111], v[192:195], v[236:239], v[108:111]
ds_read2_b32 v[36:37], v6 offset0:208 offset1:209
v_mfma_f32_16x16x32_bf16 v[108:111], v[196:199], v[232:235], v[108:111]
ds_read2_b32 v[38:39], v6 offset0:210 offset1:211
v_mfma_f32_16x16x32_bf16 v[108:111], v[200:203], v[228:231], v[108:111]
buffer_store_dword v16, v17, s[28:31], s50 offen sc1
v_mfma_f32_16x16x32_bf16 v[108:111], v[204:207], v[224:227], v[108:111]
buffer_load_dwordx4 a[208:211], v1, s[28:31], s58 offen offset:1024 sc1
v_mfma_f32_16x16x32_bf16 v[112:115], v[208:211], v[224:227], v[112:115]
ds_read_b128 v[68:71], v10 offset:3392
v_mfma_f32_16x16x32_bf16 v[112:115], v[204:207], v[228:231], v[112:115]
ds_read2_b32 v[40:41], v7 offset0:80 offset1:81
v_mfma_f32_16x16x32_bf16 v[112:115], v[200:203], v[232:235], v[112:115]
ds_read2_b32 v[42:43], v7 offset0:82 offset1:83
v_mfma_f32_16x16x32_bf16 v[112:115], v[196:199], v[236:239], v[112:115]
buffer_load_dwordx4 a[212:215], v1, s[28:31], s58 offen offset:2048 sc1
v_mfma_f32_16x16x32_bf16 v[112:115], v[192:195], v[240:243], v[112:115]
ds_read_b128 v[72:75], v10 offset:2880
v_mfma_f32_16x16x32_bf16 v[116:119], v[192:195], v[244:247], v[116:119]
ds_read2_b32 v[44:45], v7 offset0:208 offset1:209
v_mfma_f32_16x16x32_bf16 v[116:119], v[196:199], v[240:243], v[116:119]
ds_read2_b32 v[46:47], v7 offset0:210 offset1:211
s_add_u32 s52, s3, 0
v_mfma_f32_16x16x32_bf16 v[116:119], v[200:203], v[236:239], v[116:119]
buffer_load_dwordx4 a[216:219], v1, s[28:31], s58 offen offset:3072 sc1
v_mfma_f32_16x16x32_bf16 v[116:119], v[204:207], v[232:235], v[116:119]
ds_read_b128 v[76:79], v10 offset:2368
s_and_b32 s52, s52, 3
v_mfma_f32_16x16x32_bf16 v[116:119], v[208:211], v[228:231], v[116:119]
s_lshl_b32 s52, s52, 10
v_add_u32 v22, s52, v1
v_mfma_f32_16x16x32_bf16 v[116:119], v[212:215], v[224:227], v[116:119]
s_add_u32 s52, s3, 1
s_and_b32 s52, s52, 3
v_mfma_f32_16x16x32_bf16 v[120:123], v[216:219], v[224:227], v[120:123]
s_lshl_b32 s52, s52, 10
v_add_u32 v23, s52, v1
v_mfma_f32_16x16x32_bf16 v[120:123], v[212:215], v[228:231], v[120:123]
s_add_u32 s52, s3, 2
s_and_b32 s52, s52, 3
v_mfma_f32_16x16x32_bf16 v[120:123], v[208:211], v[232:235], v[120:123]
buffer_load_dwordx4 a[220:223], v29, s[28:31], s58 offen offset:0 sc1
v_mfma_f32_16x16x32_bf16 v[120:123], v[204:207], v[236:239], v[120:123]
s_lshl_b32 s52, s52, 10
v_add_u32 v24, s52, v1
v_mfma_f32_16x16x32_bf16 v[120:123], v[200:203], v[240:243], v[120:123]
s_add_u32 s52, s3, 3
s_and_b32 s52, s52, 3
v_mfma_f32_16x16x32_bf16 v[120:123], v[196:199], v[244:247], v[120:123]
s_lshl_b32 s52, s52, 10
v_add_u32 v25, s52, v1
v_mfma_f32_16x16x32_bf16 v[120:123], v[192:195], v[248:251], v[120:123]
s_add_u32 s58, s84, 110592
buffer_load_dwordx4 a[244:247], v1, s[28:31], s58 offen offset:0 sc1
v_mfma_f32_16x16x32_bf16 v[124:127], v[192:195], v[252:255], v[124:127]
ds_read2_b32 v[48:49], v8 offset0:80 offset1:81
v_mfma_f32_16x16x32_bf16 v[124:127], v[196:199], v[248:251], v[124:127]
ds_read2_b32 v[50:51], v8 offset0:82 offset1:83
v_mfma_f32_16x16x32_bf16 v[124:127], v[200:203], v[244:247], v[124:127]
ds_read_b128 v[80:83], v10 offset:1856
v_mfma_f32_16x16x32_bf16 v[124:127], v[204:207], v[240:243], v[124:127]
buffer_load_dwordx4 a[248:251], v1, s[28:31], s58 offen offset:1024 sc1
v_mfma_f32_16x16x32_bf16 v[124:127], v[208:211], v[236:239], v[124:127]
ds_read2_b32 v[52:53], v8 offset0:208 offset1:209
v_mfma_f32_16x16x32_bf16 v[124:127], v[212:215], v[232:235], v[124:127]
ds_read2_b32 v[54:55], v8 offset0:210 offset1:211
v_mfma_f32_16x16x32_bf16 v[124:127], v[216:219], v[228:231], v[124:127]
ds_read_b128 v[84:87], v10 offset:1344
s_waitcnt lgkmcnt(3)
v_mfma_f32_16x16x32_bf16 v[124:127], v[220:223], v[224:227], v[124:127]
ds_read2_b32 v[56:57], v9 offset0:80 offset1:81
v_mfma_f32_16x16x32_bf16 v[96:99], v[32:35], v[64:67], v[96:99]
ds_read2_b32 v[58:59], v9 offset0:82 offset1:83
buffer_load_dwordx4 a[252:255], v1, s[28:31], s58 offen offset:2048 sc1
v_mfma_f32_16x16x32_bf16 v[100:103], v[32:35], v[68:71], v[100:103]
ds_read_b128 v[88:91], v10 offset:832
v_mfma_f32_16x16x32_bf16 v[100:103], v[36:39], v[64:67], v[100:103]
ds_read2_b32 v[60:61], v9 offset0:208 offset1:209
v_mfma_f32_16x16x32_bf16 v[104:107], v[40:43], v[64:67], v[104:107]
ds_read2_b32 v[62:63], v9 offset0:210 offset1:211
v_mfma_f32_16x16x32_bf16 v[104:107], v[36:39], v[68:71], v[104:107]
ds_read_b128 v[92:95], v10 offset:320
buffer_load_dwordx4 a[60:63], v1, s[28:31], s58 offen offset:3072 sc1
v_mfma_f32_16x16x32_bf16 v[104:107], v[32:35], v[72:75], v[104:107]
ds_read2_b32 v[192:193], v6 offset0:96 offset1:97
v_mfma_f32_16x16x32_bf16 v[108:111], v[32:35], v[76:79], v[108:111]
ds_read2_b32 v[194:195], v6 offset0:98 offset1:99
v_mfma_f32_16x16x32_bf16 v[108:111], v[36:39], v[72:75], v[108:111]
ds_read_b128 v[224:227], v10 offset:3968
v_mfma_f32_16x16x32_bf16 v[108:111], v[40:43], v[68:71], v[108:111]
buffer_load_dwordx4 v[188:191], v29, s[28:31], s58 offen offset:0 sc1
v_mfma_f32_16x16x32_bf16 v[108:111], v[44:47], v[64:67], v[108:111]
ds_read2_b32 v[196:197], v6 offset0:224 offset1:225
s_waitcnt lgkmcnt(4)
v_mfma_f32_16x16x32_bf16 v[112:115], v[48:51], v[64:67], v[112:115]
ds_read2_b32 v[198:199], v6 offset0:226 offset1:227
s_add_u32 s58, s84, 516096
v_mfma_f32_16x16x32_bf16 v[112:115], v[44:47], v[68:71], v[112:115]
ds_read_b128 v[228:231], v10 offset:3456
v_mfma_f32_16x16x32_bf16 v[112:115], v[40:43], v[72:75], v[112:115]
buffer_load_dwordx4 a[104:107], v1, s[28:31], s58 offen offset:0 sc1
v_mfma_f32_16x16x32_bf16 v[112:115], v[36:39], v[76:79], v[112:115]
ds_read2_b32 v[200:201], v7 offset0:96 offset1:97
v_mfma_f32_16x16x32_bf16 v[112:115], v[32:35], v[80:83], v[112:115]
ds_read2_b32 v[202:203], v7 offset0:98 offset1:99
v_mfma_f32_16x16x32_bf16 v[116:119], v[32:35], v[84:87], v[116:119]
ds_read_b128 v[232:235], v10 offset:2944
v_mfma_f32_16x16x32_bf16 v[116:119], v[36:39], v[80:83], v[116:119]
buffer_load_dwordx4 a[108:111], v1, s[28:31], s58 offen offset:1024 sc1
v_mfma_f32_16x16x32_bf16 v[116:119], v[40:43], v[76:79], v[116:119]
ds_read2_b32 v[204:205], v7 offset0:224 offset1:225
v_mfma_f32_16x16x32_bf16 v[116:119], v[44:47], v[72:75], v[116:119]
ds_read2_b32 v[206:207], v7 offset0:226 offset1:227
v_mfma_f32_16x16x32_bf16 v[116:119], v[48:51], v[68:71], v[116:119]
ds_read_b128 v[236:239], v10 offset:2432
v_mfma_f32_16x16x32_bf16 v[116:119], v[52:55], v[64:67], v[116:119]
buffer_load_dwordx4 a[112:115], v1, s[28:31], s58 offen offset:2048 sc1
v_mfma_f32_16x16x32_bf16 v[120:123], v[56:59], v[64:67], v[120:123]
ds_read2_b32 v[208:209], v8 offset0:96 offset1:97
v_mfma_f32_16x16x32_bf16 v[120:123], v[52:55], v[68:71], v[120:123]
ds_read2_b32 v[210:211], v8 offset0:98 offset1:99
v_mfma_f32_16x16x32_bf16 v[120:123], v[48:51], v[72:75], v[120:123]
ds_read_b128 v[240:243], v10 offset:1920
v_mfma_f32_16x16x32_bf16 v[120:123], v[44:47], v[76:79], v[120:123]
buffer_load_dwordx4 a[116:119], v1, s[28:31], s58 offen offset:3072 sc1
v_mfma_f32_16x16x32_bf16 v[120:123], v[40:43], v[80:83], v[120:123]
ds_read2_b32 v[212:213], v8 offset0:224 offset1:225
v_mfma_f32_16x16x32_bf16 v[120:123], v[36:39], v[84:87], v[120:123]
ds_read2_b32 v[214:215], v8 offset0:226 offset1:227
v_mfma_f32_16x16x32_bf16 v[120:123], v[32:35], v[88:91], v[120:123]
ds_read_b128 v[244:247], v10 offset:1408
v_mfma_f32_16x16x32_bf16 v[124:127], v[32:35], v[92:95], v[124:127]
buffer_load_dwordx4 a[120:123], v29, s[28:31], s58 offen offset:0 sc1
v_mfma_f32_16x16x32_bf16 v[124:127], v[36:39], v[88:91], v[124:127]
ds_read2_b32 v[216:217], v9 offset0:96 offset1:97
s_add_u32 s58, s84, 552960
v_mfma_f32_16x16x32_bf16 v[124:127], v[40:43], v[84:87], v[124:127]
ds_read2_b32 v[218:219], v9 offset0:98 offset1:99
s_waitcnt lgkmcnt(5)
v_mfma_f32_16x16x32_bf16 v[124:127], v[44:47], v[80:83], v[124:127]
ds_read_b128 v[248:251], v10 offset:896
v_mfma_f32_16x16x32_bf16 v[124:127], v[48:51], v[76:79], v[124:127]
buffer_load_dwordx4 a[144:147], v1, s[28:31], s58 offen offset:0 sc1
v_mfma_f32_16x16x32_bf16 v[124:127], v[52:55], v[72:75], v[124:127]
ds_read2_b32 v[220:221], v9 offset0:224 offset1:225
v_mfma_f32_16x16x32_bf16 v[124:127], v[56:59], v[68:71], v[124:127]
ds_read2_b32 v[222:223], v9 offset0:226 offset1:227
v_mfma_f32_16x16x32_bf16 v[124:127], v[60:63], v[64:67], v[124:127]
ds_read_b128 v[252:255], v10 offset:384
v_mfma_f32_16x16x32_bf16 v[96:99], v[192:195], v[224:227], v[96:99]
buffer_load_dwordx4 a[148:151], v1, s[28:31], s58 offen offset:1024 sc1
v_mfma_f32_16x16x32_bf16 v[100:103], v[192:195], v[228:231], v[100:103]
ds_read2_b32 v[32:33], v6 offset0:112 offset1:113
v_mfma_f32_16x16x32_bf16 v[100:103], v[196:199], v[224:227], v[100:103]
buffer_load_dwordx4 a[152:155], v1, s[28:31], s58 offen offset:2048 sc1
v_mfma_f32_16x16x32_bf16 v[104:107], v[200:203], v[224:227], v[104:107]
ds_read2_b32 v[34:35], v6 offset0:114 offset1:115
v_mfma_f32_16x16x32_bf16 v[104:107], v[196:199], v[228:231], v[104:107]
ds_read_b128 v[64:67], v10 offset:4032
s_waitcnt lgkmcnt(3)
v_mfma_f32_16x16x32_bf16 v[104:107], v[192:195], v[232:235], v[104:107]
ds_read2_b32 v[36:37], v6 offset0:240 offset1:241
v_mfma_f32_16x16x32_bf16 v[108:111], v[192:195], v[236:239], v[108:111]
ds_read2_b32 v[38:39], v6 offset0:242 offset1:243
v_mfma_f32_16x16x32_bf16 v[108:111], v[196:199], v[232:235], v[108:111]
buffer_load_dwordx4 a[156:159], v1, s[28:31], s58 offen offset:3072 sc1
v_mfma_f32_16x16x32_bf16 v[108:111], v[200:203], v[228:231], v[108:111]
ds_read_b128 v[68:71], v10 offset:3520
v_mfma_f32_16x16x32_bf16 v[108:111], v[204:207], v[224:227], v[108:111]
ds_read2_b32 v[40:41], v7 offset0:112 offset1:113
v_mfma_f32_16x16x32_bf16 v[112:115], v[208:211], v[224:227], v[112:115]
ds_read2_b32 v[42:43], v7 offset0:114 offset1:115
v_mfma_f32_16x16x32_bf16 v[112:115], v[204:207], v[228:231], v[112:115]
buffer_load_dwordx4 a[160:163], v29, s[28:31], s58 offen offset:0 sc1
v_mfma_f32_16x16x32_bf16 v[112:115], v[200:203], v[232:235], v[112:115]
ds_read_b128 v[72:75], v10 offset:3008
v_mfma_f32_16x16x32_bf16 v[112:115], v[196:199], v[236:239], v[112:115]
ds_read2_b32 v[44:45], v7 offset0:240 offset1:241
v_mfma_f32_16x16x32_bf16 v[112:115], v[192:195], v[240:243], v[112:115]
ds_read2_b32 v[46:47], v7 offset0:242 offset1:243
v_mfma_f32_16x16x32_bf16 v[116:119], v[192:195], v[244:247], v[116:119]
ds_read_b128 v[76:79], v10 offset:2496
v_mfma_f32_16x16x32_bf16 v[116:119], v[196:199], v[240:243], v[116:119]
ds_read2_b32 v[48:49], v8 offset0:112 offset1:113
v_mfma_f32_16x16x32_bf16 v[116:119], v[200:203], v[236:239], v[116:119]
ds_read2_b32 v[50:51], v8 offset0:114 offset1:115
v_mfma_f32_16x16x32_bf16 v[116:119], v[204:207], v[232:235], v[116:119]
ds_read_b128 v[80:83], v10 offset:1984
v_mfma_f32_16x16x32_bf16 v[116:119], v[208:211], v[228:231], v[116:119]
ds_read2_b32 v[52:53], v8 offset0:240 offset1:241
v_mfma_f32_16x16x32_bf16 v[116:119], v[212:215], v[224:227], v[116:119]
buffer_load_dword v15, v13, s[28:31], s41 offen sc1
v_mfma_f32_16x16x32_bf16 v[120:123], v[216:219], v[224:227], v[120:123]
ds_read2_b32 v[54:55], v8 offset0:242 offset1:243
v_mfma_f32_16x16x32_bf16 v[120:123], v[212:215], v[228:231], v[120:123]
ds_read_b128 v[84:87], v10 offset:1472
v_mfma_f32_16x16x32_bf16 v[120:123], v[208:211], v[232:235], v[120:123]
ds_read2_b32 v[56:57], v9 offset0:112 offset1:113
v_mfma_f32_16x16x32_bf16 v[120:123], v[204:207], v[236:239], v[120:123]
ds_read2_b32 v[58:59], v9 offset0:114 offset1:115
v_mfma_f32_16x16x32_bf16 v[120:123], v[200:203], v[240:243], v[120:123]
ds_read_b128 v[88:91], v10 offset:960
v_mfma_f32_16x16x32_bf16 v[120:123], v[196:199], v[244:247], v[120:123]
ds_read2_b32 v[60:61], v9 offset0:240 offset1:241
v_mfma_f32_16x16x32_bf16 v[120:123], v[192:195], v[248:251], v[120:123]
ds_read2_b32 v[62:63], v9 offset0:242 offset1:243
v_mfma_f32_16x16x32_bf16 v[124:127], v[192:195], v[252:255], v[124:127]
ds_read_b128 v[92:95], v10 offset:448
v_mfma_f32_16x16x32_bf16 v[124:127], v[196:199], v[248:251], v[124:127]
v_mfma_f32_16x16x32_bf16 v[124:127], v[200:203], v[244:247], v[124:127]
v_mfma_f32_16x16x32_bf16 v[124:127], v[204:207], v[240:243], v[124:127]
v_mfma_f32_16x16x32_bf16 v[124:127], v[208:211], v[236:239], v[124:127]
v_mfma_f32_16x16x32_bf16 v[124:127], v[212:215], v[232:235], v[124:127]
v_mfma_f32_16x16x32_bf16 v[124:127], v[216:219], v[228:231], v[124:127]
s_waitcnt lgkmcnt(0)
v_mfma_f32_16x16x32_bf16 v[124:127], v[220:223], v[224:227], v[124:127]
v_mov_b64 v[6:7], v[22:23]
v_mov_b64 v[8:9], v[24:25]
s_waitcnt vmcnt(0)
v_cmp_eq_u32 vcc, 0, v15
s_cbranch_vccnz L_py_K
v_mfma_f32_16x16x32_bf16 v[124:127], v[32:35], v[92:95], v[124:127]
s_add_u32 s36, s86, 16384
v_mfma_f32_16x16x32_bf16 v[124:127], v[36:39], v[88:91], v[124:127]
buffer_load_dwordx4 v[192:195], v6, s[28:31], s36 offen sc1
v_mfma_f32_16x16x32_bf16 v[124:127], v[40:43], v[84:87], v[124:127]
buffer_load_dwordx4 v[196:199], v7, s[28:31], s36 offen sc1
v_mfma_f32_16x16x32_bf16 v[124:127], v[44:47], v[80:83], v[124:127]
v_mfma_f32_16x16x32_bf16 v[124:127], v[48:51], v[76:79], v[124:127]
buffer_load_dwordx4 v[200:203], v8, s[28:31], s36 offen sc1
v_mfma_f32_16x16x32_bf16 v[124:127], v[52:55], v[72:75], v[124:127]
v_mfma_f32_16x16x32_bf16 v[124:127], v[56:59], v[68:71], v[124:127]
buffer_load_dwordx4 v[204:207], v9, s[28:31], s36 offen sc1
v_mfma_f32_16x16x32_bf16 v[124:127], v[60:63], v[64:67], v[124:127]
ds_read_b64 v[60:61], v11 offset:0
s_add_u32 s36, s86, 20480
v_mfma_f32_16x16x32_bf16 v[120:123], v[56:59], v[64:67], v[120:123]
buffer_load_dwordx4 v[208:211], v6, s[28:31], s36 offen sc1
v_mfma_f32_16x16x32_bf16 v[120:123], v[52:55], v[68:71], v[120:123]
v_mfma_f32_16x16x32_bf16 v[120:123], v[48:51], v[72:75], v[120:123]
buffer_load_dwordx4 v[212:215], v7, s[28:31], s36 offen sc1
v_mfma_f32_16x16x32_bf16 v[120:123], v[44:47], v[76:79], v[120:123]
v_mfma_f32_16x16x32_bf16 v[120:123], v[40:43], v[80:83], v[120:123]
s_waitcnt lgkmcnt(0)
v_and_b32 v92, 0xffff0000, v61
v_lshlrev_b32 v93, 16, v61
v_and_b32 v94, 0xffff0000, v60
v_lshlrev_b32 v95, 16, v60
v_fma_f32 v92, v92, v27, v124
v_fma_f32 v93, v93, v27, v125
v_mfma_f32_16x16x32_bf16 v[120:123], v[36:39], v[84:87], v[120:123]
buffer_load_dwordx4 v[216:219], v8, s[28:31], s36 offen sc1
v_fma_f32 v94, v94, v27, v126
v_mfma_f32_16x16x32_bf16 v[120:123], v[32:35], v[88:91], v[120:123]
ds_read_b64 v[56:57], v11 offset:512
v_fma_f32 v95, v95, v27, v127
v_mfma_f32_16x16x32_bf16 v[116:119], v[32:35], v[84:87], v[116:119]
buffer_load_dwordx4 v[220:223], v9, s[28:31], s36 offen sc1
v_cvt_pk_bf16_f32 v62, v92, v93
v_mfma_f32_16x16x32_bf16 v[116:119], v[36:39], v[80:83], v[116:119]
v_cvt_pk_bf16_f32 v63, v94, v95
s_add_u32 s36, s86, 24576
v_mfma_f32_16x16x32_bf16 v[116:119], v[40:43], v[76:79], v[116:119]
buffer_load_dwordx4 v[224:227], v6, s[28:31], s36 offen sc1
v_mfma_f32_16x16x32_bf16 v[116:119], v[44:47], v[72:75], v[116:119]
v_mfma_f32_16x16x32_bf16 v[116:119], v[48:51], v[68:71], v[116:119]
buffer_load_dwordx4 v[228:231], v7, s[28:31], s36 offen sc1
s_waitcnt lgkmcnt(0)
v_and_b32 v88, 0xffff0000, v57
v_mfma_f32_16x16x32_bf16 v[116:119], v[52:55], v[64:67], v[116:119]
ds_read_b64 v[52:53], v11 offset:1024
v_lshlrev_b32 v89, 16, v57
v_and_b32 v90, 0xffff0000, v56
v_mfma_f32_16x16x32_bf16 v[112:115], v[48:51], v[64:67], v[112:115]
v_lshlrev_b32 v91, 16, v56
v_fma_f32 v88, v88, v27, v120
v_mfma_f32_16x16x32_bf16 v[112:115], v[44:47], v[68:71], v[112:115]
buffer_load_dwordx4 v[232:235], v8, s[28:31], s36 offen sc1
v_fma_f32 v89, v89, v27, v121
v_mfma_f32_16x16x32_bf16 v[112:115], v[40:43], v[72:75], v[112:115]
v_fma_f32 v90, v90, v27, v122
v_fma_f32 v91, v91, v27, v123
v_cvt_pk_bf16_f32 v60, v88, v89
v_mfma_f32_16x16x32_bf16 v[112:115], v[36:39], v[76:79], v[112:115]
v_cvt_pk_bf16_f32 v61, v90, v91
s_nop 0
v_mfma_f32_16x16x32_bf16 v[112:115], v[32:35], v[80:83], v[112:115]
ds_read_b64 v[48:49], v11 offset:1536
v_permlane16_swap_b32 v60, v62
v_permlane16_swap_b32 v61, v63
v_mfma_f32_16x16x32_bf16 v[108:111], v[32:35], v[76:79], v[108:111]
buffer_load_dwordx4 v[236:239], v9, s[28:31], s36 offen sc1
s_add_u32 s36, s86, 0
v_mfma_f32_16x16x32_bf16 v[108:111], v[36:39], v[72:75], v[108:111]
s_waitcnt lgkmcnt(1)
v_and_b32 v84, 0xffff0000, v53
v_mfma_f32_16x16x32_bf16 v[108:111], v[40:43], v[68:71], v[108:111]
buffer_load_dwordx4 v[240:243], v6, s[28:31], s36 offen sc1
v_lshlrev_b32 v85, 16, v53
v_mfma_f32_16x16x32_bf16 v[108:111], v[44:47], v[64:67], v[108:111]
ds_read_b64 v[44:45], v11 offset:2048
v_and_b32 v86, 0xffff0000, v52
v_mfma_f32_16x16x32_bf16 v[104:107], v[40:43], v[64:67], v[104:107]
buffer_load_dwordx4 v[244:247], v7, s[28:31], s36 offen sc1
v_lshlrev_b32 v87, 16, v52
v_mfma_f32_16x16x32_bf16 v[104:107], v[36:39], v[68:71], v[104:107]
buffer_load_dwordx4 v[248:251], v8, s[28:31], s36 offen sc1
v_fma_f32 v84, v84, v27, v116
v_mfma_f32_16x16x32_bf16 v[104:107], v[32:35], v[72:75], v[104:107]
ds_read_b64 v[40:41], v11 offset:2560
v_fma_f32 v85, v85, v27, v117
v_mfma_f32_16x16x32_bf16 v[100:103], v[32:35], v[68:71], v[100:103]
buffer_load_dwordx4 v[252:255], v9, s[28:31], s36 offen sc1
v_fma_f32 v86, v86, v27, v118
v_mfma_f32_16x16x32_bf16 v[100:103], v[36:39], v[64:67], v[100:103]
ds_read_b64 v[36:37], v11 offset:3072
v_fma_f32 v87, v87, v27, v119
v_mfma_f32_16x16x32_bf16 v[96:99], v[32:35], v[64:67], v[96:99]
ds_read_b64 v[32:33], v11 offset:3584
v_cvt_pk_bf16_f32 v54, v84, v85
v_cvt_pk_bf16_f32 v55, v86, v87
buffer_store_dwordx4 v[60:63], v20, s[28:31], s37 offen offset:3072 sc1
s_waitcnt lgkmcnt(0)
v_and_b32 v80, 0xffff0000, v49
v_lshlrev_b32 v81, 16, v49
v_and_b32 v82, 0xffff0000, v48
v_lshlrev_b32 v83, 16, v48
v_fma_f32 v80, v80, v27, v112
v_fma_f32 v81, v81, v27, v113
v_fma_f32 v82, v82, v27, v114
v_fma_f32 v83, v83, v27, v115
v_cvt_pk_bf16_f32 v52, v80, v81
v_cvt_pk_bf16_f32 v53, v82, v83
s_nop 0
v_permlane16_swap_b32 v52, v54
v_permlane16_swap_b32 v53, v55
buffer_store_dwordx4 v[52:55], v20, s[28:31], s37 offen offset:2048 sc1
v_and_b32 v76, 0xffff0000, v45
v_lshlrev_b32 v77, 16, v45
v_and_b32 v78, 0xffff0000, v44
v_lshlrev_b32 v79, 16, v44
v_fma_f32 v76, v76, v27, v108
v_fma_f32 v77, v77, v27, v109
v_fma_f32 v78, v78, v27, v110
v_fma_f32 v79, v79, v27, v111
v_cvt_pk_bf16_f32 v46, v76, v77
v_cvt_pk_bf16_f32 v47, v78, v79
v_and_b32 v72, 0xffff0000, v41
v_lshlrev_b32 v73, 16, v41
v_and_b32 v74, 0xffff0000, v40
v_lshlrev_b32 v75, 16, v40
v_fma_f32 v72, v72, v27, v104
v_fma_f32 v73, v73, v27, v105
v_fma_f32 v74, v74, v27, v106
v_fma_f32 v75, v75, v27, v107
v_cvt_pk_bf16_f32 v44, v72, v73
v_cvt_pk_bf16_f32 v45, v74, v75
s_nop 0
v_permlane16_swap_b32 v44, v46
v_permlane16_swap_b32 v45, v47
buffer_store_dwordx4 v[44:47], v20, s[28:31], s37 offen offset:1024 sc1
v_and_b32 v68, 0xffff0000, v37
v_lshlrev_b32 v69, 16, v37
v_and_b32 v70, 0xffff0000, v36
v_lshlrev_b32 v71, 16, v36
v_fma_f32 v68, v68, v27, v100
v_fma_f32 v69, v69, v27, v101
v_fma_f32 v70, v70, v27, v102
v_fma_f32 v71, v71, v27, v103
v_cvt_pk_bf16_f32 v38, v68, v69
v_cvt_pk_bf16_f32 v39, v70, v71
v_and_b32 v64, 0xffff0000, v33
v_lshlrev_b32 v65, 16, v33
v_and_b32 v66, 0xffff0000, v32
v_lshlrev_b32 v67, 16, v32
v_fma_f32 v64, v64, v27, v96
v_fma_f32 v65, v65, v27, v97
v_fma_f32 v66, v66, v27, v98
v_fma_f32 v67, v67, v27, v99
v_cvt_pk_bf16_f32 v36, v64, v65
v_cvt_pk_bf16_f32 v37, v66, v67
s_nop 0
v_permlane16_swap_b32 v36, v38
v_permlane16_swap_b32 v37, v39
buffer_store_dwordx4 v[36:39], v20, s[28:31], s37 offen offset:0 sc1
s_barrier
L_p4_K:
s_mov_b32 s24, s94
s_mov_b32 s25, s95
s_mov_b32 s26, 2359296
s_mov_b32 s27, 0x20000
s_lshl_b32 s41, s3, 28
s_lshr_b32 s50, s88, 5
s_add_u32 s41, s41, s50
s_add_u32 s41, s41, 69230592
s_lshl_b32 s64, s3, 10
v_mov_b32 v4, 1
v_mov_b32 v5, v26
v_lshlrev_b32 v30, 3, v0
s_waitcnt vmcnt(12)
v_mfma_f32_16x16x32_bf16 v[32:35], a[64:67], v[192:195], 0
s_add_u32 s36, s86, 4096
v_mfma_f32_16x16x32_bf16 v[36:39], a[64:67], v[196:199], 0
buffer_load_dwordx4 v[112:115], v6, s[28:31], s36 offen sc1
v_mfma_f32_16x16x32_bf16 v[40:43], a[64:67], v[200:203], 0
v_mfma_f32_16x16x32_bf16 v[44:47], a[64:67], v[204:207], 0
v_mfma_f32_16x16x32_bf16 v[60:63], a[68:71], v[204:207], 0
buffer_load_dwordx4 v[116:119], v7, s[28:31], s36 offen sc1
v_mfma_f32_16x16x32_bf16 v[56:59], a[68:71], v[200:203], 0
v_mfma_f32_16x16x32_bf16 v[52:55], a[68:71], v[196:199], 0
v_mfma_f32_16x16x32_bf16 v[48:51], a[68:71], v[192:195], 0
v_mfma_f32_16x16x32_bf16 v[64:67], a[72:75], v[192:195], 0
v_mfma_f32_16x16x32_bf16 v[68:71], a[72:75], v[196:199], 0
buffer_load_dwordx4 v[120:123], v8, s[28:31], s36 offen sc1
v_mfma_f32_16x16x32_bf16 v[72:75], a[72:75], v[200:203], 0
v_mfma_f32_16x16x32_bf16 v[76:79], a[72:75], v[204:207], 0
v_mfma_f32_16x16x32_bf16 v[92:95], a[76:79], v[204:207], 0
v_mfma_f32_16x16x32_bf16 v[88:91], a[76:79], v[200:203], 0
v_mfma_f32_16x16x32_bf16 v[84:87], a[76:79], v[196:199], 0
buffer_load_dwordx4 v[124:127], v9, s[28:31], s36 offen sc1
v_mfma_f32_16x16x32_bf16 v[80:83], a[76:79], v[192:195], 0
v_mfma_f32_16x16x32_bf16 v[96:99], a[80:83], v[192:195], 0
v_mfma_f32_16x16x32_bf16 v[100:103], a[80:83], v[196:199], 0
v_mfma_f32_16x16x32_bf16 v[104:107], a[80:83], v[200:203], 0
v_mfma_f32_16x16x32_bf16 v[108:111], a[80:83], v[204:207], 0
s_waitcnt vmcnt(12)
v_mfma_f32_16x16x32_bf16 v[32:35], a[84:87], v[208:211], v[32:35]
s_add_u32 s36, s86, 8192
s_add_u32 s64, s64, 69230592
v_mfma_f32_16x16x32_bf16 v[36:39], a[84:87], v[212:215], v[36:39]
buffer_load_dwordx4 v[192:195], v6, s[28:31], s36 offen sc1
v_mfma_f32_16x16x32_bf16 v[40:43], a[84:87], v[216:219], v[40:43]
s_mov_b32 s65, 61865984
s_lshl_b32 s50, s89, 6
v_mfma_f32_16x16x32_bf16 v[44:47], a[84:87], v[220:223], v[44:47]
s_lshl_b32 s51, s3, 4
s_add_u32 s50, s50, s51
v_mfma_f32_16x16x32_bf16 v[60:63], a[88:91], v[220:223], v[60:63]
v_add_u32 v17, s50, v3
v_mul_u32_u24 v13, 1152, v17
v_mfma_f32_16x16x32_bf16 v[56:59], a[88:91], v[216:219], v[56:59]
v_lshl_add_u32 v13, v2, 3, v13
s_lshl_b32 s51, s85, 5
v_mfma_f32_16x16x32_bf16 v[52:55], a[88:91], v[212:215], v[52:55]
v_add_u32 v13, s51, v13
v_lshlrev_b32 v17, 2, v17
v_mfma_f32_16x16x32_bf16 v[48:51], a[88:91], v[208:211], v[48:51]
s_lshl_b32 s50, s85, 4
s_mul_i32 s51, s3, 24
v_mfma_f32_16x16x32_bf16 v[64:67], a[92:95], v[208:211], v[64:67]
s_add_u32 s50, s50, s51
v_lshrrev_b32 v14, 3, v0
v_mfma_f32_16x16x32_bf16 v[68:71], a[92:95], v[212:215], v[68:71]
v_add_u32 v14, s50, v14
v_lshlrev_b32 v14, 12, v14
v_mfma_f32_16x16x32_bf16 v[72:75], a[92:95], v[216:219], v[72:75]
v_and_b32 v16, 7, v0
v_lshl_add_u32 v14, v16, 4, v14
v_mfma_f32_16x16x32_bf16 v[76:79], a[92:95], v[220:223], v[76:79]
s_lshl_b32 s37, s89, 7
s_add_u32 s37, s37, 53477376
v_mfma_f32_16x16x32_bf16 v[92:95], a[96:99], v[220:223], v[92:95]
s_mul_i32 s51, s3, 3072
v_mfma_f32_16x16x32_bf16 v[88:91], a[96:99], v[216:219], v[88:91]
buffer_load_dwordx4 v[196:199], v7, s[28:31], s36 offen sc1
v_mfma_f32_16x16x32_bf16 v[84:87], a[96:99], v[212:215], v[84:87]
buffer_load_dwordx4 v[200:203], v8, s[28:31], s36 offen sc1
v_mfma_f32_16x16x32_bf16 v[80:83], a[96:99], v[208:211], v[80:83]
buffer_load_dwordx4 v[204:207], v9, s[28:31], s36 offen sc1
v_mfma_f32_16x16x32_bf16 v[96:99], a[100:103], v[208:211], v[96:99]
v_mfma_f32_16x16x32_bf16 v[100:103], a[100:103], v[212:215], v[100:103]
v_mfma_f32_16x16x32_bf16 v[104:107], a[100:103], v[216:219], v[104:107]
v_mfma_f32_16x16x32_bf16 v[108:111], a[100:103], v[220:223], v[108:111]
s_waitcnt vmcnt(12)
v_mfma_f32_16x16x32_bf16 v[32:35], a[224:227], v[224:227], v[32:35]
s_add_u32 s36, s86, 28672
s_add_u32 s51, s51, 143360
v_mfma_f32_16x16x32_bf16 v[36:39], a[224:227], v[228:231], v[36:39]
buffer_load_dwordx4 v[208:211], v6, s[28:31], s36 offen sc1
v_mfma_f32_16x16x32_bf16 v[40:43], a[224:227], v[232:235], v[40:43]
v_add_u32 v15, s51, v1
v_lshrrev_b32 v16, 2, v0
v_mfma_f32_16x16x32_bf16 v[44:47], a[224:227], v[236:239], v[44:47]
v_lshlrev_b32 v16, 7, v16
v_and_b32 v11, 3, v0
v_mfma_f32_16x16x32_bf16 v[60:63], a[228:231], v[236:239], v[60:63]
v_lshl_add_u32 v16, v11, 3, v16
s_lshl_b32 s51, s3, 5
v_mfma_f32_16x16x32_bf16 v[56:59], a[228:231], v[232:235], v[56:59]
s_add_u32 s51, s51, 143360
v_add_u32 v16, s51, v16
v_mfma_f32_16x16x32_bf16 v[52:55], a[228:231], v[228:231], v[52:55]
s_and_b32 s50, s61, 1
s_mul_i32 s50, s50, 2146435072
v_mfma_f32_16x16x32_bf16 v[48:51], a[228:231], v[224:227], v[48:51]
v_add_u32 v29, s50, v13
s_mul_i32 s50, s3, 20480
v_mfma_f32_16x16x32_bf16 v[64:67], a[232:235], v[224:227], v[64:67]
v_add_u32 v10, s50, v1
v_sub_u32 v18, v6, v1
v_mfma_f32_16x16x32_bf16 v[68:71], a[232:235], v[228:231], v[68:71]
v_mad_u32_u24 v18, v18, 20, v1
v_sub_u32 v19, v7, v1
v_mfma_f32_16x16x32_bf16 v[72:75], a[232:235], v[232:235], v[72:75]
v_mad_u32_u24 v19, v19, 20, v1
v_sub_u32 v20, v8, v1
v_mfma_f32_16x16x32_bf16 v[76:79], a[232:235], v[236:239], v[76:79]
v_mad_u32_u24 v20, v20, 20, v1
v_sub_u32 v21, v9, v1
v_mfma_f32_16x16x32_bf16 v[92:95], a[236:239], v[236:239], v[92:95]
v_mad_u32_u24 v21, v21, 20, v1
v_mfma_f32_16x16x32_bf16 v[88:91], a[236:239], v[232:235], v[88:91]
buffer_load_dwordx4 v[212:215], v7, s[28:31], s36 offen sc1
v_mfma_f32_16x16x32_bf16 v[84:87], a[236:239], v[228:231], v[84:87]
buffer_load_dwordx4 v[216:219], v8, s[28:31], s36 offen sc1
v_mfma_f32_16x16x32_bf16 v[80:83], a[236:239], v[224:227], v[80:83]
buffer_load_dwordx4 v[220:223], v9, s[28:31], s36 offen sc1
v_mfma_f32_16x16x32_bf16 v[96:99], a[240:243], v[224:227], v[96:99]
v_mfma_f32_16x16x32_bf16 v[100:103], a[240:243], v[228:231], v[100:103]
v_mfma_f32_16x16x32_bf16 v[104:107], a[240:243], v[232:235], v[104:107]
v_mfma_f32_16x16x32_bf16 v[108:111], a[240:243], v[236:239], v[108:111]
s_waitcnt vmcnt(12)
v_mfma_f32_16x16x32_bf16 v[32:35], v[128:131], v[240:243], v[32:35]
s_add_u32 s36, s86, 32768
v_mfma_f32_16x16x32_bf16 v[36:39], v[128:131], v[244:247], v[36:39]
buffer_load_dwordx4 v[224:227], v6, s[28:31], s36 offen sc1
v_mfma_f32_16x16x32_bf16 v[40:43], v[128:131], v[248:251], v[40:43]
v_mfma_f32_16x16x32_bf16 v[44:47], v[128:131], v[252:255], v[44:47]
v_mfma_f32_16x16x32_bf16 v[60:63], v[132:135], v[252:255], v[60:63]
buffer_load_dwordx4 v[228:231], v7, s[28:31], s36 offen sc1
v_mfma_f32_16x16x32_bf16 v[56:59], v[132:135], v[248:251], v[56:59]
v_mfma_f32_16x16x32_bf16 v[52:55], v[132:135], v[244:247], v[52:55]
v_mfma_f32_16x16x32_bf16 v[48:51], v[132:135], v[240:243], v[48:51]
v_mfma_f32_16x16x32_bf16 v[64:67], v[136:139], v[240:243], v[64:67]
v_mfma_f32_16x16x32_bf16 v[68:71], v[136:139], v[244:247], v[68:71]
buffer_load_dwordx4 v[232:235], v8, s[28:31], s36 offen sc1
v_mfma_f32_16x16x32_bf16 v[72:75], v[136:139], v[248:251], v[72:75]
v_mfma_f32_16x16x32_bf16 v[76:79], v[136:139], v[252:255], v[76:79]
v_mfma_f32_16x16x32_bf16 v[92:95], v[140:143], v[252:255], v[92:95]
v_mfma_f32_16x16x32_bf16 v[88:91], v[140:143], v[248:251], v[88:91]
v_mfma_f32_16x16x32_bf16 v[84:87], v[140:143], v[244:247], v[84:87]
buffer_load_dwordx4 v[236:239], v9, s[28:31], s36 offen sc1
v_mfma_f32_16x16x32_bf16 v[80:83], v[140:143], v[240:243], v[80:83]
v_mfma_f32_16x16x32_bf16 v[96:99], v[144:147], v[240:243], v[96:99]
v_mfma_f32_16x16x32_bf16 v[100:103], v[144:147], v[244:247], v[100:103]
v_mfma_f32_16x16x32_bf16 v[104:107], v[144:147], v[248:251], v[104:107]
v_mfma_f32_16x16x32_bf16 v[108:111], v[144:147], v[252:255], v[108:111]
s_waitcnt vmcnt(12)
v_mfma_f32_16x16x32_bf16 v[32:35], v[148:151], v[112:115], v[32:35]
s_barrier
v_mfma_f32_16x16x32_bf16 v[36:39], v[148:151], v[116:119], v[36:39]
buffer_store_dword v4, v5, s[28:31], s41 offen sc1
v_mfma_f32_16x16x32_bf16 v[40:43], v[148:151], v[120:123], v[40:43]
s_add_u32 s36, s86, 36864
v_mfma_f32_16x16x32_bf16 v[44:47], v[148:151], v[124:127], v[44:47]
buffer_load_dwordx4 v[240:243], v6, s[28:31], s36 offen sc1
v_mfma_f32_16x16x32_bf16 v[60:63], v[152:155], v[124:127], v[60:63]
buffer_load_dwordx4 v[244:247], v7, s[28:31], s36 offen sc1
v_mfma_f32_16x16x32_bf16 v[56:59], v[152:155], v[120:123], v[56:59]
v_mfma_f32_16x16x32_bf16 v[52:55], v[152:155], v[116:119], v[52:55]
v_mfma_f32_16x16x32_bf16 v[48:51], v[152:155], v[112:115], v[48:51]
v_mfma_f32_16x16x32_bf16 v[64:67], v[156:159], v[112:115], v[64:67]
v_mfma_f32_16x16x32_bf16 v[68:71], v[156:159], v[116:119], v[68:71]
buffer_load_dwordx4 v[248:251], v8, s[28:31], s36 offen sc1
v_mfma_f32_16x16x32_bf16 v[72:75], v[156:159], v[120:123], v[72:75]
v_mfma_f32_16x16x32_bf16 v[76:79], v[156:159], v[124:127], v[76:79]
v_mfma_f32_16x16x32_bf16 v[92:95], v[160:163], v[124:127], v[92:95]
v_mfma_f32_16x16x32_bf16 v[88:91], v[160:163], v[120:123], v[88:91]
v_mfma_f32_16x16x32_bf16 v[84:87], v[160:163], v[116:119], v[84:87]
buffer_load_dwordx4 v[252:255], v9, s[28:31], s36 offen sc1
v_mfma_f32_16x16x32_bf16 v[80:83], v[160:163], v[112:115], v[80:83]
v_mfma_f32_16x16x32_bf16 v[96:99], v[164:167], v[112:115], v[96:99]
v_mfma_f32_16x16x32_bf16 v[100:103], v[164:167], v[116:119], v[100:103]
v_mfma_f32_16x16x32_bf16 v[104:107], v[164:167], v[120:123], v[104:107]
v_mfma_f32_16x16x32_bf16 v[108:111], v[164:167], v[124:127], v[108:111]
s_waitcnt vmcnt(13)
v_mfma_f32_16x16x32_bf16 v[32:35], v[168:171], v[192:195], v[32:35]
s_add_u32 s36, s86, 40960
v_mfma_f32_16x16x32_bf16 v[36:39], v[168:171], v[196:199], v[36:39]
buffer_load_dwordx4 v[112:115], v6, s[28:31], s36 offen sc1
v_mfma_f32_16x16x32_bf16 v[40:43], v[168:171], v[200:203], v[40:43]
v_mfma_f32_16x16x32_bf16 v[44:47], v[168:171], v[204:207], v[44:47]
v_mfma_f32_16x16x32_bf16 v[60:63], v[172:175], v[204:207], v[60:63]
buffer_load_dwordx4 v[116:119], v7, s[28:31], s36 offen sc1
v_mfma_f32_16x16x32_bf16 v[56:59], v[172:175], v[200:203], v[56:59]
v_mfma_f32_16x16x32_bf16 v[52:55], v[172:175], v[196:199], v[52:55]
v_mfma_f32_16x16x32_bf16 v[48:51], v[172:175], v[192:195], v[48:51]
v_mfma_f32_16x16x32_bf16 v[64:67], v[176:179], v[192:195], v[64:67]
v_mfma_f32_16x16x32_bf16 v[68:71], v[176:179], v[196:199], v[68:71]
buffer_load_dwordx4 v[120:123], v8, s[28:31], s36 offen sc1
v_mfma_f32_16x16x32_bf16 v[72:75], v[176:179], v[200:203], v[72:75]
v_mfma_f32_16x16x32_bf16 v[76:79], v[176:179], v[204:207], v[76:79]
v_mfma_f32_16x16x32_bf16 v[92:95], v[180:183], v[204:207], v[92:95]
v_mfma_f32_16x16x32_bf16 v[88:91], v[180:183], v[200:203], v[88:91]
v_mfma_f32_16x16x32_bf16 v[84:87], v[180:183], v[196:199], v[84:87]
buffer_load_dwordx4 v[124:127], v9, s[28:31], s36 offen sc1
v_mfma_f32_16x16x32_bf16 v[80:83], v[180:183], v[192:195], v[80:83]
v_mfma_f32_16x16x32_bf16 v[96:99], v[184:187], v[192:195], v[96:99]
v_mfma_f32_16x16x32_bf16 v[100:103], v[184:187], v[196:199], v[100:103]
v_mfma_f32_16x16x32_bf16 v[104:107], v[184:187], v[200:203], v[104:107]
v_mfma_f32_16x16x32_bf16 v[108:111], v[184:187], v[204:207], v[108:111]
s_waitcnt vmcnt(13)
v_mfma_f32_16x16x32_bf16 v[32:35], a[0:3], v[208:211], v[32:35]
s_add_u32 s36, s86, 45056
v_mfma_f32_16x16x32_bf16 v[36:39], a[0:3], v[212:215], v[36:39]
buffer_load_dwordx4 v[192:195], v6, s[28:31], s36 offen sc1
v_mfma_f32_16x16x32_bf16 v[40:43], a[0:3], v[216:219], v[40:43]
v_mfma_f32_16x16x32_bf16 v[44:47], a[0:3], v[220:223], v[44:47]
v_mfma_f32_16x16x32_bf16 v[60:63], a[4:7], v[220:223], v[60:63]
buffer_load_dwordx4 v[196:199], v7, s[28:31], s36 offen sc1
v_mfma_f32_16x16x32_bf16 v[56:59], a[4:7], v[216:219], v[56:59]
v_mfma_f32_16x16x32_bf16 v[52:55], a[4:7], v[212:215], v[52:55]
v_mfma_f32_16x16x32_bf16 v[48:51], a[4:7], v[208:211], v[48:51]
v_mfma_f32_16x16x32_bf16 v[64:67], a[8:11], v[208:211], v[64:67]
v_mfma_f32_16x16x32_bf16 v[68:71], a[8:11], v[212:215], v[68:71]
buffer_load_dwordx4 v[200:203], v8, s[28:31], s36 offen sc1
v_mfma_f32_16x16x32_bf16 v[72:75], a[8:11], v[216:219], v[72:75]
v_mfma_f32_16x16x32_bf16 v[76:79], a[8:11], v[220:223], v[76:79]
v_mfma_f32_16x16x32_bf16 v[92:95], a[12:15], v[220:223], v[92:95]
v_mfma_f32_16x16x32_bf16 v[88:91], a[12:15], v[216:219], v[88:91]
v_mfma_f32_16x16x32_bf16 v[84:87], a[12:15], v[212:215], v[84:87]
buffer_load_dwordx4 v[204:207], v9, s[28:31], s36 offen sc1
v_mfma_f32_16x16x32_bf16 v[80:83], a[12:15], v[208:211], v[80:83]
v_mfma_f32_16x16x32_bf16 v[96:99], a[16:19], v[208:211], v[96:99]
v_mfma_f32_16x16x32_bf16 v[100:103], a[16:19], v[212:215], v[100:103]
v_mfma_f32_16x16x32_bf16 v[104:107], a[16:19], v[216:219], v[104:107]
v_mfma_f32_16x16x32_bf16 v[108:111], a[16:19], v[220:223], v[108:111]
s_waitcnt vmcnt(13)
v_mfma_f32_16x16x32_bf16 v[32:35], a[20:23], v[224:227], v[32:35]
s_add_u32 s36, s86, 49152
v_mfma_f32_16x16x32_bf16 v[36:39], a[20:23], v[228:231], v[36:39]
buffer_load_dwordx4 v[208:211], v6, s[28:31], s36 offen sc1
v_mfma_f32_16x16x32_bf16 v[40:43], a[20:23], v[232:235], v[40:43]
v_mfma_f32_16x16x32_bf16 v[44:47], a[20:23], v[236:239], v[44:47]
v_mfma_f32_16x16x32_bf16 v[60:63], a[24:27], v[236:239], v[60:63]
buffer_load_dwordx4 v[212:215], v7, s[28:31], s36 offen sc1
v_mfma_f32_16x16x32_bf16 v[56:59], a[24:27], v[232:235], v[56:59]
v_mfma_f32_16x16x32_bf16 v[52:55], a[24:27], v[228:231], v[52:55]
v_mfma_f32_16x16x32_bf16 v[48:51], a[24:27], v[224:227], v[48:51]
v_mfma_f32_16x16x32_bf16 v[64:67], a[28:31], v[224:227], v[64:67]
v_mfma_f32_16x16x32_bf16 v[68:71], a[28:31], v[228:231], v[68:71]
buffer_load_dwordx4 v[216:219], v8, s[28:31], s36 offen sc1
v_mfma_f32_16x16x32_bf16 v[72:75], a[28:31], v[232:235], v[72:75]
v_mfma_f32_16x16x32_bf16 v[76:79], a[28:31], v[236:239], v[76:79]
v_mfma_f32_16x16x32_bf16 v[92:95], a[32:35], v[236:239], v[92:95]
v_mfma_f32_16x16x32_bf16 v[88:91], a[32:35], v[232:235], v[88:91]
v_mfma_f32_16x16x32_bf16 v[84:87], a[32:35], v[228:231], v[84:87]
buffer_load_dwordx4 v[220:223], v9, s[28:31], s36 offen sc1
v_mfma_f32_16x16x32_bf16 v[80:83], a[32:35], v[224:227], v[80:83]
v_mfma_f32_16x16x32_bf16 v[96:99], a[36:39], v[224:227], v[96:99]
v_mfma_f32_16x16x32_bf16 v[100:103], a[36:39], v[228:231], v[100:103]
v_mfma_f32_16x16x32_bf16 v[104:107], a[36:39], v[232:235], v[104:107]
v_mfma_f32_16x16x32_bf16 v[108:111], a[36:39], v[236:239], v[108:111]
s_waitcnt vmcnt(12)
v_mfma_f32_16x16x32_bf16 v[32:35], a[40:43], v[240:243], v[32:35]
s_add_u32 s36, s86, 53248
v_mfma_f32_16x16x32_bf16 v[36:39], a[40:43], v[244:247], v[36:39]
buffer_load_dwordx4 v[224:227], v6, s[28:31], s36 offen sc1
v_mfma_f32_16x16x32_bf16 v[40:43], a[40:43], v[248:251], v[40:43]
v_mfma_f32_16x16x32_bf16 v[44:47], a[40:43], v[252:255], v[44:47]
v_mfma_f32_16x16x32_bf16 v[60:63], a[44:47], v[252:255], v[60:63]
buffer_load_dwordx4 v[228:231], v7, s[28:31], s36 offen sc1
v_mfma_f32_16x16x32_bf16 v[56:59], a[44:47], v[248:251], v[56:59]
v_mfma_f32_16x16x32_bf16 v[52:55], a[44:47], v[244:247], v[52:55]
v_mfma_f32_16x16x32_bf16 v[48:51], a[44:47], v[240:243], v[48:51]
v_mfma_f32_16x16x32_bf16 v[64:67], a[48:51], v[240:243], v[64:67]
v_mfma_f32_16x16x32_bf16 v[68:71], a[48:51], v[244:247], v[68:71]
buffer_load_dwordx4 v[232:235], v8, s[28:31], s36 offen sc1
v_mfma_f32_16x16x32_bf16 v[72:75], a[48:51], v[248:251], v[72:75]
v_mfma_f32_16x16x32_bf16 v[76:79], a[48:51], v[252:255], v[76:79]
v_mfma_f32_16x16x32_bf16 v[92:95], a[52:55], v[252:255], v[92:95]
v_mfma_f32_16x16x32_bf16 v[88:91], a[52:55], v[248:251], v[88:91]
v_mfma_f32_16x16x32_bf16 v[84:87], a[52:55], v[244:247], v[84:87]
buffer_load_dwordx4 v[236:239], v9, s[28:31], s36 offen sc1
v_mfma_f32_16x16x32_bf16 v[80:83], a[52:55], v[240:243], v[80:83]
v_mfma_f32_16x16x32_bf16 v[96:99], a[56:59], v[240:243], v[96:99]
v_mfma_f32_16x16x32_bf16 v[100:103], a[56:59], v[244:247], v[100:103]
v_mfma_f32_16x16x32_bf16 v[104:107], a[56:59], v[248:251], v[104:107]
v_mfma_f32_16x16x32_bf16 v[108:111], a[56:59], v[252:255], v[108:111]
s_waitcnt vmcnt(12)
v_mfma_f32_16x16x32_bf16 v[32:35], a[124:127], v[112:115], v[32:35]
s_add_u32 s36, s86, 12288
v_mfma_f32_16x16x32_bf16 v[36:39], a[124:127], v[116:119], v[36:39]
buffer_load_dwordx4 v[240:243], v6, s[28:31], s36 offen sc1
v_mfma_f32_16x16x32_bf16 v[40:43], a[124:127], v[120:123], v[40:43]
v_mfma_f32_16x16x32_bf16 v[44:47], a[124:127], v[124:127], v[44:47]
v_mfma_f32_16x16x32_bf16 v[60:63], a[128:131], v[124:127], v[60:63]
buffer_load_dwordx4 v[244:247], v7, s[28:31], s36 offen sc1
v_mfma_f32_16x16x32_bf16 v[56:59], a[128:131], v[120:123], v[56:59]
v_mfma_f32_16x16x32_bf16 v[52:55], a[128:131], v[116:119], v[52:55]
v_mfma_f32_16x16x32_bf16 v[48:51], a[128:131], v[112:115], v[48:51]
v_mfma_f32_16x16x32_bf16 v[64:67], a[132:135], v[112:115], v[64:67]
v_mfma_f32_16x16x32_bf16 v[68:71], a[132:135], v[116:119], v[68:71]
buffer_load_dwordx4 v[248:251], v8, s[28:31], s36 offen sc1
v_mfma_f32_16x16x32_bf16 v[72:75], a[132:135], v[120:123], v[72:75]
v_mfma_f32_16x16x32_bf16 v[76:79], a[132:135], v[124:127], v[76:79]
v_mfma_f32_16x16x32_bf16 v[92:95], a[136:139], v[124:127], v[92:95]
v_mfma_f32_16x16x32_bf16 v[88:91], a[136:139], v[120:123], v[88:91]
v_mfma_f32_16x16x32_bf16 v[84:87], a[136:139], v[116:119], v[84:87]
buffer_load_dwordx4 v[252:255], v9, s[28:31], s36 offen sc1
v_mfma_f32_16x16x32_bf16 v[80:83], a[136:139], v[112:115], v[80:83]
v_mfma_f32_16x16x32_bf16 v[96:99], a[140:143], v[112:115], v[96:99]
v_mfma_f32_16x16x32_bf16 v[100:103], a[140:143], v[116:119], v[100:103]
v_mfma_f32_16x16x32_bf16 v[104:107], a[140:143], v[120:123], v[104:107]
v_mfma_f32_16x16x32_bf16 v[108:111], a[140:143], v[124:127], v[108:111]
s_waitcnt vmcnt(12)
v_mfma_f32_16x16x32_bf16 v[32:35], a[164:167], v[192:195], v[32:35]
s_add_u32 s36, s86, 57344
v_mfma_f32_16x16x32_bf16 v[36:39], a[164:167], v[196:199], v[36:39]
buffer_load_dwordx4 v[112:115], v6, s[28:31], s36 offen sc1
v_mfma_f32_16x16x32_bf16 v[40:43], a[164:167], v[200:203], v[40:43]
v_mfma_f32_16x16x32_bf16 v[44:47], a[164:167], v[204:207], v[44:47]
v_mfma_f32_16x16x32_bf16 v[60:63], a[168:171], v[204:207], v[60:63]
buffer_load_dwordx4 v[116:119], v7, s[28:31], s36 offen sc1
v_mfma_f32_16x16x32_bf16 v[56:59], a[168:171], v[200:203], v[56:59]
v_mfma_f32_16x16x32_bf16 v[52:55], a[168:171], v[196:199], v[52:55]
v_mfma_f32_16x16x32_bf16 v[48:51], a[168:171], v[192:195], v[48:51]
v_mfma_f32_16x16x32_bf16 v[64:67], a[172:175], v[192:195], v[64:67]
v_mfma_f32_16x16x32_bf16 v[68:71], a[172:175], v[196:199], v[68:71]
buffer_load_dwordx4 v[120:123], v8, s[28:31], s36 offen sc1
v_mfma_f32_16x16x32_bf16 v[72:75], a[172:175], v[200:203], v[72:75]
v_mfma_f32_16x16x32_bf16 v[76:79], a[172:175], v[204:207], v[76:79]
v_mfma_f32_16x16x32_bf16 v[92:95], a[176:179], v[204:207], v[92:95]
v_mfma_f32_16x16x32_bf16 v[88:91], a[176:179], v[200:203], v[88:91]
v_mfma_f32_16x16x32_bf16 v[84:87], a[176:179], v[196:199], v[84:87]
buffer_load_dwordx4 v[124:127], v9, s[28:31], s36 offen sc1
v_mfma_f32_16x16x32_bf16 v[80:83], a[176:179], v[192:195], v[80:83]
v_mfma_f32_16x16x32_bf16 v[96:99], a[180:183], v[192:195], v[96:99]
v_mfma_f32_16x16x32_bf16 v[100:103], a[180:183], v[196:199], v[100:103]
v_mfma_f32_16x16x32_bf16 v[104:107], a[180:183], v[200:203], v[104:107]
v_mfma_f32_16x16x32_bf16 v[108:111], a[180:183], v[204:207], v[108:111]
s_waitcnt vmcnt(12)
v_mfma_f32_16x16x32_bf16 v[32:35], a[184:187], v[208:211], v[32:35]
s_add_u32 s36, s86, 61440
v_mfma_f32_16x16x32_bf16 v[36:39], a[184:187], v[212:215], v[36:39]
buffer_load_dwordx4 v[192:195], v6, s[28:31], s36 offen sc1
v_mfma_f32_16x16x32_bf16 v[40:43], a[184:187], v[216:219], v[40:43]
v_mfma_f32_16x16x32_bf16 v[44:47], a[184:187], v[220:223], v[44:47]
v_mfma_f32_16x16x32_bf16 v[60:63], a[188:191], v[220:223], v[60:63]
buffer_load_dwordx4 v[196:199], v7, s[28:31], s36 offen sc1
v_mfma_f32_16x16x32_bf16 v[56:59], a[188:191], v[216:219], v[56:59]
v_mfma_f32_16x16x32_bf16 v[52:55], a[188:191], v[212:215], v[52:55]
v_mfma_f32_16x16x32_bf16 v[48:51], a[188:191], v[208:211], v[48:51]
v_mfma_f32_16x16x32_bf16 v[64:67], a[192:195], v[208:211], v[64:67]
v_mfma_f32_16x16x32_bf16 v[68:71], a[192:195], v[212:215], v[68:71]
buffer_load_dwordx4 v[200:203], v8, s[28:31], s36 offen sc1
v_mfma_f32_16x16x32_bf16 v[72:75], a[192:195], v[216:219], v[72:75]
v_mfma_f32_16x16x32_bf16 v[76:79], a[192:195], v[220:223], v[76:79]
v_mfma_f32_16x16x32_bf16 v[92:95], a[196:199], v[220:223], v[92:95]
v_mfma_f32_16x16x32_bf16 v[88:91], a[196:199], v[216:219], v[88:91]
v_mfma_f32_16x16x32_bf16 v[84:87], a[196:199], v[212:215], v[84:87]
buffer_load_dwordx4 v[204:207], v9, s[28:31], s36 offen sc1
v_mfma_f32_16x16x32_bf16 v[80:83], a[196:199], v[208:211], v[80:83]
v_mfma_f32_16x16x32_bf16 v[96:99], a[200:203], v[208:211], v[96:99]
v_mfma_f32_16x16x32_bf16 v[100:103], a[200:203], v[212:215], v[100:103]
v_mfma_f32_16x16x32_bf16 v[104:107], a[200:203], v[216:219], v[104:107]
v_mfma_f32_16x16x32_bf16 v[108:111], a[200:203], v[220:223], v[108:111]
s_waitcnt vmcnt(12)
v_mfma_f32_16x16x32_bf16 v[32:35], a[204:207], v[224:227], v[32:35]
s_add_u32 s36, s87, 0
v_mfma_f32_16x16x32_bf16 v[36:39], a[204:207], v[228:231], v[36:39]
buffer_load_dwordx4 v[208:211], v6, s[28:31], s36 offen sc1
v_mfma_f32_16x16x32_bf16 v[40:43], a[204:207], v[232:235], v[40:43]
v_mfma_f32_16x16x32_bf16 v[44:47], a[204:207], v[236:239], v[44:47]
v_mfma_f32_16x16x32_bf16 v[60:63], a[208:211], v[236:239], v[60:63]
buffer_load_dwordx4 v[212:215], v7, s[28:31], s36 offen sc1
v_mfma_f32_16x16x32_bf16 v[56:59], a[208:211], v[232:235], v[56:59]
v_mfma_f32_16x16x32_bf16 v[52:55], a[208:211], v[228:231], v[52:55]
v_mfma_f32_16x16x32_bf16 v[48:51], a[208:211], v[224:227], v[48:51]
v_mfma_f32_16x16x32_bf16 v[64:67], a[212:215], v[224:227], v[64:67]
v_mfma_f32_16x16x32_bf16 v[68:71], a[212:215], v[228:231], v[68:71]
buffer_load_dwordx4 v[216:219], v8, s[28:31], s36 offen sc1
v_mfma_f32_16x16x32_bf16 v[72:75], a[212:215], v[232:235], v[72:75]
v_mfma_f32_16x16x32_bf16 v[76:79], a[212:215], v[236:239], v[76:79]
v_mfma_f32_16x16x32_bf16 v[92:95], a[216:219], v[236:239], v[92:95]
v_mfma_f32_16x16x32_bf16 v[88:91], a[216:219], v[232:235], v[88:91]
v_mfma_f32_16x16x32_bf16 v[84:87], a[216:219], v[228:231], v[84:87]
buffer_load_dwordx4 v[220:223], v9, s[28:31], s36 offen sc1
v_mfma_f32_16x16x32_bf16 v[80:83], a[216:219], v[224:227], v[80:83]
v_mfma_f32_16x16x32_bf16 v[96:99], a[220:223], v[224:227], v[96:99]
v_mfma_f32_16x16x32_bf16 v[100:103], a[220:223], v[228:231], v[100:103]
v_mfma_f32_16x16x32_bf16 v[104:107], a[220:223], v[232:235], v[104:107]
v_mfma_f32_16x16x32_bf16 v[108:111], a[220:223], v[236:239], v[108:111]
s_waitcnt vmcnt(12)
v_mfma_f32_16x16x32_bf16 v[32:35], a[244:247], v[240:243], v[32:35]
s_add_u32 s36, s87, 4096
v_mfma_f32_16x16x32_bf16 v[36:39], a[244:247], v[244:247], v[36:39]
buffer_load_dwordx4 v[224:227], v6, s[28:31], s36 offen sc1
v_mfma_f32_16x16x32_bf16 v[40:43], a[244:247], v[248:251], v[40:43]
v_mfma_f32_16x16x32_bf16 v[44:47], a[244:247], v[252:255], v[44:47]
v_mfma_f32_16x16x32_bf16 v[60:63], a[248:251], v[252:255], v[60:63]
buffer_load_dwordx4 v[228:231], v7, s[28:31], s36 offen sc1
v_mfma_f32_16x16x32_bf16 v[56:59], a[248:251], v[248:251], v[56:59]
v_mfma_f32_16x16x32_bf16 v[52:55], a[248:251], v[244:247], v[52:55]
v_mfma_f32_16x16x32_bf16 v[48:51], a[248:251], v[240:243], v[48:51]
v_mfma_f32_16x16x32_bf16 v[64:67], a[252:255], v[240:243], v[64:67]
v_mfma_f32_16x16x32_bf16 v[68:71], a[252:255], v[244:247], v[68:71]
buffer_load_dwordx4 v[232:235], v8, s[28:31], s36 offen sc1
v_mfma_f32_16x16x32_bf16 v[72:75], a[252:255], v[248:251], v[72:75]
v_mfma_f32_16x16x32_bf16 v[76:79], a[252:255], v[252:255], v[76:79]
v_mfma_f32_16x16x32_bf16 v[92:95], a[60:63], v[252:255], v[92:95]
v_mfma_f32_16x16x32_bf16 v[88:91], a[60:63], v[248:251], v[88:91]
v_mfma_f32_16x16x32_bf16 v[84:87], a[60:63], v[244:247], v[84:87]
buffer_load_dwordx4 v[236:239], v9, s[28:31], s36 offen sc1
v_mfma_f32_16x16x32_bf16 v[80:83], a[60:63], v[240:243], v[80:83]
v_mfma_f32_16x16x32_bf16 v[96:99], v[188:191], v[240:243], v[96:99]
v_mfma_f32_16x16x32_bf16 v[100:103], v[188:191], v[244:247], v[100:103]
v_mfma_f32_16x16x32_bf16 v[104:107], v[188:191], v[248:251], v[104:107]
v_mfma_f32_16x16x32_bf16 v[108:111], v[188:191], v[252:255], v[108:111]
s_waitcnt vmcnt(8)
v_mfma_f32_16x16x32_bf16 v[32:35], a[104:107], v[112:115], v[32:35]
s_add_u32 s36, s87, 8192
v_mfma_f32_16x16x32_bf16 v[36:39], a[104:107], v[116:119], v[36:39]
buffer_load_dwordx4 v[240:243], v6, s[28:31], s36 offen sc1
v_mfma_f32_16x16x32_bf16 v[40:43], a[104:107], v[120:123], v[40:43]
v_mfma_f32_16x16x32_bf16 v[44:47], a[104:107], v[124:127], v[44:47]
buffer_load_dwordx4 v[244:247], v7, s[28:31], s36 offen sc1
v_mfma_f32_16x16x32_bf16 v[32:35], a[144:147], v[192:195], v[32:35]
v_mfma_f32_16x16x32_bf16 v[36:39], a[144:147], v[196:199], v[36:39]
v_mfma_f32_16x16x32_bf16 v[40:43], a[144:147], v[200:203], v[40:43]
v_mfma_f32_16x16x32_bf16 v[44:47], a[144:147], v[204:207], v[44:47]
buffer_load_dwordx4 v[248:251], v8, s[28:31], s36 offen sc1
v_mfma_f32_16x16x32_bf16 v[48:51], a[108:111], v[112:115], v[48:51]
v_mfma_f32_16x16x32_bf16 v[52:55], a[108:111], v[116:119], v[52:55]
v_mfma_f32_16x16x32_bf16 v[56:59], a[108:111], v[120:123], v[56:59]
buffer_load_dwordx4 v[252:255], v9, s[28:31], s36 offen sc1
v_mfma_f32_16x16x32_bf16 v[60:63], a[108:111], v[124:127], v[60:63]
v_mfma_f32_16x16x32_bf16 v[48:51], a[148:151], v[192:195], v[48:51]
v_mfma_f32_16x16x32_bf16 v[52:55], a[148:151], v[196:199], v[52:55]
ds_write_b128 v18, v[32:35] offset:0
v_mfma_f32_16x16x32_bf16 v[56:59], a[148:151], v[200:203], v[56:59]
v_mfma_f32_16x16x32_bf16 v[60:63], a[148:151], v[204:207], v[60:63]
ds_write_b128 v19, v[36:39] offset:5120
v_mfma_f32_16x16x32_bf16 v[64:67], a[112:115], v[112:115], v[64:67]
v_mfma_f32_16x16x32_bf16 v[68:71], a[112:115], v[116:119], v[68:71]
ds_write_b128 v20, v[40:43] offset:10240
v_mfma_f32_16x16x32_bf16 v[72:75], a[112:115], v[120:123], v[72:75]
v_mfma_f32_16x16x32_bf16 v[76:79], a[112:115], v[124:127], v[76:79]
ds_write_b128 v21, v[44:47] offset:15360
v_mfma_f32_16x16x32_bf16 v[64:67], a[152:155], v[192:195], v[64:67]
v_mfma_f32_16x16x32_bf16 v[68:71], a[152:155], v[196:199], v[68:71]
ds_write_b128 v18, v[48:51] offset:1024
v_mfma_f32_16x16x32_bf16 v[72:75], a[152:155], v[200:203], v[72:75]
v_mfma_f32_16x16x32_bf16 v[76:79], a[152:155], v[204:207], v[76:79]
ds_write_b128 v19, v[52:55] offset:6144
v_mfma_f32_16x16x32_bf16 v[80:83], a[116:119], v[112:115], v[80:83]
v_mfma_f32_16x16x32_bf16 v[84:87], a[116:119], v[116:119], v[84:87]
ds_write_b128 v20, v[56:59] offset:11264
v_mfma_f32_16x16x32_bf16 v[88:91], a[116:119], v[120:123], v[88:91]
v_mfma_f32_16x16x32_bf16 v[92:95], a[116:119], v[124:127], v[92:95]
ds_write_b128 v21, v[60:63] offset:16384
v_mfma_f32_16x16x32_bf16 v[80:83], a[156:159], v[192:195], v[80:83]
v_mfma_f32_16x16x32_bf16 v[84:87], a[156:159], v[196:199], v[84:87]
ds_write_b128 v18, v[64:67] offset:2048
v_mfma_f32_16x16x32_bf16 v[88:91], a[156:159], v[200:203], v[88:91]
v_mfma_f32_16x16x32_bf16 v[92:95], a[156:159], v[204:207], v[92:95]
ds_write_b128 v19, v[68:71] offset:7168
v_mfma_f32_16x16x32_bf16 v[96:99], a[120:123], v[112:115], v[96:99]
v_mfma_f32_16x16x32_bf16 v[100:103], a[120:123], v[116:119], v[100:103]
ds_write_b128 v20, v[72:75] offset:12288
v_mfma_f32_16x16x32_bf16 v[104:107], a[120:123], v[120:123], v[104:107]
v_mfma_f32_16x16x32_bf16 v[108:111], a[120:123], v[124:127], v[108:111]
ds_write_b128 v21, v[76:79] offset:17408
v_mfma_f32_16x16x32_bf16 v[96:99], a[160:163], v[192:195], v[96:99]
v_mfma_f32_16x16x32_bf16 v[100:103], a[160:163], v[196:199], v[100:103]
ds_write_b128 v18, v[80:83] offset:3072
v_mfma_f32_16x16x32_bf16 v[104:107], a[160:163], v[200:203], v[104:107]
v_mfma_f32_16x16x32_bf16 v[108:111], a[160:163], v[204:207], v[108:111]
ds_write_b128 v19, v[84:87] offset:8192
s_nop 7
ds_write_b128 v20, v[88:91] offset:13312
ds_write_b128 v21, v[92:95] offset:18432
ds_write_b128 v18, v[96:99] offset:4096
ds_write_b128 v19, v[100:103] offset:9216
ds_write_b128 v20, v[104:107] offset:14336
ds_write_b128 v21, v[108:111] offset:19456
s_waitcnt vmcnt(8)
v_mfma_f32_16x16x32_bf16 v[32:35], v[128:131], v[208:211], 0
s_add_u32 s36, s87, 12288
v_mfma_f32_16x16x32_bf16 v[36:39], v[128:131], v[212:215], 0
buffer_load_dwordx4 v[112:115], v6, s[28:31], s36 offen sc1
v_mfma_f32_16x16x32_bf16 v[40:43], v[128:131], v[216:219], 0
v_mfma_f32_16x16x32_bf16 v[44:47], v[128:131], v[220:223], 0
s_waitcnt lgkmcnt(0)
v_mfma_f32_16x16x32_bf16 v[60:63], v[132:135], v[220:223], 0
s_barrier
v_mfma_f32_16x16x32_bf16 v[56:59], v[132:135], v[216:219], 0
buffer_load_dwordx4 v[116:119], v7, s[28:31], s36 offen sc1
v_mfma_f32_16x16x32_bf16 v[52:55], v[132:135], v[212:215], 0
ds_read_b128 v[192:195], v10 offset:0
v_mfma_f32_16x16x32_bf16 v[48:51], v[132:135], v[208:211], 0
ds_read_b128 v[196:199], v10 offset:5120
v_mfma_f32_16x16x32_bf16 v[64:67], v[136:139], v[208:211], 0
ds_read_b128 v[200:203], v10 offset:10240
v_mfma_f32_16x16x32_bf16 v[68:71], v[136:139], v[212:215], 0
ds_read_b128 v[204:207], v10 offset:15360
v_mfma_f32_16x16x32_bf16 v[72:75], v[136:139], v[216:219], 0
buffer_load_dwordx4 v[120:123], v8, s[28:31], s36 offen sc1
v_mfma_f32_16x16x32_bf16 v[76:79], v[136:139], v[220:223], 0
buffer_load_dwordx4 v[124:127], v9, s[28:31], s36 offen sc1
v_mfma_f32_16x16x32_bf16 v[92:95], v[140:143], v[220:223], 0
v_mfma_f32_16x16x32_bf16 v[88:91], v[140:143], v[216:219], 0
s_waitcnt lgkmcnt(0)
v_mfma_f32_16x16x32_bf16 v[84:87], v[140:143], v[212:215], 0
v_add_f32 v192, v192, v196
v_add_f32 v193, v193, v197
v_mfma_f32_16x16x32_bf16 v[80:83], v[140:143], v[208:211], 0
v_add_f32 v194, v194, v198
v_add_f32 v195, v195, v199
v_add_f32 v200, v200, v204
v_mfma_f32_16x16x32_bf16 v[96:99], v[144:147], v[208:211], 0
v_add_f32 v201, v201, v205
v_add_f32 v202, v202, v206
v_mfma_f32_16x16x32_bf16 v[100:103], v[144:147], v[212:215], 0
v_add_f32 v203, v203, v207
v_add_f32 v192, v192, v200
v_mfma_f32_16x16x32_bf16 v[104:107], v[144:147], v[216:219], 0
v_add_f32 v193, v193, v201
v_add_f32 v194, v194, v202
v_add_f32 v195, v195, v203
v_mfma_f32_16x16x32_bf16 v[108:111], v[144:147], v[220:223], 0
v_cvt_pk_bf16_f32 v22, v192, v193
v_cvt_pk_bf16_f32 v23, v194, v195
s_waitcnt vmcnt(8)
v_mfma_f32_16x16x32_bf16 v[32:35], v[148:151], v[224:227], v[32:35]
ds_read_b128 v[128:131], v10 offset:1024
s_add_u32 s36, s87, 16384
v_mfma_f32_16x16x32_bf16 v[36:39], v[148:151], v[228:231], v[36:39]
buffer_load_dwordx4 v[208:211], v6, s[28:31], s36 offen sc1
v_mfma_f32_16x16x32_bf16 v[40:43], v[148:151], v[232:235], v[40:43]
ds_read_b128 v[132:135], v10 offset:6144
v_mfma_f32_16x16x32_bf16 v[44:47], v[148:151], v[236:239], v[44:47]
ds_read_b128 v[136:139], v10 offset:11264
buffer_load_dwordx4 v[212:215], v7, s[28:31], s36 offen sc1
v_mfma_f32_16x16x32_bf16 v[60:63], v[152:155], v[236:239], v[60:63]
ds_read_b128 v[140:143], v10 offset:16384
v_mfma_f32_16x16x32_bf16 v[56:59], v[152:155], v[232:235], v[56:59]
ds_read_b128 v[192:195], v10 offset:2048
v_mfma_f32_16x16x32_bf16 v[52:55], v[152:155], v[228:231], v[52:55]
ds_read_b128 v[196:199], v10 offset:7168
v_mfma_f32_16x16x32_bf16 v[48:51], v[152:155], v[224:227], v[48:51]
ds_read_b128 v[200:203], v10 offset:12288
buffer_load_dwordx4 v[216:219], v8, s[28:31], s36 offen sc1
v_mfma_f32_16x16x32_bf16 v[64:67], v[156:159], v[224:227], v[64:67]
ds_read_b128 v[204:207], v10 offset:17408
s_waitcnt lgkmcnt(4)
v_mfma_f32_16x16x32_bf16 v[68:71], v[156:159], v[228:231], v[68:71]
v_add_f32 v128, v128, v132
v_add_f32 v129, v129, v133
v_add_f32 v130, v130, v134
v_add_f32 v131, v131, v135
v_add_f32 v136, v136, v140
v_add_f32 v137, v137, v141
v_mfma_f32_16x16x32_bf16 v[72:75], v[156:159], v[232:235], v[72:75]
buffer_load_dwordx4 v[220:223], v9, s[28:31], s36 offen sc1
v_add_f32 v138, v138, v142
v_mfma_f32_16x16x32_bf16 v[76:79], v[156:159], v[236:239], v[76:79]
v_add_f32 v139, v139, v143
v_add_f32 v128, v128, v136
v_add_f32 v129, v129, v137
v_mfma_f32_16x16x32_bf16 v[92:95], v[160:163], v[236:239], v[92:95]
v_add_f32 v130, v130, v138
v_add_f32 v131, v131, v139
v_mfma_f32_16x16x32_bf16 v[88:91], v[160:163], v[232:235], v[88:91]
v_cvt_pk_bf16_f32 v24, v128, v129
v_cvt_pk_bf16_f32 v25, v130, v131
s_waitcnt lgkmcnt(0)
v_mfma_f32_16x16x32_bf16 v[84:87], v[160:163], v[228:231], v[84:87]
v_add_f32 v192, v192, v196
v_add_f32 v193, v193, v197
v_add_f32 v194, v194, v198
v_mfma_f32_16x16x32_bf16 v[80:83], v[160:163], v[224:227], v[80:83]
v_add_f32 v195, v195, v199
v_add_f32 v200, v200, v204
v_mfma_f32_16x16x32_bf16 v[96:99], v[164:167], v[224:227], v[96:99]
buffer_store_dwordx4 v[22:25], v1, s[28:31], s91 offen offset:0 sc1
v_add_f32 v201, v201, v205
v_mfma_f32_16x16x32_bf16 v[100:103], v[164:167], v[228:231], v[100:103]
v_add_f32 v202, v202, v206
v_add_f32 v203, v203, v207
v_add_f32 v192, v192, v200
v_mfma_f32_16x16x32_bf16 v[104:107], v[164:167], v[232:235], v[104:107]
v_add_f32 v193, v193, v201
v_add_f32 v194, v194, v202
v_mfma_f32_16x16x32_bf16 v[108:111], v[164:167], v[236:239], v[108:111]
v_add_f32 v195, v195, v203
v_cvt_pk_bf16_f32 v26, v192, v193
v_cvt_pk_bf16_f32 v27, v194, v195
s_waitcnt vmcnt(9)
v_mfma_f32_16x16x32_bf16 v[32:35], v[168:171], v[240:243], v[32:35]
ds_read_b128 v[148:151], v10 offset:3072
s_add_u32 s36, s87, 20480
v_mfma_f32_16x16x32_bf16 v[36:39], v[168:171], v[244:247], v[36:39]
ds_read_b128 v[152:155], v10 offset:8192
buffer_load_dwordx4 v[224:227], v6, s[28:31], s36 offen sc1
v_mfma_f32_16x16x32_bf16 v[40:43], v[168:171], v[248:251], v[40:43]
ds_read_b128 v[156:159], v10 offset:13312
v_mfma_f32_16x16x32_bf16 v[44:47], v[168:171], v[252:255], v[44:47]
ds_read_b128 v[160:163], v10 offset:18432
buffer_load_dwordx4 v[228:231], v7, s[28:31], s36 offen sc1
v_mfma_f32_16x16x32_bf16 v[60:63], v[172:175], v[252:255], v[60:63]
ds_read_b128 v[128:131], v10 offset:4096
v_mfma_f32_16x16x32_bf16 v[56:59], v[172:175], v[248:251], v[56:59]
ds_read_b128 v[132:135], v10 offset:9216
v_mfma_f32_16x16x32_bf16 v[52:55], v[172:175], v[244:247], v[52:55]
ds_read_b128 v[136:139], v10 offset:14336
v_mfma_f32_16x16x32_bf16 v[48:51], v[172:175], v[240:243], v[48:51]
ds_read_b128 v[140:143], v10 offset:19456
buffer_load_dwordx4 v[232:235], v8, s[28:31], s36 offen sc1
v_mfma_f32_16x16x32_bf16 v[64:67], v[176:179], v[240:243], v[64:67]
s_waitcnt lgkmcnt(4)
v_mfma_f32_16x16x32_bf16 v[68:71], v[176:179], v[244:247], v[68:71]
v_add_f32 v148, v148, v152
v_add_f32 v149, v149, v153
v_add_f32 v150, v150, v154
v_add_f32 v151, v151, v155
v_add_f32 v156, v156, v160
v_add_f32 v157, v157, v161
v_add_f32 v158, v158, v162
v_mfma_f32_16x16x32_bf16 v[72:75], v[176:179], v[248:251], v[72:75]
buffer_load_dwordx4 v[236:239], v9, s[28:31], s36 offen sc1
v_add_f32 v159, v159, v163
v_mfma_f32_16x16x32_bf16 v[76:79], v[176:179], v[252:255], v[76:79]
v_add_f32 v148, v148, v156
v_add_f32 v149, v149, v157
v_add_f32 v150, v150, v158
v_mfma_f32_16x16x32_bf16 v[92:95], v[180:183], v[252:255], v[92:95]
v_add_f32 v151, v151, v159
v_mov_b64 v[22:23], v[26:27]
v_cvt_pk_bf16_f32 v24, v148, v149
v_mfma_f32_16x16x32_bf16 v[88:91], v[180:183], v[248:251], v[88:91]
v_cvt_pk_bf16_f32 v25, v150, v151
s_waitcnt lgkmcnt(0)
v_add_f32 v128, v128, v132
v_mfma_f32_16x16x32_bf16 v[84:87], v[180:183], v[244:247], v[84:87]
v_add_f32 v129, v129, v133
v_add_f32 v130, v130, v134
v_add_f32 v131, v131, v135
v_mfma_f32_16x16x32_bf16 v[80:83], v[180:183], v[240:243], v[80:83]
buffer_store_dwordx4 v[22:25], v1, s[28:31], s91 offen offset:1024 sc1
v_add_f32 v136, v136, v140
v_mfma_f32_16x16x32_bf16 v[96:99], v[184:187], v[240:243], v[96:99]
v_add_f32 v137, v137, v141
v_add_f32 v138, v138, v142
v_mfma_f32_16x16x32_bf16 v[100:103], v[184:187], v[244:247], v[100:103]
v_add_f32 v139, v139, v143
v_add_f32 v128, v128, v136
v_add_f32 v129, v129, v137
v_mfma_f32_16x16x32_bf16 v[104:107], v[184:187], v[248:251], v[104:107]
v_add_f32 v130, v130, v138
v_add_f32 v131, v131, v139
v_cvt_pk_bf16_f32 v128, v128, v129
v_mfma_f32_16x16x32_bf16 v[108:111], v[184:187], v[252:255], v[108:111]
v_cvt_pk_bf16_f32 v129, v130, v131
buffer_store_dwordx2 v[128:129], v30, s[28:31], s91 offen offset:2048 sc1
s_waitcnt vmcnt(11)
v_mfma_f32_16x16x32_bf16 v[32:35], a[244:247], v[112:115], v[32:35]
s_add_u32 s36, s87, 24576
v_mfma_f32_16x16x32_bf16 v[36:39], a[244:247], v[116:119], v[36:39]
buffer_load_dwordx4 v[192:195], v6, s[28:31], s36 offen sc1
v_mfma_f32_16x16x32_bf16 v[40:43], a[244:247], v[120:123], v[40:43]
buffer_load_dwordx4 v[196:199], v7, s[28:31], s36 offen sc1
v_mfma_f32_16x16x32_bf16 v[44:47], a[244:247], v[124:127], v[44:47]
v_mfma_f32_16x16x32_bf16 v[60:63], a[248:251], v[124:127], v[60:63]
buffer_load_dwordx4 v[200:203], v8, s[28:31], s36 offen sc1
v_mfma_f32_16x16x32_bf16 v[56:59], a[248:251], v[120:123], v[56:59]
v_mfma_f32_16x16x32_bf16 v[52:55], a[248:251], v[116:119], v[52:55]
v_mfma_f32_16x16x32_bf16 v[48:51], a[248:251], v[112:115], v[48:51]
buffer_load_dwordx4 v[204:207], v9, s[28:31], s36 offen sc1
v_mfma_f32_16x16x32_bf16 v[64:67], a[252:255], v[112:115], v[64:67]
s_add_u32 s36, s87, 28672
v_mfma_f32_16x16x32_bf16 v[68:71], a[252:255], v[116:119], v[68:71]
buffer_load_dwordx4 v[240:243], v6, s[28:31], s36 offen sc1
v_mfma_f32_16x16x32_bf16 v[72:75], a[252:255], v[120:123], v[72:75]
v_mfma_f32_16x16x32_bf16 v[76:79], a[252:255], v[124:127], v[76:79]
buffer_load_dwordx4 v[244:247], v7, s[28:31], s36 offen sc1
v_mfma_f32_16x16x32_bf16 v[92:95], a[60:63], v[124:127], v[92:95]
v_mfma_f32_16x16x32_bf16 v[88:91], a[60:63], v[120:123], v[88:91]
v_mfma_f32_16x16x32_bf16 v[84:87], a[60:63], v[116:119], v[84:87]
buffer_load_dwordx4 v[248:251], v8, s[28:31], s36 offen sc1
v_mfma_f32_16x16x32_bf16 v[80:83], a[60:63], v[112:115], v[80:83]
v_mfma_f32_16x16x32_bf16 v[96:99], v[188:191], v[112:115], v[96:99]
buffer_load_dwordx4 v[252:255], v9, s[28:31], s36 offen sc1
v_mfma_f32_16x16x32_bf16 v[100:103], v[188:191], v[116:119], v[100:103]
v_mfma_f32_16x16x32_bf16 v[104:107], v[188:191], v[120:123], v[104:107]
v_mfma_f32_16x16x32_bf16 v[108:111], v[188:191], v[124:127], v[108:111]
s_waitcnt vmcnt(15)
v_mfma_f32_16x16x32_bf16 v[32:35], a[64:67], v[208:211], v[32:35]
s_add_u32 s36, s87, 32768
v_mfma_f32_16x16x32_bf16 v[36:39], a[64:67], v[212:215], v[36:39]
buffer_load_dwordx4 v[112:115], v6, s[28:31], s36 offen sc1
v_mfma_f32_16x16x32_bf16 v[40:43], a[64:67], v[216:219], v[40:43]
v_mfma_f32_16x16x32_bf16 v[44:47], a[64:67], v[220:223], v[44:47]
v_mfma_f32_16x16x32_bf16 v[60:63], a[68:71], v[220:223], v[60:63]
buffer_load_dwordx4 v[116:119], v7, s[28:31], s36 offen sc1
v_mfma_f32_16x16x32_bf16 v[56:59], a[68:71], v[216:219], v[56:59]
v_mfma_f32_16x16x32_bf16 v[52:55], a[68:71], v[212:215], v[52:55]
v_mfma_f32_16x16x32_bf16 v[48:51], a[68:71], v[208:211], v[48:51]
v_mfma_f32_16x16x32_bf16 v[64:67], a[72:75], v[208:211], v[64:67]
v_mfma_f32_16x16x32_bf16 v[68:71], a[72:75], v[212:215], v[68:71]
buffer_load_dwordx4 v[120:123], v8, s[28:31], s36 offen sc1
v_mfma_f32_16x16x32_bf16 v[72:75], a[72:75], v[216:219], v[72:75]
v_mfma_f32_16x16x32_bf16 v[76:79], a[72:75], v[220:223], v[76:79]
v_mfma_f32_16x16x32_bf16 v[92:95], a[76:79], v[220:223], v[92:95]
v_mfma_f32_16x16x32_bf16 v[88:91], a[76:79], v[216:219], v[88:91]
v_mfma_f32_16x16x32_bf16 v[84:87], a[76:79], v[212:215], v[84:87]
buffer_load_dwordx4 v[124:127], v9, s[28:31], s36 offen sc1
v_mfma_f32_16x16x32_bf16 v[80:83], a[76:79], v[208:211], v[80:83]
v_mfma_f32_16x16x32_bf16 v[96:99], a[80:83], v[208:211], v[96:99]
v_mfma_f32_16x16x32_bf16 v[100:103], a[80:83], v[212:215], v[100:103]
v_mfma_f32_16x16x32_bf16 v[104:107], a[80:83], v[216:219], v[104:107]
v_mfma_f32_16x16x32_bf16 v[108:111], a[80:83], v[220:223], v[108:111]
s_waitcnt vmcnt(12)
v_mfma_f32_16x16x32_bf16 v[32:35], a[84:87], v[224:227], v[32:35]
s_add_u32 s36, s87, 36864
v_mfma_f32_16x16x32_bf16 v[36:39], a[84:87], v[228:231], v[36:39]
buffer_load_dwordx4 v[208:211], v6, s[28:31], s36 offen sc1
v_mfma_f32_16x16x32_bf16 v[40:43], a[84:87], v[232:235], v[40:43]
v_mfma_f32_16x16x32_bf16 v[44:47], a[84:87], v[236:239], v[44:47]
buffer_load_dwordx4 v[212:215], v7, s[28:31], s36 offen sc1
v_mfma_f32_16x16x32_bf16 v[60:63], a[88:91], v[236:239], v[60:63]
v_mfma_f32_16x16x32_bf16 v[56:59], a[88:91], v[232:235], v[56:59]
v_mfma_f32_16x16x32_bf16 v[52:55], a[88:91], v[228:231], v[52:55]
v_mfma_f32_16x16x32_bf16 v[48:51], a[88:91], v[224:227], v[48:51]
buffer_load_dwordx4 v[216:219], v8, s[28:31], s36 offen sc1
v_mfma_f32_16x16x32_bf16 v[64:67], a[92:95], v[224:227], v[64:67]
v_mfma_f32_16x16x32_bf16 v[68:71], a[92:95], v[228:231], v[68:71]
v_mfma_f32_16x16x32_bf16 v[72:75], a[92:95], v[232:235], v[72:75]
v_mfma_f32_16x16x32_bf16 v[76:79], a[92:95], v[236:239], v[76:79]
buffer_load_dwordx4 v[220:223], v9, s[28:31], s36 offen sc1
v_mfma_f32_16x16x32_bf16 v[92:95], a[96:99], v[236:239], v[92:95]
v_mfma_f32_16x16x32_bf16 v[88:91], a[96:99], v[232:235], v[88:91]
v_mfma_f32_16x16x32_bf16 v[84:87], a[96:99], v[228:231], v[84:87]
v_mfma_f32_16x16x32_bf16 v[80:83], a[96:99], v[224:227], v[80:83]
buffer_store_dword v4, v5, s[28:31], s43 offen sc1
v_mfma_f32_16x16x32_bf16 v[96:99], a[100:103], v[224:227], v[96:99]
v_mfma_f32_16x16x32_bf16 v[100:103], a[100:103], v[228:231], v[100:103]
v_mfma_f32_16x16x32_bf16 v[104:107], a[100:103], v[232:235], v[104:107]
v_mfma_f32_16x16x32_bf16 v[108:111], a[100:103], v[236:239], v[108:111]
s_waitcnt vmcnt(13)
v_mfma_f32_16x16x32_bf16 v[32:35], a[224:227], v[192:195], v[32:35]
s_add_u32 s36, s87, 40960
s_and_b32 s50, s61, 1
v_mfma_f32_16x16x32_bf16 v[36:39], a[224:227], v[196:199], v[36:39]
buffer_load_dwordx4 a[64:67], v6, s[28:31], s36 offen sc1
v_mfma_f32_16x16x32_bf16 v[40:43], a[224:227], v[200:203], v[40:43]
s_lshl_b32 s50, s50, 1
s_mul_i32 s51, s3, 3
v_mfma_f32_16x16x32_bf16 v[44:47], a[224:227], v[204:207], v[44:47]
s_add_u32 s50, s50, s51
s_sub_u32 s39, 9, s50
v_mfma_f32_16x16x32_bf16 v[60:63], a[228:231], v[204:207], v[60:63]
s_and_b32 s50, s39, 2146435072
s_or_b32 s37, s37, s50
v_mfma_f32_16x16x32_bf16 v[56:59], a[228:231], v[200:203], v[56:59]
v_and_b32 v12, 1, v2
v_mad_u32_u24 v12, v12, 24, v13
v_mfma_f32_16x16x32_bf16 v[52:55], a[228:231], v[196:199], v[52:55]
s_mul_i32 s50, s3, 15360
s_add_u32 s50, s50, 81920
v_mfma_f32_16x16x32_bf16 v[48:51], a[228:231], v[192:195], v[48:51]
v_add_u32 v10, s50, v1
v_add_u32 v11, 81920, v1
v_mfma_f32_16x16x32_bf16 v[64:67], a[232:235], v[192:195], v[64:67]
v_sub_u32 v19, v7, v1
v_mad_u32_u24 v19, v19, 15, v11
v_mfma_f32_16x16x32_bf16 v[68:71], a[232:235], v[196:199], v[68:71]
v_sub_u32 v20, v8, v1
v_mad_u32_u24 v20, v20, 15, v11
v_mfma_f32_16x16x32_bf16 v[72:75], a[232:235], v[200:203], v[72:75]
v_sub_u32 v21, v9, v1
v_mad_u32_u24 v21, v21, 15, v11
v_mfma_f32_16x16x32_bf16 v[76:79], a[232:235], v[204:207], v[76:79]
buffer_load_dwordx4 a[68:71], v7, s[28:31], s36 offen sc1
v_mfma_f32_16x16x32_bf16 v[92:95], a[236:239], v[204:207], v[92:95]
buffer_load_dwordx4 a[72:75], v8, s[28:31], s36 offen sc1
v_mfma_f32_16x16x32_bf16 v[88:91], a[236:239], v[200:203], v[88:91]
v_mfma_f32_16x16x32_bf16 v[84:87], a[236:239], v[196:199], v[84:87]
buffer_load_dwordx4 a[76:79], v9, s[28:31], s36 offen sc1
v_mfma_f32_16x16x32_bf16 v[80:83], a[236:239], v[192:195], v[80:83]
v_mfma_f32_16x16x32_bf16 v[96:99], a[240:243], v[192:195], v[96:99]
v_mfma_f32_16x16x32_bf16 v[100:103], a[240:243], v[196:199], v[100:103]
v_mfma_f32_16x16x32_bf16 v[104:107], a[240:243], v[200:203], v[104:107]
v_mfma_f32_16x16x32_bf16 v[108:111], a[240:243], v[204:207], v[108:111]
s_waitcnt vmcnt(13)
v_mfma_f32_16x16x32_bf16 v[32:35], a[0:3], v[240:243], v[32:35]
s_add_u32 s36, s87, 45056
v_mfma_f32_16x16x32_bf16 v[36:39], a[0:3], v[244:247], v[36:39]
buffer_load_dwordx4 v[224:227], v6, s[28:31], s36 offen sc1
v_mfma_f32_16x16x32_bf16 v[40:43], a[0:3], v[248:251], v[40:43]
v_mfma_f32_16x16x32_bf16 v[44:47], a[0:3], v[252:255], v[44:47]
v_mfma_f32_16x16x32_bf16 v[60:63], a[4:7], v[252:255], v[60:63]
buffer_load_dwordx4 v[228:231], v7, s[28:31], s36 offen sc1
v_mfma_f32_16x16x32_bf16 v[56:59], a[4:7], v[248:251], v[56:59]
v_mfma_f32_16x16x32_bf16 v[52:55], a[4:7], v[244:247], v[52:55]
v_mfma_f32_16x16x32_bf16 v[48:51], a[4:7], v[240:243], v[48:51]
v_mfma_f32_16x16x32_bf16 v[64:67], a[8:11], v[240:243], v[64:67]
v_mfma_f32_16x16x32_bf16 v[68:71], a[8:11], v[244:247], v[68:71]
buffer_load_dwordx4 v[232:235], v8, s[28:31], s36 offen sc1
v_mfma_f32_16x16x32_bf16 v[72:75], a[8:11], v[248:251], v[72:75]
v_mfma_f32_16x16x32_bf16 v[76:79], a[8:11], v[252:255], v[76:79]
v_mfma_f32_16x16x32_bf16 v[92:95], a[12:15], v[252:255], v[92:95]
v_mfma_f32_16x16x32_bf16 v[88:91], a[12:15], v[248:251], v[88:91]
v_mfma_f32_16x16x32_bf16 v[84:87], a[12:15], v[244:247], v[84:87]
buffer_load_dwordx4 v[236:239], v9, s[28:31], s36 offen sc1
v_mfma_f32_16x16x32_bf16 v[80:83], a[12:15], v[240:243], v[80:83]
v_mfma_f32_16x16x32_bf16 v[96:99], a[16:19], v[240:243], v[96:99]
v_mfma_f32_16x16x32_bf16 v[100:103], a[16:19], v[244:247], v[100:103]
v_mfma_f32_16x16x32_bf16 v[104:107], a[16:19], v[248:251], v[104:107]
v_mfma_f32_16x16x32_bf16 v[108:111], a[16:19], v[252:255], v[108:111]
s_waitcnt vmcnt(13)
v_mfma_f32_16x16x32_bf16 v[32:35], a[20:23], v[112:115], v[32:35]
s_add_u32 s36, s87, 49152
v_mfma_f32_16x16x32_bf16 v[36:39], a[20:23], v[116:119], v[36:39]
buffer_load_dwordx4 a[84:87], v6, s[28:31], s36 offen sc1
v_mfma_f32_16x16x32_bf16 v[40:43], a[20:23], v[120:123], v[40:43]
v_mfma_f32_16x16x32_bf16 v[44:47], a[20:23], v[124:127], v[44:47]
v_mfma_f32_16x16x32_bf16 v[60:63], a[24:27], v[124:127], v[60:63]
buffer_load_dwordx4 a[88:91], v7, s[28:31], s36 offen sc1
v_mfma_f32_16x16x32_bf16 v[56:59], a[24:27], v[120:123], v[56:59]
v_mfma_f32_16x16x32_bf16 v[52:55], a[24:27], v[116:119], v[52:55]
v_mfma_f32_16x16x32_bf16 v[48:51], a[24:27], v[112:115], v[48:51]
v_mfma_f32_16x16x32_bf16 v[64:67], a[28:31], v[112:115], v[64:67]
v_mfma_f32_16x16x32_bf16 v[68:71], a[28:31], v[116:119], v[68:71]
buffer_load_dwordx4 a[92:95], v8, s[28:31], s36 offen sc1
v_mfma_f32_16x16x32_bf16 v[72:75], a[28:31], v[120:123], v[72:75]
v_mfma_f32_16x16x32_bf16 v[76:79], a[28:31], v[124:127], v[76:79]
v_mfma_f32_16x16x32_bf16 v[92:95], a[32:35], v[124:127], v[92:95]
v_mfma_f32_16x16x32_bf16 v[88:91], a[32:35], v[120:123], v[88:91]
v_mfma_f32_16x16x32_bf16 v[84:87], a[32:35], v[116:119], v[84:87]
buffer_load_dwordx4 a[96:99], v9, s[28:31], s36 offen sc1
v_mfma_f32_16x16x32_bf16 v[80:83], a[32:35], v[112:115], v[80:83]
v_mfma_f32_16x16x32_bf16 v[96:99], a[36:39], v[112:115], v[96:99]
v_mfma_f32_16x16x32_bf16 v[100:103], a[36:39], v[116:119], v[100:103]
v_mfma_f32_16x16x32_bf16 v[104:107], a[36:39], v[120:123], v[104:107]
v_mfma_f32_16x16x32_bf16 v[108:111], a[36:39], v[124:127], v[108:111]
s_waitcnt vmcnt(13)
v_mfma_f32_16x16x32_bf16 v[32:35], a[40:43], v[208:211], v[32:35]
s_add_u32 s36, s87, 53248
v_mfma_f32_16x16x32_bf16 v[36:39], a[40:43], v[212:215], v[36:39]
buffer_load_dwordx4 v[192:195], v6, s[28:31], s36 offen sc1
v_mfma_f32_16x16x32_bf16 v[40:43], a[40:43], v[216:219], v[40:43]
buffer_load_dwordx4 v[196:199], v7, s[28:31], s36 offen sc1
v_mfma_f32_16x16x32_bf16 v[44:47], a[40:43], v[220:223], v[44:47]
v_mfma_f32_16x16x32_bf16 v[60:63], a[44:47], v[220:223], v[60:63]
buffer_load_dwordx4 v[200:203], v8, s[28:31], s36 offen sc1
v_mfma_f32_16x16x32_bf16 v[56:59], a[44:47], v[216:219], v[56:59]
v_mfma_f32_16x16x32_bf16 v[52:55], a[44:47], v[212:215], v[52:55]
buffer_load_dwordx4 v[204:207], v9, s[28:31], s36 offen sc1
v_mfma_f32_16x16x32_bf16 v[48:51], a[44:47], v[208:211], v[48:51]
s_add_u32 s36, s87, 57344
v_mfma_f32_16x16x32_bf16 v[64:67], a[48:51], v[208:211], v[64:67]
buffer_load_dwordx4 a[224:227], v6, s[28:31], s36 offen sc1
v_mfma_f32_16x16x32_bf16 v[68:71], a[48:51], v[212:215], v[68:71]
v_mfma_f32_16x16x32_bf16 v[72:75], a[48:51], v[216:219], v[72:75]
buffer_load_dwordx4 a[228:231], v7, s[28:31], s36 offen sc1
v_mfma_f32_16x16x32_bf16 v[76:79], a[48:51], v[220:223], v[76:79]
v_mfma_f32_16x16x32_bf16 v[92:95], a[52:55], v[220:223], v[92:95]
buffer_load_dwordx4 a[232:235], v8, s[28:31], s36 offen sc1
v_mfma_f32_16x16x32_bf16 v[88:91], a[52:55], v[216:219], v[88:91]
v_mfma_f32_16x16x32_bf16 v[84:87], a[52:55], v[212:215], v[84:87]
buffer_load_dwordx4 a[236:239], v9, s[28:31], s36 offen sc1
v_mfma_f32_16x16x32_bf16 v[80:83], a[52:55], v[208:211], v[80:83]
v_mfma_f32_16x16x32_bf16 v[96:99], a[56:59], v[208:211], v[96:99]
buffer_load_dword v22, v1, s[28:31], s64 offen sc1
v_mfma_f32_16x16x32_bf16 v[100:103], a[56:59], v[212:215], v[100:103]
v_mfma_f32_16x16x32_bf16 v[104:107], a[56:59], v[216:219], v[104:107]
v_mfma_f32_16x16x32_bf16 v[108:111], a[56:59], v[220:223], v[108:111]
s_waitcnt vmcnt(17)
v_mfma_f32_16x16x32_bf16 v[32:35], a[124:127], a[64:67], v[32:35]
s_add_u32 s36, s87, 61440
v_mfma_f32_16x16x32_bf16 v[36:39], a[124:127], a[68:71], v[36:39]
buffer_load_dwordx4 v[240:243], v6, s[28:31], s36 offen sc1
v_mfma_f32_16x16x32_bf16 v[40:43], a[124:127], a[72:75], v[40:43]
v_mfma_f32_16x16x32_bf16 v[44:47], a[124:127], a[76:79], v[44:47]
v_mfma_f32_16x16x32_bf16 v[60:63], a[128:131], a[76:79], v[60:63]
buffer_load_dwordx4 v[244:247], v7, s[28:31], s36 offen sc1
v_mfma_f32_16x16x32_bf16 v[56:59], a[128:131], a[72:75], v[56:59]
v_mfma_f32_16x16x32_bf16 v[52:55], a[128:131], a[68:71], v[52:55]
v_mfma_f32_16x16x32_bf16 v[48:51], a[128:131], a[64:67], v[48:51]
v_mfma_f32_16x16x32_bf16 v[64:67], a[132:135], a[64:67], v[64:67]
v_mfma_f32_16x16x32_bf16 v[68:71], a[132:135], a[68:71], v[68:71]
buffer_load_dwordx4 v[248:251], v8, s[28:31], s36 offen sc1
v_mfma_f32_16x16x32_bf16 v[72:75], a[132:135], a[72:75], v[72:75]
v_mfma_f32_16x16x32_bf16 v[76:79], a[132:135], a[76:79], v[76:79]
v_mfma_f32_16x16x32_bf16 v[92:95], a[136:139], a[76:79], v[92:95]
v_mfma_f32_16x16x32_bf16 v[88:91], a[136:139], a[72:75], v[88:91]
v_mfma_f32_16x16x32_bf16 v[84:87], a[136:139], a[68:71], v[84:87]
buffer_load_dwordx4 v[252:255], v9, s[28:31], s36 offen sc1
v_mfma_f32_16x16x32_bf16 v[80:83], a[136:139], a[64:67], v[80:83]
v_mfma_f32_16x16x32_bf16 v[96:99], a[140:143], a[64:67], v[96:99]
v_mfma_f32_16x16x32_bf16 v[100:103], a[140:143], a[68:71], v[100:103]
v_mfma_f32_16x16x32_bf16 v[104:107], a[140:143], a[72:75], v[104:107]
v_mfma_f32_16x16x32_bf16 v[108:111], a[140:143], a[76:79], v[108:111]
s_waitcnt vmcnt(17)
v_mfma_f32_16x16x32_bf16 v[32:35], a[164:167], v[224:227], v[32:35]
buffer_load_dwordx2 v[160:161], v13, s[16:19], 0 offen offset:0
v_mfma_f32_16x16x32_bf16 v[36:39], a[164:167], v[228:231], v[36:39]
v_mfma_f32_16x16x32_bf16 v[40:43], a[164:167], v[232:235], v[40:43]
v_mfma_f32_16x16x32_bf16 v[44:47], a[164:167], v[236:239], v[44:47]
buffer_load_dwordx2 v[162:163], v13, s[16:19], 0 offen offset:32
v_mfma_f32_16x16x32_bf16 v[60:63], a[168:171], v[236:239], v[60:63]
v_mfma_f32_16x16x32_bf16 v[56:59], a[168:171], v[232:235], v[56:59]
v_mfma_f32_16x16x32_bf16 v[52:55], a[168:171], v[228:231], v[52:55]
v_mfma_f32_16x16x32_bf16 v[48:51], a[168:171], v[224:227], v[48:51]
buffer_load_dwordx2 v[164:165], v13, s[16:19], 0 offen offset:64
v_mfma_f32_16x16x32_bf16 v[64:67], a[172:175], v[224:227], v[64:67]
v_mfma_f32_16x16x32_bf16 v[68:71], a[172:175], v[228:231], v[68:71]
v_mfma_f32_16x16x32_bf16 v[72:75], a[172:175], v[232:235], v[72:75]
v_mfma_f32_16x16x32_bf16 v[76:79], a[172:175], v[236:239], v[76:79]
buffer_load_dwordx2 v[166:167], v13, s[16:19], 0 offen offset:96
v_mfma_f32_16x16x32_bf16 v[92:95], a[176:179], v[236:239], v[92:95]
v_mfma_f32_16x16x32_bf16 v[88:91], a[176:179], v[232:235], v[88:91]
v_mfma_f32_16x16x32_bf16 v[84:87], a[176:179], v[228:231], v[84:87]
v_mfma_f32_16x16x32_bf16 v[80:83], a[176:179], v[224:227], v[80:83]
buffer_load_dwordx2 v[168:169], v13, s[16:19], 0 offen offset:128
v_mfma_f32_16x16x32_bf16 v[96:99], a[180:183], v[224:227], v[96:99]
v_mfma_f32_16x16x32_bf16 v[100:103], a[180:183], v[228:231], v[100:103]
v_mfma_f32_16x16x32_bf16 v[104:107], a[180:183], v[232:235], v[104:107]
v_mfma_f32_16x16x32_bf16 v[108:111], a[180:183], v[236:239], v[108:111]
s_waitcnt vmcnt(9)
v_cmp_eq_u32 vcc, 0, v22
s_cbranch_vccnz L_sp4_K
L_sp4b_K:
s_barrier
v_mfma_f32_16x16x32_bf16 v[32:35], a[184:187], a[84:87], v[32:35]
buffer_load_dwordx4 v[148:151], v14, s[28:31], s37 offen sc1
v_mfma_f32_16x16x32_bf16 v[36:39], a[184:187], a[88:91], v[36:39]
v_mfma_f32_16x16x32_bf16 v[40:43], a[184:187], a[92:95], v[40:43]
v_mfma_f32_16x16x32_bf16 v[44:47], a[184:187], a[96:99], v[44:47]
s_add_u32 s37, s37, 32768
s_cmp_lt_u32 s39, 1
v_mfma_f32_16x16x32_bf16 v[60:63], a[188:191], a[96:99], v[60:63]
s_cselect_b32 s37, 2146435072, s37
v_mfma_f32_16x16x32_bf16 v[56:59], a[188:191], a[92:95], v[56:59]
buffer_load_dwordx4 v[152:155], v14, s[28:31], s37 offen sc1
v_mfma_f32_16x16x32_bf16 v[52:55], a[188:191], a[88:91], v[52:55]
v_mfma_f32_16x16x32_bf16 v[48:51], a[188:191], a[84:87], v[48:51]
v_mfma_f32_16x16x32_bf16 v[64:67], a[192:195], a[84:87], v[64:67]
s_add_u32 s37, s37, 32768
s_cmp_lt_u32 s39, 2
v_mfma_f32_16x16x32_bf16 v[68:71], a[192:195], a[88:91], v[68:71]
s_cselect_b32 s37, 2146435072, s37
v_mfma_f32_16x16x32_bf16 v[72:75], a[192:195], a[92:95], v[72:75]
buffer_load_dwordx4 v[156:159], v14, s[28:31], s37 offen sc1
v_mfma_f32_16x16x32_bf16 v[76:79], a[192:195], a[96:99], v[76:79]
v_mfma_f32_16x16x32_bf16 v[92:95], a[196:199], a[96:99], v[92:95]
v_mfma_f32_16x16x32_bf16 v[88:91], a[196:199], a[92:95], v[88:91]
v_mfma_f32_16x16x32_bf16 v[84:87], a[196:199], a[88:91], v[84:87]
buffer_load_dword v22, v17, s[28:31], s65 offen sc1
v_mfma_f32_16x16x32_bf16 v[80:83], a[196:199], a[84:87], v[80:83]
v_mfma_f32_16x16x32_bf16 v[96:99], a[200:203], a[84:87], v[96:99]
v_mfma_f32_16x16x32_bf16 v[100:103], a[200:203], a[88:91], v[100:103]
v_mfma_f32_16x16x32_bf16 v[104:107], a[200:203], a[92:95], v[104:107]
v_mfma_f32_16x16x32_bf16 v[108:111], a[200:203], a[96:99], v[108:111]
s_waitcnt vmcnt(9)
v_mfma_f32_16x16x32_bf16 v[32:35], a[204:207], v[192:195], v[32:35]
v_mfma_f32_16x16x32_bf16 v[36:39], a[204:207], v[196:199], v[36:39]
v_mfma_f32_16x16x32_bf16 v[40:43], a[204:207], v[200:203], v[40:43]
v_mfma_f32_16x16x32_bf16 v[44:47], a[204:207], v[204:207], v[44:47]
buffer_load_dword v11, off, s[28:31], s42 sc1
v_mfma_f32_16x16x32_bf16 v[32:35], a[104:107], a[224:227], v[32:35]
v_mfma_f32_16x16x32_bf16 v[36:39], a[104:107], a[228:231], v[36:39]
v_mfma_f32_16x16x32_bf16 v[40:43], a[104:107], a[232:235], v[40:43]
v_mfma_f32_16x16x32_bf16 v[44:47], a[104:107], a[236:239], v[44:47]
v_mfma_f32_16x16x32_bf16 v[32:35], a[144:147], v[240:243], v[32:35]
v_mfma_f32_16x16x32_bf16 v[36:39], a[144:147], v[244:247], v[36:39]
v_mfma_f32_16x16x32_bf16 v[40:43], a[144:147], v[248:251], v[40:43]
v_mfma_f32_16x16x32_bf16 v[44:47], a[144:147], v[252:255], v[44:47]
v_mfma_f32_16x16x32_bf16 v[48:51], a[208:211], v[192:195], v[48:51]
v_mfma_f32_16x16x32_bf16 v[52:55], a[208:211], v[196:199], v[52:55]
v_mfma_f32_16x16x32_bf16 v[56:59], a[208:211], v[200:203], v[56:59]
v_mfma_f32_16x16x32_bf16 v[60:63], a[208:211], v[204:207], v[60:63]
v_mfma_f32_16x16x32_bf16 v[48:51], a[108:111], a[224:227], v[48:51]
v_mfma_f32_16x16x32_bf16 v[52:55], a[108:111], a[228:231], v[52:55]
ds_write_b128 v19, v[36:39] offset:0
v_mfma_f32_16x16x32_bf16 v[56:59], a[108:111], a[232:235], v[56:59]
v_mfma_f32_16x16x32_bf16 v[60:63], a[108:111], a[236:239], v[60:63]
v_mfma_f32_16x16x32_bf16 v[48:51], a[148:151], v[240:243], v[48:51]
v_mfma_f32_16x16x32_bf16 v[52:55], a[148:151], v[244:247], v[52:55]
ds_write_b128 v20, v[40:43] offset:5120
v_mfma_f32_16x16x32_bf16 v[56:59], a[148:151], v[248:251], v[56:59]
v_mfma_f32_16x16x32_bf16 v[60:63], a[148:151], v[252:255], v[60:63]
v_mfma_f32_16x16x32_bf16 v[64:67], a[212:215], v[192:195], v[64:67]
v_mfma_f32_16x16x32_bf16 v[68:71], a[212:215], v[196:199], v[68:71]
ds_write_b128 v21, v[44:47] offset:10240
v_mfma_f32_16x16x32_bf16 v[72:75], a[212:215], v[200:203], v[72:75]
v_mfma_f32_16x16x32_bf16 v[76:79], a[212:215], v[204:207], v[76:79]
v_mfma_f32_16x16x32_bf16 v[64:67], a[112:115], a[224:227], v[64:67]
v_mfma_f32_16x16x32_bf16 v[68:71], a[112:115], a[228:231], v[68:71]
ds_write_b128 v19, v[52:55] offset:1024
v_mfma_f32_16x16x32_bf16 v[72:75], a[112:115], a[232:235], v[72:75]
v_mfma_f32_16x16x32_bf16 v[76:79], a[112:115], a[236:239], v[76:79]
v_mfma_f32_16x16x32_bf16 v[64:67], a[152:155], v[240:243], v[64:67]
v_mfma_f32_16x16x32_bf16 v[68:71], a[152:155], v[244:247], v[68:71]
ds_write_b128 v20, v[56:59] offset:6144
v_mfma_f32_16x16x32_bf16 v[72:75], a[152:155], v[248:251], v[72:75]
v_mfma_f32_16x16x32_bf16 v[76:79], a[152:155], v[252:255], v[76:79]
v_mfma_f32_16x16x32_bf16 v[80:83], a[216:219], v[192:195], v[80:83]
v_mfma_f32_16x16x32_bf16 v[84:87], a[216:219], v[196:199], v[84:87]
ds_write_b128 v21, v[60:63] offset:11264
v_mfma_f32_16x16x32_bf16 v[88:91], a[216:219], v[200:203], v[88:91]
s_waitcnt vmcnt(0)
v_cmp_eq_u32 vcc, 0, v11
s_cbranch_vccnz L_sp5_K
L_sp5b_K:
v_mfma_f32_16x16x32_bf16 v[92:95], a[216:219], v[204:207], v[92:95]
buffer_load_dwordx4 v[138:141], v1, s[28:31], s90 offen sc1
v_sub_f32 v24, 1.0, v22
v_mov_b32 v25, v24
v_lshlrev_b32 v170, 16, v160
v_and_b32 v171, 0xffff0000, v160
v_mul_f32 v170, v170, v22
v_mul_f32 v171, v171, v22
v_lshlrev_b32 v172, 16, v161
v_and_b32 v173, 0xffff0000, v161
v_mfma_f32_16x16x32_bf16 v[80:83], a[116:119], a[224:227], v[80:83]
v_mul_f32 v172, v172, v22
v_mul_f32 v173, v173, v22
v_mfma_f32_16x16x32_bf16 v[84:87], a[116:119], a[228:231], v[84:87]
ds_write_b128 v19, v[68:71] offset:2048
v_lshlrev_b32 v174, 16, v162
v_mfma_f32_16x16x32_bf16 v[88:91], a[116:119], a[232:235], v[88:91]
ds_write_b128 v15, v[148:151] offset:0
v_and_b32 v175, 0xffff0000, v162
v_mfma_f32_16x16x32_bf16 v[92:95], a[116:119], a[236:239], v[92:95]
v_mul_f32 v174, v174, v22
v_mul_f32 v175, v175, v22
v_mfma_f32_16x16x32_bf16 v[80:83], a[156:159], v[240:243], v[80:83]
buffer_load_dwordx4 v[142:145], v1, s[28:31], s90 offen offset:1024 sc1
v_lshlrev_b32 v176, 16, v163
v_mfma_f32_16x16x32_bf16 v[84:87], a[156:159], v[244:247], v[84:87]
ds_write_b128 v20, v[72:75] offset:7168
v_and_b32 v177, 0xffff0000, v163
v_mfma_f32_16x16x32_bf16 v[88:91], a[156:159], v[248:251], v[88:91]
buffer_load_dwordx2 v[146:147], v30, s[28:31], s90 offen offset:2048 sc1
v_mul_f32 v176, v176, v22
v_mfma_f32_16x16x32_bf16 v[92:95], a[156:159], v[252:255], v[92:95]
v_mul_f32 v177, v177, v22
v_lshlrev_b32 v178, 16, v164
v_mfma_f32_16x16x32_bf16 v[96:99], a[220:223], v[192:195], v[96:99]
ds_write_b128 v15, v[152:155] offset:1024
v_and_b32 v179, 0xffff0000, v164
v_mfma_f32_16x16x32_bf16 v[100:103], a[220:223], v[196:199], v[100:103]
ds_write_b128 v21, v[76:79] offset:12288
v_mul_f32 v178, v178, v22
v_mfma_f32_16x16x32_bf16 v[104:107], a[220:223], v[200:203], v[104:107]
v_mul_f32 v179, v179, v22
v_lshlrev_b32 v180, 16, v165
v_and_b32 v181, 0xffff0000, v165
v_mfma_f32_16x16x32_bf16 v[108:111], a[220:223], v[204:207], v[108:111]
v_mul_f32 v180, v180, v22
v_mul_f32 v181, v181, v22
v_mfma_f32_16x16x32_bf16 v[96:99], a[120:123], a[224:227], v[96:99]
v_lshlrev_b32 v182, 16, v166
v_and_b32 v183, 0xffff0000, v166
v_mul_f32 v182, v182, v22
v_mfma_f32_16x16x32_bf16 v[100:103], a[120:123], a[228:231], v[100:103]
ds_write_b128 v19, v[84:87] offset:3072
v_mul_f32 v183, v183, v22
v_mfma_f32_16x16x32_bf16 v[104:107], a[120:123], a[232:235], v[104:107]
ds_write_b128 v15, v[156:159] offset:2048
v_mfma_f32_16x16x32_bf16 v[108:111], a[120:123], a[236:239], v[108:111]
v_lshlrev_b32 v184, 16, v167
v_and_b32 v185, 0xffff0000, v167
v_mul_f32 v184, v184, v22
v_mfma_f32_16x16x32_bf16 v[96:99], a[160:163], v[240:243], v[96:99]
v_mul_f32 v185, v185, v22
v_lshlrev_b32 v186, 16, v168
v_and_b32 v187, 0xffff0000, v168
v_mfma_f32_16x16x32_bf16 v[100:103], a[160:163], v[244:247], v[100:103]
ds_write_b128 v20, v[88:91] offset:8192
v_mul_f32 v186, v186, v22
v_mfma_f32_16x16x32_bf16 v[104:107], a[160:163], v[248:251], v[104:107]
v_mul_f32 v187, v187, v22
v_lshlrev_b32 v188, 16, v169
v_mfma_f32_16x16x32_bf16 v[108:111], a[160:163], v[252:255], v[108:111]
v_and_b32 v189, 0xffff0000, v169
v_mul_f32 v188, v188, v22
v_mul_f32 v189, v189, v22
s_nop 7
ds_write_b128 v21, v[92:95] offset:13312
ds_write_b128 v19, v[100:103] offset:4096
ds_write_b128 v20, v[104:107] offset:9216
ds_write_b128 v21, v[108:111] offset:14336
s_waitcnt lgkmcnt(0)
s_barrier
ds_read_b128 v[36:39], v10 offset:0
ds_read_b128 v[40:43], v10 offset:5120
ds_read_b128 v[44:47], v10 offset:10240
ds_read_b64_tr_b16 v[192:193], v16 offset:0
ds_read_b128 v[52:55], v10 offset:1024
ds_read_b128 v[56:59], v10 offset:6144
ds_read_b128 v[60:63], v10 offset:11264
ds_read_b64_tr_b16 v[194:195], v16 offset:2048
ds_read_b128 v[68:71], v10 offset:2048
ds_read_b128 v[72:75], v10 offset:7168
ds_read_b128 v[76:79], v10 offset:12288
ds_read_b64_tr_b16 v[196:197], v16 offset:4096
ds_read_b128 v[84:87], v10 offset:3072
ds_read_b128 v[88:91], v10 offset:8192
ds_read_b128 v[92:95], v10 offset:13312
ds_read_b64_tr_b16 v[198:199], v16 offset:6144
ds_read_b128 v[100:103], v10 offset:4096
ds_read_b128 v[104:107], v10 offset:9216
ds_read_b128 v[108:111], v10 offset:14336
ds_read_b64_tr_b16 v[200:201], v16 offset:8192
s_waitcnt vmcnt(0)
v_lshlrev_b32 v128, 16, v138
v_and_b32 v129, 0xffff0000, v138
v_lshlrev_b32 v130, 16, v139
v_and_b32 v131, 0xffff0000, v139
v_lshlrev_b32 v132, 16, v140
v_and_b32 v133, 0xffff0000, v140
v_lshlrev_b32 v134, 16, v141
v_and_b32 v135, 0xffff0000, v141
v_lshlrev_b32 v136, 16, v142
v_and_b32 v137, 0xffff0000, v142
v_lshlrev_b32 v138, 16, v143
v_and_b32 v139, 0xffff0000, v143
v_lshlrev_b32 v140, 16, v144
v_and_b32 v141, 0xffff0000, v144
v_lshlrev_b32 v142, 16, v145
v_and_b32 v143, 0xffff0000, v145
v_lshlrev_b32 v144, 16, v146
v_and_b32 v145, 0xffff0000, v146
v_lshlrev_b32 v146, 16, v147
v_and_b32 v147, 0xffff0000, v147
v_pk_add_f32 v[32:33], v[32:33], v[128:129]
v_pk_add_f32 v[34:35], v[34:35], v[130:131]
s_waitcnt lgkmcnt(15)
v_lshlrev_b32 v232, 16, v192
v_and_b32 v233, 0xffff0000, v192
v_pk_add_f32 v[32:33], v[32:33], v[36:37]
v_pk_add_f32 v[40:41], v[40:41], v[44:45]
v_pk_mul_f32 v[170:171], v[170:171], v[232:233]
v_pk_add_f32 v[32:33], v[32:33], v[40:41]
v_pk_fma_f32 v[32:33], v[32:33], v[24:25], v[170:171]
v_lshlrev_b32 v234, 16, v193
v_and_b32 v235, 0xffff0000, v193
v_pk_add_f32 v[34:35], v[34:35], v[38:39]
v_pk_add_f32 v[42:43], v[42:43], v[46:47]
v_pk_mul_f32 v[172:173], v[172:173], v[234:235]
v_pk_add_f32 v[34:35], v[34:35], v[42:43]
v_pk_fma_f32 v[34:35], v[34:35], v[24:25], v[172:173]
v_cvt_pk_bf16_f32 v236, v32, v33
v_cvt_pk_bf16_f32 v237, v34, v35
v_pk_add_f32 v[48:49], v[48:49], v[132:133]
v_pk_add_f32 v[50:51], v[50:51], v[134:135]
s_waitcnt lgkmcnt(12)
v_lshlrev_b32 v232, 16, v194
v_and_b32 v233, 0xffff0000, v194
v_pk_add_f32 v[48:49], v[48:49], v[52:53]
v_pk_add_f32 v[56:57], v[56:57], v[60:61]
v_pk_mul_f32 v[174:175], v[174:175], v[232:233]
v_pk_add_f32 v[48:49], v[48:49], v[56:57]
v_pk_fma_f32 v[48:49], v[48:49], v[24:25], v[174:175]
v_lshlrev_b32 v234, 16, v195
v_and_b32 v235, 0xffff0000, v195
v_pk_add_f32 v[50:51], v[50:51], v[54:55]
v_pk_add_f32 v[58:59], v[58:59], v[62:63]
v_pk_mul_f32 v[176:177], v[176:177], v[234:235]
v_pk_add_f32 v[50:51], v[50:51], v[58:59]
v_pk_fma_f32 v[50:51], v[50:51], v[24:25], v[176:177]
v_cvt_pk_bf16_f32 v238, v48, v49
v_cvt_pk_bf16_f32 v239, v50, v51
s_nop 0
v_permlane16_swap_b32 v236, v238
v_permlane16_swap_b32 v237, v239
buffer_store_dwordx4 v[236:239], v12, s[24:27], 0 offen offset:0
v_pk_add_f32 v[64:65], v[64:65], v[136:137]
v_pk_add_f32 v[66:67], v[66:67], v[138:139]
s_waitcnt lgkmcnt(8)
v_lshlrev_b32 v232, 16, v196
v_and_b32 v233, 0xffff0000, v196
v_pk_add_f32 v[64:65], v[64:65], v[68:69]
v_pk_add_f32 v[72:73], v[72:73], v[76:77]
v_pk_mul_f32 v[178:179], v[178:179], v[232:233]
v_pk_add_f32 v[64:65], v[64:65], v[72:73]
v_pk_fma_f32 v[64:65], v[64:65], v[24:25], v[178:179]
v_lshlrev_b32 v234, 16, v197
v_and_b32 v235, 0xffff0000, v197
v_pk_add_f32 v[66:67], v[66:67], v[70:71]
v_pk_add_f32 v[74:75], v[74:75], v[78:79]
v_pk_mul_f32 v[180:181], v[180:181], v[234:235]
v_pk_add_f32 v[66:67], v[66:67], v[74:75]
v_pk_fma_f32 v[66:67], v[66:67], v[24:25], v[180:181]
v_cvt_pk_bf16_f32 v240, v64, v65
v_cvt_pk_bf16_f32 v241, v66, v67
v_pk_add_f32 v[80:81], v[80:81], v[140:141]
v_pk_add_f32 v[82:83], v[82:83], v[142:143]
s_waitcnt lgkmcnt(4)
v_lshlrev_b32 v232, 16, v198
v_and_b32 v233, 0xffff0000, v198
v_pk_add_f32 v[80:81], v[80:81], v[84:85]
v_pk_add_f32 v[88:89], v[88:89], v[92:93]
v_pk_mul_f32 v[182:183], v[182:183], v[232:233]
v_pk_add_f32 v[80:81], v[80:81], v[88:89]
v_pk_fma_f32 v[80:81], v[80:81], v[24:25], v[182:183]
v_lshlrev_b32 v234, 16, v199
v_and_b32 v235, 0xffff0000, v199
v_pk_add_f32 v[82:83], v[82:83], v[86:87]
v_pk_add_f32 v[90:91], v[90:91], v[94:95]
v_pk_mul_f32 v[184:185], v[184:185], v[234:235]
v_pk_add_f32 v[82:83], v[82:83], v[90:91]
v_pk_fma_f32 v[82:83], v[82:83], v[24:25], v[184:185]
v_cvt_pk_bf16_f32 v242, v80, v81
v_cvt_pk_bf16_f32 v243, v82, v83
s_nop 0
v_permlane16_swap_b32 v240, v242
v_permlane16_swap_b32 v241, v243
buffer_store_dwordx4 v[240:243], v12, s[24:27], 0 offen offset:64
v_pk_add_f32 v[96:97], v[96:97], v[144:145]
v_pk_add_f32 v[98:99], v[98:99], v[146:147]
s_waitcnt lgkmcnt(0)
v_lshlrev_b32 v232, 16, v200
v_and_b32 v233, 0xffff0000, v200
v_pk_add_f32 v[96:97], v[96:97], v[100:101]
v_pk_add_f32 v[104:105], v[104:105], v[108:109]
v_pk_mul_f32 v[186:187], v[186:187], v[232:233]
v_pk_add_f32 v[96:97], v[96:97], v[104:105]
v_pk_fma_f32 v[96:97], v[96:97], v[24:25], v[186:187]
v_lshlrev_b32 v234, 16, v201
v_and_b32 v235, 0xffff0000, v201
v_pk_add_f32 v[98:99], v[98:99], v[102:103]
v_pk_add_f32 v[106:107], v[106:107], v[110:111]
v_pk_mul_f32 v[188:189], v[188:189], v[234:235]
v_pk_add_f32 v[98:99], v[98:99], v[106:107]
v_pk_fma_f32 v[98:99], v[98:99], v[24:25], v[188:189]
v_cvt_pk_bf16_f32 v244, v96, v97
v_cvt_pk_bf16_f32 v245, v98, v99
buffer_store_dwordx2 v[244:245], v29, s[24:27], 0 offen offset:128
L_end_K:
s_endpgm
L_dc_K:
s_getpc_b64 s[50:51]
L_cp3:
s_sub_u32 s50, s50, L_cp3-(L_eb_K)
s_subb_u32 s51, s51, 0
v_lshl_add_u32 v26, v0, 6, s59
v_mov_b32 v27, s51
v_add_co_u32 v26, vcc, s50, v26
s_nop 1
v_addc_co_u32 v27, vcc, 0, v27, vcc
global_load_dword v30, v[26:27], off
s_lshl_b32 s52, s2, 2
s_add_u32 s52, s52, s3
s_mul_i32 s52, s52, 2304
v_and_b32 v26, 31, v0
v_lshlrev_b32 v26, 4, v26
v_lshrrev_b32 v27, 5, v0
v_mul_u32_u24 v27, 1152, v27
v_min_u32 v4, 112, v26
v_add_u32 v4, v4, v27
v_add_u32 v27, v26, v27
s_mov_b32 s7, 0
s_bfe_u32 s50, s61, 0x10001
s_bfe_u32 s51, s4, 0x10003
s_lshl_b32 s51, s51, 1
s_add_u32 s50, s50, s51
s_mul_i32 s85, s50, 9
s_and_b32 s50, s61, 1
s_mul_i32 s51, s50, 5
s_add_u32 s85, s85, s51
s_mul_i32 s91, s50, 2146435072
s_and_b32 s50, s4, 4
s_add_u32 s50, s50, s3
s_mul_i32 s84, s50, 589824
s_lshl_b32 s86, s50, 16
s_lshl_b32 s51, s85, 10
s_add_u32 s84, s84, s51
s_add_u32 s84, s84, 56623104
s_add_u32 s65, s98, 50331648
ds_read_b128 a[192:195], v3 offset:8192
ds_read_b128 a[196:199], v3 offset:9216
ds_read_b128 a[200:203], v3 offset:10240
ds_read_b128 a[204:207], v3 offset:11264
v_mfma_f32_16x16x32_bf16 a[136:139], a[144:147], v[104:107], a[136:139]
ds_read_b128 a[208:211], v3 offset:12288
v_exp_f32 v10, v80
v_mfma_f32_16x16x32_bf16 a[140:143], a[144:147], v[108:111], a[140:143]
ds_read_b128 a[212:215], v3 offset:13312
buffer_load_dwordx4 a[148:151], v27, s[16:19], s52 offen offset:0
v_mfma_f32_16x16x32_bf16 a[128:131], a[144:147], v[96:99], a[128:131]
v_exp_f32 v11, v81
v_mfma_f32_16x16x32_bf16 a[132:135], a[144:147], v[100:103], a[132:135]
ds_read_b128 a[216:219], v3 offset:14336
v_cvt_pk_bf16_f32 v120, v10, v11
s_waitcnt lgkmcnt(3)
v_mfma_f32_16x16x32_bf16 v[160:163], a[192:195], v[100:103], v[160:163]
ds_read_b128 a[220:223], v3 offset:15360
v_exp_f32 v12, v82
v_mfma_f32_16x16x32_bf16 v[128:131], a[192:195], v[96:99], v[128:131]
v_exp_f32 v13, v83
v_mfma_f32_16x16x32_bf16 v[224:227], a[192:195], v[108:111], v[224:227]
v_exp_f32 v14, v84
v_cvt_pk_bf16_f32 v121, v12, v13
v_mfma_f32_16x16x32_bf16 v[192:195], a[192:195], v[104:107], v[192:195]
buffer_load_dwordx4 a[152:155], v27, s[16:19], s52 offen offset:512
v_mfma_f32_16x16x32_bf16 v[196:199], a[196:199], v[104:107], v[196:199]
v_exp_f32 v15, v85
v_exp_f32 v16, v86
v_mfma_f32_16x16x32_bf16 v[228:231], a[196:199], v[108:111], v[228:231]
v_exp_f32 v17, v87
v_cvt_pk_bf16_f32 v122, v14, v15
v_mfma_f32_16x16x32_bf16 v[132:135], a[196:199], v[96:99], v[132:135]
v_exp_f32 v18, v88
v_mfma_f32_16x16x32_bf16 v[164:167], a[196:199], v[100:103], v[164:167]
buffer_load_dwordx4 a[156:159], v4, s[16:19], s52 offen offset:1024
v_cvt_pk_bf16_f32 v123, v16, v17
v_mfma_f32_16x16x32_bf16 v[168:171], a[200:203], v[100:103], v[168:171]
v_exp_f32 v19, v89
v_mfma_f32_16x16x32_bf16 v[136:139], a[200:203], v[96:99], v[136:139]
v_exp_f32 v20, v90
v_cvt_pk_bf16_f32 v124, v18, v19
v_mfma_f32_16x16x32_bf16 v[232:235], a[200:203], v[108:111], v[232:235]
v_exp_f32 v21, v91
v_mfma_f32_16x16x32_bf16 v[200:203], a[200:203], v[104:107], v[200:203]
v_exp_f32 v10, v92
v_exp_f32 v11, v93
v_mfma_f32_16x16x32_bf16 v[204:207], a[204:207], v[104:107], v[204:207]
v_exp_f32 v12, v94
v_cvt_pk_bf16_f32 v125, v20, v21
v_mfma_f32_16x16x32_bf16 v[236:239], a[204:207], v[108:111], v[236:239]
v_exp_f32 v13, v95
v_mfma_f32_16x16x32_bf16 v[140:143], a[204:207], v[96:99], v[140:143]
v_exp_f32 v14, v64
v_cvt_pk_bf16_f32 v126, v10, v11
v_mfma_f32_16x16x32_bf16 v[172:175], a[204:207], v[100:103], v[172:175]
v_cvt_pk_bf16_f32 v127, v12, v13
s_waitcnt lgkmcnt(0)
v_mfma_f32_16x16x32_bf16 v[176:179], a[208:211], v[100:103], v[176:179]
v_exp_f32 v15, v65
v_mfma_f32_16x16x32_bf16 v[144:147], a[208:211], v[96:99], v[144:147]
buffer_load_dwordx4 a[112:115], v26, s[20:23], 0 offen offset:0
v_exp_f32 v16, v66
v_mfma_f32_16x16x32_bf16 v[240:243], a[208:211], v[108:111], v[240:243]
v_exp_f32 v17, v67
v_cvt_pk_bf16_f32 v112, v14, v15
v_mfma_f32_16x16x32_bf16 v[208:211], a[208:211], v[104:107], v[208:211]
v_exp_f32 v18, v68
v_cvt_pk_bf16_f32 v113, v16, v17
v_mfma_f32_16x16x32_bf16 v[212:215], a[212:215], v[104:107], v[212:215]
v_exp_f32 v19, v69
v_mfma_f32_16x16x32_bf16 v[244:247], a[212:215], v[108:111], v[244:247]
v_exp_f32 v20, v70
v_cvt_pk_bf16_f32 v114, v18, v19
v_mfma_f32_16x16x32_bf16 v[148:151], a[212:215], v[96:99], v[148:151]
v_exp_f32 v21, v71
v_mfma_f32_16x16x32_bf16 v[180:183], a[212:215], v[100:103], v[180:183]
buffer_load_dwordx4 a[116:119], v26, s[20:23], 0 offen offset:512
v_exp_f32 v10, v72
v_mfma_f32_16x16x32_bf16 v[184:187], a[216:219], v[100:103], v[184:187]
v_exp_f32 v11, v73
v_mfma_f32_16x16x32_bf16 v[152:155], a[216:219], v[96:99], v[152:155]
v_exp_f32 v12, v74
v_cvt_pk_bf16_f32 v115, v20, v21
v_mfma_f32_16x16x32_bf16 v[248:251], a[216:219], v[108:111], v[248:251]
v_exp_f32 v13, v75
v_cvt_pk_bf16_f32 v116, v10, v11
v_mfma_f32_16x16x32_bf16 v[216:219], a[216:219], v[104:107], v[216:219]
v_exp_f32 v14, v76
v_mfma_f32_16x16x32_bf16 v[220:223], a[220:223], v[104:107], v[220:223]
v_exp_f32 v15, v77
v_cvt_pk_bf16_f32 v117, v12, v13
v_mfma_f32_16x16x32_bf16 v[252:255], a[220:223], v[108:111], v[252:255]
v_exp_f32 v16, v78
v_cvt_pk_bf16_f32 v118, v14, v15
v_mfma_f32_16x16x32_bf16 v[156:159], a[220:223], v[96:99], v[156:159]
buffer_load_dwordx4 a[120:123], v26, s[20:23], 0 offen offset:1024
v_exp_f32 v17, v79
v_mfma_f32_16x16x32_bf16 v[188:191], a[220:223], v[100:103], v[188:191]
v_cvt_pk_bf16_f32 v119, v16, v17
s_waitcnt vmcnt(7)
s_barrier
v_add_u32 v29, s91, v28
ds_read_b128 a[192:195], v3 offset:0
ds_read_b128 a[196:199], v3 offset:1024
ds_read_b128 a[200:203], v3 offset:2048
ds_read_b128 a[204:207], v3 offset:3072
v_mfma_f32_16x16x32_bf16 a[136:139], a[144:147], v[120:123], a[136:139]
ds_read_b128 a[208:211], v3 offset:4096
s_add_u32 s58, s84, 147456
v_mfma_f32_16x16x32_bf16 a[140:143], a[144:147], v[124:127], a[140:143]
buffer_load_dwordx4 a[64:67], v1, s[28:31], s58 offen offset:0 sc1
v_mfma_f32_16x16x32_bf16 a[128:131], a[144:147], v[112:115], a[128:131]
ds_read_b128 a[212:215], v3 offset:5120
s_lshr_b32 s50, s4, 4
v_mfma_f32_16x16x32_bf16 a[132:135], a[144:147], v[116:119], a[132:135]
ds_read_b128 a[216:219], v3 offset:6144
s_waitcnt lgkmcnt(3)
v_mfma_f32_16x16x32_bf16 v[160:163], a[192:195], v[116:119], v[160:163]
ds_read_b128 a[220:223], v3 offset:7168
s_lshl_b32 s50, s50, 2
v_mfma_f32_16x16x32_bf16 v[128:131], a[192:195], v[112:115], v[128:131]
s_and_b32 s51, s4, 3
s_add_u32 s50, s50, s51
v_mfma_f32_16x16x32_bf16 v[224:227], a[192:195], v[124:127], v[224:227]
buffer_load_dwordx4 a[68:71], v1, s[28:31], s58 offen offset:1024 sc1
v_mfma_f32_16x16x32_bf16 v[192:195], a[192:195], v[120:123], v[192:195]
s_lshl_b32 s50, s50, 1
s_lshr_b32 s51, s61, 2
v_mfma_f32_16x16x32_bf16 v[196:199], a[196:199], v[120:123], v[196:199]
buffer_load_dwordx4 a[72:75], v1, s[28:31], s58 offen offset:2048 sc1
v_mfma_f32_16x16x32_bf16 v[228:231], a[196:199], v[124:127], v[228:231]
s_add_u32 s50, s50, s51
v_mfma_f32_16x16x32_bf16 v[132:135], a[196:199], v[112:115], v[132:135]
s_lshl_b32 s50, s50, 1
v_mfma_f32_16x16x32_bf16 v[164:167], a[196:199], v[116:119], v[164:167]
s_bfe_u32 s51, s4, 0x10002
v_mfma_f32_16x16x32_bf16 v[168:171], a[200:203], v[116:119], v[168:171]
s_add_u32 s89, s50, s51
v_mfma_f32_16x16x32_bf16 v[136:139], a[200:203], v[112:115], v[136:139]
buffer_load_dwordx4 a[76:79], v1, s[28:31], s58 offen offset:3072 sc1
v_mfma_f32_16x16x32_bf16 v[232:235], a[200:203], v[124:127], v[232:235]
s_add_u32 s86, s86, 33554432
v_mfma_f32_16x16x32_bf16 v[200:203], a[200:203], v[120:123], v[200:203]
s_lshl_b32 s50, s89, 19
v_mfma_f32_16x16x32_bf16 v[204:207], a[204:207], v[120:123], v[204:207]
s_add_u32 s87, s86, s50
v_mfma_f32_16x16x32_bf16 v[236:239], a[204:207], v[124:127], v[236:239]
buffer_load_dwordx4 a[80:83], v29, s[28:31], s58 offen offset:0 sc1
v_mfma_f32_16x16x32_bf16 v[140:143], a[204:207], v[112:115], v[140:143]
s_waitcnt lgkmcnt(0)
s_xor_b32 s86, s87, 524288
v_mfma_f32_16x16x32_bf16 v[172:175], a[204:207], v[116:119], v[172:175]
s_add_u32 s58, s84, 184320
s_lshl_b32 s88, s5, 5
v_mfma_f32_16x16x32_bf16 v[176:179], a[208:211], v[116:119], v[176:179]
s_add_u32 s88, s88, s4
v_mfma_f32_16x16x32_bf16 v[144:147], a[208:211], v[112:115], v[144:147]
buffer_load_dwordx4 a[84:87], v1, s[28:31], s58 offen offset:0 sc1
v_mfma_f32_16x16x32_bf16 v[240:243], a[208:211], v[124:127], v[240:243]
s_lshl_b32 s88, s88, 9
v_mfma_f32_16x16x32_bf16 v[208:211], a[208:211], v[120:123], v[208:211]
s_xor_b32 s50, s2, 1
v_mfma_f32_16x16x32_bf16 v[212:215], a[212:215], v[120:123], v[212:215]
s_lshl_b32 s50, s50, 2
v_mfma_f32_16x16x32_bf16 v[244:247], a[212:215], v[124:127], v[244:247]
v_mfma_f32_16x16x32_bf16 v[148:151], a[212:215], v[112:115], v[148:151]
s_add_u32 s50, s50, s3
v_mfma_f32_16x16x32_bf16 v[180:183], a[212:215], v[116:119], v[180:183]
buffer_load_dwordx4 a[88:91], v1, s[28:31], s58 offen offset:1024 sc1
v_mfma_f32_16x16x32_bf16 v[184:187], a[216:219], v[116:119], v[184:187]
s_mul_i32 s91, s50, 5120
v_mfma_f32_16x16x32_bf16 v[152:155], a[216:219], v[112:115], v[152:155]
s_add_u32 s91, s91, 62914560
v_mfma_f32_16x16x32_bf16 v[248:251], a[216:219], v[124:127], v[248:251]
s_xor_b32 s50, s50, 4
v_mfma_f32_16x16x32_bf16 v[216:219], a[216:219], v[120:123], v[216:219]
buffer_load_dwordx4 a[92:95], v1, s[28:31], s58 offen offset:2048 sc1
v_mfma_f32_16x16x32_bf16 v[220:223], a[220:223], v[120:123], v[220:223]
s_mul_i32 s90, s50, 5120
v_mfma_f32_16x16x32_bf16 v[252:255], a[220:223], v[124:127], v[252:255]
s_add_u32 s90, s90, 62914560
v_mfma_f32_16x16x32_bf16 v[156:159], a[220:223], v[112:115], v[156:159]
v_mfma_f32_16x16x32_bf16 v[188:191], a[220:223], v[116:119], v[188:191]
s_nop 7
v_accvgpr_read_b32 v10, a128
v_accvgpr_read_b32 v11, a132
v_rcp_f32 v12, v10
v_rcp_f32 v14, v11
v_max_f32 v16, v10, v11
v_min_f32 v17, v10, v11
v_cmp_u_f32 s[50:51], v10, v11
v_cmp_lt_f32 vcc, 0x5d800000, v16
s_or_b64 s[42:43], s[50:51], vcc
v_cmp_gt_f32 vcc, 0x21800000, v17
s_or_b64 s[42:43], s[42:43], vcc
v_mov_b32 v13, v12
v_mov_b32 v15, v14
s_add_u32 s52, s56, 0
v_pk_mul_f32 v[128:129], v[128:129], v[12:13]
v_pk_mul_f32 v[130:131], v[130:131], v[12:13]
v_pk_mul_f32 v[132:133], v[132:133], v[12:13]
v_pk_mul_f32 v[134:135], v[134:135], v[12:13]
v_cvt_pk_bf16_f32 v128, v128, v129
v_cvt_pk_bf16_f32 v129, v130, v131
v_cvt_pk_bf16_f32 v130, v132, v133
v_cvt_pk_bf16_f32 v131, v134, v135
buffer_store_dwordx4 v[128:131], v1, s[28:31], s52 offen offset:0 sc1
v_pk_mul_f32 v[160:161], v[160:161], v[14:15]
v_pk_mul_f32 v[162:163], v[162:163], v[14:15]
v_pk_mul_f32 v[164:165], v[164:165], v[14:15]
v_pk_mul_f32 v[166:167], v[166:167], v[14:15]
v_cvt_pk_bf16_f32 v160, v160, v161
v_cvt_pk_bf16_f32 v161, v162, v163
v_cvt_pk_bf16_f32 v162, v164, v165
v_cvt_pk_bf16_f32 v163, v166, v167
buffer_store_dwordx4 v[160:163], v1, s[28:31], s52 offen offset:1024 sc1
s_add_u32 s52, s56, 4096
v_pk_mul_f32 v[136:137], v[136:137], v[12:13]
v_pk_mul_f32 v[138:139], v[138:139], v[12:13]
v_pk_mul_f32 v[140:141], v[140:141], v[12:13]
v_pk_mul_f32 v[142:143], v[142:143], v[12:13]
v_cvt_pk_bf16_f32 v136, v136, v137
v_cvt_pk_bf16_f32 v137, v138, v139
v_cvt_pk_bf16_f32 v138, v140, v141
v_cvt_pk_bf16_f32 v139, v142, v143
buffer_store_dwordx4 v[136:139], v1, s[28:31], s52 offen offset:0 sc1
v_pk_mul_f32 v[168:169], v[168:169], v[14:15]
v_pk_mul_f32 v[170:171], v[170:171], v[14:15]
v_pk_mul_f32 v[172:173], v[172:173], v[14:15]
v_pk_mul_f32 v[174:175], v[174:175], v[14:15]
v_cvt_pk_bf16_f32 v168, v168, v169
v_cvt_pk_bf16_f32 v169, v170, v171
v_cvt_pk_bf16_f32 v170, v172, v173
v_cvt_pk_bf16_f32 v171, v174, v175
buffer_store_dwordx4 v[168:171], v1, s[28:31], s52 offen offset:1024 sc1
s_add_u32 s52, s56, 8192
v_pk_mul_f32 v[144:145], v[144:145], v[12:13]
v_pk_mul_f32 v[146:147], v[146:147], v[12:13]
v_pk_mul_f32 v[148:149], v[148:149], v[12:13]
v_pk_mul_f32 v[150:151], v[150:151], v[12:13]
v_cvt_pk_bf16_f32 v144, v144, v145
v_cvt_pk_bf16_f32 v145, v146, v147
v_cvt_pk_bf16_f32 v146, v148, v149
v_cvt_pk_bf16_f32 v147, v150, v151
buffer_store_dwordx4 v[144:147], v1, s[28:31], s52 offen offset:0 sc1
v_pk_mul_f32 v[176:177], v[176:177], v[14:15]
v_pk_mul_f32 v[178:179], v[178:179], v[14:15]
v_pk_mul_f32 v[180:181], v[180:181], v[14:15]
v_pk_mul_f32 v[182:183], v[182:183], v[14:15]
v_cvt_pk_bf16_f32 v176, v176, v177
v_cvt_pk_bf16_f32 v177, v178, v179
v_cvt_pk_bf16_f32 v178, v180, v181
v_cvt_pk_bf16_f32 v179, v182, v183
buffer_store_dwordx4 v[176:179], v1, s[28:31], s52 offen offset:1024 sc1
s_add_u32 s52, s56, 12288
v_pk_mul_f32 v[152:153], v[152:153], v[12:13]
v_pk_mul_f32 v[154:155], v[154:155], v[12:13]
v_pk_mul_f32 v[156:157], v[156:157], v[12:13]
v_pk_mul_f32 v[158:159], v[158:159], v[12:13]
v_cvt_pk_bf16_f32 v152, v152, v153
v_cvt_pk_bf16_f32 v153, v154, v155
v_cvt_pk_bf16_f32 v154, v156, v157
v_cvt_pk_bf16_f32 v155, v158, v159
buffer_store_dwordx4 v[152:155], v1, s[28:31], s52 offen offset:0 sc1
v_pk_mul_f32 v[184:185], v[184:185], v[14:15]
v_pk_mul_f32 v[186:187], v[186:187], v[14:15]
v_pk_mul_f32 v[188:189], v[188:189], v[14:15]
v_pk_mul_f32 v[190:191], v[190:191], v[14:15]
v_cvt_pk_bf16_f32 v184, v184, v185
v_cvt_pk_bf16_f32 v185, v186, v187
v_cvt_pk_bf16_f32 v186, v188, v189
v_cvt_pk_bf16_f32 v187, v190, v191
buffer_store_dwordx4 v[184:187], v1, s[28:31], s52 offen offset:1024 sc1
s_branch L_eb_K
L_p1sw_KK:
s_cmp_eq_u32 s42, 3
s_cbranch_scc1 L_p1s3_KK
s_cmp_lt_u32 s42, 6
s_cbranch_scc1 L_p1sj_KK
s_cmp_eq_u32 s42, 7
s_cbranch_scc1 L_p1s7_KK
s_mov_b32 s8, s16
s_mov_b32 s12, s20
s_mov_b32 s9, s17
s_mov_b32 s13, s21
s_mov_b32 s10, s18
s_mov_b32 s14, s22
v_mov_b32 v6, v24
v_mov_b32 v7, v25
v_mov_b32 v8, v26
v_mov_b32 v9, v27
s_mov_b32 s36, s46
s_mov_b32 s37, s47
s_lshl_b32 s38, s3, 18
s_add_u32 s38, s38, s48
s_add_u32 s39, s38, 131072
s_mov_b32 s45, 1048576
s_branch L_p1bk_KK
L_p1sj_KK:
s_lshl_b32 s50, s4, 3
v_mov_b32 v14, 1
buffer_atomic_add v14, v15, s[32:35], s50 offen sc1
s_branch L_p1bk_KK
L_p1s3_KK:
s_mov_b32 s94, 0
s_sub_u32 s7, s47, 36608
s_cmp_lg_u32 s3, 1
s_cbranch_scc1 L_p1bk_KK
s_mov_b32 s88, s96
s_mov_b32 s89, s97
s_mov_b32 s86, 4294953472
s_branch L_p1bk_KK
L_p1s7_KK:
s_lshl_b32 s50, s3, 13
s_and_b32 s51, s3, 1
s_lshl_b32 s51, s51, 14
s_sub_u32 s50, s50, s51
s_add_u32 s43, s43, s50
s_lshr_b32 s51, s3, 1
s_lshl_b32 s51, s51, 14
s_sub_u32 s44, s44, s51
s_branch L_p1bk_KK
L_p1sw_KV:
s_cmp_eq_u32 s42, 3
s_cbranch_scc1 L_p1s3_KV
s_cmp_lt_u32 s42, 6
s_cbranch_scc1 L_p1sj_KV
s_cmp_eq_u32 s42, 7
s_cbranch_scc1 L_p1s7_KV
s_mov_b32 s8, s16
s_mov_b32 s12, s20
s_mov_b32 s9, s17
s_mov_b32 s13, s21
s_mov_b32 s10, s18
s_mov_b32 s14, s22
v_mov_b32 v6, v24
v_mov_b32 v7, v25
v_mov_b32 v8, v26
v_mov_b32 v9, v27
s_mov_b32 s36, s46
s_mov_b32 s37, s47
s_lshl_b32 s38, s3, 18
s_add_u32 s38, s38, s48
s_add_u32 s39, s38, 131072
s_mov_b32 s45, 1048576
s_branch L_p1bk_KV
L_p1sj_KV:
s_lshl_b32 s50, s4, 3
v_mov_b32 v14, 1
buffer_atomic_add v14, v15, s[32:35], s50 offen sc1
s_branch L_p1bk_KV
L_p1s3_KV:
s_mov_b32 s94, 0
s_sub_u32 s7, s47, 36608
s_cmp_lg_u32 s3, 1
s_cbranch_scc1 L_p1bk_KV
s_mov_b32 s88, s96
s_mov_b32 s89, s97
s_mov_b32 s86, 4294953472
s_branch L_p1bk_KV
L_p1s7_KV:
s_lshl_b32 s50, s3, 13
s_and_b32 s51, s3, 1
s_lshl_b32 s51, s51, 14
s_sub_u32 s50, s50, s51
s_add_u32 s43, s43, s50
s_lshr_b32 s51, s3, 1
s_lshl_b32 s51, s51, 14
s_sub_u32 s44, s44, s51
s_branch L_p1bk_KV
L_spj_K:
s_mov_b32 s51, 0
L_spj_K_l:
buffer_load_dword v30, v125, s[32:35], 0 offen sc1
s_waitcnt vmcnt(0)
v_cmp_gt_u32 vcc, 8, v30
s_cbranch_vccz L_spjb_K
s_sleep 2
s_add_u32 s51, s51, 1
s_cmp_lt_u32 s51, 131072
s_cbranch_scc1 L_spj_K_l
s_branch L_spjb_K
L_mix_K:
s_add_u32 s51, s51, 1
s_cmp_lt_u32 s51, 24
s_cbranch_scc1 L_sp0_K
s_cmp_lg_u32 s51, 24
s_cbranch_scc1 L_mix2_K
buffer_wbl2 sc1
s_waitcnt vmcnt(0)
v_mov_b32 v49, 1
buffer_store_dword v49, v15, s[28:31], s99 offen offset:2048 sc1
L_mix2_K:
buffer_load_dword v49, v48, s[28:31], s50 offen offset:2048 sc1
s_waitcnt vmcnt(0)
v_cmp_eq_u32 vcc, 0, v49
s_cbranch_vccz L_mix3_K
s_sleep 2
s_cmp_lt_u32 s51, 131072
s_cbranch_scc1 L_sp0_K
L_mix3_K:
buffer_inv sc1
s_waitcnt vmcnt(0)
s_branch L_mixr_K
L_sp2_K:
s_mov_b32 s51, 0
L_sp2_K_l:
buffer_load_dwordx4 v[22:25], v1, s[28:31], s64 offen sc1
s_waitcnt vmcnt(0)
v_min_u32 v22, v22, v23
v_min3_u32 v22, v22, v24, v25
v_cmp_eq_u32 vcc, 0, v22
s_cbranch_vccz L_evr_K
s_sleep 2
s_add_u32 s51, s51, 1
s_cmp_lt_u32 s51, 131072
s_cbranch_scc1 L_sp2_K_l
s_branch L_evr_K
L_nc_K:
v_pk_mul_f32 v[192:193], v[192:193], v[24:25]
v_pk_mul_f32 v[194:195], v[194:195], v[24:25]
v_pk_mul_f32 v[196:197], v[196:197], v[24:25]
v_pk_mul_f32 v[198:199], v[198:199], v[24:25]
v_cvt_pk_bf16_f32 v192, v192, v193
v_cvt_pk_bf16_f32 v193, v194, v195
v_cvt_pk_bf16_f32 v194, v196, v197
v_cvt_pk_bf16_f32 v195, v198, v199
buffer_store_dwordx4 v[192:195], v1, s[28:31], s57 offen offset:0 sc1
v_pk_mul_f32 v[224:225], v[224:225], v[22:23]
v_pk_mul_f32 v[226:227], v[226:227], v[22:23]
v_pk_mul_f32 v[228:229], v[228:229], v[22:23]
v_pk_mul_f32 v[230:231], v[230:231], v[22:23]
v_cvt_pk_bf16_f32 v224, v224, v225
v_cvt_pk_bf16_f32 v225, v226, v227
v_cvt_pk_bf16_f32 v226, v228, v229
v_cvt_pk_bf16_f32 v227, v230, v231
buffer_store_dwordx4 v[224:227], v1, s[28:31], s57 offen offset:1024 sc1
v_pk_mul_f32 v[200:201], v[200:201], v[24:25]
v_pk_mul_f32 v[202:203], v[202:203], v[24:25]
v_pk_mul_f32 v[204:205], v[204:205], v[24:25]
v_pk_mul_f32 v[206:207], v[206:207], v[24:25]
v_cvt_pk_bf16_f32 v200, v200, v201
v_cvt_pk_bf16_f32 v201, v202, v203
v_cvt_pk_bf16_f32 v202, v204, v205
v_cvt_pk_bf16_f32 v203, v206, v207
s_add_u32 s57, s57, 4096
buffer_store_dwordx4 v[200:203], v1, s[28:31], s57 offen offset:0 sc1
v_pk_mul_f32 v[232:233], v[232:233], v[22:23]
v_pk_mul_f32 v[234:235], v[234:235], v[22:23]
v_pk_mul_f32 v[236:237], v[236:237], v[22:23]
v_pk_mul_f32 v[238:239], v[238:239], v[22:23]
v_cvt_pk_bf16_f32 v232, v232, v233
v_cvt_pk_bf16_f32 v233, v234, v235
v_cvt_pk_bf16_f32 v234, v236, v237
v_cvt_pk_bf16_f32 v235, v238, v239
buffer_store_dwordx4 v[232:235], v1, s[28:31], s57 offen offset:1024 sc1
v_pk_mul_f32 v[208:209], v[208:209], v[24:25]
v_pk_mul_f32 v[210:211], v[210:211], v[24:25]
v_pk_mul_f32 v[212:213], v[212:213], v[24:25]
v_pk_mul_f32 v[214:215], v[214:215], v[24:25]
v_cvt_pk_bf16_f32 v208, v208, v209
v_cvt_pk_bf16_f32 v209, v210, v211
v_cvt_pk_bf16_f32 v210, v212, v213
v_cvt_pk_bf16_f32 v211, v214, v215
s_add_u32 s57, s57, 4096
buffer_store_dwordx4 v[208:211], v1, s[28:31], s57 offen offset:0 sc1
v_pk_mul_f32 v[240:241], v[240:241], v[22:23]
v_pk_mul_f32 v[242:243], v[242:243], v[22:23]
v_pk_mul_f32 v[244:245], v[244:245], v[22:23]
v_pk_mul_f32 v[246:247], v[246:247], v[22:23]
v_cvt_pk_bf16_f32 v240, v240, v241
v_cvt_pk_bf16_f32 v241, v242, v243
v_cvt_pk_bf16_f32 v242, v244, v245
v_cvt_pk_bf16_f32 v243, v246, v247
buffer_store_dwordx4 v[240:243], v1, s[28:31], s57 offen offset:1024 sc1
v_pk_mul_f32 v[216:217], v[216:217], v[24:25]
v_pk_mul_f32 v[218:219], v[218:219], v[24:25]
v_pk_mul_f32 v[220:221], v[220:221], v[24:25]
v_pk_mul_f32 v[222:223], v[222:223], v[24:25]
v_cvt_pk_bf16_f32 v216, v216, v217
v_cvt_pk_bf16_f32 v217, v218, v219
v_cvt_pk_bf16_f32 v218, v220, v221
v_cvt_pk_bf16_f32 v219, v222, v223
s_add_u32 s57, s57, 4096
buffer_store_dwordx4 v[216:219], v1, s[28:31], s57 offen offset:0 sc1
v_pk_mul_f32 v[248:249], v[248:249], v[22:23]
v_pk_mul_f32 v[250:251], v[250:251], v[22:23]
v_pk_mul_f32 v[252:253], v[252:253], v[22:23]
v_pk_mul_f32 v[254:255], v[254:255], v[22:23]
v_cvt_pk_bf16_f32 v248, v248, v249
v_cvt_pk_bf16_f32 v249, v250, v251
v_cvt_pk_bf16_f32 v250, v252, v253
v_cvt_pk_bf16_f32 v251, v254, v255
buffer_store_dwordx4 v[248:251], v1, s[28:31], s57 offen offset:1024 sc1
s_cmp_lg_u32 s5, 7
s_cbranch_scc1 L_nc2_K
buffer_load_dwordx4 a[96:99], v1, s[28:31], s58 offen offset:3072 sc1
buffer_load_dwordx4 a[100:103], v29, s[28:31], s58 offen offset:0 sc1
s_add_u32 s58, s84, 221184
buffer_load_dwordx4 a[224:227], v1, s[28:31], s58 offen offset:0 sc1
buffer_load_dwordx4 a[228:231], v1, s[28:31], s58 offen offset:1024 sc1
buffer_load_dwordx4 a[232:235], v1, s[28:31], s58 offen offset:2048 sc1
buffer_load_dwordx4 a[236:239], v1, s[28:31], s58 offen offset:3072 sc1
buffer_load_dwordx4 a[240:243], v29, s[28:31], s58 offen offset:0 sc1
s_add_u32 s58, s84, 0
buffer_load_dwordx4 v[128:131], v1, s[28:31], s58 offen offset:0 sc1
buffer_load_dwordx4 v[132:135], v1, s[28:31], s58 offen offset:1024 sc1
buffer_load_dwordx4 v[136:139], v1, s[28:31], s58 offen offset:2048 sc1
buffer_load_dwordx4 v[140:143], v1, s[28:31], s58 offen offset:3072 sc1
buffer_load_dwordx4 v[144:147], v29, s[28:31], s58 offen offset:0 sc1
s_waitcnt vmcnt(12)
s_barrier
buffer_store_dword v21, v26, s[28:31], s40 offen sc1
s_add_u32 s58, s84, 36864
buffer_load_dwordx4 v[148:151], v1, s[28:31], s58 offen offset:0 sc1
buffer_load_dwordx4 v[152:155], v1, s[28:31], s58 offen offset:1024 sc1
buffer_load_dwordx4 v[156:159], v1, s[28:31], s58 offen offset:2048 sc1
buffer_load_dwordx4 v[160:163], v1, s[28:31], s58 offen offset:3072 sc1
buffer_load_dwordx4 v[164:167], v29, s[28:31], s58 offen offset:0 sc1
L_nc2_K:
s_add_u32 s58, s84, 73728
buffer_load_dwordx4 v[168:171], v1, s[28:31], s58 offen offset:0 sc1
buffer_load_dwordx4 v[172:175], v1, s[28:31], s58 offen offset:1024 sc1
buffer_load_dwordx4 v[176:179], v1, s[28:31], s58 offen offset:2048 sc1
buffer_load_dwordx4 v[180:183], v1, s[28:31], s58 offen offset:3072 sc1
buffer_load_dwordx4 v[184:187], v29, s[28:31], s58 offen offset:0 sc1
s_add_u32 s58, s84, 258048
buffer_load_dwordx4 a[0:3], v1, s[28:31], s58 offen offset:0 sc1
buffer_load_dwordx4 a[4:7], v1, s[28:31], s58 offen offset:1024 sc1
buffer_load_dwordx4 a[8:11], v1, s[28:31], s58 offen offset:2048 sc1
buffer_load_dwordx4 a[12:15], v1, s[28:31], s58 offen offset:3072 sc1
buffer_load_dwordx4 a[16:19], v29, s[28:31], s58 offen offset:0 sc1
s_add_u32 s58, s84, 294912
buffer_load_dwordx4 a[20:23], v1, s[28:31], s58 offen offset:0 sc1
buffer_load_dwordx4 a[24:27], v1, s[28:31], s58 offen offset:1024 sc1
s_lshr_b32 s50, s89, 1
s_sub_u32 s51, 15, s50
s_min_u32 s50, s50, s51
s_lshl_b32 s50, s50, 14
s_and_b32 s51, s4, 4
s_lshl_b32 s51, s51, 11
s_add_u32 s50, s50, s51
s_add_u32 s41, s50, 69337088
s_add_u32 s42, s36, 131072
s_xor_b32 s43, s42, 2048
v_lshrrev_b32 v13, 2, v0
v_and_b32 v14, 0, v0
v_lshlrev_b32 v14, 7, v14
v_lshl_add_u32 v13, v13, 9, v14
s_add_u32 s52, s3, 0
s_and_b32 s52, s52, 3
s_lshl_b32 s52, s52, 10
v_add_u32 v6, s52, v1
s_add_u32 s52, s3, 1
s_and_b32 s52, s52, 3
s_lshl_b32 s52, s52, 10
v_add_u32 v7, s52, v1
s_add_u32 s52, s3, 2
s_and_b32 s52, s52, 3
s_lshl_b32 s52, s52, 10
v_add_u32 v8, s52, v1
s_add_u32 s52, s3, 3
s_and_b32 s52, s52, 3
s_lshl_b32 s52, s52, 10
v_add_u32 v9, s52, v1
s_waitcnt vmcnt(12)
s_barrier
buffer_store_dword v21, v26, s[28:31], s40 offen sc1
buffer_load_dwordx4 a[28:31], v1, s[28:31], s58 offen offset:2048 sc1
v_accvgpr_read_b32 v16, a148
v_accvgpr_read_b32 v17, a112
v_dot2_f32_bf16 v30, v16, v17, 0
v_accvgpr_read_b32 v16, a149
v_accvgpr_read_b32 v17, a113
v_dot2_f32_bf16 v30, v16, v17, v30
v_accvgpr_read_b32 v16, a150
v_accvgpr_read_b32 v17, a114
buffer_load_dwordx4 a[32:35], v1, s[28:31], s58 offen offset:3072 sc1
v_dot2_f32_bf16 v30, v16, v17, v30
v_accvgpr_read_b32 v16, a151
v_accvgpr_read_b32 v17, a115
v_dot2_f32_bf16 v30, v16, v17, v30
v_accvgpr_read_b32 v16, a152
v_accvgpr_read_b32 v17, a116
v_dot2_f32_bf16 v30, v16, v17, v30
v_accvgpr_read_b32 v16, a153
buffer_load_dwordx4 a[36:39], v29, s[28:31], s58 offen offset:0 sc1
v_accvgpr_read_b32 v17, a117
v_dot2_f32_bf16 v30, v16, v17, v30
v_accvgpr_read_b32 v16, a154
v_accvgpr_read_b32 v17, a118
v_dot2_f32_bf16 v30, v16, v17, v30
v_accvgpr_read_b32 v16, a155
v_accvgpr_read_b32 v17, a119
v_dot2_f32_bf16 v30, v16, v17, v30
s_add_u32 s58, s84, 331776
buffer_load_dwordx4 a[40:43], v1, s[28:31], s58 offen offset:0 sc1
v_accvgpr_read_b32 v16, a156
v_accvgpr_read_b32 v17, a120
v_dot2_f32_bf16 v30, v16, v17, v30
v_accvgpr_read_b32 v16, a157
v_accvgpr_read_b32 v17, a121
v_dot2_f32_bf16 v30, v16, v17, v30
v_accvgpr_read_b32 v16, a158
v_accvgpr_read_b32 v17, a122
buffer_load_dwordx4 a[44:47], v1, s[28:31], s58 offen offset:1024 sc1
v_dot2_f32_bf16 v30, v16, v17, v30
v_accvgpr_read_b32 v16, a159
v_accvgpr_read_b32 v17, a123
v_dot2_f32_bf16 v30, v16, v17, v30
s_lshl_b32 s50, s2, 5
s_lshl_b32 s51, s3, 3
s_add_u32 s50, s50, s51
v_mov_b32 v16, v30
buffer_load_dwordx4 a[48:51], v1, s[28:31], s58 offen offset:2048 sc1
s_nop 1
v_add_f32_dpp v16, v16, v16 quad_perm:[1,0,3,2] row_mask:0xf bank_mask:0xf
s_nop 1
v_add_f32_dpp v16, v16, v16 quad_perm:[2,3,0,1] row_mask:0xf bank_mask:0xf
s_nop 1
v_add_f32_dpp v16, v16, v16 row_half_mirror row_mask:0xf bank_mask:0xf
s_nop 1
v_add_f32_dpp v16, v16, v16 row_mirror row_mask:0xf bank_mask:0xf
buffer_load_dwordx4 a[52:55], v1, s[28:31], s58 offen offset:3072 sc1
v_mov_b32 v17, v16
s_add_u32 s50, s50, 61865984
s_nop 0
v_permlane16_swap_b32 v16, v17
v_add_f32 v16, v16, v17
v_mul_f32 v16, 0xbfb8aa3b, v16
v_exp_f32 v16, v16
v_lshrrev_b32 v17, 5, v0
buffer_load_dwordx4 a[56:59], v29, s[28:31], s58 offen offset:0 sc1
v_add_f32 v16, 1.0, v16
v_rcp_f32 v16, v16
v_lshlrev_b32 v17, 2, v17
buffer_store_dword v16, v17, s[28:31], s50 offen sc1
s_add_u32 s58, s84, 368640
buffer_load_dwordx4 a[124:127], v1, s[28:31], s58 offen offset:0 sc1
buffer_load_dwordx4 a[128:131], v1, s[28:31], s58 offen offset:1024 sc1
buffer_load_dwordx4 a[132:135], v1, s[28:31], s58 offen offset:2048 sc1
buffer_load_dwordx4 a[136:139], v1, s[28:31], s58 offen offset:3072 sc1
buffer_load_dwordx4 a[140:143], v29, s[28:31], s58 offen offset:0 sc1
s_add_u32 s58, s84, 405504
buffer_load_dwordx4 a[164:167], v1, s[28:31], s58 offen offset:0 sc1
buffer_load_dwordx4 a[168:171], v1, s[28:31], s58 offen offset:1024 sc1
buffer_load_dwordx4 a[172:175], v1, s[28:31], s58 offen offset:2048 sc1
buffer_load_dwordx4 a[176:179], v1, s[28:31], s58 offen offset:3072 sc1
buffer_load_dwordx4 a[180:183], v29, s[28:31], s58 offen offset:0 sc1
s_add_u32 s58, s84, 442368
buffer_load_dwordx4 a[184:187], v1, s[28:31], s58 offen offset:0 sc1
buffer_load_dwordx4 a[188:191], v1, s[28:31], s58 offen offset:1024 sc1
buffer_load_dwordx4 a[192:195], v1, s[28:31], s58 offen offset:2048 sc1
buffer_load_dwordx4 a[196:199], v1, s[28:31], s58 offen offset:3072 sc1
buffer_load_dwordx4 a[200:203], v29, s[28:31], s58 offen offset:0 sc1
s_add_u32 s58, s84, 479232
buffer_load_dwordx4 a[204:207], v1, s[28:31], s58 offen offset:0 sc1
buffer_load_dwordx4 a[208:211], v1, s[28:31], s58 offen offset:1024 sc1
buffer_load_dwordx4 a[212:215], v1, s[28:31], s58 offen offset:2048 sc1
buffer_load_dwordx4 a[216:219], v1, s[28:31], s58 offen offset:3072 sc1
buffer_load_dwordx4 a[220:223], v29, s[28:31], s58 offen offset:0 sc1
s_add_u32 s58, s84, 110592
buffer_load_dwordx4 a[244:247], v1, s[28:31], s58 offen offset:0 sc1
buffer_load_dwordx4 a[248:251], v1, s[28:31], s58 offen offset:1024 sc1
buffer_load_dwordx4 a[252:255], v1, s[28:31], s58 offen offset:2048 sc1
buffer_load_dword v15, v13, s[28:31], s41 offen sc1
buffer_load_dwordx4 a[60:63], v1, s[28:31], s58 offen offset:3072 sc1
buffer_load_dwordx4 v[188:191], v29, s[28:31], s58 offen offset:0 sc1
s_add_u32 s58, s84, 516096
buffer_load_dwordx4 a[104:107], v1, s[28:31], s58 offen offset:0 sc1
buffer_load_dwordx4 a[108:111], v1, s[28:31], s58 offen offset:1024 sc1
buffer_load_dwordx4 a[112:115], v1, s[28:31], s58 offen offset:2048 sc1
buffer_load_dwordx4 a[116:119], v1, s[28:31], s58 offen offset:3072 sc1
buffer_load_dwordx4 a[120:123], v29, s[28:31], s58 offen offset:0 sc1
s_add_u32 s58, s84, 552960
buffer_load_dwordx4 a[144:147], v1, s[28:31], s58 offen offset:0 sc1
buffer_load_dwordx4 a[148:151], v1, s[28:31], s58 offen offset:1024 sc1
buffer_load_dwordx4 a[152:155], v1, s[28:31], s58 offen offset:2048 sc1
buffer_load_dwordx4 a[156:159], v1, s[28:31], s58 offen offset:3072 sc1
buffer_load_dwordx4 a[160:163], v29, s[28:31], s58 offen offset:0 sc1
s_waitcnt vmcnt(12)
s_branch L_py2_K
L_py_K:
v_mfma_f32_16x16x32_bf16 v[124:127], v[32:35], v[92:95], v[124:127]
v_mfma_f32_16x16x32_bf16 v[124:127], v[36:39], v[88:91], v[124:127]
v_mfma_f32_16x16x32_bf16 v[124:127], v[40:43], v[84:87], v[124:127]
v_mfma_f32_16x16x32_bf16 v[124:127], v[44:47], v[80:83], v[124:127]
v_mfma_f32_16x16x32_bf16 v[124:127], v[48:51], v[76:79], v[124:127]
v_mfma_f32_16x16x32_bf16 v[124:127], v[52:55], v[72:75], v[124:127]
v_mfma_f32_16x16x32_bf16 v[124:127], v[56:59], v[68:71], v[124:127]
v_mfma_f32_16x16x32_bf16 v[124:127], v[60:63], v[64:67], v[124:127]
ds_read_b64 v[60:61], v11 offset:0
v_mfma_f32_16x16x32_bf16 v[120:123], v[56:59], v[64:67], v[120:123]
v_mfma_f32_16x16x32_bf16 v[120:123], v[52:55], v[68:71], v[120:123]
v_mfma_f32_16x16x32_bf16 v[120:123], v[48:51], v[72:75], v[120:123]
v_mfma_f32_16x16x32_bf16 v[120:123], v[44:47], v[76:79], v[120:123]
v_mfma_f32_16x16x32_bf16 v[120:123], v[40:43], v[80:83], v[120:123]
s_waitcnt lgkmcnt(0)
v_and_b32 v92, 0xffff0000, v61
v_mfma_f32_16x16x32_bf16 v[120:123], v[36:39], v[84:87], v[120:123]
v_lshlrev_b32 v93, 16, v61
v_and_b32 v94, 0xffff0000, v60
v_mfma_f32_16x16x32_bf16 v[120:123], v[32:35], v[88:91], v[120:123]
ds_read_b64 v[56:57], v11 offset:512
v_lshlrev_b32 v95, 16, v60
v_mfma_f32_16x16x32_bf16 v[116:119], v[32:35], v[84:87], v[116:119]
v_fma_f32 v92, v92, v27, v124
v_fma_f32 v93, v93, v27, v125
v_mfma_f32_16x16x32_bf16 v[116:119], v[36:39], v[80:83], v[116:119]
v_fma_f32 v94, v94, v27, v126
v_fma_f32 v95, v95, v27, v127
v_mfma_f32_16x16x32_bf16 v[116:119], v[40:43], v[76:79], v[116:119]
v_cvt_pk_bf16_f32 v62, v92, v93
v_cvt_pk_bf16_f32 v63, v94, v95
v_mfma_f32_16x16x32_bf16 v[116:119], v[44:47], v[72:75], v[116:119]
v_mfma_f32_16x16x32_bf16 v[116:119], v[48:51], v[68:71], v[116:119]
s_waitcnt lgkmcnt(0)
v_and_b32 v88, 0xffff0000, v57
v_mfma_f32_16x16x32_bf16 v[116:119], v[52:55], v[64:67], v[116:119]
ds_read_b64 v[52:53], v11 offset:1024
v_lshlrev_b32 v89, 16, v57
v_mfma_f32_16x16x32_bf16 v[112:115], v[48:51], v[64:67], v[112:115]
v_and_b32 v90, 0xffff0000, v56
v_lshlrev_b32 v91, 16, v56
v_mfma_f32_16x16x32_bf16 v[112:115], v[44:47], v[68:71], v[112:115]
v_fma_f32 v88, v88, v27, v120
v_fma_f32 v89, v89, v27, v121
v_mfma_f32_16x16x32_bf16 v[112:115], v[40:43], v[72:75], v[112:115]
v_fma_f32 v90, v90, v27, v122
v_fma_f32 v91, v91, v27, v123
v_mfma_f32_16x16x32_bf16 v[112:115], v[36:39], v[76:79], v[112:115]
v_cvt_pk_bf16_f32 v60, v88, v89
v_cvt_pk_bf16_f32 v61, v90, v91
v_mfma_f32_16x16x32_bf16 v[112:115], v[32:35], v[80:83], v[112:115]
ds_read_b64 v[48:49], v11 offset:1536
s_nop 0
v_mfma_f32_16x16x32_bf16 v[108:111], v[32:35], v[76:79], v[108:111]
v_permlane16_swap_b32 v60, v62
v_permlane16_swap_b32 v61, v63
v_mfma_f32_16x16x32_bf16 v[108:111], v[36:39], v[72:75], v[108:111]
s_waitcnt lgkmcnt(1)
v_and_b32 v84, 0xffff0000, v53
v_mfma_f32_16x16x32_bf16 v[108:111], v[40:43], v[68:71], v[108:111]
v_lshlrev_b32 v85, 16, v53
v_and_b32 v86, 0xffff0000, v52
v_mfma_f32_16x16x32_bf16 v[108:111], v[44:47], v[64:67], v[108:111]
ds_read_b64 v[44:45], v11 offset:2048
v_lshlrev_b32 v87, 16, v52
v_mfma_f32_16x16x32_bf16 v[104:107], v[40:43], v[64:67], v[104:107]
v_fma_f32 v84, v84, v27, v116
v_fma_f32 v85, v85, v27, v117
v_mfma_f32_16x16x32_bf16 v[104:107], v[36:39], v[68:71], v[104:107]
v_fma_f32 v86, v86, v27, v118
v_fma_f32 v87, v87, v27, v119
v_mfma_f32_16x16x32_bf16 v[104:107], v[32:35], v[72:75], v[104:107]
ds_read_b64 v[40:41], v11 offset:2560
v_cvt_pk_bf16_f32 v54, v84, v85
v_mfma_f32_16x16x32_bf16 v[100:103], v[32:35], v[68:71], v[100:103]
v_cvt_pk_bf16_f32 v55, v86, v87
v_mfma_f32_16x16x32_bf16 v[100:103], v[36:39], v[64:67], v[100:103]
ds_read_b64 v[36:37], v11 offset:3072
v_mfma_f32_16x16x32_bf16 v[96:99], v[32:35], v[64:67], v[96:99]
ds_read_b64 v[32:33], v11 offset:3584
buffer_store_dwordx4 v[60:63], v20, s[28:31], s37 offen offset:3072 sc1
s_waitcnt lgkmcnt(0)
v_and_b32 v80, 0xffff0000, v49
v_lshlrev_b32 v81, 16, v49
v_and_b32 v82, 0xffff0000, v48
v_lshlrev_b32 v83, 16, v48
v_fma_f32 v80, v80, v27, v112
v_fma_f32 v81, v81, v27, v113
v_fma_f32 v82, v82, v27, v114
v_fma_f32 v83, v83, v27, v115
v_cvt_pk_bf16_f32 v52, v80, v81
v_cvt_pk_bf16_f32 v53, v82, v83
s_nop 0
v_permlane16_swap_b32 v52, v54
v_permlane16_swap_b32 v53, v55
buffer_store_dwordx4 v[52:55], v20, s[28:31], s37 offen offset:2048 sc1
v_and_b32 v76, 0xffff0000, v45
v_lshlrev_b32 v77, 16, v45
v_and_b32 v78, 0xffff0000, v44
v_lshlrev_b32 v79, 16, v44
v_fma_f32 v76, v76, v27, v108
v_fma_f32 v77, v77, v27, v109
v_fma_f32 v78, v78, v27, v110
v_fma_f32 v79, v79, v27, v111
v_cvt_pk_bf16_f32 v46, v76, v77
v_cvt_pk_bf16_f32 v47, v78, v79
v_and_b32 v72, 0xffff0000, v41
v_lshlrev_b32 v73, 16, v41
v_and_b32 v74, 0xffff0000, v40
v_lshlrev_b32 v75, 16, v40
v_fma_f32 v72, v72, v27, v104
v_fma_f32 v73, v73, v27, v105
v_fma_f32 v74, v74, v27, v106
v_fma_f32 v75, v75, v27, v107
v_cvt_pk_bf16_f32 v44, v72, v73
v_cvt_pk_bf16_f32 v45, v74, v75
s_nop 0
v_permlane16_swap_b32 v44, v46
v_permlane16_swap_b32 v45, v47
buffer_store_dwordx4 v[44:47], v20, s[28:31], s37 offen offset:1024 sc1
v_and_b32 v68, 0xffff0000, v37
v_lshlrev_b32 v69, 16, v37
v_and_b32 v70, 0xffff0000, v36
v_lshlrev_b32 v71, 16, v36
v_fma_f32 v68, v68, v27, v100
v_fma_f32 v69, v69, v27, v101
v_fma_f32 v70, v70, v27, v102
v_fma_f32 v71, v71, v27, v103
v_cvt_pk_bf16_f32 v38, v68, v69
v_cvt_pk_bf16_f32 v39, v70, v71
v_and_b32 v64, 0xffff0000, v33
v_lshlrev_b32 v65, 16, v33
v_and_b32 v66, 0xffff0000, v32
v_lshlrev_b32 v67, 16, v32
v_fma_f32 v64, v64, v27, v96
v_fma_f32 v65, v65, v27, v97
v_fma_f32 v66, v66, v27, v98
v_fma_f32 v67, v67, v27, v99
v_cvt_pk_bf16_f32 v36, v64, v65
v_cvt_pk_bf16_f32 v37, v66, v67
s_nop 0
v_permlane16_swap_b32 v36, v38
v_permlane16_swap_b32 v37, v39
buffer_store_dwordx4 v[36:39], v20, s[28:31], s37 offen offset:0 sc1
L_py2_K:
s_cmp_lg_u32 s3, 0
s_cbranch_scc1 L_py3_K
v_cmp_eq_u32 vcc, 0, v15
s_cbranch_vccnz L_sp3_K
L_py3_K:
s_barrier
s_add_u32 s36, s86, 16384
buffer_load_dwordx4 v[192:195], v6, s[28:31], s36 offen sc1
buffer_load_dwordx4 v[196:199], v7, s[28:31], s36 offen sc1
buffer_load_dwordx4 v[200:203], v8, s[28:31], s36 offen sc1
buffer_load_dwordx4 v[204:207], v9, s[28:31], s36 offen sc1
s_add_u32 s36, s86, 20480
buffer_load_dwordx4 v[208:211], v6, s[28:31], s36 offen sc1
buffer_load_dwordx4 v[212:215], v7, s[28:31], s36 offen sc1
buffer_load_dwordx4 v[216:219], v8, s[28:31], s36 offen sc1
buffer_load_dwordx4 v[220:223], v9, s[28:31], s36 offen sc1
s_add_u32 s36, s86, 24576
buffer_load_dwordx4 v[224:227], v6, s[28:31], s36 offen sc1
buffer_load_dwordx4 v[228:231], v7, s[28:31], s36 offen sc1
buffer_load_dwordx4 v[232:235], v8, s[28:31], s36 offen sc1
buffer_load_dwordx4 v[236:239], v9, s[28:31], s36 offen sc1
s_add_u32 s36, s86, 0
buffer_load_dwordx4 v[240:243], v6, s[28:31], s36 offen sc1
buffer_load_dwordx4 v[244:247], v7, s[28:31], s36 offen sc1
buffer_load_dwordx4 v[248:251], v8, s[28:31], s36 offen sc1
buffer_load_dwordx4 v[252:255], v9, s[28:31], s36 offen sc1
s_branch L_p4_K
L_sp3_K:
s_mov_b32 s51, 0
L_sp3_K_l:
buffer_load_dword v15, v13, s[28:31], s41 offen sc1
s_waitcnt vmcnt(0)
v_cmp_eq_u32 vcc, 0, v15
s_cbranch_vccz L_py3_K
s_sleep 3
s_add_u32 s51, s51, 1
s_cmp_lt_u32 s51, 131072
s_cbranch_scc1 L_sp3_K_l
s_branch L_py3_K
L_sp4_K:
s_mov_b32 s51, 0
L_sp4_K_l:
buffer_load_dword v22, v1, s[28:31], s64 offen sc1
s_waitcnt vmcnt(0)
v_cmp_eq_u32 vcc, 0, v22
s_cbranch_vccz L_sp4b_K
s_sleep 2
s_add_u32 s51, s51, 1
s_cmp_lt_u32 s51, 131072
s_cbranch_scc1 L_sp4_K_l
s_branch L_sp4b_K
L_sp5_K:
s_mov_b32 s51, 0
L_sp5_K_l:
buffer_load_dword v11, off, s[28:31], s42 sc1
s_waitcnt vmcnt(0)
v_cmp_eq_u32 vcc, 0, v11
s_cbranch_vccz L_sp5b_K
s_sleep 2
s_add_u32 s51, s51, 1
s_cmp_lt_u32 s51, 131072
s_cbranch_scc1 L_sp5_K_l
s_branch L_sp5b_K
CODE_END:
L_fix_K:
s_cmp_eq_u64 s[42:43], 0
s_cbranch_scc1 L_fixb_K
s_lshl_b32 s46, s5, 2
s_add_u32 s46, s46, s3
s_mov_b32 s48, 1
L_slow_K:
s_mov_b32 s26, 1048576
s_waitcnt vmcnt(0)
v_mov_b32 v128, 0
v_mov_b32 v129, 0
v_mov_b32 v130, 0
v_mov_b32 v131, 0
v_mov_b32 v132, 0
v_mov_b32 v133, 0
v_mov_b32 v134, 0
v_mov_b32 v135, 0
v_mov_b32 v136, 0
v_mov_b32 v137, 0
v_mov_b32 v138, 0
v_mov_b32 v139, 0
v_mov_b32 v140, 0
v_mov_b32 v141, 0
v_mov_b32 v142, 0
v_mov_b32 v143, 0
v_mov_b32 v144, 0
v_mov_b32 v145, 0
v_mov_b32 v146, 0
v_mov_b32 v147, 0
v_mov_b32 v148, 0
v_mov_b32 v149, 0
v_mov_b32 v150, 0
v_mov_b32 v151, 0
v_mov_b32 v152, 0
v_mov_b32 v153, 0
v_mov_b32 v154, 0
v_mov_b32 v155, 0
v_mov_b32 v156, 0
v_mov_b32 v157, 0
v_mov_b32 v158, 0
v_mov_b32 v159, 0
v_mov_b32 v160, 0
v_mov_b32 v161, 0
v_mov_b32 v162, 0
v_mov_b32 v163, 0
v_mov_b32 v164, 0
v_mov_b32 v165, 0
v_mov_b32 v166, 0
v_mov_b32 v167, 0
v_mov_b32 v168, 0
v_mov_b32 v169, 0
v_mov_b32 v170, 0
v_mov_b32 v171, 0
v_mov_b32 v172, 0
v_mov_b32 v173, 0
v_mov_b32 v174, 0
v_mov_b32 v175, 0
v_mov_b32 v176, 0
v_mov_b32 v177, 0
v_mov_b32 v178, 0
v_mov_b32 v179, 0
v_mov_b32 v180, 0
v_mov_b32 v181, 0
v_mov_b32 v182, 0
v_mov_b32 v183, 0
v_mov_b32 v184, 0
v_mov_b32 v185, 0
v_mov_b32 v186, 0
v_mov_b32 v187, 0
v_mov_b32 v188, 0
v_mov_b32 v189, 0
v_mov_b32 v190, 0
v_mov_b32 v191, 0
v_accvgpr_write_b32 a128, 0
v_accvgpr_write_b32 a129, 0
v_accvgpr_write_b32 a130, 0
v_accvgpr_write_b32 a131, 0
v_accvgpr_write_b32 a132, 0
v_accvgpr_write_b32 a133, 0
v_accvgpr_write_b32 a134, 0
v_accvgpr_write_b32 a135, 0
v_mov_b32 v112, 0
v_mov_b32 v113, 0
v_mov_b32 v114, 0
v_mov_b32 v115, 0
v_mov_b32 v116, 0
v_mov_b32 v117, 0
v_mov_b32 v118, 0
v_mov_b32 v119, 0
v_mov_b32 v64, 0xff7fffff
v_mov_b32 v65, 0xff7fffff
s_mov_b32 s36, 0
L_slowloop_K:
s_lshr_b32 s47, s36, 1
s_lshl_b32 s47, s47, 15
s_and_b32 s50, s36, 1
s_lshl_b32 s50, s50, 13
s_add_u32 s47, s47, s50
s_add_u32 s51, s47, 16384
buffer_load_dwordx4 a[160:163], v1, s[24:27], s47 offen offset:0 sc1
buffer_load_dwordx4 a[164:167], v1, s[24:27], s47 offen offset:1024 sc1
buffer_load_dwordx4 a[168:171], v1, s[24:27], s47 offen offset:2048 sc1
buffer_load_dwordx4 a[172:175], v1, s[24:27], s47 offen offset:3072 sc1
buffer_load_dwordx4 a[176:179], v28, s[24:27], s47 offen offset:0 sc1
buffer_load_dwordx4 a[180:183], v28, s[24:27], s47 offen offset:1024 sc1
buffer_load_dwordx4 a[184:187], v28, s[24:27], s47 offen offset:2048 sc1
buffer_load_dwordx4 a[188:191], v28, s[24:27], s47 offen offset:3072 sc1
buffer_load_dwordx4 a[192:195], v1, s[24:27], s51 offen offset:0 sc1
buffer_load_dwordx4 a[196:199], v1, s[24:27], s51 offen offset:1024 sc1
buffer_load_dwordx4 a[200:203], v1, s[24:27], s51 offen offset:2048 sc1
buffer_load_dwordx4 a[204:207], v1, s[24:27], s51 offen offset:3072 sc1
buffer_load_dwordx4 a[208:211], v28, s[24:27], s51 offen offset:0 sc1
buffer_load_dwordx4 a[212:215], v28, s[24:27], s51 offen offset:1024 sc1
buffer_load_dwordx4 a[216:219], v28, s[24:27], s51 offen offset:2048 sc1
buffer_load_dwordx4 a[220:223], v28, s[24:27], s51 offen offset:3072 sc1
s_cmp_lg_u32 s36, s46
s_cbranch_scc1 L_slownd_K
v_mov_b32 v112, v6
v_mov_b32 v116, 0xff800000
v_mov_b32 v113, v7
v_mov_b32 v117, 0xff800000
v_mov_b32 v114, v8
v_mov_b32 v118, 0xff800000
v_mov_b32 v115, v9
v_mov_b32 v119, 0xff800000
L_slownd_K:
s_waitcnt vmcnt(0)
s_nop 1
v_mfma_f32_16x16x32_bf16 v[32:35], a[160:163], a[0:3], v[112:115]
v_mfma_f32_16x16x32_bf16 v[32:35], a[164:167], a[4:7], v[32:35]
v_mfma_f32_16x16x32_bf16 v[32:35], a[168:171], a[8:11], v[32:35]
v_mfma_f32_16x16x32_bf16 v[32:35], a[172:175], a[12:15], v[32:35]
v_mfma_f32_16x16x32_bf16 v[36:39], a[176:179], a[0:3], v[116:119]
v_mfma_f32_16x16x32_bf16 v[36:39], a[180:183], a[4:7], v[36:39]
v_mfma_f32_16x16x32_bf16 v[36:39], a[184:187], a[8:11], v[36:39]
v_mfma_f32_16x16x32_bf16 v[36:39], a[188:191], a[12:15], v[36:39]
v_mfma_f32_16x16x32_bf16 v[40:43], a[160:163], a[16:19], 0
v_mfma_f32_16x16x32_bf16 v[40:43], a[164:167], a[20:23], v[40:43]
v_mfma_f32_16x16x32_bf16 v[40:43], a[168:171], a[24:27], v[40:43]
v_mfma_f32_16x16x32_bf16 v[40:43], a[172:175], a[28:31], v[40:43]
v_mfma_f32_16x16x32_bf16 v[44:47], a[176:179], a[16:19], v[112:115]
v_mfma_f32_16x16x32_bf16 v[44:47], a[180:183], a[20:23], v[44:47]
v_mfma_f32_16x16x32_bf16 v[44:47], a[184:187], a[24:27], v[44:47]
v_mfma_f32_16x16x32_bf16 v[44:47], a[188:191], a[28:31], v[44:47]
s_nop 7
v_max3_f32 v66, v32, v33, v64
v_max3_f32 v66, v34, v35, v66
v_max3_f32 v66, v36, v37, v66
v_max3_f32 v66, v38, v39, v66
v_mov_b32 v10, v66
s_nop 1
v_permlane16_swap_b32 v10, v66
v_max_f32 v66, v66, v10
v_mov_b32 v10, v66
s_nop 1
v_permlane32_swap_b32 v10, v66
v_max_f32 v66, v66, v10
v_sub_f32 v68, v64, v66
v_exp_f32 v68, v68
v_mov_b32 v64, v66
v_sub_f32 v32, v32, v66
v_exp_f32 v32, v32
v_sub_f32 v33, v33, v66
v_exp_f32 v33, v33
v_sub_f32 v34, v34, v66
v_exp_f32 v34, v34
v_sub_f32 v35, v35, v66
v_exp_f32 v35, v35
v_sub_f32 v36, v36, v66
v_exp_f32 v36, v36
v_sub_f32 v37, v37, v66
v_exp_f32 v37, v37
v_sub_f32 v38, v38, v66
v_exp_f32 v38, v38
v_sub_f32 v39, v39, v66
v_exp_f32 v39, v39
s_nop 0
v_cvt_pk_bf16_f32 v96, v32, v33
v_cvt_pk_bf16_f32 v97, v34, v35
v_cvt_pk_bf16_f32 v98, v36, v37
v_cvt_pk_bf16_f32 v99, v38, v39
v_mul_f32 v128, v68, v128
v_mul_f32 v129, v68, v129
v_mul_f32 v130, v68, v130
v_mul_f32 v131, v68, v131
v_mul_f32 v132, v68, v132
v_mul_f32 v133, v68, v133
v_mul_f32 v134, v68, v134
v_mul_f32 v135, v68, v135
v_mul_f32 v136, v68, v136
v_mul_f32 v137, v68, v137
v_mul_f32 v138, v68, v138
v_mul_f32 v139, v68, v139
v_mul_f32 v140, v68, v140
v_mul_f32 v141, v68, v141
v_mul_f32 v142, v68, v142
v_mul_f32 v143, v68, v143
v_mul_f32 v144, v68, v144
v_mul_f32 v145, v68, v145
v_mul_f32 v146, v68, v146
v_mul_f32 v147, v68, v147
v_mul_f32 v148, v68, v148
v_mul_f32 v149, v68, v149
v_mul_f32 v150, v68, v150
v_mul_f32 v151, v68, v151
v_mul_f32 v152, v68, v152
v_mul_f32 v153, v68, v153
v_mul_f32 v154, v68, v154
v_mul_f32 v155, v68, v155
v_mul_f32 v156, v68, v156
v_mul_f32 v157, v68, v157
v_mul_f32 v158, v68, v158
v_mul_f32 v159, v68, v159
v_accvgpr_read_b32 v10, a128
v_mul_f32 v10, v68, v10
v_accvgpr_write_b32 a128, v10
v_accvgpr_read_b32 v10, a129
v_mul_f32 v10, v68, v10
v_accvgpr_write_b32 a129, v10
v_accvgpr_read_b32 v10, a130
v_mul_f32 v10, v68, v10
v_accvgpr_write_b32 a130, v10
v_accvgpr_read_b32 v10, a131
v_mul_f32 v10, v68, v10
v_accvgpr_write_b32 a131, v10
v_max3_f32 v67, v40, v41, v65
v_max3_f32 v67, v42, v43, v67
v_max3_f32 v67, v44, v45, v67
v_max3_f32 v67, v46, v47, v67
v_mov_b32 v10, v67
s_nop 1
v_permlane16_swap_b32 v10, v67
v_max_f32 v67, v67, v10
v_mov_b32 v10, v67
s_nop 1
v_permlane32_swap_b32 v10, v67
v_max_f32 v67, v67, v10
v_sub_f32 v69, v65, v67
v_exp_f32 v69, v69
v_mov_b32 v65, v67
v_sub_f32 v40, v40, v67
v_exp_f32 v40, v40
v_sub_f32 v41, v41, v67
v_exp_f32 v41, v41
v_sub_f32 v42, v42, v67
v_exp_f32 v42, v42
v_sub_f32 v43, v43, v67
v_exp_f32 v43, v43
v_sub_f32 v44, v44, v67
v_exp_f32 v44, v44
v_sub_f32 v45, v45, v67
v_exp_f32 v45, v45
v_sub_f32 v46, v46, v67
v_exp_f32 v46, v46
v_sub_f32 v47, v47, v67
v_exp_f32 v47, v47
s_nop 0
v_cvt_pk_bf16_f32 v100, v40, v41
v_cvt_pk_bf16_f32 v101, v42, v43
v_cvt_pk_bf16_f32 v102, v44, v45
v_cvt_pk_bf16_f32 v103, v46, v47
v_mul_f32 v160, v69, v160
v_mul_f32 v161, v69, v161
v_mul_f32 v162, v69, v162
v_mul_f32 v163, v69, v163
v_mul_f32 v164, v69, v164
v_mul_f32 v165, v69, v165
v_mul_f32 v166, v69, v166
v_mul_f32 v167, v69, v167
v_mul_f32 v168, v69, v168
v_mul_f32 v169, v69, v169
v_mul_f32 v170, v69, v170
v_mul_f32 v171, v69, v171
v_mul_f32 v172, v69, v172
v_mul_f32 v173, v69, v173
v_mul_f32 v174, v69, v174
v_mul_f32 v175, v69, v175
v_mul_f32 v176, v69, v176
v_mul_f32 v177, v69, v177
v_mul_f32 v178, v69, v178
v_mul_f32 v179, v69, v179
v_mul_f32 v180, v69, v180
v_mul_f32 v181, v69, v181
v_mul_f32 v182, v69, v182
v_mul_f32 v183, v69, v183
v_mul_f32 v184, v69, v184
v_mul_f32 v185, v69, v185
v_mul_f32 v186, v69, v186
v_mul_f32 v187, v69, v187
v_mul_f32 v188, v69, v188
v_mul_f32 v189, v69, v189
v_mul_f32 v190, v69, v190
v_mul_f32 v191, v69, v191
v_accvgpr_read_b32 v10, a132
v_mul_f32 v10, v69, v10
v_accvgpr_write_b32 a132, v10
v_accvgpr_read_b32 v10, a133
v_mul_f32 v10, v69, v10
v_accvgpr_write_b32 a133, v10
v_accvgpr_read_b32 v10, a134
v_mul_f32 v10, v69, v10
v_accvgpr_write_b32 a134, v10
v_accvgpr_read_b32 v10, a135
v_mul_f32 v10, v69, v10
v_accvgpr_write_b32 a135, v10
s_nop 1
v_mfma_f32_16x16x32_bf16 a[128:131], a[144:147], v[96:99], a[128:131]
v_mfma_f32_16x16x32_bf16 a[132:135], a[144:147], v[100:103], a[132:135]
v_mfma_f32_16x16x32_bf16 v[128:131], a[192:195], v[96:99], v[128:131]
v_mfma_f32_16x16x32_bf16 v[160:163], a[192:195], v[100:103], v[160:163]
v_mfma_f32_16x16x32_bf16 v[132:135], a[196:199], v[96:99], v[132:135]
v_mfma_f32_16x16x32_bf16 v[164:167], a[196:199], v[100:103], v[164:167]
v_mfma_f32_16x16x32_bf16 v[136:139], a[200:203], v[96:99], v[136:139]
v_mfma_f32_16x16x32_bf16 v[168:171], a[200:203], v[100:103], v[168:171]
v_mfma_f32_16x16x32_bf16 v[140:143], a[204:207], v[96:99], v[140:143]
v_mfma_f32_16x16x32_bf16 v[172:175], a[204:207], v[100:103], v[172:175]
v_mfma_f32_16x16x32_bf16 v[144:147], a[208:211], v[96:99], v[144:147]
v_mfma_f32_16x16x32_bf16 v[176:179], a[208:211], v[100:103], v[176:179]
v_mfma_f32_16x16x32_bf16 v[148:151], a[212:215], v[96:99], v[148:151]
v_mfma_f32_16x16x32_bf16 v[180:183], a[212:215], v[100:103], v[180:183]
v_mfma_f32_16x16x32_bf16 v[152:155], a[216:219], v[96:99], v[152:155]
v_mfma_f32_16x16x32_bf16 v[184:187], a[216:219], v[100:103], v[184:187]
v_mfma_f32_16x16x32_bf16 v[156:159], a[220:223], v[96:99], v[156:159]
v_mfma_f32_16x16x32_bf16 v[188:191], a[220:223], v[100:103], v[188:191]
s_nop 7
s_add_u32 s36, s36, 1
s_cmp_le_u32 s36, s46
s_cbranch_scc1 L_slowloop_K
s_cmp_eq_u32 s48, 0
s_cbranch_scc1 L_fixe_K
s_nop 7
v_accvgpr_read_b32 v10, a128
v_accvgpr_read_b32 v11, a132
v_rcp_f32 v12, v10
v_rcp_f32 v14, v11
v_mov_b32 v13, v12
v_mov_b32 v15, v14
s_add_u32 s52, s56, 0
v_pk_mul_f32 v[128:129], v[128:129], v[12:13]
v_pk_mul_f32 v[130:131], v[130:131], v[12:13]
v_pk_mul_f32 v[132:133], v[132:133], v[12:13]
v_pk_mul_f32 v[134:135], v[134:135], v[12:13]
v_cvt_pk_bf16_f32 v128, v128, v129
v_cvt_pk_bf16_f32 v129, v130, v131
v_cvt_pk_bf16_f32 v130, v132, v133
v_cvt_pk_bf16_f32 v131, v134, v135
buffer_store_dwordx4 v[128:131], v1, s[28:31], s52 offen offset:0 sc1
v_pk_mul_f32 v[160:161], v[160:161], v[14:15]
v_pk_mul_f32 v[162:163], v[162:163], v[14:15]
v_pk_mul_f32 v[164:165], v[164:165], v[14:15]
v_pk_mul_f32 v[166:167], v[166:167], v[14:15]
v_cvt_pk_bf16_f32 v160, v160, v161
v_cvt_pk_bf16_f32 v161, v162, v163
v_cvt_pk_bf16_f32 v162, v164, v165
v_cvt_pk_bf16_f32 v163, v166, v167
buffer_store_dwordx4 v[160:163], v1, s[28:31], s52 offen offset:1024 sc1
s_add_u32 s52, s56, 4096
v_pk_mul_f32 v[136:137], v[136:137], v[12:13]
v_pk_mul_f32 v[138:139], v[138:139], v[12:13]
v_pk_mul_f32 v[140:141], v[140:141], v[12:13]
v_pk_mul_f32 v[142:143], v[142:143], v[12:13]
v_cvt_pk_bf16_f32 v136, v136, v137
v_cvt_pk_bf16_f32 v137, v138, v139
v_cvt_pk_bf16_f32 v138, v140, v141
v_cvt_pk_bf16_f32 v139, v142, v143
buffer_store_dwordx4 v[136:139], v1, s[28:31], s52 offen offset:0 sc1
v_pk_mul_f32 v[168:169], v[168:169], v[14:15]
v_pk_mul_f32 v[170:171], v[170:171], v[14:15]
v_pk_mul_f32 v[172:173], v[172:173], v[14:15]
v_pk_mul_f32 v[174:175], v[174:175], v[14:15]
v_cvt_pk_bf16_f32 v168, v168, v169
v_cvt_pk_bf16_f32 v169, v170, v171
v_cvt_pk_bf16_f32 v170, v172, v173
v_cvt_pk_bf16_f32 v171, v174, v175
buffer_store_dwordx4 v[168:171], v1, s[28:31], s52 offen offset:1024 sc1
s_add_u32 s52, s56, 8192
v_pk_mul_f32 v[144:145], v[144:145], v[12:13]
v_pk_mul_f32 v[146:147], v[146:147], v[12:13]
v_pk_mul_f32 v[148:149], v[148:149], v[12:13]
v_pk_mul_f32 v[150:151], v[150:151], v[12:13]
v_cvt_pk_bf16_f32 v144, v144, v145
v_cvt_pk_bf16_f32 v145, v146, v147
v_cvt_pk_bf16_f32 v146, v148, v149
v_cvt_pk_bf16_f32 v147, v150, v151
buffer_store_dwordx4 v[144:147], v1, s[28:31], s52 offen offset:0 sc1
v_pk_mul_f32 v[176:177], v[176:177], v[14:15]
v_pk_mul_f32 v[178:179], v[178:179], v[14:15]
v_pk_mul_f32 v[180:181], v[180:181], v[14:15]
v_pk_mul_f32 v[182:183], v[182:183], v[14:15]
v_cvt_pk_bf16_f32 v176, v176, v177
v_cvt_pk_bf16_f32 v177, v178, v179
v_cvt_pk_bf16_f32 v178, v180, v181
v_cvt_pk_bf16_f32 v179, v182, v183
buffer_store_dwordx4 v[176:179], v1, s[28:31], s52 offen offset:1024 sc1
s_add_u32 s52, s56, 12288
v_pk_mul_f32 v[152:153], v[152:153], v[12:13]
v_pk_mul_f32 v[154:155], v[154:155], v[12:13]
v_pk_mul_f32 v[156:157], v[156:157], v[12:13]
v_pk_mul_f32 v[158:159], v[158:159], v[12:13]
v_cvt_pk_bf16_f32 v152, v152, v153
v_cvt_pk_bf16_f32 v153, v154, v155
v_cvt_pk_bf16_f32 v154, v156, v157
v_cvt_pk_bf16_f32 v155, v158, v159
buffer_store_dwordx4 v[152:155], v1, s[28:31], s52 offen offset:0 sc1
v_pk_mul_f32 v[184:185], v[184:185], v[14:15]
v_pk_mul_f32 v[186:187], v[186:187], v[14:15]
v_pk_mul_f32 v[188:189], v[188:189], v[14:15]
v_pk_mul_f32 v[190:191], v[190:191], v[14:15]
v_cvt_pk_bf16_f32 v184, v184, v185
v_cvt_pk_bf16_f32 v185, v186, v187
v_cvt_pk_bf16_f32 v186, v188, v189
v_cvt_pk_bf16_f32 v187, v190, v191
buffer_store_dwordx4 v[184:187], v1, s[28:31], s52 offen offset:1024 sc1
L_fixb_K:
s_waitcnt vmcnt(0)
s_cmp_eq_u64 s[44:45], 0
s_cbranch_scc1 L_fixr_K
s_mov_b64 s[44:45], 0
v_accvgpr_mov_b32 a0, a32
v_accvgpr_mov_b32 a1, a33
v_accvgpr_mov_b32 a2, a34
v_accvgpr_mov_b32 a3, a35
v_accvgpr_mov_b32 a4, a36
v_accvgpr_mov_b32 a5, a37
v_accvgpr_mov_b32 a6, a38
v_accvgpr_mov_b32 a7, a39
v_accvgpr_mov_b32 a8, a40
v_accvgpr_mov_b32 a9, a41
v_accvgpr_mov_b32 a10, a42
v_accvgpr_mov_b32 a11, a43
v_accvgpr_mov_b32 a12, a44
v_accvgpr_mov_b32 a13, a45
v_accvgpr_mov_b32 a14, a46
v_accvgpr_mov_b32 a15, a47
v_accvgpr_mov_b32 a16, a48
v_accvgpr_mov_b32 a17, a49
v_accvgpr_mov_b32 a18, a50
v_accvgpr_mov_b32 a19, a51
v_accvgpr_mov_b32 a20, a52
v_accvgpr_mov_b32 a21, a53
v_accvgpr_mov_b32 a22, a54
v_accvgpr_mov_b32 a23, a55
v_accvgpr_mov_b32 a24, a56
v_accvgpr_mov_b32 a25, a57
v_accvgpr_mov_b32 a26, a58
v_accvgpr_mov_b32 a27, a59
v_accvgpr_mov_b32 a28, a60
v_accvgpr_mov_b32 a29, a61
v_accvgpr_mov_b32 a30, a62
v_accvgpr_mov_b32 a31, a63
s_sub_u32 s46, 15, s5
s_lshl_b32 s46, s46, 2
s_add_u32 s46, s46, s3
s_mov_b32 s48, 0
s_branch L_slow_K
L_fixe_K:
v_mov_b32 v192, v128
v_mov_b32 v193, v129
v_mov_b32 v194, v130
v_mov_b32 v195, v131
v_mov_b32 v196, v132
v_mov_b32 v197, v133
v_mov_b32 v198, v134
v_mov_b32 v199, v135
v_mov_b32 v200, v136
v_mov_b32 v201, v137
v_mov_b32 v202, v138
v_mov_b32 v203, v139
v_mov_b32 v204, v140
v_mov_b32 v205, v141
v_mov_b32 v206, v142
v_mov_b32 v207, v143
v_mov_b32 v208, v144
v_mov_b32 v209, v145
v_mov_b32 v210, v146
v_mov_b32 v211, v147
v_mov_b32 v212, v148
v_mov_b32 v213, v149
v_mov_b32 v214, v150
v_mov_b32 v215, v151
v_mov_b32 v216, v152
v_mov_b32 v217, v153
v_mov_b32 v218, v154
v_mov_b32 v219, v155
v_mov_b32 v220, v156
v_mov_b32 v221, v157
v_mov_b32 v222, v158
v_mov_b32 v223, v159
v_mov_b32 v224, v160
v_mov_b32 v225, v161
v_mov_b32 v226, v162
v_mov_b32 v227, v163
v_mov_b32 v228, v164
v_mov_b32 v229, v165
v_mov_b32 v230, v166
v_mov_b32 v231, v167
v_mov_b32 v232, v168
v_mov_b32 v233, v169
v_mov_b32 v234, v170
v_mov_b32 v235, v171
v_mov_b32 v236, v172
v_mov_b32 v237, v173
v_mov_b32 v238, v174
v_mov_b32 v239, v175
v_mov_b32 v240, v176
v_mov_b32 v241, v177
v_mov_b32 v242, v178
v_mov_b32 v243, v179
v_mov_b32 v244, v180
v_mov_b32 v245, v181
v_mov_b32 v246, v182
v_mov_b32 v247, v183
v_mov_b32 v248, v184
v_mov_b32 v249, v185
v_mov_b32 v250, v186
v_mov_b32 v251, v187
v_mov_b32 v252, v188
v_mov_b32 v253, v189
v_mov_b32 v254, v190
v_mov_b32 v255, v191
v_accvgpr_mov_b32 a136, a128
v_accvgpr_mov_b32 a137, a129
v_accvgpr_mov_b32 a138, a130
v_accvgpr_mov_b32 a139, a131
v_accvgpr_mov_b32 a140, a132
v_accvgpr_mov_b32 a141, a133
v_accvgpr_mov_b32 a142, a134
v_accvgpr_mov_b32 a143, a135
L_fixr_K:
s_cmp_eq_u32 s5, 7
s_cbranch_scc1 L_tail_K
s_add_u32 s58, s84, 0
buffer_load_dwordx4 v[128:131], v1, s[28:31], s58 offen offset:0 sc1
buffer_load_dwordx4 v[132:135], v1, s[28:31], s58 offen offset:1024 sc1
buffer_load_dwordx4 v[136:139], v1, s[28:31], s58 offen offset:2048 sc1
buffer_load_dwordx4 v[140:143], v1, s[28:31], s58 offen offset:3072 sc1
buffer_load_dwordx4 v[144:147], v29, s[28:31], s58 offen offset:0 sc1
s_add_u32 s58, s84, 36864
buffer_load_dwordx4 v[148:151], v1, s[28:31], s58 offen offset:0 sc1
buffer_load_dwordx4 v[152:155], v1, s[28:31], s58 offen offset:1024 sc1
buffer_load_dwordx4 v[156:159], v1, s[28:31], s58 offen offset:2048 sc1
buffer_load_dwordx4 v[160:163], v1, s[28:31], s58 offen offset:3072 sc1
buffer_load_dwordx4 v[164:167], v29, s[28:31], s58 offen offset:0 sc1
s_waitcnt vmcnt(0)
s_branch L_tail_K
.section .rodata,"a"
.p2align 6
.amdhsa_kernel gated_mix__ssm_conv_h3__compressed_kv_cla__prompt_kernel
  .amdhsa_next_free_vgpr 512
  .amdhsa_next_free_sgpr 102
  .amdhsa_accum_offset 256
  .amdhsa_group_segment_fixed_size 0
  .amdhsa_kernarg_size 128
  .amdhsa_user_sgpr_count 2
  .amdhsa_user_sgpr_kernarg_segment_ptr 1
  .amdhsa_system_sgpr_workgroup_id_x 1
  .amdhsa_float_denorm_mode_32 3
.end_amdhsa_kernel
```
